```python
import torch

def _softmax(x, axis=-1):
    return torch.softmax(x, dim=axis)

def _gelu(x):
    return torch.nn.functional.gelu(x, approximate='tanh')

def _silu(x):
    return torch.nn.functional.silu(x)

def _sigmoid(x):
    return torch.sigmoid(x)

def _layernorm(x, axis=-1, eps=1e-05):
    m = x.mean(dim=axis, keepdim=True)
    v = x.var(dim=axis, keepdim=True, unbiased=False)
    return (x - m) / torch.sqrt(v + eps)

def _scatter_add(tgt, idx, src, axis=0):
    return tgt.clone().index_add_(axis, idx, src)

def _segment_sum(src, seg, n):
    out = torch.zeros((n,) + src.shape[1:], dtype=src.dtype)
    return out.index_add_(0, seg, src)

def _pad(x, pw):
    flat = tuple((v for pair in reversed(pw) for v in pair))
    return torch.nn.functional.pad(x, flat)
kernel_name = 'adaLN_cond__memory_aug_recurrent_mem_tr__glu_gated_geglu__prompt'

def setup_inputs():

    _w = lambda a: (lambda t: t.to(torch.bfloat16) if t.is_floating_point() else t)(torch.as_tensor(a))

    def _A_setup():
        B, S, Dm = (1, 2048, 640)
        H, Dh = (32, 192)
        M, seg = (8, 32)
        seg = min(seg, S)
        S = S // seg * seg
        return {'x': _w((lambda *s: torch.randn(*s, dtype=torch.bfloat16) * 0.05)(B, S, Dm)), 'mem0': _w((lambda *s: torch.randn(*s, dtype=torch.bfloat16) * 0.8)(B, M, Dm)), 'Wq': _w((lambda *s: torch.randn(*s, dtype=torch.bfloat16) * 0.8)(Dm, H, Dh) * Dm ** (-0.5)), 'Wk': _w((lambda *s: torch.randn(*s, dtype=torch.bfloat16) * 0.8)(Dm, H, Dh) * Dm ** (-0.5)), 'Wv': _w((lambda *s: torch.randn(*s, dtype=torch.bfloat16) * 0.8)(Dm, H, Dh) * Dm ** (-0.5)), 'Wo': _w((lambda *s: torch.randn(*s, dtype=torch.bfloat16) * 0.8)(H, Dh, Dm) * (H * Dh) ** (-0.5)), 'seg_len': seg}
    _A_in = _A_setup()

    def _B_setup():
        B, S, Dm, Df = (1, 2048, 640, 1536)
        return {'x': _w((lambda *s: torch.randn(*s, dtype=torch.bfloat16) * 0.05)(B, S, Dm)), 'w_gate': _w((lambda *s: torch.randn(*s, dtype=torch.bfloat16) * 0.4)(Dm, Df) * Dm ** (-0.5)), 'w_up': _w((lambda *s: torch.randn(*s, dtype=torch.bfloat16) * 0.4)(Dm, Df) * Dm ** (-0.5)), 'w_down': _w((lambda *s: torch.randn(*s, dtype=torch.bfloat16) * 0.4)(Df, Dm) * Df ** (-0.5))}
    _B_in = _B_setup()
    return {'A_x': _A_in['x'], 'A_mem0': _A_in['mem0'], 'A_Wq': _A_in['Wq'], 'A_Wk': _A_in['Wk'], 'A_Wv': _A_in['Wv'], 'A_Wo': _A_in['Wo'], 'A_seg_len': _A_in['seg_len'], 'B_x': _B_in['x'], 'B_w_gate': _B_in['w_gate'], 'B_w_up': _B_in['w_up'], 'B_w_down': _B_in['w_down'], 'c': _w((lambda *s: torch.randn(*s, dtype=torch.bfloat16) * 0.2)(1, 640) * 8.0), 'w_mod': _w((lambda *s: torch.randn(*s, dtype=torch.bfloat16) * 0.2)(640, 6 * 640) * 640 ** (-0.5) * 8.0)}

def reference(A_x, A_mem0, A_Wq, A_Wk, A_Wv, A_Wo, A_seg_len, B_x, B_w_gate, B_w_up, B_w_down, c, w_mod):

    def _A_ref(x, mem0, Wq, Wk, Wv, Wo, seg_len):
        B, S, Dm = x.shape
        H, Dh = (Wq.shape[1], Wq.shape[2])
        M = mem0.shape[1]
        scale = Dh ** (-0.5)
        n_seg = S // seg_len
        L = M + seg_len
        idx = torch.arange(L)
        mask = (idx[:, None] < M) | (idx[:, None] >= idx[None, :])
        mem = mem0
        outs = []
        for s in range(n_seg):
            xs = x[:, s * seg_len:(s + 1) * seg_len, :].clone()
            h = torch.concatenate([mem, xs], axis=1)
            q = torch.einsum('btd,dhe->bhte', h, Wq)
            k = torch.einsum('btd,dhe->bhte', h, Wk)
            v = torch.einsum('btd,dhe->bhte', h, Wv)
            scores = torch.einsum('bhqe,bhke->bhqk', q, k) * scale
            scores = torch.where(mask[None, None], scores, -1000000000.0)
            p = _softmax(scores, axis=-1)
            o = torch.einsum('bhqk,bhke->bhqe', p, v)
            o = torch.einsum('bhte,hed->btd', o, Wo)
            mem = o[:, :M, :].clone()
            outs.append(o[:, M:, :])
        return torch.concatenate(outs, axis=1)

    def _B_ref(x, w_gate, w_up, w_down):
        g = torch.einsum('bsd,df->bsf', x, w_gate)
        u = torch.einsum('bsd,df->bsf', x, w_up)
        h = _gelu(g) * u
        return torch.einsum('bsf,fd->bsd', h, w_down)
    x = A_x
    mod = (_silu(c) @ w_mod).reshape(c.shape[0], 6, 1, -1)
    sa, ca, ga, sb, cb, gb = (mod[:, 0].clone(), mod[:, 1].clone(), mod[:, 2].clone(), mod[:, 3].clone(), mod[:, 4].clone(), mod[:, 5].clone())
    h = _layernorm(x, axis=-1) * (1 + ca) + sa
    x = x + ga * _A_ref(h, A_mem0, A_Wq, A_Wk, A_Wv, A_Wo, A_seg_len)
    h = _layernorm(x, axis=-1) * (1 + cb) + sb
    x = x + gb * _B_ref(h, B_w_gate, B_w_up, B_w_down)
    return x
```

```asm
; @launch kernel=kf_kernel grid=(256,1,1) block=(256,1,1) lds=131072
.amdgcn_target "amdgcn-amd-amdhsa--gfx950"
.text
.globl kf_kernel
.p2align 8
.type kf_kernel,@function
kf_kernel:
  s_getreg_b32 s3, hwreg(HW_REG_XCC_ID)
  s_and_b32 s3, s3, 7
  s_load_dwordx2 s[8:9], s[0:1], 120
  s_load_dwordx2 s[12:13], s[0:1], 112
  s_load_dwordx2 s[16:17], s[0:1], 16
  s_load_dwordx2 s[64:65], s[0:1], 24
  s_load_dwordx2 s[68:69], s[0:1], 32
  s_load_dwordx2 s[72:73], s[0:1], 40
  s_load_dwordx2 s[76:77], s[0:1], 8
  s_load_dwordx2 s[44:45], s[0:1], 0
  s_load_dwordx2 s[48:49], s[0:1], 88
  s_load_dwordx2 s[52:53], s[0:1], 96
  s_waitcnt lgkmcnt(0)
  s_and_b32 s9, s9, 0xffff
  s_mov_b32 s10, 268435456
  s_mov_b32 s11, 0x00020000
  s_and_b32 s13, s13, 0xffff
  s_mov_b32 s14, 256
  s_mov_b32 s15, 0x00020000
  s_and_b32 s17, s17, 0xffff
  s_mov_b32 s18, 7864320
  s_mov_b32 s19, 0x00020000
  s_and_b32 s65, s65, 0xffff
  s_mov_b32 s66, 7864320
  s_mov_b32 s67, 0x00020000
  s_and_b32 s69, s69, 0xffff
  s_mov_b32 s70, 7864320
  s_mov_b32 s71, 0x00020000
  s_and_b32 s73, s73, 0xffff
  s_mov_b32 s74, 7864320
  s_mov_b32 s75, 0x00020000
  s_and_b32 s77, s77, 0xffff
  s_mov_b32 s78, 10240
  s_mov_b32 s79, 0x00020000
  s_and_b32 s45, s45, 0xffff
  s_mov_b32 s46, 2621440
  s_mov_b32 s47, 0x00020000
  s_and_b32 s49, s49, 0xffff
  s_mov_b32 s50, 1280
  s_mov_b32 s51, 0x00020000
  s_and_b32 s53, s53, 0xffff
  s_mov_b32 s54, 4915200
  s_mov_b32 s55, 0x00020000
  v_lshrrev_b32 v1, 6, v0
  v_and_b32 v2, 63, v0
  v_readfirstlane_b32 s4, v1
  v_mov_b32 v3, 1
  s_lshl_b32 s21, s3, 2
  v_mov_b32 v4, s21
  v_cmp_eq_u32 vcc, 0, v0
  s_nop 0
  s_and_saveexec_b64 s[22:23], vcc
  s_cbranch_execz K3_noat
  buffer_atomic_add v3, v4, s[12:15], 0 offen sc0 sc1
  s_waitcnt vmcnt(0)
  v_mov_b32 v5, 0
  ds_write_b32 v5, v3
K3_noat:
  s_mov_b64 exec, s[22:23]
  s_waitcnt lgkmcnt(0)
  s_barrier
  v_mov_b32 v5, 0
  ds_read_b32 v3, v5
  s_waitcnt lgkmcnt(0)
  v_readfirstlane_b32 s5, v3
  s_barrier
  s_cmp_ge_u32 s5, 32
  s_cbranch_scc1 K3_end
  s_cmp_ge_u32 s3, 4
  s_cbranch_scc1 G_start
  s_lshr_b32 s6, s5, 2
  s_and_b32 s7, s5, 3
  s_lshl_b32 s20, s3, 3
  s_add_u32 s20, s20, s6
  v_lshrrev_b32 v3, 4, v2
  v_and_b32 v4, 15, v2
  v_and_b32 v5, 7, v2
  s_mul_i32 s21, s4, 18432
  s_mul_i32 s21, s4, 32768
  s_mul_i32 s25, s20, 384
  s_mul_i32 s26, s7, 96
  s_add_u32 s25, s25, s26
  s_mul_i32 s27, s4, 3
  s_lshl_b32 s28, s4, 1
  s_add_u32 s28, s28, 2
  s_cmp_lt_u32 s4, 2
  s_cselect_b32 s29, s27, s28
  s_mul_i32 s30, s20, 245760
  s_mul_i32 s31, s7, 320
  s_add_u32 s30, s30, s31
  s_lshl_b32 s31, s29, 5
  s_add_u32 s30, s30, s31
  v_lshrrev_b32 v6, 2, v4
  v_lshl_add_u32 v6, v3, 2, v6
  v_mul_u32_u24 v6, 32, v6
  v_and_b32 v7, 3, v4
  v_lshl_add_u32 v6, v7, 3, v6
  v_add_u32 v10, s21, v6
  v_lshrrev_b32 v6, 2, v4
  v_lshl_add_u32 v6, v3, 2, v6
  v_mul_u32_u24 v6, 96, v6
  v_and_b32 v7, 3, v4
  v_lshl_add_u32 v6, v7, 3, v6
  v_add_u32 v11, s21, v6
  v_add_u32 v7, 0, v2
  v_mul_u32_u24 v8, 10923, v7
  v_lshrrev_b32 v8, 16, v8
  v_mul_u32_u24 v9, 6, v8
  v_sub_u32 v9, v7, v9
  v_mul_u32_u24 v8, 12288, v8
  v_lshl_add_u32 v120, v9, 4, v8
  v_add_u32 v7, 64, v2
  v_mul_u32_u24 v8, 10923, v7
  v_lshrrev_b32 v8, 16, v8
  v_mul_u32_u24 v9, 6, v8
  v_sub_u32 v9, v7, v9
  v_mul_u32_u24 v8, 12288, v8
  v_lshl_add_u32 v121, v9, 4, v8
  v_add_u32 v7, 128, v2
  v_mul_u32_u24 v8, 10923, v7
  v_lshrrev_b32 v8, 16, v8
  v_mul_u32_u24 v9, 6, v8
  v_sub_u32 v9, v7, v9
  v_mul_u32_u24 v8, 12288, v8
  v_lshl_add_u32 v122, v9, 4, v8
  v_lshrrev_b32 v8, 1, v2
  v_and_b32 v9, 1, v2
  v_mul_u32_u24 v8, 12288, v8
  v_lshl_add_u32 v123, v9, 4, v8
  s_lshl_b32 s80, s3, 5
  s_add_u32 s80, s80, s5
  v_mov_b32 v102, -1
  v_mov_b32 v103, -1
  v_mov_b32 v104, -1
  v_mov_b32 v105, -1
  v_lshlrev_b32 v101, 4, v2
  s_mul_i32 s81, s5, 40
  v_add_u32 v100, s81, v2
  v_and_b32 v109, 7, v100
  v_lshrrev_b32 v110, 3, v100
  v_mul_u32_u24 v111, 1280, v109
  v_lshl_add_u32 v111, v110, 3, v111
  v_lshrrev_b32 v108, 3, v110
  v_and_b32 v112, 3, v110
  v_bfe_u32 v110, v110, 2, 1
  v_lshlrev_b32 v108, 9, v108
  v_lshl_add_u32 v108, v112, 7, v108
  v_lshl_add_u32 v108, v109, 4, v108
  v_lshl_add_u32 v108, v110, 3, v108
  s_mul_i32 s81, s3, 40960
  s_add_u32 s81, s81, 65536
  v_add_u32 v108, s81, v108
  v_mov_b32 v106, 0
  v_mov_b32 v107, 0
  s_cmp_eq_u32 s4, 0
  s_cbranch_scc0 KB_nm
  s_mov_b32 exec_lo, -1
  s_mov_b32 exec_hi, 0xff
  buffer_load_dwordx2 v[106:107], v111, s[76:79], 0 offen
  s_mov_b64 exec, -1
KB_nm:
  s_mul_i32 s81, s80, 5120
  s_mul_i32 s82, s4, 1280
  s_add_u32 s81, s81, s82
  s_add_u32 s81, s81, 1572864
  s_add_u32 s82, s81, 655360
  buffer_store_dwordx4 v[102:105], v101, s[8:11], s81 offen
  buffer_store_dwordx4 v[102:105], v101, s[8:11], s82 offen
  s_mov_b64 exec, 0xffff
  buffer_store_dwordx4 v[102:105], v101, s[8:11], s81 offen offset:1024
  buffer_store_dwordx4 v[102:105], v101, s[8:11], s82 offen offset:1024
  s_mul_i32 s83, s20, 12
  s_mul_i32 s84, s7, 3
  s_add_u32 s83, s83, s84
  s_lshl_b32 s81, s83, 10
  s_mul_i32 s82, s4, 768
  s_add_u32 s81, s81, s82
  s_add_u32 s81, s81, 234881024
  s_add_u32 s82, s81, 393216
  s_mov_b32 exec_lo, -1
  s_mov_b32 exec_hi, 0xffff
  buffer_store_dwordx4 v[102:105], v101, s[8:11], s81 offen
  buffer_store_dwordx4 v[102:105], v101, s[8:11], s82 offen
  s_cmp_eq_u32 s4, 1
  s_cbranch_scc1 KB_w1
  s_cmp_eq_u32 s4, 2
  s_cbranch_scc1 KB_w2
  s_cmp_eq_u32 s4, 3
  s_cbranch_scc1 KB_w3
  s_lshl_b32 s81, s83, 8
  s_add_u32 s81, s81, 1048576
  s_add_u32 s82, s81, 98304
  buffer_store_dwordx4 v[102:105], v101, s[8:11], s81 offen
  buffer_store_dwordx4 v[102:105], v101, s[8:11], s82 offen
  s_branch KB_wd
KB_w1:
  s_lshl_b32 s81, s83, 8
  s_add_u32 s81, s81, 236978176
  s_add_u32 s82, s81, 98304
  buffer_store_dwordx4 v[102:105], v101, s[8:11], s81 offen
  buffer_store_dwordx4 v[102:105], v101, s[8:11], s82 offen
  s_branch KB_wd
KB_w2:
  s_mul_i32 s81, s3, 40960
  s_mul_i32 s82, s5, 320
  s_add_u32 s81, s81, s82
  s_add_u32 s81, s81, 75776
  s_add_u32 s82, s81, 10240
  s_mov_b32 exec_lo, 0xfffff
  s_mov_b32 exec_hi, 0
  buffer_store_dwordx4 v[102:105], v101, s[8:11], s81 offen
  buffer_store_dwordx4 v[102:105], v101, s[8:11], s82 offen
  s_branch KB_wd
KB_w3:
  s_mul_i32 s83, s5, 43
  s_lshr_b32 s83, s83, 7
  s_mul_i32 s84, s83, 3
  s_sub_u32 s84, s5, s84
  s_mul_i32 s84, s84, 2560
  s_lshl_b32 s83, s83, 14
  s_add_u32 s81, s83, s84
  s_add_u32 s81, s81, 237371392
  s_mul_i32 s82, s3, 640
  s_add_u32 s81, s81, s82
  s_add_u32 s82, s81, 180224
  s_mov_b32 exec_lo, -1
  s_mov_b32 exec_hi, 0xff
  buffer_store_dwordx4 v[102:105], v101, s[8:11], s81 offen sc1
  buffer_store_dwordx4 v[102:105], v101, s[8:11], s82 offen sc1
  s_add_u32 s81, s81, 8192
  s_add_u32 s82, s82, 8192
  buffer_store_dwordx4 v[102:105], v101, s[8:11], s81 offen sc1
  buffer_store_dwordx4 v[102:105], v101, s[8:11], s82 offen sc1
KB_wd:
  s_mov_b64 exec, -1
  s_cmp_ge_u32 s80, 16
  s_cbranch_scc1 KB_zc
  s_lshl_b32 s81, s80, 12
  s_lshl_b32 s82, s4, 10
  s_add_u32 s81, s81, s82
  s_add_u32 s81, s81, 4587520
  v_mov_b32 v110, 0
  v_mov_b32 v111, 0
  v_mov_b32 v112, 0
  v_mov_b32 v113, 0
  buffer_store_dwordx4 v[110:113], v101, s[8:11], s81 offen sc1
KB_zc:
  s_cmp_eq_u32 s4, 3
  s_cbranch_scc1 K3_ldv
  s_lshl_b32 s26, s4, 5
  s_add_u32 s25, s25, s26
  s_add_u32 s24, s25, 0
  s_mov_b32 s22, s24
  s_add_u32 m0, s21, 0
  s_nop 0
  buffer_load_dwordx4 v123, s[16:19], s24 offen lds
  s_add_u32 s24, s24, 393216
  s_add_u32 m0, s21, 1024
  s_nop 0
  buffer_load_dwordx4 v123, s[16:19], s24 offen lds
  s_add_u32 s24, s24, 393216
  s_add_u32 m0, s21, 2048
  s_nop 0
  buffer_load_dwordx4 v123, s[16:19], s24 offen lds
  s_add_u32 s24, s24, 393216
  s_add_u32 m0, s21, 3072
  s_nop 0
  buffer_load_dwordx4 v123, s[16:19], s24 offen lds
  s_add_u32 s24, s24, 393216
  s_add_u32 m0, s21, 4096
  s_nop 0
  buffer_load_dwordx4 v123, s[16:19], s24 offen lds
  s_add_u32 m0, s21, 5120
  s_nop 0
  buffer_load_dwordx4 v123, s[64:67], s22 offen lds
  s_add_u32 s22, s22, 393216
  s_add_u32 m0, s21, 6144
  s_nop 0
  buffer_load_dwordx4 v123, s[64:67], s22 offen lds
  s_add_u32 s22, s22, 393216
  s_add_u32 m0, s21, 7168
  s_nop 0
  buffer_load_dwordx4 v123, s[64:67], s22 offen lds
  s_add_u32 s22, s22, 393216
  s_add_u32 m0, s21, 8192
  s_nop 0
  buffer_load_dwordx4 v123, s[64:67], s22 offen lds
  s_add_u32 s22, s22, 393216
  s_add_u32 m0, s21, 9216
  s_nop 0
  buffer_load_dwordx4 v123, s[64:67], s22 offen lds
  s_add_u32 s24, s25, 1966080
  s_mov_b32 s22, s24
  s_add_u32 m0, s21, 16384
  s_nop 0
  buffer_load_dwordx4 v123, s[16:19], s24 offen lds
  s_add_u32 s24, s24, 393216
  s_add_u32 m0, s21, 17408
  s_nop 0
  buffer_load_dwordx4 v123, s[16:19], s24 offen lds
  s_add_u32 s24, s24, 393216
  s_add_u32 m0, s21, 18432
  s_nop 0
  buffer_load_dwordx4 v123, s[16:19], s24 offen lds
  s_add_u32 s24, s24, 393216
  s_add_u32 m0, s21, 19456
  s_nop 0
  buffer_load_dwordx4 v123, s[16:19], s24 offen lds
  s_add_u32 s24, s24, 393216
  s_add_u32 m0, s21, 20480
  s_nop 0
  buffer_load_dwordx4 v123, s[16:19], s24 offen lds
  s_add_u32 m0, s21, 21504
  s_nop 0
  buffer_load_dwordx4 v123, s[64:67], s22 offen lds
  s_add_u32 s22, s22, 393216
  s_add_u32 m0, s21, 22528
  s_nop 0
  buffer_load_dwordx4 v123, s[64:67], s22 offen lds
  s_add_u32 s22, s22, 393216
  s_add_u32 m0, s21, 23552
  s_nop 0
  buffer_load_dwordx4 v123, s[64:67], s22 offen lds
  s_add_u32 s22, s22, 393216
  s_add_u32 m0, s21, 24576
  s_nop 0
  buffer_load_dwordx4 v123, s[64:67], s22 offen lds
  s_add_u32 s22, s22, 393216
  s_add_u32 m0, s21, 25600
  s_nop 0
  buffer_load_dwordx4 v123, s[64:67], s22 offen lds
  s_waitcnt vmcnt(10)
  s_cmp_eq_u32 s4, 0
  s_cbranch_scc0 KBpa
  s_mov_b32 exec_lo, -1
  s_mov_b32 exec_hi, 0xff
  buffer_store_dwordx2 v[106:107], v108, s[8:11], 0 offen
  s_mov_b64 exec, -1
KBpa:
  s_cmp_eq_u32 s4, 0
  s_cbranch_scc0 K3_rw0_0
  ds_read_b64_tr_b16 a[0:1], v10 offset:0
  ds_read_b64_tr_b16 a[2:3], v10 offset:512
  ds_read_b64_tr_b16 a[4:5], v10 offset:1024
  ds_read_b64_tr_b16 a[6:7], v10 offset:1536
  ds_read_b64_tr_b16 a[8:9], v10 offset:2048
  ds_read_b64_tr_b16 a[10:11], v10 offset:2560
  ds_read_b64_tr_b16 a[12:13], v10 offset:3072
  ds_read_b64_tr_b16 a[14:15], v10 offset:3584
  ds_read_b64_tr_b16 a[16:17], v10 offset:4096
  ds_read_b64_tr_b16 a[18:19], v10 offset:4608
  ds_read_b64_tr_b16 a[80:81], v10 offset:5120
  ds_read_b64_tr_b16 a[82:83], v10 offset:5632
  ds_read_b64_tr_b16 a[84:85], v10 offset:6144
  ds_read_b64_tr_b16 a[86:87], v10 offset:6656
  ds_read_b64_tr_b16 a[88:89], v10 offset:7168
  ds_read_b64_tr_b16 a[90:91], v10 offset:7680
  ds_read_b64_tr_b16 a[92:93], v10 offset:8192
  ds_read_b64_tr_b16 a[94:95], v10 offset:8704
  ds_read_b64_tr_b16 a[96:97], v10 offset:9216
  ds_read_b64_tr_b16 a[98:99], v10 offset:9728
K3_rw0_0:
  s_cmp_eq_u32 s4, 1
  s_cbranch_scc0 K3_rw0_1
  ds_read_b64_tr_b16 a[60:61], v10 offset:0
  ds_read_b64_tr_b16 a[62:63], v10 offset:512
  ds_read_b64_tr_b16 a[64:65], v10 offset:1024
  ds_read_b64_tr_b16 a[66:67], v10 offset:1536
  ds_read_b64_tr_b16 a[68:69], v10 offset:2048
  ds_read_b64_tr_b16 a[70:71], v10 offset:2560
  ds_read_b64_tr_b16 a[72:73], v10 offset:3072
  ds_read_b64_tr_b16 a[74:75], v10 offset:3584
  ds_read_b64_tr_b16 a[76:77], v10 offset:4096
  ds_read_b64_tr_b16 a[78:79], v10 offset:4608
  ds_read_b64_tr_b16 a[140:141], v10 offset:5120
  ds_read_b64_tr_b16 a[142:143], v10 offset:5632
  ds_read_b64_tr_b16 a[144:145], v10 offset:6144
  ds_read_b64_tr_b16 a[146:147], v10 offset:6656
  ds_read_b64_tr_b16 a[148:149], v10 offset:7168
  ds_read_b64_tr_b16 a[150:151], v10 offset:7680
  ds_read_b64_tr_b16 a[152:153], v10 offset:8192
  ds_read_b64_tr_b16 a[154:155], v10 offset:8704
  ds_read_b64_tr_b16 a[156:157], v10 offset:9216
  ds_read_b64_tr_b16 a[158:159], v10 offset:9728
K3_rw0_1:
  s_cmp_eq_u32 s4, 2
  s_cbranch_scc0 K3_rw0_2
  ds_read_b64_tr_b16 a[40:41], v10 offset:0
  ds_read_b64_tr_b16 a[42:43], v10 offset:512
  ds_read_b64_tr_b16 a[44:45], v10 offset:1024
  ds_read_b64_tr_b16 a[46:47], v10 offset:1536
  ds_read_b64_tr_b16 a[48:49], v10 offset:2048
  ds_read_b64_tr_b16 a[50:51], v10 offset:2560
  ds_read_b64_tr_b16 a[52:53], v10 offset:3072
  ds_read_b64_tr_b16 a[54:55], v10 offset:3584
  ds_read_b64_tr_b16 a[56:57], v10 offset:4096
  ds_read_b64_tr_b16 a[58:59], v10 offset:4608
  ds_read_b64_tr_b16 a[120:121], v10 offset:5120
  ds_read_b64_tr_b16 a[122:123], v10 offset:5632
  ds_read_b64_tr_b16 a[124:125], v10 offset:6144
  ds_read_b64_tr_b16 a[126:127], v10 offset:6656
  ds_read_b64_tr_b16 a[128:129], v10 offset:7168
  ds_read_b64_tr_b16 a[130:131], v10 offset:7680
  ds_read_b64_tr_b16 a[132:133], v10 offset:8192
  ds_read_b64_tr_b16 a[134:135], v10 offset:8704
  ds_read_b64_tr_b16 a[136:137], v10 offset:9216
  ds_read_b64_tr_b16 a[138:139], v10 offset:9728
K3_rw0_2:
  s_waitcnt lgkmcnt(0)
  s_add_u32 s24, s25, 3932160
  s_mov_b32 s22, s24
  s_add_u32 m0, s21, 0
  s_nop 0
  buffer_load_dwordx4 v123, s[16:19], s24 offen lds
  s_add_u32 s24, s24, 393216
  s_add_u32 m0, s21, 1024
  s_nop 0
  buffer_load_dwordx4 v123, s[16:19], s24 offen lds
  s_add_u32 s24, s24, 393216
  s_add_u32 m0, s21, 2048
  s_nop 0
  buffer_load_dwordx4 v123, s[16:19], s24 offen lds
  s_add_u32 s24, s24, 393216
  s_add_u32 m0, s21, 3072
  s_nop 0
  buffer_load_dwordx4 v123, s[16:19], s24 offen lds
  s_add_u32 s24, s24, 393216
  s_add_u32 m0, s21, 4096
  s_nop 0
  buffer_load_dwordx4 v123, s[16:19], s24 offen lds
  s_add_u32 m0, s21, 5120
  s_nop 0
  buffer_load_dwordx4 v123, s[64:67], s22 offen lds
  s_add_u32 s22, s22, 393216
  s_add_u32 m0, s21, 6144
  s_nop 0
  buffer_load_dwordx4 v123, s[64:67], s22 offen lds
  s_add_u32 s22, s22, 393216
  s_add_u32 m0, s21, 7168
  s_nop 0
  buffer_load_dwordx4 v123, s[64:67], s22 offen lds
  s_add_u32 s22, s22, 393216
  s_add_u32 m0, s21, 8192
  s_nop 0
  buffer_load_dwordx4 v123, s[64:67], s22 offen lds
  s_add_u32 s22, s22, 393216
  s_add_u32 m0, s21, 9216
  s_nop 0
  buffer_load_dwordx4 v123, s[64:67], s22 offen lds
  s_waitcnt vmcnt(10)
  s_barrier
  s_cmp_eq_u32 s4, 0
  s_cbranch_scc0 KBaa
  s_mov_b64 exec, 1
  v_mov_b32 v252, 64
  v_mov_b32 v251, 1
  buffer_atomic_add v251, v252, s[12:15], 0 offen sc1
  s_mov_b64 exec, -1
KBaa:
  s_cmp_eq_u32 s4, 0
  s_cbranch_scc0 K3_rw1_0
  ds_read_b64_tr_b16 a[20:21], v10 offset:16384
  ds_read_b64_tr_b16 a[22:23], v10 offset:16896
  ds_read_b64_tr_b16 a[24:25], v10 offset:17408
  ds_read_b64_tr_b16 a[26:27], v10 offset:17920
  ds_read_b64_tr_b16 a[28:29], v10 offset:18432
  ds_read_b64_tr_b16 a[30:31], v10 offset:18944
  ds_read_b64_tr_b16 a[32:33], v10 offset:19456
  ds_read_b64_tr_b16 a[34:35], v10 offset:19968
  ds_read_b64_tr_b16 a[36:37], v10 offset:20480
  ds_read_b64_tr_b16 a[38:39], v10 offset:20992
  ds_read_b64_tr_b16 a[100:101], v10 offset:21504
  ds_read_b64_tr_b16 a[102:103], v10 offset:22016
  ds_read_b64_tr_b16 a[104:105], v10 offset:22528
  ds_read_b64_tr_b16 a[106:107], v10 offset:23040
  ds_read_b64_tr_b16 a[108:109], v10 offset:23552
  ds_read_b64_tr_b16 a[110:111], v10 offset:24064
  ds_read_b64_tr_b16 a[112:113], v10 offset:24576
  ds_read_b64_tr_b16 a[114:115], v10 offset:25088
  ds_read_b64_tr_b16 a[116:117], v10 offset:25600
  ds_read_b64_tr_b16 a[118:119], v10 offset:26112
K3_rw1_0:
  s_cmp_eq_u32 s4, 1
  s_cbranch_scc0 K3_rw1_1
  ds_read_b64_tr_b16 a[0:1], v10 offset:16384
  ds_read_b64_tr_b16 a[2:3], v10 offset:16896
  ds_read_b64_tr_b16 a[4:5], v10 offset:17408
  ds_read_b64_tr_b16 a[6:7], v10 offset:17920
  ds_read_b64_tr_b16 a[8:9], v10 offset:18432
  ds_read_b64_tr_b16 a[10:11], v10 offset:18944
  ds_read_b64_tr_b16 a[12:13], v10 offset:19456
  ds_read_b64_tr_b16 a[14:15], v10 offset:19968
  ds_read_b64_tr_b16 a[16:17], v10 offset:20480
  ds_read_b64_tr_b16 a[18:19], v10 offset:20992
  ds_read_b64_tr_b16 a[80:81], v10 offset:21504
  ds_read_b64_tr_b16 a[82:83], v10 offset:22016
  ds_read_b64_tr_b16 a[84:85], v10 offset:22528
  ds_read_b64_tr_b16 a[86:87], v10 offset:23040
  ds_read_b64_tr_b16 a[88:89], v10 offset:23552
  ds_read_b64_tr_b16 a[90:91], v10 offset:24064
  ds_read_b64_tr_b16 a[92:93], v10 offset:24576
  ds_read_b64_tr_b16 a[94:95], v10 offset:25088
  ds_read_b64_tr_b16 a[96:97], v10 offset:25600
  ds_read_b64_tr_b16 a[98:99], v10 offset:26112
K3_rw1_1:
  s_cmp_eq_u32 s4, 2
  s_cbranch_scc0 K3_rw1_2
  ds_read_b64_tr_b16 a[60:61], v10 offset:16384
  ds_read_b64_tr_b16 a[62:63], v10 offset:16896
  ds_read_b64_tr_b16 a[64:65], v10 offset:17408
  ds_read_b64_tr_b16 a[66:67], v10 offset:17920
  ds_read_b64_tr_b16 a[68:69], v10 offset:18432
  ds_read_b64_tr_b16 a[70:71], v10 offset:18944
  ds_read_b64_tr_b16 a[72:73], v10 offset:19456
  ds_read_b64_tr_b16 a[74:75], v10 offset:19968
  ds_read_b64_tr_b16 a[76:77], v10 offset:20480
  ds_read_b64_tr_b16 a[78:79], v10 offset:20992
  ds_read_b64_tr_b16 a[140:141], v10 offset:21504
  ds_read_b64_tr_b16 a[142:143], v10 offset:22016
  ds_read_b64_tr_b16 a[144:145], v10 offset:22528
  ds_read_b64_tr_b16 a[146:147], v10 offset:23040
  ds_read_b64_tr_b16 a[148:149], v10 offset:23552
  ds_read_b64_tr_b16 a[150:151], v10 offset:24064
  ds_read_b64_tr_b16 a[152:153], v10 offset:24576
  ds_read_b64_tr_b16 a[154:155], v10 offset:25088
  ds_read_b64_tr_b16 a[156:157], v10 offset:25600
  ds_read_b64_tr_b16 a[158:159], v10 offset:26112
K3_rw1_2:
  s_waitcnt lgkmcnt(0)
  s_add_u32 s24, s25, 5898240
  s_mov_b32 s22, s24
  s_add_u32 m0, s21, 16384
  s_nop 0
  buffer_load_dwordx4 v123, s[16:19], s24 offen lds
  s_add_u32 s24, s24, 393216
  s_add_u32 m0, s21, 17408
  s_nop 0
  buffer_load_dwordx4 v123, s[16:19], s24 offen lds
  s_add_u32 s24, s24, 393216
  s_add_u32 m0, s21, 18432
  s_nop 0
  buffer_load_dwordx4 v123, s[16:19], s24 offen lds
  s_add_u32 s24, s24, 393216
  s_add_u32 m0, s21, 19456
  s_nop 0
  buffer_load_dwordx4 v123, s[16:19], s24 offen lds
  s_add_u32 s24, s24, 393216
  s_add_u32 m0, s21, 20480
  s_nop 0
  buffer_load_dwordx4 v123, s[16:19], s24 offen lds
  s_add_u32 m0, s21, 21504
  s_nop 0
  buffer_load_dwordx4 v123, s[64:67], s22 offen lds
  s_add_u32 s22, s22, 393216
  s_add_u32 m0, s21, 22528
  s_nop 0
  buffer_load_dwordx4 v123, s[64:67], s22 offen lds
  s_add_u32 s22, s22, 393216
  s_add_u32 m0, s21, 23552
  s_nop 0
  buffer_load_dwordx4 v123, s[64:67], s22 offen lds
  s_add_u32 s22, s22, 393216
  s_add_u32 m0, s21, 24576
  s_nop 0
  buffer_load_dwordx4 v123, s[64:67], s22 offen lds
  s_add_u32 s22, s22, 393216
  s_add_u32 m0, s21, 25600
  s_nop 0
  buffer_load_dwordx4 v123, s[64:67], s22 offen lds
  s_waitcnt vmcnt(10)
  s_cmp_eq_u32 s4, 0
  s_cbranch_scc0 K3_rw2_0
  ds_read_b64_tr_b16 a[40:41], v10 offset:0
  ds_read_b64_tr_b16 a[42:43], v10 offset:512
  ds_read_b64_tr_b16 a[44:45], v10 offset:1024
  ds_read_b64_tr_b16 a[46:47], v10 offset:1536
  ds_read_b64_tr_b16 a[48:49], v10 offset:2048
  ds_read_b64_tr_b16 a[50:51], v10 offset:2560
  ds_read_b64_tr_b16 a[52:53], v10 offset:3072
  ds_read_b64_tr_b16 a[54:55], v10 offset:3584
  ds_read_b64_tr_b16 a[56:57], v10 offset:4096
  ds_read_b64_tr_b16 a[58:59], v10 offset:4608
  ds_read_b64_tr_b16 a[120:121], v10 offset:5120
  ds_read_b64_tr_b16 a[122:123], v10 offset:5632
  ds_read_b64_tr_b16 a[124:125], v10 offset:6144
  ds_read_b64_tr_b16 a[126:127], v10 offset:6656
  ds_read_b64_tr_b16 a[128:129], v10 offset:7168
  ds_read_b64_tr_b16 a[130:131], v10 offset:7680
  ds_read_b64_tr_b16 a[132:133], v10 offset:8192
  ds_read_b64_tr_b16 a[134:135], v10 offset:8704
  ds_read_b64_tr_b16 a[136:137], v10 offset:9216
  ds_read_b64_tr_b16 a[138:139], v10 offset:9728
K3_rw2_0:
  s_cmp_eq_u32 s4, 1
  s_cbranch_scc0 K3_rw2_1
  ds_read_b64_tr_b16 a[20:21], v10 offset:0
  ds_read_b64_tr_b16 a[22:23], v10 offset:512
  ds_read_b64_tr_b16 a[24:25], v10 offset:1024
  ds_read_b64_tr_b16 a[26:27], v10 offset:1536
  ds_read_b64_tr_b16 a[28:29], v10 offset:2048
  ds_read_b64_tr_b16 a[30:31], v10 offset:2560
  ds_read_b64_tr_b16 a[32:33], v10 offset:3072
  ds_read_b64_tr_b16 a[34:35], v10 offset:3584
  ds_read_b64_tr_b16 a[36:37], v10 offset:4096
  ds_read_b64_tr_b16 a[38:39], v10 offset:4608
  ds_read_b64_tr_b16 a[100:101], v10 offset:5120
  ds_read_b64_tr_b16 a[102:103], v10 offset:5632
  ds_read_b64_tr_b16 a[104:105], v10 offset:6144
  ds_read_b64_tr_b16 a[106:107], v10 offset:6656
  ds_read_b64_tr_b16 a[108:109], v10 offset:7168
  ds_read_b64_tr_b16 a[110:111], v10 offset:7680
  ds_read_b64_tr_b16 a[112:113], v10 offset:8192
  ds_read_b64_tr_b16 a[114:115], v10 offset:8704
  ds_read_b64_tr_b16 a[116:117], v10 offset:9216
  ds_read_b64_tr_b16 a[118:119], v10 offset:9728
K3_rw2_1:
  s_cmp_eq_u32 s4, 2
  s_cbranch_scc0 K3_rw2_2
  ds_read_b64_tr_b16 a[0:1], v10 offset:0
  ds_read_b64_tr_b16 a[2:3], v10 offset:512
  ds_read_b64_tr_b16 a[4:5], v10 offset:1024
  ds_read_b64_tr_b16 a[6:7], v10 offset:1536
  ds_read_b64_tr_b16 a[8:9], v10 offset:2048
  ds_read_b64_tr_b16 a[10:11], v10 offset:2560
  ds_read_b64_tr_b16 a[12:13], v10 offset:3072
  ds_read_b64_tr_b16 a[14:15], v10 offset:3584
  ds_read_b64_tr_b16 a[16:17], v10 offset:4096
  ds_read_b64_tr_b16 a[18:19], v10 offset:4608
  ds_read_b64_tr_b16 a[80:81], v10 offset:5120
  ds_read_b64_tr_b16 a[82:83], v10 offset:5632
  ds_read_b64_tr_b16 a[84:85], v10 offset:6144
  ds_read_b64_tr_b16 a[86:87], v10 offset:6656
  ds_read_b64_tr_b16 a[88:89], v10 offset:7168
  ds_read_b64_tr_b16 a[90:91], v10 offset:7680
  ds_read_b64_tr_b16 a[92:93], v10 offset:8192
  ds_read_b64_tr_b16 a[94:95], v10 offset:8704
  ds_read_b64_tr_b16 a[96:97], v10 offset:9216
  ds_read_b64_tr_b16 a[98:99], v10 offset:9728
K3_rw2_2:
  s_waitcnt lgkmcnt(0)
  v_add_u32 v7, 0, v2
  v_mul_u32_u24 v8, 10923, v7
  v_lshrrev_b32 v8, 16, v8
  v_mul_u32_u24 v9, 6, v8
  v_sub_u32 v9, v7, v9
  v_mul_u32_u24 v8, 1280, v8
  v_lshl_add_u32 v120, v9, 4, v8
  v_add_u32 v7, 64, v2
  v_mul_u32_u24 v8, 10923, v7
  v_lshrrev_b32 v8, 16, v8
  v_mul_u32_u24 v9, 6, v8
  v_sub_u32 v9, v7, v9
  v_mul_u32_u24 v8, 1280, v8
  v_lshl_add_u32 v121, v9, 4, v8
  v_add_u32 v7, 128, v2
  v_mul_u32_u24 v8, 10923, v7
  v_lshrrev_b32 v8, 16, v8
  v_mul_u32_u24 v9, 6, v8
  v_sub_u32 v9, v7, v9
  v_mul_u32_u24 v8, 1280, v8
  v_lshl_add_u32 v122, v9, 4, v8
  s_add_u32 s24, s30, 0
  s_add_u32 m0, s21, 0
  s_nop 0
  buffer_load_dwordx4 v120, s[72:75], s24 offen lds
  s_add_u32 m0, s21, 1024
  s_nop 0
  buffer_load_dwordx4 v121, s[72:75], s24 offen lds
  s_add_u32 m0, s21, 2048
  s_nop 0
  buffer_load_dwordx4 v122, s[72:75], s24 offen lds
  s_add_u32 s24, s24, 40960
  s_add_u32 m0, s21, 3072
  s_nop 0
  buffer_load_dwordx4 v120, s[72:75], s24 offen lds
  s_add_u32 m0, s21, 4096
  s_nop 0
  buffer_load_dwordx4 v121, s[72:75], s24 offen lds
  s_add_u32 m0, s21, 5120
  s_nop 0
  buffer_load_dwordx4 v122, s[72:75], s24 offen lds
  s_add_u32 s24, s24, 40960
  s_add_u32 m0, s21, 6144
  s_nop 0
  buffer_load_dwordx4 v120, s[72:75], s24 offen lds
  s_add_u32 m0, s21, 7168
  s_nop 0
  buffer_load_dwordx4 v121, s[72:75], s24 offen lds
  s_add_u32 m0, s21, 8192
  s_nop 0
  buffer_load_dwordx4 v122, s[72:75], s24 offen lds
  s_waitcnt vmcnt(9)
  s_cmp_eq_u32 s4, 0
  s_cbranch_scc0 K3_rw3_0
  ds_read_b64_tr_b16 a[60:61], v10 offset:16384
  ds_read_b64_tr_b16 a[62:63], v10 offset:16896
  ds_read_b64_tr_b16 a[64:65], v10 offset:17408
  ds_read_b64_tr_b16 a[66:67], v10 offset:17920
  ds_read_b64_tr_b16 a[68:69], v10 offset:18432
  ds_read_b64_tr_b16 a[70:71], v10 offset:18944
  ds_read_b64_tr_b16 a[72:73], v10 offset:19456
  ds_read_b64_tr_b16 a[74:75], v10 offset:19968
  ds_read_b64_tr_b16 a[76:77], v10 offset:20480
  ds_read_b64_tr_b16 a[78:79], v10 offset:20992
  ds_read_b64_tr_b16 a[140:141], v10 offset:21504
  ds_read_b64_tr_b16 a[142:143], v10 offset:22016
  ds_read_b64_tr_b16 a[144:145], v10 offset:22528
  ds_read_b64_tr_b16 a[146:147], v10 offset:23040
  ds_read_b64_tr_b16 a[148:149], v10 offset:23552
  ds_read_b64_tr_b16 a[150:151], v10 offset:24064
  ds_read_b64_tr_b16 a[152:153], v10 offset:24576
  ds_read_b64_tr_b16 a[154:155], v10 offset:25088
  ds_read_b64_tr_b16 a[156:157], v10 offset:25600
  ds_read_b64_tr_b16 a[158:159], v10 offset:26112
K3_rw3_0:
  s_cmp_eq_u32 s4, 1
  s_cbranch_scc0 K3_rw3_1
  ds_read_b64_tr_b16 a[40:41], v10 offset:16384
  ds_read_b64_tr_b16 a[42:43], v10 offset:16896
  ds_read_b64_tr_b16 a[44:45], v10 offset:17408
  ds_read_b64_tr_b16 a[46:47], v10 offset:17920
  ds_read_b64_tr_b16 a[48:49], v10 offset:18432
  ds_read_b64_tr_b16 a[50:51], v10 offset:18944
  ds_read_b64_tr_b16 a[52:53], v10 offset:19456
  ds_read_b64_tr_b16 a[54:55], v10 offset:19968
  ds_read_b64_tr_b16 a[56:57], v10 offset:20480
  ds_read_b64_tr_b16 a[58:59], v10 offset:20992
  ds_read_b64_tr_b16 a[120:121], v10 offset:21504
  ds_read_b64_tr_b16 a[122:123], v10 offset:22016
  ds_read_b64_tr_b16 a[124:125], v10 offset:22528
  ds_read_b64_tr_b16 a[126:127], v10 offset:23040
  ds_read_b64_tr_b16 a[128:129], v10 offset:23552
  ds_read_b64_tr_b16 a[130:131], v10 offset:24064
  ds_read_b64_tr_b16 a[132:133], v10 offset:24576
  ds_read_b64_tr_b16 a[134:135], v10 offset:25088
  ds_read_b64_tr_b16 a[136:137], v10 offset:25600
  ds_read_b64_tr_b16 a[138:139], v10 offset:26112
K3_rw3_1:
  s_cmp_eq_u32 s4, 2
  s_cbranch_scc0 K3_rw3_2
  ds_read_b64_tr_b16 a[20:21], v10 offset:16384
  ds_read_b64_tr_b16 a[22:23], v10 offset:16896
  ds_read_b64_tr_b16 a[24:25], v10 offset:17408
  ds_read_b64_tr_b16 a[26:27], v10 offset:17920
  ds_read_b64_tr_b16 a[28:29], v10 offset:18432
  ds_read_b64_tr_b16 a[30:31], v10 offset:18944
  ds_read_b64_tr_b16 a[32:33], v10 offset:19456
  ds_read_b64_tr_b16 a[34:35], v10 offset:19968
  ds_read_b64_tr_b16 a[36:37], v10 offset:20480
  ds_read_b64_tr_b16 a[38:39], v10 offset:20992
  ds_read_b64_tr_b16 a[100:101], v10 offset:21504
  ds_read_b64_tr_b16 a[102:103], v10 offset:22016
  ds_read_b64_tr_b16 a[104:105], v10 offset:22528
  ds_read_b64_tr_b16 a[106:107], v10 offset:23040
  ds_read_b64_tr_b16 a[108:109], v10 offset:23552
  ds_read_b64_tr_b16 a[110:111], v10 offset:24064
  ds_read_b64_tr_b16 a[112:113], v10 offset:24576
  ds_read_b64_tr_b16 a[114:115], v10 offset:25088
  ds_read_b64_tr_b16 a[116:117], v10 offset:25600
  ds_read_b64_tr_b16 a[118:119], v10 offset:26112
K3_rw3_2:
  s_waitcnt lgkmcnt(0)
  s_add_u32 s24, s30, 122880
  s_add_u32 m0, s21, 16384
  s_nop 0
  buffer_load_dwordx4 v120, s[72:75], s24 offen lds
  s_add_u32 m0, s21, 17408
  s_nop 0
  buffer_load_dwordx4 v121, s[72:75], s24 offen lds
  s_add_u32 m0, s21, 18432
  s_nop 0
  buffer_load_dwordx4 v122, s[72:75], s24 offen lds
  s_add_u32 s24, s24, 40960
  s_add_u32 m0, s21, 19456
  s_nop 0
  buffer_load_dwordx4 v120, s[72:75], s24 offen lds
  s_add_u32 m0, s21, 20480
  s_nop 0
  buffer_load_dwordx4 v121, s[72:75], s24 offen lds
  s_add_u32 m0, s21, 21504
  s_nop 0
  buffer_load_dwordx4 v122, s[72:75], s24 offen lds
  s_add_u32 s24, s24, 40960
  s_add_u32 m0, s21, 22528
  s_nop 0
  buffer_load_dwordx4 v120, s[72:75], s24 offen lds
  s_add_u32 m0, s21, 23552
  s_nop 0
  buffer_load_dwordx4 v121, s[72:75], s24 offen lds
  s_add_u32 m0, s21, 24576
  s_nop 0
  buffer_load_dwordx4 v122, s[72:75], s24 offen lds
  s_waitcnt vmcnt(9)
  ds_read_b64_tr_b16 a[160:161], v11 offset:0
  ds_read_b64_tr_b16 a[162:163], v11 offset:1536
  ds_read_b64_tr_b16 a[164:165], v11 offset:3072
  ds_read_b64_tr_b16 a[166:167], v11 offset:4608
  ds_read_b64_tr_b16 a[168:169], v11 offset:6144
  ds_read_b64_tr_b16 a[170:171], v11 offset:7680
  ds_read_b64_tr_b16 a[184:185], v11 offset:32
  ds_read_b64_tr_b16 a[186:187], v11 offset:1568
  ds_read_b64_tr_b16 a[188:189], v11 offset:3104
  ds_read_b64_tr_b16 a[190:191], v11 offset:4640
  ds_read_b64_tr_b16 a[192:193], v11 offset:6176
  ds_read_b64_tr_b16 a[194:195], v11 offset:7712
  ds_read_b64_tr_b16 a[208:209], v11 offset:64
  ds_read_b64_tr_b16 a[210:211], v11 offset:1600
  ds_read_b64_tr_b16 a[212:213], v11 offset:3136
  ds_read_b64_tr_b16 a[214:215], v11 offset:4672
  ds_read_b64_tr_b16 a[216:217], v11 offset:6208
  ds_read_b64_tr_b16 a[218:219], v11 offset:7744
  s_waitcnt lgkmcnt(0)
  s_waitcnt vmcnt(0)
  ds_read_b64_tr_b16 a[172:173], v11 offset:16384
  ds_read_b64_tr_b16 a[174:175], v11 offset:17920
  ds_read_b64_tr_b16 a[176:177], v11 offset:19456
  ds_read_b64_tr_b16 a[178:179], v11 offset:20992
  ds_read_b64_tr_b16 a[180:181], v11 offset:22528
  ds_read_b64_tr_b16 a[182:183], v11 offset:24064
  ds_read_b64_tr_b16 a[196:197], v11 offset:16416
  ds_read_b64_tr_b16 a[198:199], v11 offset:17952
  ds_read_b64_tr_b16 a[200:201], v11 offset:19488
  ds_read_b64_tr_b16 a[202:203], v11 offset:21024
  ds_read_b64_tr_b16 a[204:205], v11 offset:22560
  ds_read_b64_tr_b16 a[206:207], v11 offset:24096
  ds_read_b64_tr_b16 a[220:221], v11 offset:16448
  ds_read_b64_tr_b16 a[222:223], v11 offset:17984
  ds_read_b64_tr_b16 a[224:225], v11 offset:19520
  ds_read_b64_tr_b16 a[226:227], v11 offset:21056
  ds_read_b64_tr_b16 a[228:229], v11 offset:22592
  ds_read_b64_tr_b16 a[230:231], v11 offset:24128
  s_waitcnt lgkmcnt(0)
  s_waitcnt vmcnt(0)
  s_branch K3_ldd
K3_ldv:
  s_add_u32 s24, s25, 0
  s_add_u32 m0, s21, 0
  s_nop 0
  buffer_load_dwordx4 v120, s[68:71], s24 offen lds
  s_add_u32 m0, s21, 1024
  s_nop 0
  buffer_load_dwordx4 v121, s[68:71], s24 offen lds
  s_add_u32 m0, s21, 2048
  s_nop 0
  buffer_load_dwordx4 v122, s[68:71], s24 offen lds
  s_add_u32 s24, s24, 393216
  s_add_u32 m0, s21, 3072
  s_nop 0
  buffer_load_dwordx4 v120, s[68:71], s24 offen lds
  s_add_u32 m0, s21, 4096
  s_nop 0
  buffer_load_dwordx4 v121, s[68:71], s24 offen lds
  s_add_u32 m0, s21, 5120
  s_nop 0
  buffer_load_dwordx4 v122, s[68:71], s24 offen lds
  s_add_u32 s24, s24, 393216
  s_add_u32 m0, s21, 6144
  s_nop 0
  buffer_load_dwordx4 v120, s[68:71], s24 offen lds
  s_add_u32 m0, s21, 7168
  s_nop 0
  buffer_load_dwordx4 v121, s[68:71], s24 offen lds
  s_add_u32 m0, s21, 8192
  s_nop 0
  buffer_load_dwordx4 v122, s[68:71], s24 offen lds
  s_add_u32 s24, s24, 393216
  s_add_u32 m0, s21, 9216
  s_nop 0
  buffer_load_dwordx4 v120, s[68:71], s24 offen lds
  s_add_u32 m0, s21, 10240
  s_nop 0
  buffer_load_dwordx4 v121, s[68:71], s24 offen lds
  s_add_u32 m0, s21, 11264
  s_nop 0
  buffer_load_dwordx4 v122, s[68:71], s24 offen lds
  s_add_u32 s24, s24, 393216
  s_add_u32 m0, s21, 12288
  s_nop 0
  buffer_load_dwordx4 v120, s[68:71], s24 offen lds
  s_add_u32 m0, s21, 13312
  s_nop 0
  buffer_load_dwordx4 v121, s[68:71], s24 offen lds
  s_add_u32 m0, s21, 14336
  s_nop 0
  buffer_load_dwordx4 v122, s[68:71], s24 offen lds
  s_add_u32 s24, s25, 1966080
  s_add_u32 m0, s21, 16384
  s_nop 0
  buffer_load_dwordx4 v120, s[68:71], s24 offen lds
  s_add_u32 m0, s21, 17408
  s_nop 0
  buffer_load_dwordx4 v121, s[68:71], s24 offen lds
  s_add_u32 m0, s21, 18432
  s_nop 0
  buffer_load_dwordx4 v122, s[68:71], s24 offen lds
  s_add_u32 s24, s24, 393216
  s_add_u32 m0, s21, 19456
  s_nop 0
  buffer_load_dwordx4 v120, s[68:71], s24 offen lds
  s_add_u32 m0, s21, 20480
  s_nop 0
  buffer_load_dwordx4 v121, s[68:71], s24 offen lds
  s_add_u32 m0, s21, 21504
  s_nop 0
  buffer_load_dwordx4 v122, s[68:71], s24 offen lds
  s_add_u32 s24, s24, 393216
  s_add_u32 m0, s21, 22528
  s_nop 0
  buffer_load_dwordx4 v120, s[68:71], s24 offen lds
  s_add_u32 m0, s21, 23552
  s_nop 0
  buffer_load_dwordx4 v121, s[68:71], s24 offen lds
  s_add_u32 m0, s21, 24576
  s_nop 0
  buffer_load_dwordx4 v122, s[68:71], s24 offen lds
  s_add_u32 s24, s24, 393216
  s_add_u32 m0, s21, 25600
  s_nop 0
  buffer_load_dwordx4 v120, s[68:71], s24 offen lds
  s_add_u32 m0, s21, 26624
  s_nop 0
  buffer_load_dwordx4 v121, s[68:71], s24 offen lds
  s_add_u32 m0, s21, 27648
  s_nop 0
  buffer_load_dwordx4 v122, s[68:71], s24 offen lds
  s_add_u32 s24, s24, 393216
  s_add_u32 m0, s21, 28672
  s_nop 0
  buffer_load_dwordx4 v120, s[68:71], s24 offen lds
  s_add_u32 m0, s21, 29696
  s_nop 0
  buffer_load_dwordx4 v121, s[68:71], s24 offen lds
  s_add_u32 m0, s21, 30720
  s_nop 0
  buffer_load_dwordx4 v122, s[68:71], s24 offen lds
  s_waitcnt vmcnt(15)
  s_cmp_eq_u32 s4, 0
  s_cbranch_scc0 KBpb
  s_mov_b32 exec_lo, -1
  s_mov_b32 exec_hi, 0xff
  buffer_store_dwordx2 v[106:107], v108, s[8:11], 0 offen
  s_mov_b64 exec, -1
KBpb:
  ds_read_b64_tr_b16 a[20:21], v11 offset:0
  ds_read_b64_tr_b16 a[22:23], v11 offset:1536
  ds_read_b64_tr_b16 a[24:25], v11 offset:3072
  ds_read_b64_tr_b16 a[26:27], v11 offset:4608
  ds_read_b64_tr_b16 a[28:29], v11 offset:6144
  ds_read_b64_tr_b16 a[30:31], v11 offset:7680
  ds_read_b64_tr_b16 a[32:33], v11 offset:9216
  ds_read_b64_tr_b16 a[34:35], v11 offset:10752
  ds_read_b64_tr_b16 a[36:37], v11 offset:12288
  ds_read_b64_tr_b16 a[38:39], v11 offset:13824
  ds_read_b64_tr_b16 a[100:101], v11 offset:32
  ds_read_b64_tr_b16 a[102:103], v11 offset:1568
  ds_read_b64_tr_b16 a[104:105], v11 offset:3104
  ds_read_b64_tr_b16 a[106:107], v11 offset:4640
  ds_read_b64_tr_b16 a[108:109], v11 offset:6176
  ds_read_b64_tr_b16 a[110:111], v11 offset:7712
  ds_read_b64_tr_b16 a[112:113], v11 offset:9248
  ds_read_b64_tr_b16 a[114:115], v11 offset:10784
  ds_read_b64_tr_b16 a[116:117], v11 offset:12320
  ds_read_b64_tr_b16 a[118:119], v11 offset:13856
  ds_read_b64_tr_b16 a[180:181], v11 offset:64
  ds_read_b64_tr_b16 a[182:183], v11 offset:1600
  ds_read_b64_tr_b16 a[184:185], v11 offset:3136
  ds_read_b64_tr_b16 a[186:187], v11 offset:4672
  ds_read_b64_tr_b16 a[188:189], v11 offset:6208
  ds_read_b64_tr_b16 a[190:191], v11 offset:7744
  ds_read_b64_tr_b16 a[192:193], v11 offset:9280
  ds_read_b64_tr_b16 a[194:195], v11 offset:10816
  ds_read_b64_tr_b16 a[196:197], v11 offset:12352
  ds_read_b64_tr_b16 a[198:199], v11 offset:13888
  s_waitcnt lgkmcnt(0)
  s_add_u32 s24, s25, 3932160
  s_add_u32 m0, s21, 0
  s_nop 0
  buffer_load_dwordx4 v120, s[68:71], s24 offen lds
  s_add_u32 m0, s21, 1024
  s_nop 0
  buffer_load_dwordx4 v121, s[68:71], s24 offen lds
  s_add_u32 m0, s21, 2048
  s_nop 0
  buffer_load_dwordx4 v122, s[68:71], s24 offen lds
  s_add_u32 s24, s24, 393216
  s_add_u32 m0, s21, 3072
  s_nop 0
  buffer_load_dwordx4 v120, s[68:71], s24 offen lds
  s_add_u32 m0, s21, 4096
  s_nop 0
  buffer_load_dwordx4 v121, s[68:71], s24 offen lds
  s_add_u32 m0, s21, 5120
  s_nop 0
  buffer_load_dwordx4 v122, s[68:71], s24 offen lds
  s_add_u32 s24, s24, 393216
  s_add_u32 m0, s21, 6144
  s_nop 0
  buffer_load_dwordx4 v120, s[68:71], s24 offen lds
  s_add_u32 m0, s21, 7168
  s_nop 0
  buffer_load_dwordx4 v121, s[68:71], s24 offen lds
  s_add_u32 m0, s21, 8192
  s_nop 0
  buffer_load_dwordx4 v122, s[68:71], s24 offen lds
  s_add_u32 s24, s24, 393216
  s_add_u32 m0, s21, 9216
  s_nop 0
  buffer_load_dwordx4 v120, s[68:71], s24 offen lds
  s_add_u32 m0, s21, 10240
  s_nop 0
  buffer_load_dwordx4 v121, s[68:71], s24 offen lds
  s_add_u32 m0, s21, 11264
  s_nop 0
  buffer_load_dwordx4 v122, s[68:71], s24 offen lds
  s_add_u32 s24, s24, 393216
  s_add_u32 m0, s21, 12288
  s_nop 0
  buffer_load_dwordx4 v120, s[68:71], s24 offen lds
  s_add_u32 m0, s21, 13312
  s_nop 0
  buffer_load_dwordx4 v121, s[68:71], s24 offen lds
  s_add_u32 m0, s21, 14336
  s_nop 0
  buffer_load_dwordx4 v122, s[68:71], s24 offen lds
  s_waitcnt vmcnt(15)
  s_barrier
  s_cmp_eq_u32 s4, 0
  s_cbranch_scc0 KBab
  s_mov_b64 exec, 1
  v_mov_b32 v252, 64
  v_mov_b32 v251, 1
  buffer_atomic_add v251, v252, s[12:15], 0 offen sc1
  s_mov_b64 exec, -1
KBab:
  ds_read_b64_tr_b16 a[40:41], v11 offset:16384
  ds_read_b64_tr_b16 a[42:43], v11 offset:17920
  ds_read_b64_tr_b16 a[44:45], v11 offset:19456
  ds_read_b64_tr_b16 a[46:47], v11 offset:20992
  ds_read_b64_tr_b16 a[48:49], v11 offset:22528
  ds_read_b64_tr_b16 a[50:51], v11 offset:24064
  ds_read_b64_tr_b16 a[52:53], v11 offset:25600
  ds_read_b64_tr_b16 a[54:55], v11 offset:27136
  ds_read_b64_tr_b16 a[56:57], v11 offset:28672
  ds_read_b64_tr_b16 a[58:59], v11 offset:30208
  ds_read_b64_tr_b16 a[120:121], v11 offset:16416
  ds_read_b64_tr_b16 a[122:123], v11 offset:17952
  ds_read_b64_tr_b16 a[124:125], v11 offset:19488
  ds_read_b64_tr_b16 a[126:127], v11 offset:21024
  ds_read_b64_tr_b16 a[128:129], v11 offset:22560
  ds_read_b64_tr_b16 a[130:131], v11 offset:24096
  ds_read_b64_tr_b16 a[132:133], v11 offset:25632
  ds_read_b64_tr_b16 a[134:135], v11 offset:27168
  ds_read_b64_tr_b16 a[136:137], v11 offset:28704
  ds_read_b64_tr_b16 a[138:139], v11 offset:30240
  ds_read_b64_tr_b16 a[200:201], v11 offset:16448
  ds_read_b64_tr_b16 a[202:203], v11 offset:17984
  ds_read_b64_tr_b16 a[204:205], v11 offset:19520
  ds_read_b64_tr_b16 a[206:207], v11 offset:21056
  ds_read_b64_tr_b16 a[208:209], v11 offset:22592
  ds_read_b64_tr_b16 a[210:211], v11 offset:24128
  ds_read_b64_tr_b16 a[212:213], v11 offset:25664
  ds_read_b64_tr_b16 a[214:215], v11 offset:27200
  ds_read_b64_tr_b16 a[216:217], v11 offset:28736
  ds_read_b64_tr_b16 a[218:219], v11 offset:30272
  s_waitcnt lgkmcnt(0)
  s_add_u32 s24, s25, 5898240
  s_add_u32 m0, s21, 16384
  s_nop 0
  buffer_load_dwordx4 v120, s[68:71], s24 offen lds
  s_add_u32 m0, s21, 17408
  s_nop 0
  buffer_load_dwordx4 v121, s[68:71], s24 offen lds
  s_add_u32 m0, s21, 18432
  s_nop 0
  buffer_load_dwordx4 v122, s[68:71], s24 offen lds
  s_add_u32 s24, s24, 393216
  s_add_u32 m0, s21, 19456
  s_nop 0
  buffer_load_dwordx4 v120, s[68:71], s24 offen lds
  s_add_u32 m0, s21, 20480
  s_nop 0
  buffer_load_dwordx4 v121, s[68:71], s24 offen lds
  s_add_u32 m0, s21, 21504
  s_nop 0
  buffer_load_dwordx4 v122, s[68:71], s24 offen lds
  s_add_u32 s24, s24, 393216
  s_add_u32 m0, s21, 22528
  s_nop 0
  buffer_load_dwordx4 v120, s[68:71], s24 offen lds
  s_add_u32 m0, s21, 23552
  s_nop 0
  buffer_load_dwordx4 v121, s[68:71], s24 offen lds
  s_add_u32 m0, s21, 24576
  s_nop 0
  buffer_load_dwordx4 v122, s[68:71], s24 offen lds
  s_add_u32 s24, s24, 393216
  s_add_u32 m0, s21, 25600
  s_nop 0
  buffer_load_dwordx4 v120, s[68:71], s24 offen lds
  s_add_u32 m0, s21, 26624
  s_nop 0
  buffer_load_dwordx4 v121, s[68:71], s24 offen lds
  s_add_u32 m0, s21, 27648
  s_nop 0
  buffer_load_dwordx4 v122, s[68:71], s24 offen lds
  s_add_u32 s24, s24, 393216
  s_add_u32 m0, s21, 28672
  s_nop 0
  buffer_load_dwordx4 v120, s[68:71], s24 offen lds
  s_add_u32 m0, s21, 29696
  s_nop 0
  buffer_load_dwordx4 v121, s[68:71], s24 offen lds
  s_add_u32 m0, s21, 30720
  s_nop 0
  buffer_load_dwordx4 v122, s[68:71], s24 offen lds
  s_waitcnt vmcnt(15)
  ds_read_b64_tr_b16 a[60:61], v11 offset:0
  ds_read_b64_tr_b16 a[62:63], v11 offset:1536
  ds_read_b64_tr_b16 a[64:65], v11 offset:3072
  ds_read_b64_tr_b16 a[66:67], v11 offset:4608
  ds_read_b64_tr_b16 a[68:69], v11 offset:6144
  ds_read_b64_tr_b16 a[70:71], v11 offset:7680
  ds_read_b64_tr_b16 a[72:73], v11 offset:9216
  ds_read_b64_tr_b16 a[74:75], v11 offset:10752
  ds_read_b64_tr_b16 a[76:77], v11 offset:12288
  ds_read_b64_tr_b16 a[78:79], v11 offset:13824
  ds_read_b64_tr_b16 a[140:141], v11 offset:32
  ds_read_b64_tr_b16 a[142:143], v11 offset:1568
  ds_read_b64_tr_b16 a[144:145], v11 offset:3104
  ds_read_b64_tr_b16 a[146:147], v11 offset:4640
  ds_read_b64_tr_b16 a[148:149], v11 offset:6176
  ds_read_b64_tr_b16 a[150:151], v11 offset:7712
  ds_read_b64_tr_b16 a[152:153], v11 offset:9248
  ds_read_b64_tr_b16 a[154:155], v11 offset:10784
  ds_read_b64_tr_b16 a[156:157], v11 offset:12320
  ds_read_b64_tr_b16 a[158:159], v11 offset:13856
  ds_read_b64_tr_b16 a[220:221], v11 offset:64
  ds_read_b64_tr_b16 a[222:223], v11 offset:1600
  ds_read_b64_tr_b16 a[224:225], v11 offset:3136
  ds_read_b64_tr_b16 a[226:227], v11 offset:4672
  ds_read_b64_tr_b16 a[228:229], v11 offset:6208
  ds_read_b64_tr_b16 a[230:231], v11 offset:7744
  ds_read_b64_tr_b16 a[232:233], v11 offset:9280
  ds_read_b64_tr_b16 a[234:235], v11 offset:10816
  ds_read_b64_tr_b16 a[236:237], v11 offset:12352
  ds_read_b64_tr_b16 a[238:239], v11 offset:13888
  s_waitcnt lgkmcnt(0)
  v_add_u32 v7, 0, v2
  v_mul_u32_u24 v8, 10923, v7
  v_lshrrev_b32 v8, 16, v8
  v_mul_u32_u24 v9, 6, v8
  v_sub_u32 v9, v7, v9
  v_mul_u32_u24 v8, 1280, v8
  v_lshl_add_u32 v120, v9, 4, v8
  v_add_u32 v7, 64, v2
  v_mul_u32_u24 v8, 10923, v7
  v_lshrrev_b32 v8, 16, v8
  v_mul_u32_u24 v9, 6, v8
  v_sub_u32 v9, v7, v9
  v_mul_u32_u24 v8, 1280, v8
  v_lshl_add_u32 v121, v9, 4, v8
  v_add_u32 v7, 128, v2
  v_mul_u32_u24 v8, 10923, v7
  v_lshrrev_b32 v8, 16, v8
  v_mul_u32_u24 v9, 6, v8
  v_sub_u32 v9, v7, v9
  v_mul_u32_u24 v8, 1280, v8
  v_lshl_add_u32 v122, v9, 4, v8
  s_add_u32 s24, s30, 0
  s_add_u32 m0, s21, 0
  s_nop 0
  buffer_load_dwordx4 v120, s[72:75], s24 offen lds
  s_add_u32 m0, s21, 1024
  s_nop 0
  buffer_load_dwordx4 v121, s[72:75], s24 offen lds
  s_add_u32 m0, s21, 2048
  s_nop 0
  buffer_load_dwordx4 v122, s[72:75], s24 offen lds
  s_add_u32 s24, s24, 40960
  s_add_u32 m0, s21, 3072
  s_nop 0
  buffer_load_dwordx4 v120, s[72:75], s24 offen lds
  s_add_u32 m0, s21, 4096
  s_nop 0
  buffer_load_dwordx4 v121, s[72:75], s24 offen lds
  s_add_u32 m0, s21, 5120
  s_nop 0
  buffer_load_dwordx4 v122, s[72:75], s24 offen lds
  s_add_u32 s24, s24, 40960
  s_add_u32 m0, s21, 6144
  s_nop 0
  buffer_load_dwordx4 v120, s[72:75], s24 offen lds
  s_add_u32 m0, s21, 7168
  s_nop 0
  buffer_load_dwordx4 v121, s[72:75], s24 offen lds
  s_add_u32 m0, s21, 8192
  s_nop 0
  buffer_load_dwordx4 v122, s[72:75], s24 offen lds
  s_waitcnt vmcnt(9)
  ds_read_b64_tr_b16 a[0:1], v11 offset:16384
  ds_read_b64_tr_b16 a[2:3], v11 offset:17920
  ds_read_b64_tr_b16 a[4:5], v11 offset:19456
  ds_read_b64_tr_b16 a[6:7], v11 offset:20992
  ds_read_b64_tr_b16 a[8:9], v11 offset:22528
  ds_read_b64_tr_b16 a[10:11], v11 offset:24064
  ds_read_b64_tr_b16 a[12:13], v11 offset:25600
  ds_read_b64_tr_b16 a[14:15], v11 offset:27136
  ds_read_b64_tr_b16 a[16:17], v11 offset:28672
  ds_read_b64_tr_b16 a[18:19], v11 offset:30208
  ds_read_b64_tr_b16 a[80:81], v11 offset:16416
  ds_read_b64_tr_b16 a[82:83], v11 offset:17952
  ds_read_b64_tr_b16 a[84:85], v11 offset:19488
  ds_read_b64_tr_b16 a[86:87], v11 offset:21024
  ds_read_b64_tr_b16 a[88:89], v11 offset:22560
  ds_read_b64_tr_b16 a[90:91], v11 offset:24096
  ds_read_b64_tr_b16 a[92:93], v11 offset:25632
  ds_read_b64_tr_b16 a[94:95], v11 offset:27168
  ds_read_b64_tr_b16 a[96:97], v11 offset:28704
  ds_read_b64_tr_b16 a[98:99], v11 offset:30240
  ds_read_b64_tr_b16 a[160:161], v11 offset:16448
  ds_read_b64_tr_b16 a[162:163], v11 offset:17984
  ds_read_b64_tr_b16 a[164:165], v11 offset:19520
  ds_read_b64_tr_b16 a[166:167], v11 offset:21056
  ds_read_b64_tr_b16 a[168:169], v11 offset:22592
  ds_read_b64_tr_b16 a[170:171], v11 offset:24128
  ds_read_b64_tr_b16 a[172:173], v11 offset:25664
  ds_read_b64_tr_b16 a[174:175], v11 offset:27200
  ds_read_b64_tr_b16 a[176:177], v11 offset:28736
  ds_read_b64_tr_b16 a[178:179], v11 offset:30272
  s_waitcnt lgkmcnt(0)
  s_add_u32 s24, s30, 122880
  s_add_u32 m0, s21, 16384
  s_nop 0
  buffer_load_dwordx4 v120, s[72:75], s24 offen lds
  s_add_u32 m0, s21, 17408
  s_nop 0
  buffer_load_dwordx4 v121, s[72:75], s24 offen lds
  s_add_u32 m0, s21, 18432
  s_nop 0
  buffer_load_dwordx4 v122, s[72:75], s24 offen lds
  s_add_u32 s24, s24, 40960
  s_add_u32 m0, s21, 19456
  s_nop 0
  buffer_load_dwordx4 v120, s[72:75], s24 offen lds
  s_add_u32 m0, s21, 20480
  s_nop 0
  buffer_load_dwordx4 v121, s[72:75], s24 offen lds
  s_add_u32 m0, s21, 21504
  s_nop 0
  buffer_load_dwordx4 v122, s[72:75], s24 offen lds
  s_add_u32 s24, s24, 40960
  s_add_u32 m0, s21, 22528
  s_nop 0
  buffer_load_dwordx4 v120, s[72:75], s24 offen lds
  s_add_u32 m0, s21, 23552
  s_nop 0
  buffer_load_dwordx4 v121, s[72:75], s24 offen lds
  s_add_u32 m0, s21, 24576
  s_nop 0
  buffer_load_dwordx4 v122, s[72:75], s24 offen lds
  s_waitcnt vmcnt(9)
  ds_read_b64_tr_b16 v[200:201], v11 offset:0
  ds_read_b64_tr_b16 v[202:203], v11 offset:1536
  ds_read_b64_tr_b16 v[204:205], v11 offset:3072
  ds_read_b64_tr_b16 v[206:207], v11 offset:4608
  ds_read_b64_tr_b16 v[208:209], v11 offset:6144
  ds_read_b64_tr_b16 v[210:211], v11 offset:7680
  ds_read_b64_tr_b16 v[224:225], v11 offset:32
  ds_read_b64_tr_b16 v[226:227], v11 offset:1568
  ds_read_b64_tr_b16 v[228:229], v11 offset:3104
  ds_read_b64_tr_b16 v[230:231], v11 offset:4640
  ds_read_b64_tr_b16 v[232:233], v11 offset:6176
  ds_read_b64_tr_b16 v[234:235], v11 offset:7712
  s_waitcnt lgkmcnt(0)
  s_waitcnt vmcnt(0)
  ds_read_b64_tr_b16 v[212:213], v11 offset:16384
  ds_read_b64_tr_b16 v[214:215], v11 offset:17920
  ds_read_b64_tr_b16 v[216:217], v11 offset:19456
  ds_read_b64_tr_b16 v[218:219], v11 offset:20992
  ds_read_b64_tr_b16 v[220:221], v11 offset:22528
  ds_read_b64_tr_b16 v[222:223], v11 offset:24064
  ds_read_b64_tr_b16 v[236:237], v11 offset:16416
  ds_read_b64_tr_b16 v[238:239], v11 offset:17952
  ds_read_b64_tr_b16 v[240:241], v11 offset:19488
  ds_read_b64_tr_b16 v[242:243], v11 offset:21024
  ds_read_b64_tr_b16 v[244:245], v11 offset:22560
  ds_read_b64_tr_b16 v[246:247], v11 offset:24096
  s_waitcnt lgkmcnt(0)
  s_waitcnt vmcnt(0)
K3_ldd:
  s_barrier
  s_cmp_eq_u32 s4, 0
  s_cbranch_scc0 K3_bi
  s_mov_b64 exec, 1
  v_mov_b32 v252, 96
  v_mov_b32 v251, 1
  buffer_atomic_add v251, v252, s[12:15], 0 offen sc1
  s_mov_b64 exec, -1
K3_bi:
  v_lshlrev_b32 v6, 7, v3
  v_lshl_add_u32 v6, v5, 4, v6
  s_mul_i32 s24, s3, 40960
  s_mul_i32 s25, s4, 2560
  s_add_u32 s24, s24, s25
  s_add_u32 s24, s24, 65536
  v_add_u32 v10, s24, v6
  v_add_u32 v11, s25, v6
  s_add_u32 s26, s4, 1
  s_and_b32 s26, s26, 3
  s_mul_i32 s26, s26, 2560
  v_add_u32 v12, s26, v6
  s_add_u32 s26, s4, 2
  s_and_b32 s26, s26, 3
  s_mul_i32 s26, s26, 2560
  v_add_u32 v13, s26, v6
  s_add_u32 s26, s4, 3
  s_and_b32 s26, s26, 3
  s_mul_i32 s26, s26, 2560
  v_add_u32 v14, s26, v6
  s_mov_b32 s96, 0x00ff00ff
  s_mov_b32 s97, 0x00ff00ff
  s_cmp_eq_u32 s4, 0
  s_cbranch_scc0 K3_w3n_a
  s_mov_b64 s[96:97], -1
  v_lshrrev_b32 v7, 3, v4
  v_mul_u32_u24 v7, 7680, v7
  v_add_u32 v10, v10, v7
  v_add_u32 v11, v11, v7
K3_w3n_a:
  s_mul_i32 s24, s20, 12
  s_mul_i32 s25, s7, 3
  s_add_u32 s24, s24, s25
  s_add_u32 s24, s24, s4
  s_lshl_b32 s25, s24, 10
  s_add_u32 s25, s25, 234881024
  v_add_u32 v15, s25, v6
  s_lshl_b32 s25, s24, 8
  s_add_u32 s25, s25, 236978176
  v_add_u32 v16, s25, v6
  v_lshlrev_b32 v17, 7, v3
  v_lshl_add_u32 v17, v5, 4, v17
  s_lshr_b32 s25, s24, 1
  s_lshl_b32 s25, s25, 9
  s_and_b32 s26, s24, 1
  s_lshl_b32 s26, s26, 3
  s_add_u32 s25, s25, s26
  s_add_u32 s25, s25, 5242880
  v_add_u32 v17, s25, v17
  v_and_b32 v7, 1, v3
  v_lshlrev_b32 v7, 8, v7
  v_lshl_add_u32 v7, v4, 4, v7
  s_mul_i32 s24, s20, 3072
  s_add_u32 s26, s24, 1048576
  s_mul_i32 s25, s7, 3
  s_add_u32 s27, s25, 0
  s_lshr_b32 s28, s27, 1
  s_lshl_b32 s28, s28, 9
  s_and_b32 s27, s27, 1
  s_lshl_b32 s27, s27, 3
  s_add_u32 s27, s27, s28
  s_add_u32 s27, s27, s26
  v_add_u32 v18, s27, v7
  s_add_u32 s27, s25, 1
  s_lshr_b32 s28, s27, 1
  s_lshl_b32 s28, s28, 9
  s_and_b32 s27, s27, 1
  s_lshl_b32 s27, s27, 3
  s_add_u32 s27, s27, s28
  s_add_u32 s27, s27, s26
  v_add_u32 v19, s27, v7
  s_add_u32 s27, s25, 2
  s_lshr_b32 s28, s27, 1
  s_lshl_b32 s28, s28, 9
  s_and_b32 s27, s27, 1
  s_lshl_b32 s27, s27, 3
  s_add_u32 s27, s27, s28
  s_add_u32 s27, s27, s26
  v_add_u32 v24, s27, v7
  v_lshlrev_b32 v27, 4, v2
  s_mul_i32 s26, s20, 12288
  s_add_u32 s26, s26, 234881024
  v_add_u32 v20, s26, v27
  s_add_u32 s26, s24, 236978176
  v_add_u32 v45, s26, v27
  s_mul_i32 s26, s20, 12288
  s_lshl_b32 s27, s7, 10
  s_add_u32 s26, s26, s27
  s_lshl_b32 s27, s4, 9
  s_add_u32 s26, s26, s27
  s_add_u32 s26, s26, 234881024
  s_mul_i32 s27, s20, 3072
  s_lshl_b32 s28, s7, 8
  s_add_u32 s27, s27, s28
  s_add_u32 s27, s27, 236978176
  s_cmp_eq_u32 s4, 2
  s_cselect_b32 s26, s27, s26
  v_add_u32 v15, s26, v6
  s_mov_b32 s88, 393216
  s_mov_b32 s89, 98304
  s_cselect_b32 s88, s89, s88
  s_mov_b32 s89, 4096
  s_mov_b32 s92, 1024
  s_cselect_b32 s89, s92, s89
  s_mov_b32 s90, 0x00ff00ff
  s_cselect_b32 s91, 0, s90
  s_and_b32 s26, s7, 1
  s_sub_u32 s27, s4, s26
  s_cmp_eq_u32 s27, -1
  s_cselect_b32 s27, 2, s27
  v_lshlrev_b32 v25, 4, v2
  v_add_u32 v25, 20480, v25
  v_lshlrev_b32 v16, 3, v2
  v_add_u32 v16, 21504, v16
  s_lshl_b32 s28, s27, 3
  v_add_u32 v46, s28, v25
  s_cmp_eq_u32 s27, 2
  s_cselect_b64 vcc, -1, 0
  v_cndmask_b32 v46, v46, v16, vcc
  v_mov_b32 v47, v46
  s_mul_i32 s27, s7, 3
  s_add_u32 s28, s27, s26
  s_lshr_b32 s28, s28, 1
  s_lshl_b32 s28, s28, 10
  s_add_u32 s87, s27, 2
  s_cmp_eq_u32 s26, 1
  s_cselect_b32 s27, s27, s87
  s_lshr_b32 s87, s27, 1
  s_lshl_b32 s87, s87, 10
  s_and_b32 s27, s27, 1
  s_lshl_b32 s27, s27, 3
  s_add_u32 s87, s87, s27
  s_mul_i32 s27, s20, 12288
  s_and_b32 s26, s4, 1
  s_mul_i32 s26, s26, 6144
  s_add_u32 s27, s27, s26
  s_add_u32 s27, s27, 75497472
  s_add_u32 s80, s27, s28
  s_add_u32 s81, s27, s87
  s_add_u32 s26, s24, 1048576
  v_add_u32 v26, s26, v27
  s_add_u32 s26, s24, 12582912
  v_add_u32 v43, s26, v27
  v_lshrrev_b32 v8, 3, v2
  v_and_b32 v9, 3, v8
  v_lshlrev_b32 v21, 4, v9
  v_lshrrev_b32 v9, 2, v8
  v_lshl_add_u32 v21, v9, 3, v21
  v_lshl_add_u32 v21, v5, 7, v21
  v_add_u32 v21, 10240, v21
  v_and_b32 v9, 1, v8
  v_lshlrev_b32 v22, 2, v9
  v_lshrrev_b32 v9, 1, v8
  v_add_u32 v22, v22, v9
  v_lshlrev_b32 v22, 1, v22
  v_lshl_add_u32 v22, v5, 7, v22
  v_add_u32 v22, 10304, v22
  v_lshrrev_b32 v23, 1, v8
  v_lshlrev_b32 v28, 7, v5
  v_lshl_add_u32 v29, v3, 3, v28
  v_add_u32 v29, 10304, v29
  v_lshl_add_u32 v28, v3, 4, v28
  v_add_u32 v28, 10240, v28
  s_lshl_b32 s26, s4, 10
  s_add_u32 s26, s26, 11264
  v_add_u32 v30, s26, v7
  v_add_u32 v31, 14336, v6
  s_lshl_b32 s26, s4, 10
  v_add_u32 v32, s26, v31
  s_add_u32 s27, s29, 0
  s_lshl_b32 s27, s27, 2
  s_mul_i32 s26, s7, 40
  s_add_u32 s27, s27, s26
  v_add_u32 v9, s27, v3
  v_mul_u32_u24 v6, 52429, v9
  v_lshrrev_b32 v6, 18, v6
  v_mul_u32_u24 v7, 5, v6
  v_sub_u32 v7, v9, v7
  s_lshl_b32 s27, s3, 5
  v_add_u32 v6, s27, v6
  v_lshlrev_b32 v6, 3, v6
  v_add_u32 v6, s6, v6
  v_mul_u32_u24 v6, 640, v6
  v_lshl_add_u32 v7, v7, 3, v5
  v_lshl_add_u32 v6, v7, 4, v6
  v_add_u32 v35, 1572864, v6
  s_add_u32 s27, s29, 1
  s_lshl_b32 s27, s27, 2
  s_mul_i32 s26, s7, 40
  s_add_u32 s27, s27, s26
  v_add_u32 v9, s27, v3
  v_mul_u32_u24 v6, 52429, v9
  v_lshrrev_b32 v6, 18, v6
  v_mul_u32_u24 v7, 5, v6
  v_sub_u32 v7, v9, v7
  s_lshl_b32 s27, s3, 5
  v_add_u32 v6, s27, v6
  v_lshlrev_b32 v6, 3, v6
  v_add_u32 v6, s6, v6
  v_mul_u32_u24 v6, 640, v6
  v_lshl_add_u32 v7, v7, 3, v5
  v_lshl_add_u32 v6, v7, 4, v6
  v_add_u32 v36, 1572864, v6
  s_add_u32 s27, s29, 2
  s_lshl_b32 s27, s27, 2
  s_mul_i32 s26, s7, 40
  s_add_u32 s27, s27, s26
  v_add_u32 v9, s27, v3
  v_mul_u32_u24 v6, 52429, v9
  v_lshrrev_b32 v6, 18, v6
  v_mul_u32_u24 v7, 5, v6
  v_sub_u32 v7, v9, v7
  s_lshl_b32 s27, s3, 5
  v_add_u32 v6, s27, v6
  v_lshlrev_b32 v6, 3, v6
  v_add_u32 v6, s6, v6
  v_mul_u32_u24 v6, 640, v6
  v_lshl_add_u32 v7, v7, 3, v5
  v_lshl_add_u32 v6, v7, 4, v6
  v_add_u32 v37, 1572864, v6
  v_min_u32 v7, 39, v2
  v_lshlrev_b32 v6, 4, v7
  s_lshl_b32 s27, s3, 5
  s_add_u32 s27, s27, s5
  s_mul_i32 s27, s27, 5120
  s_add_u32 s27, s27, 1572864
  v_add_u32 v38, s27, v6
  s_mul_i32 s28, s5, 43
  s_lshr_b32 s28, s28, 7
  s_mul_i32 s26, s28, 3
  s_sub_u32 s26, s5, s26
  s_mul_i32 s26, s26, 2560
  s_lshl_b32 s28, s28, 14
  s_add_u32 s27, s28, s26
  s_add_u32 s27, s27, 237371392
  v_add_u32 v39, s27, v6
  s_mul_i32 s28, s3, 640
  v_add_u32 v40, s28, v39
  v_and_b32 v8, 7, v7
  v_lshrrev_b32 v9, 3, v7
  s_mul_i32 s27, s5, 5
  v_add_u32 v9, s27, v9
  v_lshrrev_b32 v6, 3, v9
  v_lshlrev_b32 v6, 9, v6
  v_and_b32 v7, 3, v9
  v_lshl_add_u32 v6, v7, 7, v6
  v_lshl_add_u32 v6, v8, 4, v6
  v_bfe_u32 v7, v9, 2, 1
  v_lshl_add_u32 v6, v7, 3, v6
  s_mul_i32 s27, s3, 40960
  s_add_u32 s27, s27, 65536
  v_add_u32 v41, s27, v6
  s_mul_i32 s26, s7, 3
  s_add_u32 s26, s26, s4
  s_lshr_b32 s27, s26, 1
  s_lshl_b32 s27, s27, 10
  s_and_b32 s26, s26, 1
  s_lshl_b32 s26, s26, 3
  s_add_u32 s26, s26, s27
  s_mul_i32 s27, s20, 12288
  s_add_u32 s26, s26, s27
  s_add_u32 s26, s26, 75497472
  v_add_u32 v42, s26, v27
  s_lshl_b32 s26, s4, 12
  s_add_u32 s26, s26, s27
  s_add_u32 s26, s26, 100663296
  v_add_u32 v44, s26, v27
  v_mov_b32 v48, -1
  v_mov_b32 v49, -1
  v_mov_b32 v50, -1
  v_mov_b32 v51, -1
  v_mov_b32 v52, 0
  v_mov_b32 v53, 0
  v_mov_b32 v54, 0
  v_mov_b32 v55, 0
  v_add_u32 v6, 10240, v27
  ds_write_b128 v6, v[52:55]
  s_waitcnt lgkmcnt(0)
  s_barrier
  s_mov_b32 s40, 0
  s_mov_b32 s41, 0
  s_mov_b32 s47, 0
  v_mov_b32 v52, v47
  v_add_u32 v42, s80, v27
  v_add_u32 v53, s81, v27
  s_mul_i32 s26, s20, 3072
  s_add_u32 s26, s26, 236978176
  v_add_u32 v45, s26, v27
  s_cmp_eq_u32 s4, 3
  s_cbranch_scc1 K3_kvd_n
  s_mul_i32 s26, s20, 12288
  s_add_u32 s27, s26, 100663296
  v_add_u32 v18, s27, v27
  s_and_b32 s26, s4, 1
  s_mul_i32 s26, s26, 6144
  s_sub_u32 s27, s80, s26
  v_add_u32 v19, s27, v27
  s_sub_u32 s27, s81, s26
  s_and_b32 s28, s27, 8
  s_andn2_b32 s27, s27, 8
  v_add_u32 v24, s27, v27
  s_lshl_b32 s26, s4, 12
  s_add_u32 s26, s26, 32768
  v_add_u32 v44, s26, v27
  s_and_b32 s26, s4, 1
  s_lshl_b32 s26, s26, 11
  s_add_u32 s26, s26, 45056
  v_add_u32 v42, s26, v27
  s_add_u32 s26, s26, s28
  s_add_u32 s26, s26, 1024
  v_add_u32 v53, s26, v27
  s_mov_b32 s93, 32768
K3_kvd_n:
  s_mov_b32 s94, 16384
  s_cmp_eq_u32 s4, 2
  s_cbranch_scc0 K3_kvd_m
  s_mov_b32 s94, 0
  v_add_u32 v42, 2048, v25
  v_add_u32 v53, 2048, v16
K3_kvd_m:
  s_cmp_eq_u32 s4, 3
  s_cbranch_scc0 K3_lw_n
  s_mul_i32 s26, s20, 12288
  s_add_u32 s27, s26, 100663296
  v_add_u32 v42, s27, v27
  s_sub_u32 s27, s80, 6144
  v_add_u32 v43, s27, v27
  s_sub_u32 s27, s81, 6144
  s_andn2_b32 s27, s27, 8
  v_add_u32 v44, s27, v27
  s_mov_b32 s93, 49152
  v_mov_b32 v45, 0
  v_mov_b32 v46, 4587520
  s_min_u32 s26, s7, 2
  s_lshl_b32 s26, s26, 10
  s_mul_i32 s27, s20, 3072
  s_add_u32 s27, s27, s26
  s_add_u32 s27, s27, 12582912
  v_add_u32 v47, s27, v27
  s_add_u32 s26, s26, 11264
  v_add_u32 v52, s26, v27
  v_and_b32 v7, 1, v2
  v_lshlrev_b32 v7, 6, v7
  v_add_u32 v46, v46, v7
  v_mov_b32 v53, 24576
K3_lw_n:
  s_mul_i32 s26, s20, 12288
  s_mul_i32 s27, s7, 3072
  s_add_u32 s26, s26, s27
  s_mul_i32 s27, s4, 1024
  s_add_u32 s26, s26, s27
  s_add_u32 s84, s26, 100663296
  s_add_u32 s85, s26, 75497472
  v_mov_b32 v6, 24576
  v_mov_b32 v7, 0
  ds_write_b32 v6, v7
  s_waitcnt lgkmcnt(0)
  s_barrier
  s_cmp_eq_u32 s4, 3
  s_cbranch_scc0 K3_rsm_n
  s_lshl_b32 s26, s3, 5
  s_lshl_b32 s27, s7, 3
  s_add_u32 s26, s26, s27
  s_mul_i32 s26, s26, 5120
  s_mul_i32 s27, s6, 640
  s_add_u32 s26, s26, s27
  s_add_u32 s26, s26, 1572864
  v_add_u32 v6, 0, v2
  v_mul_u32_u24 v7, 1639, v6
  v_lshrrev_b32 v7, 16, v7
  v_mul_u32_u24 v8, 40, v7
  v_sub_u32 v8, v6, v8
  v_mul_u32_u24 v7, 5120, v7
  v_lshl_add_u32 v7, v8, 4, v7
  v_add_u32 v20, s26, v7
  v_add_u32 v6, 64, v2
  v_mul_u32_u24 v7, 1639, v6
  v_lshrrev_b32 v7, 16, v7
  v_mul_u32_u24 v8, 40, v7
  v_sub_u32 v8, v6, v8
  v_mul_u32_u24 v7, 5120, v7
  v_lshl_add_u32 v7, v8, 4, v7
  v_add_u32 v21, s26, v7
  v_add_u32 v6, 128, v2
  v_mul_u32_u24 v7, 1639, v6
  v_lshrrev_b32 v7, 16, v7
  v_mul_u32_u24 v8, 40, v7
  v_sub_u32 v8, v6, v8
  v_mul_u32_u24 v7, 5120, v7
  v_lshl_add_u32 v7, v8, 4, v7
  v_add_u32 v22, s26, v7
  v_add_u32 v6, 192, v2
  v_mul_u32_u24 v7, 1639, v6
  v_lshrrev_b32 v7, 16, v7
  v_mul_u32_u24 v8, 40, v7
  v_sub_u32 v8, v6, v8
  v_mul_u32_u24 v7, 5120, v7
  v_lshl_add_u32 v7, v8, 4, v7
  v_add_u32 v23, s26, v7
  v_add_u32 v6, 256, v2
  v_mul_u32_u24 v7, 1639, v6
  v_lshrrev_b32 v7, 16, v7
  v_mul_u32_u24 v8, 40, v7
  v_sub_u32 v8, v6, v8
  v_mul_u32_u24 v7, 5120, v7
  v_lshl_add_u32 v7, v8, 4, v7
  v_add_u32 v26, s26, v7
  s_mul_i32 s26, s20, 12288
  s_lshl_b32 s27, s7, 10
  s_add_u32 s26, s26, s27
  s_add_u32 s26, s26, 234881024
  v_add_u32 v28, s26, v27
  s_mul_i32 s26, s20, 3072
  s_lshl_b32 s27, s7, 8
  s_add_u32 s26, s26, s27
  s_add_u32 s26, s26, 236978176
  v_add_u32 v29, s26, v27
K3_rsm_n:
  s_mov_b32 s36, 0
  s_mov_b32 s37, 0
  s_mov_b32 s38, 512
  v_mov_b32 v33, 0
  v_mov_b32 v34, 4587520
  s_cmp_eq_u32 s4, 3
  s_cbranch_scc0 K3_ncw
  v_mov_b32 v252, 224
K3_cw_w:
  buffer_load_dword v253, v252, s[12:15], 0 offen sc1
  s_waitcnt vmcnt(0)
  v_readfirstlane_b32 s57, v253
  s_nop 0
  s_cmp_eq_u32 s57, 0
  s_cbranch_scc0 K3_cw_ok
  s_sleep 24
  s_add_u32 s41, s41, 32
  s_cmp_lt_u32 s41, 4000000
  s_cbranch_scc1 K3_cw_w
  s_mov_b32 s57, 1
K3_cw_ok:
  s_sub_u32 s57, s57, 1
  s_and_b32 s57, s57, 1
  s_lshl_b32 s57, s57, 13
  v_add_u32 v39, s57, v39
  v_add_u32 v40, s57, v40
  s_xor_b32 s27, s3, 1
  s_mul_i32 s27, s27, 640
  v_add_u32 v25, s27, v39
  s_xor_b32 s27, s3, 2
  s_mul_i32 s27, s27, 640
  v_add_u32 v33, s27, v39
  s_xor_b32 s27, s3, 3
  s_mul_i32 s27, s27, 640
  v_add_u32 v34, s27, v39
K3_ncw:
  s_cmp_eq_u32 s4, 0
  s_cbranch_scc0 K3_gI_ok
  v_mov_b32 v252, 64
K3_gI_w:
  buffer_load_dword v253, v252, s[12:15], 0 offen sc1
  s_waitcnt vmcnt(0)
  v_readfirstlane_b32 s57, v253
  s_nop 0
  s_cmp_ge_u32 s57, 128
  s_cbranch_scc1 K3_gI_ok
  s_sleep 36
  s_add_u32 s41, s41, 64
  s_cmp_lt_u32 s41, 4000000
  s_cbranch_scc1 K3_gI_w
K3_gI_ok:
  s_barrier
  s_cmp_eq_u32 s4, 3
  s_cbranch_scc1 K3_i1
  v_mov_b32 v196, 4587520
K3_g0_w:
  buffer_load_dword v197, v196, s[8:11], s47 offen sc1
  s_waitcnt vmcnt(0)
  v_readfirstlane_b32 s57, v197
  s_nop 0
  s_cmp_ge_u32 s57, 64
  s_cbranch_scc1 K3_g0_ok
  s_sleep 4
  s_add_u32 s41, s41, 1
  s_cmp_lt_u32 s41, 4000000
  s_cbranch_scc1 K3_g0_w
K3_g0_ok:
  s_cmp_eq_u32 s4, 2
  s_cbranch_scc0 K3_i1
  s_add_u32 m0, s93, 0
  s_add_u32 s48, s47, 0
  buffer_load_dwordx4 v18, s[8:11], s48 offen offset:0 sc1 lds
  buffer_load_dwordx4 v18, s[8:11], s48 offen offset:1024 sc1 lds
  buffer_load_dwordx4 v18, s[8:11], s48 offen offset:2048 sc1 lds
  buffer_load_dwordx4 v18, s[8:11], s48 offen offset:3072 sc1 lds
  s_add_u32 m0, s93, 4096
  s_add_u32 s48, s47, 4096
  buffer_load_dwordx4 v18, s[8:11], s48 offen offset:0 sc1 lds
  buffer_load_dwordx4 v18, s[8:11], s48 offen offset:1024 sc1 lds
  buffer_load_dwordx4 v18, s[8:11], s48 offen offset:2048 sc1 lds
  buffer_load_dwordx4 v18, s[8:11], s48 offen offset:3072 sc1 lds
  s_add_u32 m0, s93, 8192
  s_add_u32 s48, s47, 8192
  buffer_load_dwordx4 v18, s[8:11], s48 offen offset:0 sc1 lds
  buffer_load_dwordx4 v18, s[8:11], s48 offen offset:1024 sc1 lds
  buffer_load_dwordx4 v18, s[8:11], s48 offen offset:2048 sc1 lds
  buffer_load_dwordx4 v18, s[8:11], s48 offen offset:3072 sc1 lds
  s_add_u32 s48, s47, 0
  s_add_u32 m0, s93, 12288
  s_nop 0
  buffer_load_dwordx4 v19, s[8:11], s48 offen sc1 lds
  s_add_u32 m0, s93, 13312
  s_nop 0
  buffer_load_dwordx4 v24, s[8:11], s48 offen sc1 lds
  s_add_u32 s48, s47, 6144
  s_add_u32 m0, s93, 14336
  s_nop 0
  buffer_load_dwordx4 v19, s[8:11], s48 offen sc1 lds
  s_add_u32 m0, s93, 15360
  s_nop 0
  buffer_load_dwordx4 v24, s[8:11], s48 offen sc1 lds
  s_xor_b32 s93, s93, 16384
K3_i1:
  s_cmp_eq_u32 s4, 3
  s_cbranch_scc1 K3_W3
  s_and_b32 s42, s40, 3
  s_add_u32 s43, s40, 2
  s_and_b32 s43, s43, 3
  s_add_u32 s44, s40, 1
  s_and_b32 s44, s44, 3
  s_add_u32 s45, s40, 3
  s_and_b32 s45, s45, 3
  s_mul_i32 s46, s42, 10240
  s_branch K3_step
K3_top:
  s_barrier
K3_step:
  buffer_load_dwordx4 v[76:79], v10, s[8:11], s46 offen offset:0 sc1
  buffer_load_dwordx4 v[80:83], v10, s[8:11], s46 offen offset:512 sc1
  buffer_load_dwordx4 v[84:87], v10, s[8:11], s46 offen offset:1024 sc1
  buffer_load_dwordx4 v[88:91], v10, s[8:11], s46 offen offset:1536 sc1
  buffer_load_dwordx4 v[92:95], v10, s[8:11], s46 offen offset:2048 sc1
  s_sleep 1
  s_sleep 1
  buffer_load_dwordx4 v[96:99], v10, s[8:11], s46 offen offset:0 sc1
  buffer_load_dwordx4 v[100:103], v10, s[8:11], s46 offen offset:512 sc1
  buffer_load_dwordx4 v[104:107], v10, s[8:11], s46 offen offset:1024 sc1
  buffer_load_dwordx4 v[108:111], v10, s[8:11], s46 offen offset:1536 sc1
  buffer_load_dwordx4 v[112:115], v10, s[8:11], s46 offen offset:2048 sc1
K3_c_l0:
  s_waitcnt vmcnt(5)
  v_max3_u32 v188, v76, v78, v80
  v_max3_u32 v188, v188, v82, v84
  v_max3_u32 v188, v188, v86, v88
  v_max3_u32 v188, v188, v90, v92
  v_max_u32 v188, v188, v94
  v_cmp_eq_u32 vcc, -1, v188
  s_cbranch_vccnz K3_c_r0
  s_mov_b64 exec, s[96:97]
  ds_write_b128 v11, v[76:79] offset:0
  ds_write_b128 v11, v[80:83] offset:512
  ds_write_b128 v11, v[84:87] offset:1024
  ds_write_b128 v11, v[88:91] offset:1536
  ds_write_b128 v11, v[92:95] offset:2048
  s_mov_b64 exec, -1
  v_mfma_f32_16x16x32_bf16 v[176:179], a[0:3], v[76:79], 0
  v_mfma_f32_16x16x32_bf16 v[180:183], a[80:83], v[76:79], 0
  v_mfma_f32_16x16x32_bf16 v[176:179], a[4:7], v[80:83], v[176:179]
  v_mfma_f32_16x16x32_bf16 v[180:183], a[84:87], v[80:83], v[180:183]
  v_mfma_f32_16x16x32_bf16 v[176:179], a[8:11], v[84:87], v[176:179]
  v_mfma_f32_16x16x32_bf16 v[180:183], a[88:91], v[84:87], v[180:183]
  v_mfma_f32_16x16x32_bf16 v[176:179], a[12:15], v[88:91], v[176:179]
  v_mfma_f32_16x16x32_bf16 v[180:183], a[92:95], v[88:91], v[180:183]
  v_mfma_f32_16x16x32_bf16 v[176:179], a[16:19], v[92:95], v[176:179]
  v_mfma_f32_16x16x32_bf16 v[180:183], a[96:99], v[92:95], v[180:183]
  s_branch K3_c_done
K3_c_r1:
  buffer_load_dwordx4 v[96:99], v10, s[8:11], s46 offen offset:0 sc1
  buffer_load_dwordx4 v[100:103], v10, s[8:11], s46 offen offset:512 sc1
  buffer_load_dwordx4 v[104:107], v10, s[8:11], s46 offen offset:1024 sc1
  buffer_load_dwordx4 v[108:111], v10, s[8:11], s46 offen offset:1536 sc1
  buffer_load_dwordx4 v[112:115], v10, s[8:11], s46 offen offset:2048 sc1
  s_add_u32 s41, s41, 1
  s_cmp_lt_u32 s41, 4000000
  s_cbranch_scc1 K3_c_l0
  s_branch K3_c_done
K3_c_r0:
  buffer_load_dwordx4 v[76:79], v10, s[8:11], s46 offen offset:0 sc1
  buffer_load_dwordx4 v[80:83], v10, s[8:11], s46 offen offset:512 sc1
  buffer_load_dwordx4 v[84:87], v10, s[8:11], s46 offen offset:1024 sc1
  buffer_load_dwordx4 v[88:91], v10, s[8:11], s46 offen offset:1536 sc1
  buffer_load_dwordx4 v[92:95], v10, s[8:11], s46 offen offset:2048 sc1
K3_c_l1:
  s_waitcnt vmcnt(5)
  v_max3_u32 v188, v96, v98, v100
  v_max3_u32 v188, v188, v102, v104
  v_max3_u32 v188, v188, v106, v108
  v_max3_u32 v188, v188, v110, v112
  v_max_u32 v188, v188, v114
  v_cmp_eq_u32 vcc, -1, v188
  s_cbranch_vccnz K3_c_r1
  s_mov_b64 exec, s[96:97]
  ds_write_b128 v11, v[96:99] offset:0
  ds_write_b128 v11, v[100:103] offset:512
  ds_write_b128 v11, v[104:107] offset:1024
  ds_write_b128 v11, v[108:111] offset:1536
  ds_write_b128 v11, v[112:115] offset:2048
  s_mov_b64 exec, -1
  v_mfma_f32_16x16x32_bf16 v[176:179], a[0:3], v[96:99], 0
  v_mfma_f32_16x16x32_bf16 v[180:183], a[80:83], v[96:99], 0
  v_mfma_f32_16x16x32_bf16 v[176:179], a[4:7], v[100:103], v[176:179]
  v_mfma_f32_16x16x32_bf16 v[180:183], a[84:87], v[100:103], v[180:183]
  v_mfma_f32_16x16x32_bf16 v[176:179], a[8:11], v[104:107], v[176:179]
  v_mfma_f32_16x16x32_bf16 v[180:183], a[88:91], v[104:107], v[180:183]
  v_mfma_f32_16x16x32_bf16 v[176:179], a[12:15], v[108:111], v[176:179]
  v_mfma_f32_16x16x32_bf16 v[180:183], a[92:95], v[108:111], v[180:183]
  v_mfma_f32_16x16x32_bf16 v[176:179], a[16:19], v[112:115], v[176:179]
  v_mfma_f32_16x16x32_bf16 v[180:183], a[96:99], v[112:115], v[180:183]
K3_c_done:
  s_waitcnt lgkmcnt(0)
  s_barrier
  ds_read_b128 v[116:119], v12 offset:0
  ds_read_b128 v[120:123], v12 offset:512
  ds_read_b128 v[124:127], v12 offset:1024
  ds_read_b128 v[128:131], v12 offset:1536
  ds_read_b128 v[132:135], v12 offset:2048
  ds_read_b128 v[136:139], v13 offset:0
  ds_read_b128 v[140:143], v13 offset:512
  ds_read_b128 v[144:147], v13 offset:1024
  ds_read_b128 v[148:151], v13 offset:1536
  ds_read_b128 v[152:155], v13 offset:2048
  ds_read_b128 v[156:159], v14 offset:0
  ds_read_b128 v[160:163], v14 offset:512
  ds_read_b128 v[164:167], v14 offset:1024
  ds_read_b128 v[168:171], v14 offset:1536
  ds_read_b128 v[172:175], v14 offset:2048
  s_waitcnt lgkmcnt(14)
  v_mfma_f32_16x16x32_bf16 v[176:179], a[20:23], v[116:119], v[176:179]
  v_mfma_f32_16x16x32_bf16 v[180:183], a[100:103], v[116:119], v[180:183]
  s_waitcnt lgkmcnt(13)
  v_mfma_f32_16x16x32_bf16 v[176:179], a[24:27], v[120:123], v[176:179]
  v_mfma_f32_16x16x32_bf16 v[180:183], a[104:107], v[120:123], v[180:183]
  s_waitcnt lgkmcnt(12)
  v_mfma_f32_16x16x32_bf16 v[176:179], a[28:31], v[124:127], v[176:179]
  v_mfma_f32_16x16x32_bf16 v[180:183], a[108:111], v[124:127], v[180:183]
  s_waitcnt lgkmcnt(11)
  v_mfma_f32_16x16x32_bf16 v[176:179], a[32:35], v[128:131], v[176:179]
  v_mfma_f32_16x16x32_bf16 v[180:183], a[112:115], v[128:131], v[180:183]
  s_waitcnt lgkmcnt(10)
  v_mfma_f32_16x16x32_bf16 v[176:179], a[36:39], v[132:135], v[176:179]
  v_mfma_f32_16x16x32_bf16 v[180:183], a[116:119], v[132:135], v[180:183]
  s_waitcnt lgkmcnt(9)
  v_mfma_f32_16x16x32_bf16 v[176:179], a[40:43], v[136:139], v[176:179]
  v_mfma_f32_16x16x32_bf16 v[180:183], a[120:123], v[136:139], v[180:183]
  s_waitcnt lgkmcnt(8)
  v_mfma_f32_16x16x32_bf16 v[176:179], a[44:47], v[140:143], v[176:179]
  v_mfma_f32_16x16x32_bf16 v[180:183], a[124:127], v[140:143], v[180:183]
  s_waitcnt lgkmcnt(7)
  v_mfma_f32_16x16x32_bf16 v[176:179], a[48:51], v[144:147], v[176:179]
  v_mfma_f32_16x16x32_bf16 v[180:183], a[128:131], v[144:147], v[180:183]
  s_waitcnt lgkmcnt(6)
  v_mfma_f32_16x16x32_bf16 v[176:179], a[52:55], v[148:151], v[176:179]
  v_mfma_f32_16x16x32_bf16 v[180:183], a[132:135], v[148:151], v[180:183]
  s_waitcnt lgkmcnt(5)
  v_mfma_f32_16x16x32_bf16 v[176:179], a[56:59], v[152:155], v[176:179]
  v_mfma_f32_16x16x32_bf16 v[180:183], a[136:139], v[152:155], v[180:183]
  s_waitcnt lgkmcnt(4)
  v_mfma_f32_16x16x32_bf16 v[176:179], a[60:63], v[156:159], v[176:179]
  v_mfma_f32_16x16x32_bf16 v[180:183], a[140:143], v[156:159], v[180:183]
  s_waitcnt lgkmcnt(3)
  v_mfma_f32_16x16x32_bf16 v[176:179], a[64:67], v[160:163], v[176:179]
  v_mfma_f32_16x16x32_bf16 v[180:183], a[144:147], v[160:163], v[180:183]
  s_waitcnt lgkmcnt(2)
  v_mfma_f32_16x16x32_bf16 v[176:179], a[68:71], v[164:167], v[176:179]
  v_mfma_f32_16x16x32_bf16 v[180:183], a[148:151], v[164:167], v[180:183]
  s_waitcnt lgkmcnt(1)
  v_mfma_f32_16x16x32_bf16 v[176:179], a[72:75], v[168:171], v[176:179]
  v_mfma_f32_16x16x32_bf16 v[180:183], a[152:155], v[168:171], v[180:183]
  s_waitcnt lgkmcnt(0)
  v_mfma_f32_16x16x32_bf16 v[176:179], a[76:79], v[172:175], v[176:179]
  v_mfma_f32_16x16x32_bf16 v[180:183], a[156:159], v[172:175], v[180:183]
  s_nop 6
  v_cvt_pk_bf16_f32 v188, v176, v177
  v_cvt_pk_bf16_f32 v189, v178, v179
  v_cvt_pk_bf16_f32 v190, v180, v181
  v_cvt_pk_bf16_f32 v191, v182, v183
  s_mul_i32 s47, s40, 98304
  ds_write_b64 v52, v[188:189]
  ds_write_b64 v52, v[190:191] offset:2048
  s_lshr_b32 s46, s42, 1
  s_mul_i32 s46, s46, s88
  s_and_b32 s57, s42, 1
  s_mul_i32 s57, s57, s89
  s_add_u32 s46, s46, s57
  s_lshr_b32 s52, s42, 1
  s_mul_i32 s52, s52, 98304
  s_and_b32 s57, s42, 1
  s_lshl_b32 s57, s57, 10
  s_add_u32 s52, s52, s57
  s_waitcnt lgkmcnt(0)
  s_barrier
  s_cmp_eq_u32 s40, 63
  s_cbranch_scc1 K3_last
  ds_read_b128 v[116:119], v25
  ds_read_b128 v[56:59], v42
  ds_read_b64 v[120:121], v16
  ds_read_b64 v[54:55], v53
  s_waitcnt lgkmcnt(2)
  v_mfma_f32_16x16x32_bf16 v[124:127], v[56:59], v[116:119], 0
  s_waitcnt lgkmcnt(0)
  s_nop 4
  v_mfma_f32_16x16x16_bf16 v[124:127], v[54:55], v[120:121], v[124:127]
  s_mov_b32 exec_lo, 0x00ff00ff
  s_mov_b32 exec_hi, s91
  s_nop 5
  buffer_store_dwordx4 v[124:127], v15, s[8:11], s46 offen
  s_mov_b64 exec, -1
  ds_read_b128 v[60:63], v44 offset:0
  ds_read_b128 v[64:67], v44 offset:1024
  ds_read_b128 v[68:71], v44 offset:2048
  ds_read_b128 v[72:75], v44 offset:3072
  v_xor_b32 v44, 16384, v44
  v_xor_b32 v42, s94, v42
  v_xor_b32 v53, s94, v53
  v_mov_b32 v46, v190
  v_mov_b32 v47, v191
  s_cmp_eq_u32 s4, 0
  s_cbranch_scc1 K3_sm
  s_cmp_eq_u32 s4, 1
  s_cbranch_scc0 K3_w2x
  s_mul_i32 s46, s42, 98304
  buffer_load_dwordx4 v[200:203], v26, s[8:11], s46 offen offset:0 sc1
  buffer_load_dwordx4 v[204:207], v26, s[8:11], s46 offen offset:1024 sc1
  buffer_load_dwordx4 v[208:211], v26, s[8:11], s46 offen offset:2048 sc1
  s_sleep 1
  s_sleep 1
  buffer_load_dwordx4 v[212:215], v26, s[8:11], s46 offen offset:0 sc1
  buffer_load_dwordx4 v[216:219], v26, s[8:11], s46 offen offset:1024 sc1
  buffer_load_dwordx4 v[220:223], v26, s[8:11], s46 offen offset:2048 sc1
K3_pv_l0:
  s_waitcnt vmcnt(3)
  v_max3_u32 v192, v200, v201, v202
  v_max3_u32 v192, v192, v203, v204
  v_max3_u32 v192, v192, v205, v206
  v_max3_u32 v192, v192, v207, v208
  v_max3_u32 v192, v192, v209, v210
  v_max_u32 v192, v192, v211
  v_cmp_eq_u32 vcc, -1, v192
  s_cbranch_vccnz K3_pv_r0
  ds_write_b128 v27, v[200:203] offset:11264
  ds_write_b128 v27, v[204:207] offset:12288
  ds_write_b128 v27, v[208:211] offset:13312
  s_branch K3_pv_done
K3_pv_r1:
  buffer_load_dwordx4 v[212:215], v26, s[8:11], s46 offen offset:0 sc1
  buffer_load_dwordx4 v[216:219], v26, s[8:11], s46 offen offset:1024 sc1
  buffer_load_dwordx4 v[220:223], v26, s[8:11], s46 offen offset:2048 sc1
  s_add_u32 s41, s41, 1
  s_cmp_lt_u32 s41, 4000000
  s_cbranch_scc1 K3_pv_l0
  s_branch K3_pv_done
K3_pv_r0:
  buffer_load_dwordx4 v[200:203], v26, s[8:11], s46 offen offset:0 sc1
  buffer_load_dwordx4 v[204:207], v26, s[8:11], s46 offen offset:1024 sc1
  buffer_load_dwordx4 v[208:211], v26, s[8:11], s46 offen offset:2048 sc1
K3_pv_l1:
  s_waitcnt vmcnt(3)
  v_max3_u32 v192, v212, v213, v214
  v_max3_u32 v192, v192, v215, v216
  v_max3_u32 v192, v192, v217, v218
  v_max3_u32 v192, v192, v219, v220
  v_max3_u32 v192, v192, v221, v222
  v_max_u32 v192, v192, v223
  v_cmp_eq_u32 vcc, -1, v192
  s_cbranch_vccnz K3_pv_r1
  ds_write_b128 v27, v[212:215] offset:11264
  ds_write_b128 v27, v[216:219] offset:12288
  ds_write_b128 v27, v[220:223] offset:13312
K3_pv_done:
  s_branch K3_b2
K3_w2x:
  s_cmp_eq_u32 s40, 0
  s_cbranch_scc0 K3_pto_n
  s_lshl_b32 s48, s3, 5
  s_lshl_b32 s57, s7, 3
  s_add_u32 s48, s48, s57
  s_mul_i32 s48, s48, 5120
  s_mul_i32 s57, s6, 640
  s_add_u32 s48, s48, s57
  s_add_u32 s48, s48, 1572864
  v_add_u32 v205, 0, v2
  v_mul_u32_u24 v206, 1639, v205
  v_lshrrev_b32 v206, 16, v206
  v_mul_u32_u24 v207, 40, v206
  v_sub_u32 v207, v205, v207
  v_mul_u32_u24 v206, 5120, v206
  v_lshl_add_u32 v206, v207, 4, v206
  v_add_u32 v200, s48, v206
  v_add_u32 v205, 64, v2
  v_mul_u32_u24 v206, 1639, v205
  v_lshrrev_b32 v206, 16, v206
  v_mul_u32_u24 v207, 40, v206
  v_sub_u32 v207, v205, v207
  v_mul_u32_u24 v206, 5120, v206
  v_lshl_add_u32 v206, v207, 4, v206
  v_add_u32 v201, s48, v206
  v_add_u32 v205, 128, v2
  v_mul_u32_u24 v206, 1639, v205
  v_lshrrev_b32 v206, 16, v206
  v_mul_u32_u24 v207, 40, v206
  v_sub_u32 v207, v205, v207
  v_mul_u32_u24 v206, 5120, v206
  v_lshl_add_u32 v206, v207, 4, v206
  v_add_u32 v202, s48, v206
  v_add_u32 v205, 192, v2
  v_mul_u32_u24 v206, 1639, v205
  v_lshrrev_b32 v206, 16, v206
  v_mul_u32_u24 v207, 40, v206
  v_sub_u32 v207, v205, v207
  v_mul_u32_u24 v206, 5120, v206
  v_lshl_add_u32 v206, v207, 4, v206
  v_add_u32 v203, s48, v206
  v_add_u32 v205, 256, v2
  v_mul_u32_u24 v206, 1639, v205
  v_lshrrev_b32 v206, 16, v206
  v_mul_u32_u24 v207, 40, v206
  v_sub_u32 v207, v205, v207
  v_mul_u32_u24 v206, 5120, v206
  v_lshl_add_u32 v206, v207, 4, v206
  v_add_u32 v204, s48, v206
  s_mov_b32 s48, 655360
  buffer_load_dwordx4 v[208:211], v200, s[8:11], s48 offen
  buffer_load_dwordx4 v[208:211], v201, s[8:11], s48 offen
  buffer_load_dwordx4 v[208:211], v202, s[8:11], s48 offen
  buffer_load_dwordx4 v[208:211], v203, s[8:11], s48 offen
  buffer_load_dwordx4 v[208:211], v204, s[8:11], s48 offen
  s_mov_b32 s48, 1310720
  buffer_load_dwordx4 v[208:211], v200, s[8:11], s48 offen
  buffer_load_dwordx4 v[208:211], v201, s[8:11], s48 offen
  buffer_load_dwordx4 v[208:211], v202, s[8:11], s48 offen
  buffer_load_dwordx4 v[208:211], v203, s[8:11], s48 offen
  buffer_load_dwordx4 v[208:211], v204, s[8:11], s48 offen
  s_mov_b32 s48, 1966080
  buffer_load_dwordx4 v[208:211], v200, s[8:11], s48 offen
  buffer_load_dwordx4 v[208:211], v201, s[8:11], s48 offen
  buffer_load_dwordx4 v[208:211], v202, s[8:11], s48 offen
  buffer_load_dwordx4 v[208:211], v203, s[8:11], s48 offen
  buffer_load_dwordx4 v[208:211], v204, s[8:11], s48 offen
  s_mul_i32 s48, s20, 12288
  s_lshl_b32 s57, s7, 10
  s_add_u32 s48, s48, s57
  s_add_u32 s48, s48, 234881024
  s_add_u32 s57, s48, 4096
  buffer_load_dwordx4 v[208:211], v27, s[8:11], s57 offen
  s_add_u32 s57, s48, 393216
  buffer_load_dwordx4 v[208:211], v27, s[8:11], s57 offen
  s_add_u32 s57, s48, 397312
  buffer_load_dwordx4 v[208:211], v27, s[8:11], s57 offen
  s_mul_i32 s48, s20, 3072
  s_lshl_b32 s57, s7, 8
  s_add_u32 s48, s48, s57
  s_add_u32 s48, s48, 236978176
  s_mov_b64 exec, 0xffff
  s_add_u32 s57, s48, 1024
  buffer_load_dwordx4 v[208:211], v27, s[8:11], s57 offen
  s_add_u32 s57, s48, 98304
  buffer_load_dwordx4 v[208:211], v27, s[8:11], s57 offen
  s_add_u32 s57, s48, 99328
  buffer_load_dwordx4 v[208:211], v27, s[8:11], s57 offen
  s_mul_i32 s48, s20, 3072
  s_mul_i32 s57, s7, 768
  s_add_u32 s48, s48, s57
  s_add_u32 s48, s48, 1048576
  s_mov_b32 exec_lo, -1
  s_mov_b32 exec_hi, 0xffff
  s_add_u32 s57, s48, 98304
  buffer_load_dwordx4 v[208:211], v27, s[8:11], s57 offen
  s_add_u32 s57, s48, 196608
  buffer_load_dwordx4 v[208:211], v27, s[8:11], s57 offen
  s_add_u32 s57, s48, 294912
  buffer_load_dwordx4 v[208:211], v27, s[8:11], s57 offen
  s_mul_i32 s48, s3, 40960
  s_mul_i32 s57, s5, 320
  s_add_u32 s48, s48, s57
  s_add_u32 s48, s48, 65536
  s_mov_b32 exec_lo, 0xfffff
  s_mov_b32 exec_hi, 0
  s_add_u32 s57, s48, 10240
  buffer_load_dwordx4 v[208:211], v27, s[8:11], s57 offen
  s_add_u32 s57, s48, 20480
  buffer_load_dwordx4 v[208:211], v27, s[8:11], s57 offen
  s_add_u32 s57, s48, 30720
  buffer_load_dwordx4 v[208:211], v27, s[8:11], s57 offen
  s_mov_b64 exec, -1
K3_pto_n:
  s_branch K3_b2
  v_readfirstlane_b32 s57, v33
  s_nop 0
  s_cmp_ge_u32 s57, 64
  s_cbranch_scc1 K3_gnk
  s_add_u32 s58, s40, 1
  s_lshl_b32 s58, s58, 6
  v_mov_b32 v196, 4587520
K3_gn_w:
  buffer_load_dword v197, v196, s[8:11], s58 offen sc1
  s_waitcnt vmcnt(0)
  v_readfirstlane_b32 s57, v197
  s_nop 0
  s_cmp_ge_u32 s57, 64
  s_cbranch_scc1 K3_gn_ok
  s_sleep 4
  s_add_u32 s41, s41, 1
  s_cmp_lt_u32 s41, 4000000
  s_cbranch_scc1 K3_gn_w
K3_gn_ok:
K3_gnk:
  s_add_u32 s50, s40, 1
  s_mul_i32 s50, s50, 393216
  s_add_u32 m0, s93, 0
  s_add_u32 s48, s50, 0
  buffer_load_dwordx4 v18, s[8:11], s48 offen offset:0 sc1 lds
  buffer_load_dwordx4 v18, s[8:11], s48 offen offset:1024 sc1 lds
  buffer_load_dwordx4 v18, s[8:11], s48 offen offset:2048 sc1 lds
  buffer_load_dwordx4 v18, s[8:11], s48 offen offset:3072 sc1 lds
  s_add_u32 m0, s93, 4096
  s_add_u32 s48, s50, 4096
  buffer_load_dwordx4 v18, s[8:11], s48 offen offset:0 sc1 lds
  buffer_load_dwordx4 v18, s[8:11], s48 offen offset:1024 sc1 lds
  buffer_load_dwordx4 v18, s[8:11], s48 offen offset:2048 sc1 lds
  buffer_load_dwordx4 v18, s[8:11], s48 offen offset:3072 sc1 lds
  s_add_u32 m0, s93, 8192
  s_add_u32 s48, s50, 8192
  buffer_load_dwordx4 v18, s[8:11], s48 offen offset:0 sc1 lds
  buffer_load_dwordx4 v18, s[8:11], s48 offen offset:1024 sc1 lds
  buffer_load_dwordx4 v18, s[8:11], s48 offen offset:2048 sc1 lds
  buffer_load_dwordx4 v18, s[8:11], s48 offen offset:3072 sc1 lds
  s_add_u32 s48, s50, 0
  s_add_u32 m0, s93, 12288
  s_nop 0
  buffer_load_dwordx4 v19, s[8:11], s48 offen sc1 lds
  s_add_u32 m0, s93, 13312
  s_nop 0
  buffer_load_dwordx4 v24, s[8:11], s48 offen sc1 lds
  s_add_u32 s48, s50, 6144
  s_add_u32 m0, s93, 14336
  s_nop 0
  buffer_load_dwordx4 v19, s[8:11], s48 offen sc1 lds
  s_add_u32 m0, s93, 15360
  s_nop 0
  buffer_load_dwordx4 v24, s[8:11], s48 offen sc1 lds
  s_xor_b32 s93, s93, 16384
  s_branch K3_b2
K3_sm:
  buffer_load_dwordx4 v[204:207], v45, s[8:11], s52 offen sc1
  buffer_load_dwordx4 v[76:79], v20, s[8:11], s46 offen offset:0 sc1
  buffer_load_dwordx4 v[80:83], v20, s[8:11], s46 offen offset:1024 sc1
  buffer_load_dwordx4 v[84:87], v20, s[8:11], s46 offen offset:2048 sc1
  buffer_load_dwordx4 v[88:91], v20, s[8:11], s46 offen offset:3072 sc1
  s_sleep 1
  s_sleep 1
  s_sleep 1
  buffer_load_dwordx4 v[164:167], v45, s[8:11], s52 offen sc1
  buffer_load_dwordx4 v[216:219], v20, s[8:11], s46 offen offset:0 sc1
  buffer_load_dwordx4 v[220:223], v20, s[8:11], s46 offen offset:1024 sc1
  buffer_load_dwordx4 v[224:227], v20, s[8:11], s46 offen offset:2048 sc1
  buffer_load_dwordx4 v[228:231], v20, s[8:11], s46 offen offset:3072 sc1
K3_p1_l0:
  s_waitcnt vmcnt(5)
  v_pk_add_f32 v[76:77], v[76:77], v[80:81]
  v_pk_add_f32 v[78:79], v[78:79], v[82:83]
  v_pk_add_f32 v[76:77], v[76:77], v[84:85]
  v_pk_add_f32 v[78:79], v[78:79], v[86:87]
  v_pk_add_f32 v[76:77], v[76:77], v[88:89]
  v_pk_add_f32 v[78:79], v[78:79], v[90:91]
  v_add_f32 v193, v76, v77
  v_add_f32 v194, v78, v79
  v_add_f32 v195, v204, v205
  v_add_f32 v193, v193, v194
  v_add_f32 v194, v206, v207
  v_add_f32 v193, v193, v195
  v_add_f32 v193, v193, v194
  v_cmp_u_f32 vcc, v193, v193
  s_cbranch_vccnz K3_p1_r0
  v_mov_b32 v208, v204
  v_mov_b32 v209, v205
  v_mov_b32 v210, v206
  v_mov_b32 v211, v207
  v_permlane32_swap_b32 v204, v208
  v_permlane32_swap_b32 v205, v209
  v_permlane32_swap_b32 v206, v210
  v_permlane32_swap_b32 v207, v211
  v_add_f32 v204, v204, v208
  v_add_f32 v205, v205, v209
  v_add_f32 v206, v206, v210
  v_add_f32 v207, v207, v211
  v_mov_b32 v208, v204
  v_mov_b32 v209, v205
  v_mov_b32 v210, v206
  v_mov_b32 v211, v207
  v_permlane16_swap_b32 v204, v208
  v_permlane16_swap_b32 v205, v209
  v_permlane16_swap_b32 v206, v210
  v_permlane16_swap_b32 v207, v211
  v_add_f32 v204, v204, v208
  v_add_f32 v205, v205, v209
  v_add_f32 v206, v206, v210
  v_add_f32 v207, v207, v211
  v_cmp_eq_u32 vcc, 1, v23
  s_nop 1
  v_cndmask_b32 v192, v204, v205, vcc
  v_cmp_eq_u32 vcc, 2, v23
  s_nop 1
  v_cndmask_b32 v192, v192, v206, vcc
  v_cmp_eq_u32 vcc, 3, v23
  s_nop 1
  v_cndmask_b32 v192, v192, v207, vcc
  v_cvt_pk_bf16_f32 v193, v76, v77
  v_cvt_pk_bf16_f32 v194, v78, v79
  s_branch K3_p1_done
K3_p1_r1:
  buffer_load_dwordx4 v[164:167], v45, s[8:11], s52 offen sc1
  buffer_load_dwordx4 v[216:219], v20, s[8:11], s46 offen offset:0 sc1
  buffer_load_dwordx4 v[220:223], v20, s[8:11], s46 offen offset:1024 sc1
  buffer_load_dwordx4 v[224:227], v20, s[8:11], s46 offen offset:2048 sc1
  buffer_load_dwordx4 v[228:231], v20, s[8:11], s46 offen offset:3072 sc1
  s_add_u32 s41, s41, 1
  s_cmp_lt_u32 s41, 4000000
  s_cbranch_scc1 K3_p1_l0
  s_branch K3_p1_done
K3_p1_r0:
  buffer_load_dwordx4 v[204:207], v45, s[8:11], s52 offen sc1
  buffer_load_dwordx4 v[76:79], v20, s[8:11], s46 offen offset:0 sc1
  buffer_load_dwordx4 v[80:83], v20, s[8:11], s46 offen offset:1024 sc1
  buffer_load_dwordx4 v[84:87], v20, s[8:11], s46 offen offset:2048 sc1
  buffer_load_dwordx4 v[88:91], v20, s[8:11], s46 offen offset:3072 sc1
K3_p1_l1:
  s_waitcnt vmcnt(5)
  v_pk_add_f32 v[216:217], v[216:217], v[220:221]
  v_pk_add_f32 v[218:219], v[218:219], v[222:223]
  v_pk_add_f32 v[216:217], v[216:217], v[224:225]
  v_pk_add_f32 v[218:219], v[218:219], v[226:227]
  v_pk_add_f32 v[216:217], v[216:217], v[228:229]
  v_pk_add_f32 v[218:219], v[218:219], v[230:231]
  v_add_f32 v193, v216, v217
  v_add_f32 v194, v218, v219
  v_add_f32 v195, v164, v165
  v_add_f32 v193, v193, v194
  v_add_f32 v194, v166, v167
  v_add_f32 v193, v193, v195
  v_add_f32 v193, v193, v194
  v_cmp_u_f32 vcc, v193, v193
  s_cbranch_vccnz K3_p1_r1
  v_mov_b32 v168, v164
  v_mov_b32 v169, v165
  v_mov_b32 v170, v166
  v_mov_b32 v171, v167
  v_permlane32_swap_b32 v164, v168
  v_permlane32_swap_b32 v165, v169
  v_permlane32_swap_b32 v166, v170
  v_permlane32_swap_b32 v167, v171
  v_add_f32 v164, v164, v168
  v_add_f32 v165, v165, v169
  v_add_f32 v166, v166, v170
  v_add_f32 v167, v167, v171
  v_mov_b32 v168, v164
  v_mov_b32 v169, v165
  v_mov_b32 v170, v166
  v_mov_b32 v171, v167
  v_permlane16_swap_b32 v164, v168
  v_permlane16_swap_b32 v165, v169
  v_permlane16_swap_b32 v166, v170
  v_permlane16_swap_b32 v167, v171
  v_add_f32 v164, v164, v168
  v_add_f32 v165, v165, v169
  v_add_f32 v166, v166, v170
  v_add_f32 v167, v167, v171
  v_cmp_eq_u32 vcc, 1, v23
  s_nop 1
  v_cndmask_b32 v192, v164, v165, vcc
  v_cmp_eq_u32 vcc, 2, v23
  s_nop 1
  v_cndmask_b32 v192, v192, v166, vcc
  v_cmp_eq_u32 vcc, 3, v23
  s_nop 1
  v_cndmask_b32 v192, v192, v167, vcc
  v_cvt_pk_bf16_f32 v193, v216, v217
  v_cvt_pk_bf16_f32 v194, v218, v219
K3_p1_done:
  v_cvt_pk_bf16_f32 v195, v192, v192
  v_lshlrev_b32 v188, 16, v193
  v_and_b32 v189, 0xffff0000, v193
  v_lshlrev_b32 v190, 16, v194
  v_and_b32 v191, 0xffff0000, v194
  v_lshlrev_b32 v192, 16, v195
  v_mul_f32 v188, 0x3d93cd3a, v188
  v_mul_f32 v189, 0x3d93cd3a, v189
  v_mul_f32 v190, 0x3d93cd3a, v190
  v_mul_f32 v191, 0x3d93cd3a, v191
  v_mul_f32 v192, 0x3d93cd3a, v192
  v_cvt_pk_bf16_f32 v193, v188, v189
  v_lshlrev_b32 v188, 16, v193
  v_and_b32 v189, 0xffff0000, v193
  v_cvt_pk_bf16_f32 v194, v190, v191
  v_lshlrev_b32 v190, 16, v194
  v_and_b32 v191, 0xffff0000, v194
  v_cvt_pk_bf16_f32 v192, v192, v192
  v_lshlrev_b32 v192, 16, v192
  v_max3_f32 v193, v188, v189, v190
  v_max3_f32 v193, v193, v191, v192
  s_nop 1
  v_max_f32_dpp v193, v193, v193 row_ror:8 row_mask:0xf bank_mask:0xf
  v_mov_b32 v194, v193
  s_nop 1
  v_permlane16_swap_b32 v193, v194
  v_max_f32 v193, v193, v194
  v_mov_b32 v194, v193
  s_nop 1
  v_permlane32_swap_b32 v193, v194
  v_max_f32 v193, v193, v194
  v_sub_f32 v188, v188, v193
  v_sub_f32 v189, v189, v193
  v_sub_f32 v190, v190, v193
  v_sub_f32 v191, v191, v193
  v_sub_f32 v192, v192, v193
  v_mul_f32 v188, 0x3fb8aa3b, v188
  v_mul_f32 v189, 0x3fb8aa3b, v189
  v_mul_f32 v190, 0x3fb8aa3b, v190
  v_mul_f32 v191, 0x3fb8aa3b, v191
  v_mul_f32 v192, 0x3fb8aa3b, v192
  v_exp_f32 v188, v188
  v_exp_f32 v189, v189
  v_exp_f32 v190, v190
  v_exp_f32 v191, v191
  v_exp_f32 v192, v192
  v_add_f32 v193, v188, v189
  v_add_f32 v194, v190, v191
  v_add_f32 v193, v193, v192
  v_add_f32 v193, v193, v194
  s_nop 1
  v_add_f32_dpp v193, v193, v193 row_ror:8 row_mask:0xf bank_mask:0xf
  v_mov_b32 v194, v193
  s_nop 1
  v_permlane16_swap_b32 v193, v194
  v_add_f32 v193, v193, v194
  v_mov_b32 v194, v193
  s_nop 1
  v_permlane32_swap_b32 v193, v194
  v_add_f32 v193, v193, v194
  v_rcp_f32 v193, v193
  s_nop 0
  v_mul_f32 v188, v188, v193
  v_mul_f32 v189, v189, v193
  v_mul_f32 v190, v190, v193
  v_mul_f32 v191, v191, v193
  v_mul_f32 v192, v192, v193
  v_cvt_pk_bf16_f32 v188, v188, v189
  v_cvt_pk_bf16_f32 v189, v190, v191
  v_cvt_pk_bf16_f32 v192, v192, v192
  ds_write_b64 v21, v[188:189]
  ds_write_b16 v22, v192
K3_b2:
  s_waitcnt lgkmcnt(0)
  s_barrier
  ds_read_b128 v[188:191], v28
  ds_read_b64 v[192:193], v29
  ds_read_b128 v[116:119], v30 offset:0
  ds_read_b128 v[120:123], v30 offset:512
  s_mov_b32 exec_lo, 0x00ff00ff
  s_mov_b32 exec_hi, 0x00ff00ff
  buffer_store_dwordx2 v[46:47], v17, s[8:11], s47 offen sc1
  s_mov_b64 exec, -1
  s_waitcnt lgkmcnt(2)
  v_mfma_f32_16x16x32_bf16 v[124:127], v[60:63], v[188:191], 0
  v_mfma_f32_16x16x32_bf16 v[128:131], v[64:67], v[188:191], 0
  v_mfma_f32_16x16x32_bf16 v[132:135], v[68:71], v[188:191], 0
  v_mfma_f32_16x16x32_bf16 v[136:139], v[72:75], v[188:191], 0
  s_waitcnt lgkmcnt(0)
  s_nop 1
  v_mfma_f32_16x16x16_bf16 v[124:127], v[116:117], v[192:193], v[124:127]
  v_mfma_f32_16x16x16_bf16 v[128:131], v[118:119], v[192:193], v[128:131]
  v_mfma_f32_16x16x16_bf16 v[132:135], v[120:121], v[192:193], v[132:135]
  v_mfma_f32_16x16x16_bf16 v[136:139], v[122:123], v[192:193], v[136:139]
  s_nop 4
  v_cvt_pk_bf16_f32 v140, v124, v125
  v_cvt_pk_bf16_f32 v141, v126, v127
  v_cvt_pk_bf16_f32 v142, v128, v129
  v_cvt_pk_bf16_f32 v143, v130, v131
  v_cvt_pk_bf16_f32 v144, v132, v133
  v_cvt_pk_bf16_f32 v145, v134, v135
  v_cvt_pk_bf16_f32 v146, v136, v137
  v_cvt_pk_bf16_f32 v147, v138, v139
  s_mov_b32 exec_lo, 0x00ff00ff
  s_mov_b32 exec_hi, 0x00ff00ff
  ds_write_b128 v32, v[140:143] offset:0
  ds_write_b128 v32, v[144:147] offset:512
  s_mov_b64 exec, -1
  s_waitcnt lgkmcnt(0)
  s_barrier
  s_cmp_eq_u32 s4, 2
  s_cbranch_scc1 K3_g2two
  ds_read_b128 v[116:119], v31 offset:0
  ds_read_b128 v[120:123], v31 offset:512
  ds_read_b128 v[124:127], v31 offset:1024
  ds_read_b128 v[128:131], v31 offset:1536
  ds_read_b128 v[132:135], v31 offset:2048
  ds_read_b128 v[136:139], v31 offset:2560
  s_mul_i32 s46, s42, 655360
  s_mul_i32 s49, s43, 655360
  s_waitcnt lgkmcnt(5)
  v_mfma_f32_16x16x32_bf16 v[176:179], a[160:163], v[116:119], 0
  v_mfma_f32_16x16x32_bf16 v[180:183], a[184:187], v[116:119], 0
  v_mfma_f32_16x16x32_bf16 v[184:187], a[208:211], v[116:119], 0
  s_waitcnt lgkmcnt(4)
  v_mfma_f32_16x16x32_bf16 v[176:179], a[164:167], v[120:123], v[176:179]
  v_mfma_f32_16x16x32_bf16 v[180:183], a[188:191], v[120:123], v[180:183]
  v_mfma_f32_16x16x32_bf16 v[184:187], a[212:215], v[120:123], v[184:187]
  s_waitcnt lgkmcnt(3)
  v_mfma_f32_16x16x32_bf16 v[176:179], a[168:171], v[124:127], v[176:179]
  v_mfma_f32_16x16x32_bf16 v[180:183], a[192:195], v[124:127], v[180:183]
  v_mfma_f32_16x16x32_bf16 v[184:187], a[216:219], v[124:127], v[184:187]
  s_waitcnt lgkmcnt(2)
  v_mfma_f32_16x16x32_bf16 v[176:179], a[172:175], v[128:131], v[176:179]
  v_mfma_f32_16x16x32_bf16 v[180:183], a[196:199], v[128:131], v[180:183]
  v_mfma_f32_16x16x32_bf16 v[184:187], a[220:223], v[128:131], v[184:187]
  s_waitcnt lgkmcnt(1)
  v_mfma_f32_16x16x32_bf16 v[176:179], a[176:179], v[132:135], v[176:179]
  v_mfma_f32_16x16x32_bf16 v[180:183], a[200:203], v[132:135], v[180:183]
  v_mfma_f32_16x16x32_bf16 v[184:187], a[224:227], v[132:135], v[184:187]
  s_waitcnt lgkmcnt(0)
  v_mfma_f32_16x16x32_bf16 v[176:179], a[180:183], v[136:139], v[176:179]
  v_mfma_f32_16x16x32_bf16 v[180:183], a[204:207], v[136:139], v[180:183]
  v_mfma_f32_16x16x32_bf16 v[184:187], a[228:231], v[136:139], v[184:187]
  s_mov_b32 exec_lo, 0x00ff00ff
  s_mov_b32 exec_hi, 0x00ff00ff
  s_nop 3
  buffer_store_dwordx4 v[176:179], v35, s[8:11], s46 offen
  buffer_store_dwordx4 v[180:183], v36, s[8:11], s46 offen
  buffer_store_dwordx4 v[184:187], v37, s[8:11], s46 offen
  s_mov_b64 exec, -1
  s_branch K3_g2done
K3_g2two:
  ds_read_b128 v[116:119], v31 offset:0
  ds_read_b128 v[120:123], v31 offset:512
  ds_read_b128 v[124:127], v31 offset:1024
  ds_read_b128 v[128:131], v31 offset:1536
  ds_read_b128 v[132:135], v31 offset:2048
  ds_read_b128 v[136:139], v31 offset:2560
  s_mul_i32 s46, s42, 655360
  s_mul_i32 s49, s43, 655360
  s_waitcnt lgkmcnt(5)
  v_mfma_f32_16x16x32_bf16 v[176:179], a[160:163], v[116:119], 0
  v_mfma_f32_16x16x32_bf16 v[180:183], a[184:187], v[116:119], 0
  s_waitcnt lgkmcnt(4)
  v_mfma_f32_16x16x32_bf16 v[176:179], a[164:167], v[120:123], v[176:179]
  v_mfma_f32_16x16x32_bf16 v[180:183], a[188:191], v[120:123], v[180:183]
  s_waitcnt lgkmcnt(3)
  v_mfma_f32_16x16x32_bf16 v[176:179], a[168:171], v[124:127], v[176:179]
  v_mfma_f32_16x16x32_bf16 v[180:183], a[192:195], v[124:127], v[180:183]
  s_waitcnt lgkmcnt(2)
  v_mfma_f32_16x16x32_bf16 v[176:179], a[172:175], v[128:131], v[176:179]
  v_mfma_f32_16x16x32_bf16 v[180:183], a[196:199], v[128:131], v[180:183]
  s_waitcnt lgkmcnt(1)
  v_mfma_f32_16x16x32_bf16 v[176:179], a[176:179], v[132:135], v[176:179]
  v_mfma_f32_16x16x32_bf16 v[180:183], a[200:203], v[132:135], v[180:183]
  s_waitcnt lgkmcnt(0)
  v_mfma_f32_16x16x32_bf16 v[176:179], a[180:183], v[136:139], v[176:179]
  v_mfma_f32_16x16x32_bf16 v[180:183], a[204:207], v[136:139], v[180:183]
  s_mov_b32 exec_lo, 0x00ff00ff
  s_mov_b32 exec_hi, 0x00ff00ff
  s_nop 4
  buffer_store_dwordx4 v[176:179], v35, s[8:11], s46 offen
  buffer_store_dwordx4 v[180:183], v36, s[8:11], s46 offen
  s_mov_b64 exec, -1
K3_g2done:
  v_mov_b32 v6, 24576
  ds_read_b32 v7, v6
  s_add_u32 s50, s40, 2
  s_waitcnt lgkmcnt(0)
  v_readfirstlane_b32 s57, v7
  s_nop 0
  s_cmp_ge_u32 s57, 64
  s_cbranch_scc0 K3_spf_n
  s_cmp_le_u32 s50, 63
  s_cbranch_scc0 K3_spf_n
  s_mul_i32 s50, s50, 393216
  s_add_u32 s57, s50, s84
  s_add_u32 s86, s8, s57
  s_addc_u32 s87, s9, 0
  s_load_dword s95, s[86:87], 0
  s_load_dword s95, s[86:87], 64
  s_load_dword s95, s[86:87], 128
  s_load_dword s95, s[86:87], 192
  s_load_dword s95, s[86:87], 256
  s_load_dword s95, s[86:87], 320
  s_load_dword s95, s[86:87], 384
  s_load_dword s95, s[86:87], 448
  s_load_dword s95, s[86:87], 512
  s_load_dword s95, s[86:87], 576
  s_load_dword s95, s[86:87], 640
  s_load_dword s95, s[86:87], 704
  s_load_dword s95, s[86:87], 768
  s_load_dword s95, s[86:87], 832
  s_load_dword s95, s[86:87], 896
  s_load_dword s95, s[86:87], 960
  s_add_u32 s57, s50, s85
  s_add_u32 s82, s8, s57
  s_addc_u32 s83, s9, 0
  s_load_dword s95, s[82:83], 0
  s_load_dword s95, s[82:83], 64
  s_load_dword s95, s[82:83], 128
  s_load_dword s95, s[82:83], 192
  s_load_dword s95, s[82:83], 256
  s_load_dword s95, s[82:83], 320
  s_load_dword s95, s[82:83], 384
  s_load_dword s95, s[82:83], 448
  s_load_dword s95, s[82:83], 512
  s_load_dword s95, s[82:83], 576
  s_load_dword s95, s[82:83], 640
  s_load_dword s95, s[82:83], 704
  s_load_dword s95, s[82:83], 768
  s_load_dword s95, s[82:83], 832
  s_load_dword s95, s[82:83], 896
  s_load_dword s95, s[82:83], 960
K3_spf_n:
  s_add_u32 s50, s40, 1
  s_mul_i32 s50, s50, 393216
  s_add_u32 s40, s40, 1
  s_and_b32 s42, s40, 3
  s_add_u32 s43, s40, 2
  s_and_b32 s43, s43, 3
  s_add_u32 s44, s40, 1
  s_and_b32 s44, s44, 3
  s_add_u32 s45, s40, 3
  s_and_b32 s45, s45, 3
  s_mul_i32 s46, s42, 10240
  s_branch K3_top
K3_last:
  s_cmp_eq_u32 s4, 2
  s_cbranch_scc0 K3_lsp
K3_lsp:
  s_mov_b32 exec_lo, 0x00ff00ff
  s_mov_b32 exec_hi, 0x00ff00ff
  buffer_store_dwordx2 v[190:191], v17, s[8:11], s47 offen sc1
  s_mov_b64 exec, -1
  s_branch K3_fin
  s_and_b32 s42, s40, 3
  s_add_u32 s43, s40, 2
  s_and_b32 s43, s43, 3
  s_add_u32 s44, s40, 1
  s_and_b32 s44, s44, 3
  s_add_u32 s45, s40, 3
  s_and_b32 s45, s45, 3
  s_mul_i32 s46, s42, 10240
K3_W3:
  s_and_b32 s42, s40, 3
  s_add_u32 s43, s40, 2
  s_and_b32 s43, s43, 3
  s_add_u32 s44, s40, 1
  s_and_b32 s44, s44, 3
  s_add_u32 s45, s40, 3
  s_and_b32 s45, s45, 3
  s_mul_i32 s46, s42, 10240
  s_add_u32 s50, s40, 1
  s_min_u32 s50, s50, 63
  v_readfirstlane_b32 s57, v45
  s_nop 0
  s_cmp_ge_u32 s57, 64
  s_cbranch_scc1 K3_lw_g
  s_lshl_b32 s58, s50, 6
  v_mov_b32 v196, 4587520
K3_gn3_w:
  buffer_load_dword v197, v196, s[8:11], s58 offen sc1
  s_waitcnt vmcnt(0)
  v_readfirstlane_b32 s57, v197
  s_nop 0
  s_cmp_ge_u32 s57, 64
  s_cbranch_scc1 K3_gn3_ok
  s_sleep 4
  s_add_u32 s41, s41, 1
  s_cmp_lt_u32 s41, 4000000
  s_cbranch_scc1 K3_gn3_w
K3_gn3_ok:
K3_lw_g:
  v_readlane_b32 s57, v45, 1
  s_nop 1
  v_mov_b32 v6, s57
  ds_write_b32 v53, v6
  s_waitcnt lgkmcnt(0)
  s_mul_i32 s50, s50, 393216
  s_barrier
  ds_read_b128 v[116:119], v11 offset:0
  ds_read_b128 v[120:123], v11 offset:512
  ds_read_b128 v[124:127], v11 offset:1024
  ds_read_b128 v[128:131], v11 offset:1536
  ds_read_b128 v[132:135], v11 offset:2048
  ds_read_b128 v[136:139], v12 offset:0
  ds_read_b128 v[140:143], v12 offset:512
  ds_read_b128 v[144:147], v12 offset:1024
  ds_read_b128 v[148:151], v12 offset:1536
  ds_read_b128 v[152:155], v12 offset:2048
  ds_read_b128 v[156:159], v13 offset:0
  ds_read_b128 v[160:163], v13 offset:512
  ds_read_b128 v[164:167], v13 offset:1024
  ds_read_b128 v[168:171], v13 offset:1536
  ds_read_b128 v[172:175], v13 offset:2048
  s_waitcnt lgkmcnt(14)
  v_mfma_f32_16x16x32_bf16 v[176:179], v[116:119], a[0:3], 0
  v_mfma_f32_16x16x32_bf16 v[180:183], v[116:119], a[80:83], 0
  v_mfma_f32_16x16x32_bf16 v[184:187], v[116:119], a[160:163], 0
  ds_read_b128 v[116:119], v14 offset:0
  s_add_u32 m0, s93, 0
  s_add_u32 s48, s50, 0
  buffer_load_dwordx4 v42, s[8:11], s48 offen offset:0 sc1 lds
  buffer_load_dwordx4 v42, s[8:11], s48 offen offset:1024 sc1 lds
  buffer_load_dwordx4 v42, s[8:11], s48 offen offset:2048 sc1 lds
  buffer_load_dwordx4 v42, s[8:11], s48 offen offset:3072 sc1 lds
  s_waitcnt lgkmcnt(14)
  v_mfma_f32_16x16x32_bf16 v[176:179], v[120:123], a[4:7], v[176:179]
  v_mfma_f32_16x16x32_bf16 v[180:183], v[120:123], a[84:87], v[180:183]
  v_mfma_f32_16x16x32_bf16 v[184:187], v[120:123], a[164:167], v[184:187]
  ds_read_b128 v[120:123], v14 offset:512
  s_add_u32 m0, s93, 4096
  s_add_u32 s48, s50, 4096
  buffer_load_dwordx4 v42, s[8:11], s48 offen offset:0 sc1 lds
  buffer_load_dwordx4 v42, s[8:11], s48 offen offset:1024 sc1 lds
  buffer_load_dwordx4 v42, s[8:11], s48 offen offset:2048 sc1 lds
  buffer_load_dwordx4 v42, s[8:11], s48 offen offset:3072 sc1 lds
  s_waitcnt lgkmcnt(14)
  v_mfma_f32_16x16x32_bf16 v[176:179], v[124:127], a[8:11], v[176:179]
  v_mfma_f32_16x16x32_bf16 v[180:183], v[124:127], a[88:91], v[180:183]
  v_mfma_f32_16x16x32_bf16 v[184:187], v[124:127], a[168:171], v[184:187]
  ds_read_b128 v[124:127], v14 offset:1024
  s_add_u32 m0, s93, 8192
  s_add_u32 s48, s50, 8192
  buffer_load_dwordx4 v42, s[8:11], s48 offen offset:0 sc1 lds
  buffer_load_dwordx4 v42, s[8:11], s48 offen offset:1024 sc1 lds
  buffer_load_dwordx4 v42, s[8:11], s48 offen offset:2048 sc1 lds
  buffer_load_dwordx4 v42, s[8:11], s48 offen offset:3072 sc1 lds
  s_waitcnt lgkmcnt(14)
  v_mfma_f32_16x16x32_bf16 v[176:179], v[128:131], a[12:15], v[176:179]
  v_mfma_f32_16x16x32_bf16 v[180:183], v[128:131], a[92:95], v[180:183]
  v_mfma_f32_16x16x32_bf16 v[184:187], v[128:131], a[172:175], v[184:187]
  ds_read_b128 v[128:131], v14 offset:1536
  s_add_u32 s48, s50, 0
  s_add_u32 m0, s93, 12288
  s_nop 0
  buffer_load_dwordx4 v43, s[8:11], s48 offen sc1 lds
  s_add_u32 m0, s93, 13312
  s_nop 0
  buffer_load_dwordx4 v44, s[8:11], s48 offen sc1 lds
  s_add_u32 s48, s50, 6144
  s_add_u32 m0, s93, 14336
  s_nop 0
  buffer_load_dwordx4 v43, s[8:11], s48 offen sc1 lds
  s_add_u32 m0, s93, 15360
  s_nop 0
  buffer_load_dwordx4 v44, s[8:11], s48 offen sc1 lds
  s_waitcnt lgkmcnt(14)
  v_mfma_f32_16x16x32_bf16 v[176:179], v[132:135], a[16:19], v[176:179]
  v_mfma_f32_16x16x32_bf16 v[180:183], v[132:135], a[96:99], v[180:183]
  v_mfma_f32_16x16x32_bf16 v[184:187], v[132:135], a[176:179], v[184:187]
  ds_read_b128 v[132:135], v14 offset:2048
  s_waitcnt lgkmcnt(14)
  v_mfma_f32_16x16x32_bf16 v[176:179], v[136:139], a[20:23], v[176:179]
  v_mfma_f32_16x16x32_bf16 v[180:183], v[136:139], a[100:103], v[180:183]
  v_mfma_f32_16x16x32_bf16 v[184:187], v[136:139], a[180:183], v[184:187]
  s_waitcnt lgkmcnt(13)
  v_mfma_f32_16x16x32_bf16 v[176:179], v[140:143], a[24:27], v[176:179]
  v_mfma_f32_16x16x32_bf16 v[180:183], v[140:143], a[104:107], v[180:183]
  v_mfma_f32_16x16x32_bf16 v[184:187], v[140:143], a[184:187], v[184:187]
  s_waitcnt lgkmcnt(12)
  v_mfma_f32_16x16x32_bf16 v[176:179], v[144:147], a[28:31], v[176:179]
  v_mfma_f32_16x16x32_bf16 v[180:183], v[144:147], a[108:111], v[180:183]
  v_mfma_f32_16x16x32_bf16 v[184:187], v[144:147], a[188:191], v[184:187]
  s_waitcnt lgkmcnt(11)
  v_mfma_f32_16x16x32_bf16 v[176:179], v[148:151], a[32:35], v[176:179]
  v_mfma_f32_16x16x32_bf16 v[180:183], v[148:151], a[112:115], v[180:183]
  v_mfma_f32_16x16x32_bf16 v[184:187], v[148:151], a[192:195], v[184:187]
  s_barrier
  s_waitcnt lgkmcnt(10)
  v_mfma_f32_16x16x32_bf16 v[176:179], v[152:155], a[36:39], v[176:179]
  v_mfma_f32_16x16x32_bf16 v[180:183], v[152:155], a[116:119], v[180:183]
  v_mfma_f32_16x16x32_bf16 v[184:187], v[152:155], a[196:199], v[184:187]
  s_waitcnt lgkmcnt(9)
  v_mfma_f32_16x16x32_bf16 v[176:179], v[156:159], a[40:43], v[176:179]
  v_mfma_f32_16x16x32_bf16 v[180:183], v[156:159], a[120:123], v[180:183]
  v_mfma_f32_16x16x32_bf16 v[184:187], v[156:159], a[200:203], v[184:187]
  s_waitcnt lgkmcnt(8)
  v_mfma_f32_16x16x32_bf16 v[176:179], v[160:163], a[44:47], v[176:179]
  v_mfma_f32_16x16x32_bf16 v[180:183], v[160:163], a[124:127], v[180:183]
  v_mfma_f32_16x16x32_bf16 v[184:187], v[160:163], a[204:207], v[184:187]
  s_waitcnt lgkmcnt(7)
  v_mfma_f32_16x16x32_bf16 v[176:179], v[164:167], a[48:51], v[176:179]
  v_mfma_f32_16x16x32_bf16 v[180:183], v[164:167], a[128:131], v[180:183]
  v_mfma_f32_16x16x32_bf16 v[184:187], v[164:167], a[208:211], v[184:187]
  s_waitcnt lgkmcnt(6)
  v_mfma_f32_16x16x32_bf16 v[176:179], v[168:171], a[52:55], v[176:179]
  v_mfma_f32_16x16x32_bf16 v[180:183], v[168:171], a[132:135], v[180:183]
  v_mfma_f32_16x16x32_bf16 v[184:187], v[168:171], a[212:215], v[184:187]
  s_waitcnt lgkmcnt(5)
  v_mfma_f32_16x16x32_bf16 v[176:179], v[172:175], a[56:59], v[176:179]
  v_mfma_f32_16x16x32_bf16 v[180:183], v[172:175], a[136:139], v[180:183]
  v_mfma_f32_16x16x32_bf16 v[184:187], v[172:175], a[216:219], v[184:187]
  s_waitcnt lgkmcnt(4)
  v_mfma_f32_16x16x32_bf16 v[176:179], v[116:119], a[60:63], v[176:179]
  v_mfma_f32_16x16x32_bf16 v[180:183], v[116:119], a[140:143], v[180:183]
  v_mfma_f32_16x16x32_bf16 v[184:187], v[116:119], a[220:223], v[184:187]
  s_waitcnt lgkmcnt(3)
  v_mfma_f32_16x16x32_bf16 v[176:179], v[120:123], a[64:67], v[176:179]
  v_mfma_f32_16x16x32_bf16 v[180:183], v[120:123], a[144:147], v[180:183]
  v_mfma_f32_16x16x32_bf16 v[184:187], v[120:123], a[224:227], v[184:187]
  s_waitcnt lgkmcnt(2)
  v_mfma_f32_16x16x32_bf16 v[176:179], v[124:127], a[68:71], v[176:179]
  v_mfma_f32_16x16x32_bf16 v[180:183], v[124:127], a[148:151], v[180:183]
  v_mfma_f32_16x16x32_bf16 v[184:187], v[124:127], a[228:231], v[184:187]
  s_waitcnt lgkmcnt(1)
  v_mfma_f32_16x16x32_bf16 v[176:179], v[128:131], a[72:75], v[176:179]
  v_mfma_f32_16x16x32_bf16 v[180:183], v[128:131], a[152:155], v[180:183]
  v_mfma_f32_16x16x32_bf16 v[184:187], v[128:131], a[232:235], v[184:187]
  s_waitcnt lgkmcnt(0)
  v_mfma_f32_16x16x32_bf16 v[176:179], v[132:135], a[76:79], v[176:179]
  v_mfma_f32_16x16x32_bf16 v[180:183], v[132:135], a[156:159], v[180:183]
  v_mfma_f32_16x16x32_bf16 v[184:187], v[132:135], a[236:239], v[184:187]
  s_xor_b32 s93, s93, 16384
  s_nop 4
  v_cvt_pk_bf16_f32 v188, v176, v177
  v_cvt_pk_bf16_f32 v189, v178, v179
  v_cvt_pk_bf16_f32 v190, v180, v181
  v_cvt_pk_bf16_f32 v191, v182, v183
  v_cvt_pk_bf16_f32 v192, v184, v185
  v_cvt_pk_bf16_f32 v193, v186, v187
  s_mul_i32 s46, s42, 98304
  s_mul_i32 s49, s43, 98304
  s_mul_i32 s47, s40, 98304
  s_mov_b32 exec_lo, -1
  s_mov_b32 exec_hi, 0
  s_cmp_eq_u32 s40, 63
  s_cbranch_scc1 K3_w3_last
  buffer_store_dwordx2 v[188:189], v18, s[8:11], s46 offen
  buffer_store_dwordx2 v[190:191], v19, s[8:11], s46 offen
  buffer_store_dwordx2 v[192:193], v24, s[8:11], s46 offen
  buffer_store_dwordx2 v[48:49], v18, s[8:11], s49 offen
  buffer_store_dwordx2 v[48:49], v19, s[8:11], s49 offen
  buffer_store_dwordx2 v[48:49], v24, s[8:11], s49 offen
  s_mov_b64 exec, -1
  s_barrier
  ds_read_b128 v[56:59], v52
  s_add_u32 s58, s40, 2
  s_min_u32 s58, s58, 63
  s_lshl_b32 s58, s58, 6
  s_mov_b64 exec, 3
  buffer_load_dword v45, v46, s[8:11], s58 offen sc1
  s_mov_b64 exec, -1
  s_cmp_eq_u32 s7, 3
  s_cbranch_scc1 K3_lw_a
  s_waitcnt lgkmcnt(0)
  buffer_store_dwordx4 v[56:59], v47, s[8:11], s47 offen sc1
K3_lw_a:
  s_mul_i32 s49, s43, 655360
  buffer_store_dwordx4 v[48:51], v20, s[8:11], s49 offen
  buffer_store_dwordx4 v[48:51], v21, s[8:11], s49 offen
  buffer_store_dwordx4 v[48:51], v22, s[8:11], s49 offen
  buffer_store_dwordx4 v[48:51], v23, s[8:11], s49 offen
  buffer_store_dwordx4 v[48:51], v26, s[8:11], s49 offen
  s_lshr_b32 s46, s43, 1
  s_mul_i32 s52, s46, 98304
  s_mul_i32 s46, s46, 393216
  s_and_b32 s57, s43, 1
  s_lshl_b32 s48, s57, 12
  s_add_u32 s46, s46, s48
  s_lshl_b32 s48, s57, 10
  s_add_u32 s52, s52, s48
  buffer_store_dwordx4 v[48:51], v28, s[8:11], s46 offen
  s_mov_b64 exec, 0xffff
  buffer_store_dwordx4 v[48:51], v29, s[8:11], s52 offen
  s_mov_b64 exec, -1
  s_barrier
  ds_read_b128 v[116:119], v31 offset:0
  ds_read_b128 v[120:123], v31 offset:512
  ds_read_b128 v[124:127], v31 offset:1024
  ds_read_b128 v[128:131], v31 offset:1536
  ds_read_b128 v[132:135], v31 offset:2048
  ds_read_b128 v[136:139], v31 offset:2560
  s_mul_i32 s46, s42, 655360
  s_mul_i32 s49, s43, 655360
  s_waitcnt lgkmcnt(5)
  v_mfma_f32_16x16x32_bf16 v[176:179], v[200:203], v[116:119], 0
  v_mfma_f32_16x16x32_bf16 v[180:183], v[224:227], v[116:119], 0
  s_waitcnt lgkmcnt(4)
  v_mfma_f32_16x16x32_bf16 v[176:179], v[204:207], v[120:123], v[176:179]
  v_mfma_f32_16x16x32_bf16 v[180:183], v[228:231], v[120:123], v[180:183]
  s_waitcnt lgkmcnt(3)
  v_mfma_f32_16x16x32_bf16 v[176:179], v[208:211], v[124:127], v[176:179]
  v_mfma_f32_16x16x32_bf16 v[180:183], v[232:235], v[124:127], v[180:183]
  s_waitcnt lgkmcnt(2)
  v_mfma_f32_16x16x32_bf16 v[176:179], v[212:215], v[128:131], v[176:179]
  v_mfma_f32_16x16x32_bf16 v[180:183], v[236:239], v[128:131], v[180:183]
  s_waitcnt lgkmcnt(1)
  v_mfma_f32_16x16x32_bf16 v[176:179], v[216:219], v[132:135], v[176:179]
  v_mfma_f32_16x16x32_bf16 v[180:183], v[240:243], v[132:135], v[180:183]
  s_waitcnt lgkmcnt(0)
  v_mfma_f32_16x16x32_bf16 v[176:179], v[220:223], v[136:139], v[176:179]
  v_mfma_f32_16x16x32_bf16 v[180:183], v[244:247], v[136:139], v[180:183]
  s_mov_b32 exec_lo, 0x00ff00ff
  s_mov_b32 exec_hi, 0x00ff00ff
  s_nop 4
  buffer_store_dwordx4 v[176:179], v35, s[8:11], s46 offen
  buffer_store_dwordx4 v[180:183], v36, s[8:11], s46 offen
  s_mov_b64 exec, -1
  s_waitcnt vmcnt(0)
  s_add_u32 s48, s46, 0
  buffer_load_dwordx4 v[116:119], v38, s[8:11], s48 offen offset:0 sc1
  buffer_load_dwordx4 v[120:123], v38, s[8:11], s48 offen offset:640 sc1
  buffer_load_dwordx4 v[124:127], v38, s[8:11], s48 offen offset:1280 sc1
  buffer_load_dwordx4 v[128:131], v38, s[8:11], s48 offen offset:1920 sc1
  s_add_u32 s48, s46, 2560
  buffer_load_dwordx4 v[132:135], v38, s[8:11], s48 offen offset:0 sc1
  buffer_load_dwordx4 v[136:139], v38, s[8:11], s48 offen offset:640 sc1
  buffer_load_dwordx4 v[140:143], v38, s[8:11], s48 offen offset:1280 sc1
  buffer_load_dwordx4 v[144:147], v38, s[8:11], s48 offen offset:1920 sc1
  s_sleep 1
  s_sleep 1
  s_add_u32 s48, s46, 0
  buffer_load_dwordx4 v[148:151], v38, s[8:11], s48 offen offset:0 sc1
  buffer_load_dwordx4 v[152:155], v38, s[8:11], s48 offen offset:640 sc1
  buffer_load_dwordx4 v[156:159], v38, s[8:11], s48 offen offset:1280 sc1
  buffer_load_dwordx4 v[160:163], v38, s[8:11], s48 offen offset:1920 sc1
  s_add_u32 s48, s46, 2560
  buffer_load_dwordx4 v[164:167], v38, s[8:11], s48 offen offset:0 sc1
  buffer_load_dwordx4 v[168:171], v38, s[8:11], s48 offen offset:640 sc1
  buffer_load_dwordx4 v[172:175], v38, s[8:11], s48 offen offset:1280 sc1
  buffer_load_dwordx4 v[248:251], v38, s[8:11], s48 offen offset:1920 sc1
K3_pa_l0:
  s_waitcnt vmcnt(8)
  v_pk_add_f32 v[116:117], v[116:117], v[120:121]
  v_pk_add_f32 v[118:119], v[118:119], v[122:123]
  v_pk_add_f32 v[116:117], v[116:117], v[124:125]
  v_pk_add_f32 v[118:119], v[118:119], v[126:127]
  v_pk_add_f32 v[116:117], v[116:117], v[128:129]
  v_pk_add_f32 v[118:119], v[118:119], v[130:131]
  v_pk_add_f32 v[116:117], v[116:117], v[132:133]
  v_pk_add_f32 v[118:119], v[118:119], v[134:135]
  v_pk_add_f32 v[116:117], v[116:117], v[136:137]
  v_pk_add_f32 v[118:119], v[118:119], v[138:139]
  v_pk_add_f32 v[116:117], v[116:117], v[140:141]
  v_pk_add_f32 v[118:119], v[118:119], v[142:143]
  v_pk_add_f32 v[116:117], v[116:117], v[144:145]
  v_pk_add_f32 v[118:119], v[118:119], v[146:147]
  v_add_f32 v188, v116, v117
  v_add_f32 v189, v118, v119
  v_add_f32 v188, v188, v189
  v_cmp_u_f32 vcc, v188, v188
  s_cbranch_vccnz K3_pa_r0
  s_mul_i32 s54, s42, 180224
  s_mul_i32 s55, s43, 180224
  s_mov_b32 exec_lo, -1
  s_mov_b32 exec_hi, 0xff
  buffer_store_dwordx4 v[116:119], v40, s[8:11], s54 offen sc1
  buffer_store_dwordx4 v[48:51], v40, s[8:11], s55 offen sc1
  s_mov_b64 exec, -1
  v_mov_b32 v192, v116
  v_mov_b32 v193, v117
  v_mov_b32 v194, v118
  v_mov_b32 v195, v119
  s_branch K3_pa_done
K3_pa_r1:
  s_add_u32 s48, s46, 0
  buffer_load_dwordx4 v[148:151], v38, s[8:11], s48 offen offset:0 sc1
  buffer_load_dwordx4 v[152:155], v38, s[8:11], s48 offen offset:640 sc1
  buffer_load_dwordx4 v[156:159], v38, s[8:11], s48 offen offset:1280 sc1
  buffer_load_dwordx4 v[160:163], v38, s[8:11], s48 offen offset:1920 sc1
  s_add_u32 s48, s46, 2560
  buffer_load_dwordx4 v[164:167], v38, s[8:11], s48 offen offset:0 sc1
  buffer_load_dwordx4 v[168:171], v38, s[8:11], s48 offen offset:640 sc1
  buffer_load_dwordx4 v[172:175], v38, s[8:11], s48 offen offset:1280 sc1
  buffer_load_dwordx4 v[248:251], v38, s[8:11], s48 offen offset:1920 sc1
  s_add_u32 s41, s41, 1
  s_cmp_lt_u32 s41, 4000000
  s_cbranch_scc1 K3_pa_l0
  s_branch K3_pa_done
K3_pa_r0:
  s_add_u32 s48, s46, 0
  buffer_load_dwordx4 v[116:119], v38, s[8:11], s48 offen offset:0 sc1
  buffer_load_dwordx4 v[120:123], v38, s[8:11], s48 offen offset:640 sc1
  buffer_load_dwordx4 v[124:127], v38, s[8:11], s48 offen offset:1280 sc1
  buffer_load_dwordx4 v[128:131], v38, s[8:11], s48 offen offset:1920 sc1
  s_add_u32 s48, s46, 2560
  buffer_load_dwordx4 v[132:135], v38, s[8:11], s48 offen offset:0 sc1
  buffer_load_dwordx4 v[136:139], v38, s[8:11], s48 offen offset:640 sc1
  buffer_load_dwordx4 v[140:143], v38, s[8:11], s48 offen offset:1280 sc1
  buffer_load_dwordx4 v[144:147], v38, s[8:11], s48 offen offset:1920 sc1
K3_pa_l1:
  s_waitcnt vmcnt(8)
  v_pk_add_f32 v[148:149], v[148:149], v[152:153]
  v_pk_add_f32 v[150:151], v[150:151], v[154:155]
  v_pk_add_f32 v[148:149], v[148:149], v[156:157]
  v_pk_add_f32 v[150:151], v[150:151], v[158:159]
  v_pk_add_f32 v[148:149], v[148:149], v[160:161]
  v_pk_add_f32 v[150:151], v[150:151], v[162:163]
  v_pk_add_f32 v[148:149], v[148:149], v[164:165]
  v_pk_add_f32 v[150:151], v[150:151], v[166:167]
  v_pk_add_f32 v[148:149], v[148:149], v[168:169]
  v_pk_add_f32 v[150:151], v[150:151], v[170:171]
  v_pk_add_f32 v[148:149], v[148:149], v[172:173]
  v_pk_add_f32 v[150:151], v[150:151], v[174:175]
  v_pk_add_f32 v[148:149], v[148:149], v[248:249]
  v_pk_add_f32 v[150:151], v[150:151], v[250:251]
  v_add_f32 v188, v148, v149
  v_add_f32 v189, v150, v151
  v_add_f32 v188, v188, v189
  v_cmp_u_f32 vcc, v188, v188
  s_cbranch_vccnz K3_pa_r1
  s_mul_i32 s54, s42, 180224
  s_mul_i32 s55, s43, 180224
  s_mov_b32 exec_lo, -1
  s_mov_b32 exec_hi, 0xff
  buffer_store_dwordx4 v[148:151], v40, s[8:11], s54 offen sc1
  buffer_store_dwordx4 v[48:51], v40, s[8:11], s55 offen sc1
  s_mov_b64 exec, -1
  v_mov_b32 v192, v148
  v_mov_b32 v193, v149
  v_mov_b32 v194, v150
  v_mov_b32 v195, v151
K3_pa_done:
  s_waitcnt vmcnt(0)
  buffer_load_dwordx4 v[76:79], v25, s[8:11], s54 offen sc1
  buffer_load_dwordx4 v[80:83], v33, s[8:11], s54 offen sc1
  buffer_load_dwordx4 v[84:87], v34, s[8:11], s54 offen sc1
  s_sleep 1
  s_sleep 1
  buffer_load_dwordx4 v[92:95], v25, s[8:11], s54 offen sc1
  buffer_load_dwordx4 v[96:99], v33, s[8:11], s54 offen sc1
  buffer_load_dwordx4 v[100:103], v34, s[8:11], s54 offen sc1
  s_sleep 1
  s_sleep 1
  buffer_load_dwordx4 v[60:63], v25, s[8:11], s54 offen sc1
  buffer_load_dwordx4 v[64:67], v33, s[8:11], s54 offen sc1
  buffer_load_dwordx4 v[68:71], v34, s[8:11], s54 offen sc1
K3_pb_l0:
  s_waitcnt vmcnt(6)
  v_pk_add_f32 v[76:77], v[76:77], v[192:193]
  v_pk_add_f32 v[78:79], v[78:79], v[194:195]
  v_pk_add_f32 v[80:81], v[80:81], v[84:85]
  v_pk_add_f32 v[82:83], v[82:83], v[86:87]
  v_pk_add_f32 v[76:77], v[76:77], v[80:81]
  v_pk_add_f32 v[78:79], v[78:79], v[82:83]
  v_add_f32 v188, v76, v77
  v_add_f32 v189, v78, v79
  v_add_f32 v188, v188, v189
  v_cmp_u_f32 vcc, v188, v188
  s_cbranch_vccnz K3_pb_r0
  v_cvt_pk_bf16_f32 v190, v76, v77
  v_cvt_pk_bf16_f32 v191, v78, v79
  s_mul_i32 s46, s44, 10240
  s_mul_i32 s49, s45, 10240
  s_mov_b32 exec_lo, -1
  s_mov_b32 exec_hi, 0xff
  buffer_store_dwordx2 v[190:191], v41, s[8:11], s46 offen
  s_barrier
  buffer_store_dwordx2 v[48:49], v41, s[8:11], s49 offen
  s_mov_b64 exec, -1
  s_add_u32 s40, s40, 1
  s_branch K3_W3
K3_pb_r2:
  buffer_load_dwordx4 v[60:63], v25, s[8:11], s54 offen sc1
  buffer_load_dwordx4 v[64:67], v33, s[8:11], s54 offen sc1
  buffer_load_dwordx4 v[68:71], v34, s[8:11], s54 offen sc1
  s_add_u32 s41, s41, 1
  s_cmp_lt_u32 s41, 4000000
  s_cbranch_scc1 K3_pb_l0
  s_branch K3_pb_done
K3_pb_r0:
  buffer_load_dwordx4 v[76:79], v25, s[8:11], s54 offen sc1
  buffer_load_dwordx4 v[80:83], v33, s[8:11], s54 offen sc1
  buffer_load_dwordx4 v[84:87], v34, s[8:11], s54 offen sc1
K3_pb_l1:
  s_waitcnt vmcnt(6)
  v_pk_add_f32 v[92:93], v[92:93], v[192:193]
  v_pk_add_f32 v[94:95], v[94:95], v[194:195]
  v_pk_add_f32 v[96:97], v[96:97], v[100:101]
  v_pk_add_f32 v[98:99], v[98:99], v[102:103]
  v_pk_add_f32 v[92:93], v[92:93], v[96:97]
  v_pk_add_f32 v[94:95], v[94:95], v[98:99]
  v_add_f32 v188, v92, v93
  v_add_f32 v189, v94, v95
  v_add_f32 v188, v188, v189
  v_cmp_u_f32 vcc, v188, v188
  s_cbranch_vccnz K3_pb_r1
  v_cvt_pk_bf16_f32 v190, v92, v93
  v_cvt_pk_bf16_f32 v191, v94, v95
  s_mul_i32 s46, s44, 10240
  s_mul_i32 s49, s45, 10240
  s_mov_b32 exec_lo, -1
  s_mov_b32 exec_hi, 0xff
  buffer_store_dwordx2 v[190:191], v41, s[8:11], s46 offen
  s_barrier
  buffer_store_dwordx2 v[48:49], v41, s[8:11], s49 offen
  s_mov_b64 exec, -1
  s_add_u32 s40, s40, 1
  s_branch K3_W3
K3_pb_r1:
  buffer_load_dwordx4 v[92:95], v25, s[8:11], s54 offen sc1
  buffer_load_dwordx4 v[96:99], v33, s[8:11], s54 offen sc1
  buffer_load_dwordx4 v[100:103], v34, s[8:11], s54 offen sc1
K3_pb_l2:
  s_waitcnt vmcnt(6)
  v_pk_add_f32 v[60:61], v[60:61], v[192:193]
  v_pk_add_f32 v[62:63], v[62:63], v[194:195]
  v_pk_add_f32 v[64:65], v[64:65], v[68:69]
  v_pk_add_f32 v[66:67], v[66:67], v[70:71]
  v_pk_add_f32 v[60:61], v[60:61], v[64:65]
  v_pk_add_f32 v[62:63], v[62:63], v[66:67]
  v_add_f32 v188, v60, v61
  v_add_f32 v189, v62, v63
  v_add_f32 v188, v188, v189
  v_cmp_u_f32 vcc, v188, v188
  s_cbranch_vccnz K3_pb_r2
  v_cvt_pk_bf16_f32 v190, v60, v61
  v_cvt_pk_bf16_f32 v191, v62, v63
  s_mul_i32 s46, s44, 10240
  s_mul_i32 s49, s45, 10240
  s_mov_b32 exec_lo, -1
  s_mov_b32 exec_hi, 0xff
  buffer_store_dwordx2 v[190:191], v41, s[8:11], s46 offen
  s_barrier
  buffer_store_dwordx2 v[48:49], v41, s[8:11], s49 offen
  s_mov_b64 exec, -1
  s_add_u32 s40, s40, 1
  s_branch K3_W3
K3_pb_done:
  s_barrier
  s_add_u32 s40, s40, 1
  s_branch K3_W3
K3_w3_last:
  s_add_u32 s47, s47, 11534336
  buffer_store_dwordx2 v[188:189], v18, s[8:11], s47 offen sc1
  buffer_store_dwordx2 v[190:191], v19, s[8:11], s47 offen sc1
  buffer_store_dwordx2 v[192:193], v24, s[8:11], s47 offen sc1
  s_mov_b64 exec, -1
K3_fin:
  s_waitcnt vmcnt(0)
  s_barrier
  s_cmp_eq_u32 s4, 2
  s_cbranch_scc0 K3_end
  s_branch K3_end
G_start:
  s_sub_u32 s80, s3, 4
  s_lshl_b32 s90, s80, 5
  s_add_u32 s90, s90, s5
  s_mov_b32 s41, 0
  v_lshrrev_b32 v1, 6, v0
  s_nop 0
  v_readfirstlane_b32 s91, v1
  v_mov_b32 v240, -1
  v_mov_b32 v241, -1
  v_mov_b32 v242, -1
  v_mov_b32 v243, -1
  v_lshlrev_b32 v244, 4, v0
  s_mov_b32 s81, s80
  s_mov_b32 s82, 0
  s_cmp_eq_u32 s80, 0
  s_cselect_b32 s83, 26, 64
  s_cmp_eq_u32 s80, 2
  s_cselect_b32 s83, 16, s83
  s_cmp_lt_u32 s80, 2
  s_cbranch_scc1 XQ_start
  s_cmp_eq_u32 s80, 3
  s_cbranch_scc1 G3_start
  v_lshrrev_b32 v1, 2, v0
  v_and_b32 v9, 3, v0
  v_mul_u32_u24 v7, 7680, v1
  v_lshl_add_u32 v7, v9, 4, v7
  s_lshl_b32 s29, s5, 6
  v_add_u32 v7, s29, v7
  v_lshlrev_b32 v6, 1, v1
  buffer_load_ushort v10, v6, s[48:51], 0 offen offset:0
  buffer_load_ushort v11, v6, s[48:51], 0 offen offset:128
  buffer_load_ushort v12, v6, s[48:51], 0 offen offset:256
  buffer_load_ushort v13, v6, s[48:51], 0 offen offset:384
  buffer_load_ushort v14, v6, s[48:51], 0 offen offset:512
  buffer_load_ushort v15, v6, s[48:51], 0 offen offset:640
  buffer_load_ushort v16, v6, s[48:51], 0 offen offset:768
  buffer_load_ushort v17, v6, s[48:51], 0 offen offset:896
  buffer_load_ushort v18, v6, s[48:51], 0 offen offset:1024
  buffer_load_ushort v19, v6, s[48:51], 0 offen offset:1152
  s_cmp_ge_u32 s5, 16
  s_cbranch_scc1 G2_v1
  s_mov_b32 s28, 2560
  buffer_load_dwordx4 v[20:23], v7, s[52:55], s28 offen
  s_mov_b32 s28, 494080
  buffer_load_dwordx4 v[24:27], v7, s[52:55], s28 offen
  s_mov_b32 s28, 985600
  buffer_load_dwordx4 v[28:31], v7, s[52:55], s28 offen
  s_mov_b32 s28, 1477120
  buffer_load_dwordx4 v[32:35], v7, s[52:55], s28 offen
  s_mov_b32 s28, 1968640
  buffer_load_dwordx4 v[36:39], v7, s[52:55], s28 offen
  s_mov_b32 s28, 2460160
  buffer_load_dwordx4 v[40:43], v7, s[52:55], s28 offen
  s_mov_b32 s28, 2951680
  buffer_load_dwordx4 v[44:47], v7, s[52:55], s28 offen
  s_mov_b32 s28, 3443200
  buffer_load_dwordx4 v[48:51], v7, s[52:55], s28 offen
  s_mov_b32 s28, 3934720
  buffer_load_dwordx4 v[52:55], v7, s[52:55], s28 offen
  s_mov_b32 s28, 4426240
  buffer_load_dwordx4 v[56:59], v7, s[52:55], s28 offen
  s_mov_b32 s28, 4608
  buffer_load_dwordx4 v[60:63], v7, s[52:55], s28 offen
  s_mov_b32 s28, 496128
  buffer_load_dwordx4 v[64:67], v7, s[52:55], s28 offen
  s_mov_b32 s28, 987648
  buffer_load_dwordx4 v[68:71], v7, s[52:55], s28 offen
  s_mov_b32 s28, 1479168
  buffer_load_dwordx4 v[72:75], v7, s[52:55], s28 offen
  s_mov_b32 s28, 1970688
  buffer_load_dwordx4 v[76:79], v7, s[52:55], s28 offen
  s_mov_b32 s28, 2462208
  buffer_load_dwordx4 v[80:83], v7, s[52:55], s28 offen
  s_mov_b32 s28, 2953728
  buffer_load_dwordx4 v[84:87], v7, s[52:55], s28 offen
  s_mov_b32 s28, 3445248
  buffer_load_dwordx4 v[88:91], v7, s[52:55], s28 offen
  s_mov_b32 s28, 3936768
  buffer_load_dwordx4 v[92:95], v7, s[52:55], s28 offen
  s_mov_b32 s28, 4428288
  buffer_load_dwordx4 v[96:99], v7, s[52:55], s28 offen
  s_mov_b32 s28, 6656
  buffer_load_dwordx4 v[100:103], v7, s[52:55], s28 offen
  s_mov_b32 s28, 498176
  buffer_load_dwordx4 v[104:107], v7, s[52:55], s28 offen
  s_mov_b32 s28, 989696
  buffer_load_dwordx4 v[108:111], v7, s[52:55], s28 offen
  s_mov_b32 s28, 1481216
  buffer_load_dwordx4 v[112:115], v7, s[52:55], s28 offen
  s_mov_b32 s28, 1972736
  buffer_load_dwordx4 v[116:119], v7, s[52:55], s28 offen
  s_mov_b32 s28, 2464256
  buffer_load_dwordx4 v[120:123], v7, s[52:55], s28 offen
  s_mov_b32 s28, 2955776
  buffer_load_dwordx4 v[124:127], v7, s[52:55], s28 offen
  s_mov_b32 s28, 3447296
  buffer_load_dwordx4 v[128:131], v7, s[52:55], s28 offen
  s_mov_b32 s28, 3938816
  buffer_load_dwordx4 v[132:135], v7, s[52:55], s28 offen
  s_mov_b32 s28, 4430336
  buffer_load_dwordx4 v[136:139], v7, s[52:55], s28 offen
  s_waitcnt vmcnt(30)
  v_lshlrev_b32 v10, 16, v10
  v_mul_f32 v5, 0xbfb8aa3b, v10
  v_exp_f32 v5, v5
  s_nop 0
  v_add_f32 v5, 1.0, v5
  v_rcp_f32 v5, v5
  s_nop 0
  v_mul_f32 v10, v10, v5
  v_cvt_pk_bf16_f32 v10, v10, v10
  v_lshlrev_b32 v10, 16, v10
  v_lshlrev_b32 v11, 16, v11
  v_mul_f32 v5, 0xbfb8aa3b, v11
  v_exp_f32 v5, v5
  s_nop 0
  v_add_f32 v5, 1.0, v5
  v_rcp_f32 v5, v5
  s_nop 0
  v_mul_f32 v11, v11, v5
  v_cvt_pk_bf16_f32 v11, v11, v11
  v_lshlrev_b32 v11, 16, v11
  v_lshlrev_b32 v12, 16, v12
  v_mul_f32 v5, 0xbfb8aa3b, v12
  v_exp_f32 v5, v5
  s_nop 0
  v_add_f32 v5, 1.0, v5
  v_rcp_f32 v5, v5
  s_nop 0
  v_mul_f32 v12, v12, v5
  v_cvt_pk_bf16_f32 v12, v12, v12
  v_lshlrev_b32 v12, 16, v12
  v_lshlrev_b32 v13, 16, v13
  v_mul_f32 v5, 0xbfb8aa3b, v13
  v_exp_f32 v5, v5
  s_nop 0
  v_add_f32 v5, 1.0, v5
  v_rcp_f32 v5, v5
  s_nop 0
  v_mul_f32 v13, v13, v5
  v_cvt_pk_bf16_f32 v13, v13, v13
  v_lshlrev_b32 v13, 16, v13
  v_lshlrev_b32 v14, 16, v14
  v_mul_f32 v5, 0xbfb8aa3b, v14
  v_exp_f32 v5, v5
  s_nop 0
  v_add_f32 v5, 1.0, v5
  v_rcp_f32 v5, v5
  s_nop 0
  v_mul_f32 v14, v14, v5
  v_cvt_pk_bf16_f32 v14, v14, v14
  v_lshlrev_b32 v14, 16, v14
  v_lshlrev_b32 v15, 16, v15
  v_mul_f32 v5, 0xbfb8aa3b, v15
  v_exp_f32 v5, v5
  s_nop 0
  v_add_f32 v5, 1.0, v5
  v_rcp_f32 v5, v5
  s_nop 0
  v_mul_f32 v15, v15, v5
  v_cvt_pk_bf16_f32 v15, v15, v15
  v_lshlrev_b32 v15, 16, v15
  v_lshlrev_b32 v16, 16, v16
  v_mul_f32 v5, 0xbfb8aa3b, v16
  v_exp_f32 v5, v5
  s_nop 0
  v_add_f32 v5, 1.0, v5
  v_rcp_f32 v5, v5
  s_nop 0
  v_mul_f32 v16, v16, v5
  v_cvt_pk_bf16_f32 v16, v16, v16
  v_lshlrev_b32 v16, 16, v16
  v_lshlrev_b32 v17, 16, v17
  v_mul_f32 v5, 0xbfb8aa3b, v17
  v_exp_f32 v5, v5
  s_nop 0
  v_add_f32 v5, 1.0, v5
  v_rcp_f32 v5, v5
  s_nop 0
  v_mul_f32 v17, v17, v5
  v_cvt_pk_bf16_f32 v17, v17, v17
  v_lshlrev_b32 v17, 16, v17
  v_lshlrev_b32 v18, 16, v18
  v_mul_f32 v5, 0xbfb8aa3b, v18
  v_exp_f32 v5, v5
  s_nop 0
  v_add_f32 v5, 1.0, v5
  v_rcp_f32 v5, v5
  s_nop 0
  v_mul_f32 v18, v18, v5
  v_cvt_pk_bf16_f32 v18, v18, v18
  v_lshlrev_b32 v18, 16, v18
  v_lshlrev_b32 v19, 16, v19
  v_mul_f32 v5, 0xbfb8aa3b, v19
  v_exp_f32 v5, v5
  s_nop 0
  v_add_f32 v5, 1.0, v5
  v_rcp_f32 v5, v5
  s_nop 0
  v_mul_f32 v19, v19, v5
  v_cvt_pk_bf16_f32 v19, v19, v19
  v_lshlrev_b32 v19, 16, v19
  v_lshlrev_b32 v248, 7, v1
  v_lshl_add_u32 v248, v9, 5, v248
  v_add_u32 v248, 16384, v248
  v_and_b32 v6, 31, v0
  v_lshrrev_b32 v249, 5, v0
  v_lshlrev_b32 v249, 10, v249
  v_lshl_add_u32 v249, v6, 2, v249
  v_add_u32 v249, 16384, v249
  v_lshlrev_b32 v250, 2, v0
  v_mov_b32 v240, 0
  v_mov_b32 v241, 0
  v_mov_b32 v242, 0
  v_mov_b32 v243, 0
  v_mov_b32 v244, 0
  v_mov_b32 v245, 0
  v_mov_b32 v246, 0
  v_mov_b32 v247, 0
  s_waitcnt vmcnt(29)
  v_lshlrev_b32 v5, 16, v20
  v_and_b32 v6, 0xffff0000, v20
  v_fmac_f32 v240, v10, v5
  v_fmac_f32 v241, v10, v6
  v_lshlrev_b32 v5, 16, v21
  v_and_b32 v6, 0xffff0000, v21
  v_fmac_f32 v242, v10, v5
  v_fmac_f32 v243, v10, v6
  v_lshlrev_b32 v5, 16, v22
  v_and_b32 v6, 0xffff0000, v22
  v_fmac_f32 v244, v10, v5
  v_fmac_f32 v245, v10, v6
  v_lshlrev_b32 v5, 16, v23
  v_and_b32 v6, 0xffff0000, v23
  v_fmac_f32 v246, v10, v5
  v_fmac_f32 v247, v10, v6
  s_waitcnt vmcnt(28)
  v_lshlrev_b32 v5, 16, v24
  v_and_b32 v6, 0xffff0000, v24
  v_fmac_f32 v240, v11, v5
  v_fmac_f32 v241, v11, v6
  v_lshlrev_b32 v5, 16, v25
  v_and_b32 v6, 0xffff0000, v25
  v_fmac_f32 v242, v11, v5
  v_fmac_f32 v243, v11, v6
  v_lshlrev_b32 v5, 16, v26
  v_and_b32 v6, 0xffff0000, v26
  v_fmac_f32 v244, v11, v5
  v_fmac_f32 v245, v11, v6
  v_lshlrev_b32 v5, 16, v27
  v_and_b32 v6, 0xffff0000, v27
  v_fmac_f32 v246, v11, v5
  v_fmac_f32 v247, v11, v6
  s_waitcnt vmcnt(27)
  v_lshlrev_b32 v5, 16, v28
  v_and_b32 v6, 0xffff0000, v28
  v_fmac_f32 v240, v12, v5
  v_fmac_f32 v241, v12, v6
  v_lshlrev_b32 v5, 16, v29
  v_and_b32 v6, 0xffff0000, v29
  v_fmac_f32 v242, v12, v5
  v_fmac_f32 v243, v12, v6
  v_lshlrev_b32 v5, 16, v30
  v_and_b32 v6, 0xffff0000, v30
  v_fmac_f32 v244, v12, v5
  v_fmac_f32 v245, v12, v6
  v_lshlrev_b32 v5, 16, v31
  v_and_b32 v6, 0xffff0000, v31
  v_fmac_f32 v246, v12, v5
  v_fmac_f32 v247, v12, v6
  s_waitcnt vmcnt(26)
  v_lshlrev_b32 v5, 16, v32
  v_and_b32 v6, 0xffff0000, v32
  v_fmac_f32 v240, v13, v5
  v_fmac_f32 v241, v13, v6
  v_lshlrev_b32 v5, 16, v33
  v_and_b32 v6, 0xffff0000, v33
  v_fmac_f32 v242, v13, v5
  v_fmac_f32 v243, v13, v6
  v_lshlrev_b32 v5, 16, v34
  v_and_b32 v6, 0xffff0000, v34
  v_fmac_f32 v244, v13, v5
  v_fmac_f32 v245, v13, v6
  v_lshlrev_b32 v5, 16, v35
  v_and_b32 v6, 0xffff0000, v35
  v_fmac_f32 v246, v13, v5
  v_fmac_f32 v247, v13, v6
  s_waitcnt vmcnt(25)
  v_lshlrev_b32 v5, 16, v36
  v_and_b32 v6, 0xffff0000, v36
  v_fmac_f32 v240, v14, v5
  v_fmac_f32 v241, v14, v6
  v_lshlrev_b32 v5, 16, v37
  v_and_b32 v6, 0xffff0000, v37
  v_fmac_f32 v242, v14, v5
  v_fmac_f32 v243, v14, v6
  v_lshlrev_b32 v5, 16, v38
  v_and_b32 v6, 0xffff0000, v38
  v_fmac_f32 v244, v14, v5
  v_fmac_f32 v245, v14, v6
  v_lshlrev_b32 v5, 16, v39
  v_and_b32 v6, 0xffff0000, v39
  v_fmac_f32 v246, v14, v5
  v_fmac_f32 v247, v14, v6
  s_waitcnt vmcnt(24)
  v_lshlrev_b32 v5, 16, v40
  v_and_b32 v6, 0xffff0000, v40
  v_fmac_f32 v240, v15, v5
  v_fmac_f32 v241, v15, v6
  v_lshlrev_b32 v5, 16, v41
  v_and_b32 v6, 0xffff0000, v41
  v_fmac_f32 v242, v15, v5
  v_fmac_f32 v243, v15, v6
  v_lshlrev_b32 v5, 16, v42
  v_and_b32 v6, 0xffff0000, v42
  v_fmac_f32 v244, v15, v5
  v_fmac_f32 v245, v15, v6
  v_lshlrev_b32 v5, 16, v43
  v_and_b32 v6, 0xffff0000, v43
  v_fmac_f32 v246, v15, v5
  v_fmac_f32 v247, v15, v6
  s_waitcnt vmcnt(23)
  v_lshlrev_b32 v5, 16, v44
  v_and_b32 v6, 0xffff0000, v44
  v_fmac_f32 v240, v16, v5
  v_fmac_f32 v241, v16, v6
  v_lshlrev_b32 v5, 16, v45
  v_and_b32 v6, 0xffff0000, v45
  v_fmac_f32 v242, v16, v5
  v_fmac_f32 v243, v16, v6
  v_lshlrev_b32 v5, 16, v46
  v_and_b32 v6, 0xffff0000, v46
  v_fmac_f32 v244, v16, v5
  v_fmac_f32 v245, v16, v6
  v_lshlrev_b32 v5, 16, v47
  v_and_b32 v6, 0xffff0000, v47
  v_fmac_f32 v246, v16, v5
  v_fmac_f32 v247, v16, v6
  s_waitcnt vmcnt(22)
  v_lshlrev_b32 v5, 16, v48
  v_and_b32 v6, 0xffff0000, v48
  v_fmac_f32 v240, v17, v5
  v_fmac_f32 v241, v17, v6
  v_lshlrev_b32 v5, 16, v49
  v_and_b32 v6, 0xffff0000, v49
  v_fmac_f32 v242, v17, v5
  v_fmac_f32 v243, v17, v6
  v_lshlrev_b32 v5, 16, v50
  v_and_b32 v6, 0xffff0000, v50
  v_fmac_f32 v244, v17, v5
  v_fmac_f32 v245, v17, v6
  v_lshlrev_b32 v5, 16, v51
  v_and_b32 v6, 0xffff0000, v51
  v_fmac_f32 v246, v17, v5
  v_fmac_f32 v247, v17, v6
  s_waitcnt vmcnt(21)
  v_lshlrev_b32 v5, 16, v52
  v_and_b32 v6, 0xffff0000, v52
  v_fmac_f32 v240, v18, v5
  v_fmac_f32 v241, v18, v6
  v_lshlrev_b32 v5, 16, v53
  v_and_b32 v6, 0xffff0000, v53
  v_fmac_f32 v242, v18, v5
  v_fmac_f32 v243, v18, v6
  v_lshlrev_b32 v5, 16, v54
  v_and_b32 v6, 0xffff0000, v54
  v_fmac_f32 v244, v18, v5
  v_fmac_f32 v245, v18, v6
  v_lshlrev_b32 v5, 16, v55
  v_and_b32 v6, 0xffff0000, v55
  v_fmac_f32 v246, v18, v5
  v_fmac_f32 v247, v18, v6
  s_waitcnt vmcnt(20)
  v_lshlrev_b32 v5, 16, v56
  v_and_b32 v6, 0xffff0000, v56
  v_fmac_f32 v240, v19, v5
  v_fmac_f32 v241, v19, v6
  v_lshlrev_b32 v5, 16, v57
  v_and_b32 v6, 0xffff0000, v57
  v_fmac_f32 v242, v19, v5
  v_fmac_f32 v243, v19, v6
  v_lshlrev_b32 v5, 16, v58
  v_and_b32 v6, 0xffff0000, v58
  v_fmac_f32 v244, v19, v5
  v_fmac_f32 v245, v19, v6
  v_lshlrev_b32 v5, 16, v59
  v_and_b32 v6, 0xffff0000, v59
  v_fmac_f32 v246, v19, v5
  v_fmac_f32 v247, v19, v6
  ds_write_b128 v248, v[240:243]
  ds_write_b128 v248, v[244:247] offset:16
  s_waitcnt lgkmcnt(0)
  s_barrier
  ds_read_b32 v240, v249 offset:0
  ds_read_b32 v241, v249 offset:128
  ds_read_b32 v242, v249 offset:256
  ds_read_b32 v243, v249 offset:384
  ds_read_b32 v244, v249 offset:512
  ds_read_b32 v245, v249 offset:640
  ds_read_b32 v246, v249 offset:768
  ds_read_b32 v247, v249 offset:896
  s_waitcnt lgkmcnt(0)
  v_add_f32 v240, v240, v241
  v_add_f32 v240, v240, v242
  v_add_f32 v240, v240, v243
  v_add_f32 v240, v240, v244
  v_add_f32 v240, v240, v245
  v_add_f32 v240, v240, v246
  v_add_f32 v240, v240, v247
  ds_write_b32 v250, v240 offset:24576
  s_waitcnt lgkmcnt(0)
  s_barrier
  v_cmp_gt_u32 vcc, 32, v0
  s_nop 0
  s_and_saveexec_b64 s[30:31], vcc
  s_cbranch_execz G3_mq00
  ds_read_b32 v240, v250 offset:24576
  ds_read_b32 v241, v250 offset:24704
  ds_read_b32 v242, v250 offset:24832
  ds_read_b32 v243, v250 offset:24960
  ds_read_b32 v244, v250 offset:25088
  ds_read_b32 v245, v250 offset:25216
  ds_read_b32 v246, v250 offset:25344
  ds_read_b32 v247, v250 offset:25472
  s_waitcnt lgkmcnt(0)
  v_add_f32 v240, v240, v241
  v_add_f32 v240, v240, v242
  v_add_f32 v240, v240, v243
  v_add_f32 v240, v240, v244
  v_add_f32 v240, v240, v245
  v_add_f32 v240, v240, v246
  v_add_f32 v240, v240, v247
  v_cvt_pk_bf16_f32 v240, v240, v240
  v_lshlrev_b32 v240, 16, v240
  s_add_u32 s28, s5, 40
  s_mul_i32 s29, s28, 52429
  s_lshr_b32 s29, s29, 20
  s_cmp_eq_u32 s29, 1
  s_cselect_b32 s58, 1, 0
  s_cmp_eq_u32 s29, 4
  s_cselect_b32 s58, 1, s58
  s_cmp_eq_u32 s58, 0
  s_cbranch_scc1 G3_nq00
  v_add_f32 v240, 1.0, v240
  v_cvt_pk_bf16_f32 v240, v240, v240
  v_lshlrev_b32 v240, 16, v240
G3_nq00:
  s_lshl_b32 s28, s28, 7
  v_add_u32 v5, s28, v250
  buffer_store_dword v240, v5, s[8:11], 0 offen offset:0 sc1
G3_mq00:
  s_mov_b64 exec, s[30:31]
  v_mov_b32 v240, 0
  v_mov_b32 v241, 0
  v_mov_b32 v242, 0
  v_mov_b32 v243, 0
  v_mov_b32 v244, 0
  v_mov_b32 v245, 0
  v_mov_b32 v246, 0
  v_mov_b32 v247, 0
  s_waitcnt vmcnt(19)
  v_lshlrev_b32 v5, 16, v60
  v_and_b32 v6, 0xffff0000, v60
  v_fmac_f32 v240, v10, v5
  v_fmac_f32 v241, v10, v6
  v_lshlrev_b32 v5, 16, v61
  v_and_b32 v6, 0xffff0000, v61
  v_fmac_f32 v242, v10, v5
  v_fmac_f32 v243, v10, v6
  v_lshlrev_b32 v5, 16, v62
  v_and_b32 v6, 0xffff0000, v62
  v_fmac_f32 v244, v10, v5
  v_fmac_f32 v245, v10, v6
  v_lshlrev_b32 v5, 16, v63
  v_and_b32 v6, 0xffff0000, v63
  v_fmac_f32 v246, v10, v5
  v_fmac_f32 v247, v10, v6
  s_waitcnt vmcnt(18)
  v_lshlrev_b32 v5, 16, v64
  v_and_b32 v6, 0xffff0000, v64
  v_fmac_f32 v240, v11, v5
  v_fmac_f32 v241, v11, v6
  v_lshlrev_b32 v5, 16, v65
  v_and_b32 v6, 0xffff0000, v65
  v_fmac_f32 v242, v11, v5
  v_fmac_f32 v243, v11, v6
  v_lshlrev_b32 v5, 16, v66
  v_and_b32 v6, 0xffff0000, v66
  v_fmac_f32 v244, v11, v5
  v_fmac_f32 v245, v11, v6
  v_lshlrev_b32 v5, 16, v67
  v_and_b32 v6, 0xffff0000, v67
  v_fmac_f32 v246, v11, v5
  v_fmac_f32 v247, v11, v6
  s_waitcnt vmcnt(17)
  v_lshlrev_b32 v5, 16, v68
  v_and_b32 v6, 0xffff0000, v68
  v_fmac_f32 v240, v12, v5
  v_fmac_f32 v241, v12, v6
  v_lshlrev_b32 v5, 16, v69
  v_and_b32 v6, 0xffff0000, v69
  v_fmac_f32 v242, v12, v5
  v_fmac_f32 v243, v12, v6
  v_lshlrev_b32 v5, 16, v70
  v_and_b32 v6, 0xffff0000, v70
  v_fmac_f32 v244, v12, v5
  v_fmac_f32 v245, v12, v6
  v_lshlrev_b32 v5, 16, v71
  v_and_b32 v6, 0xffff0000, v71
  v_fmac_f32 v246, v12, v5
  v_fmac_f32 v247, v12, v6
  s_waitcnt vmcnt(16)
  v_lshlrev_b32 v5, 16, v72
  v_and_b32 v6, 0xffff0000, v72
  v_fmac_f32 v240, v13, v5
  v_fmac_f32 v241, v13, v6
  v_lshlrev_b32 v5, 16, v73
  v_and_b32 v6, 0xffff0000, v73
  v_fmac_f32 v242, v13, v5
  v_fmac_f32 v243, v13, v6
  v_lshlrev_b32 v5, 16, v74
  v_and_b32 v6, 0xffff0000, v74
  v_fmac_f32 v244, v13, v5
  v_fmac_f32 v245, v13, v6
  v_lshlrev_b32 v5, 16, v75
  v_and_b32 v6, 0xffff0000, v75
  v_fmac_f32 v246, v13, v5
  v_fmac_f32 v247, v13, v6
  s_waitcnt vmcnt(15)
  v_lshlrev_b32 v5, 16, v76
  v_and_b32 v6, 0xffff0000, v76
  v_fmac_f32 v240, v14, v5
  v_fmac_f32 v241, v14, v6
  v_lshlrev_b32 v5, 16, v77
  v_and_b32 v6, 0xffff0000, v77
  v_fmac_f32 v242, v14, v5
  v_fmac_f32 v243, v14, v6
  v_lshlrev_b32 v5, 16, v78
  v_and_b32 v6, 0xffff0000, v78
  v_fmac_f32 v244, v14, v5
  v_fmac_f32 v245, v14, v6
  v_lshlrev_b32 v5, 16, v79
  v_and_b32 v6, 0xffff0000, v79
  v_fmac_f32 v246, v14, v5
  v_fmac_f32 v247, v14, v6
  s_waitcnt vmcnt(14)
  v_lshlrev_b32 v5, 16, v80
  v_and_b32 v6, 0xffff0000, v80
  v_fmac_f32 v240, v15, v5
  v_fmac_f32 v241, v15, v6
  v_lshlrev_b32 v5, 16, v81
  v_and_b32 v6, 0xffff0000, v81
  v_fmac_f32 v242, v15, v5
  v_fmac_f32 v243, v15, v6
  v_lshlrev_b32 v5, 16, v82
  v_and_b32 v6, 0xffff0000, v82
  v_fmac_f32 v244, v15, v5
  v_fmac_f32 v245, v15, v6
  v_lshlrev_b32 v5, 16, v83
  v_and_b32 v6, 0xffff0000, v83
  v_fmac_f32 v246, v15, v5
  v_fmac_f32 v247, v15, v6
  s_waitcnt vmcnt(13)
  v_lshlrev_b32 v5, 16, v84
  v_and_b32 v6, 0xffff0000, v84
  v_fmac_f32 v240, v16, v5
  v_fmac_f32 v241, v16, v6
  v_lshlrev_b32 v5, 16, v85
  v_and_b32 v6, 0xffff0000, v85
  v_fmac_f32 v242, v16, v5
  v_fmac_f32 v243, v16, v6
  v_lshlrev_b32 v5, 16, v86
  v_and_b32 v6, 0xffff0000, v86
  v_fmac_f32 v244, v16, v5
  v_fmac_f32 v245, v16, v6
  v_lshlrev_b32 v5, 16, v87
  v_and_b32 v6, 0xffff0000, v87
  v_fmac_f32 v246, v16, v5
  v_fmac_f32 v247, v16, v6
  s_waitcnt vmcnt(12)
  v_lshlrev_b32 v5, 16, v88
  v_and_b32 v6, 0xffff0000, v88
  v_fmac_f32 v240, v17, v5
  v_fmac_f32 v241, v17, v6
  v_lshlrev_b32 v5, 16, v89
  v_and_b32 v6, 0xffff0000, v89
  v_fmac_f32 v242, v17, v5
  v_fmac_f32 v243, v17, v6
  v_lshlrev_b32 v5, 16, v90
  v_and_b32 v6, 0xffff0000, v90
  v_fmac_f32 v244, v17, v5
  v_fmac_f32 v245, v17, v6
  v_lshlrev_b32 v5, 16, v91
  v_and_b32 v6, 0xffff0000, v91
  v_fmac_f32 v246, v17, v5
  v_fmac_f32 v247, v17, v6
  s_waitcnt vmcnt(11)
  v_lshlrev_b32 v5, 16, v92
  v_and_b32 v6, 0xffff0000, v92
  v_fmac_f32 v240, v18, v5
  v_fmac_f32 v241, v18, v6
  v_lshlrev_b32 v5, 16, v93
  v_and_b32 v6, 0xffff0000, v93
  v_fmac_f32 v242, v18, v5
  v_fmac_f32 v243, v18, v6
  v_lshlrev_b32 v5, 16, v94
  v_and_b32 v6, 0xffff0000, v94
  v_fmac_f32 v244, v18, v5
  v_fmac_f32 v245, v18, v6
  v_lshlrev_b32 v5, 16, v95
  v_and_b32 v6, 0xffff0000, v95
  v_fmac_f32 v246, v18, v5
  v_fmac_f32 v247, v18, v6
  s_waitcnt vmcnt(10)
  v_lshlrev_b32 v5, 16, v96
  v_and_b32 v6, 0xffff0000, v96
  v_fmac_f32 v240, v19, v5
  v_fmac_f32 v241, v19, v6
  v_lshlrev_b32 v5, 16, v97
  v_and_b32 v6, 0xffff0000, v97
  v_fmac_f32 v242, v19, v5
  v_fmac_f32 v243, v19, v6
  v_lshlrev_b32 v5, 16, v98
  v_and_b32 v6, 0xffff0000, v98
  v_fmac_f32 v244, v19, v5
  v_fmac_f32 v245, v19, v6
  v_lshlrev_b32 v5, 16, v99
  v_and_b32 v6, 0xffff0000, v99
  v_fmac_f32 v246, v19, v5
  v_fmac_f32 v247, v19, v6
  ds_write_b128 v248, v[240:243]
  ds_write_b128 v248, v[244:247] offset:16
  s_waitcnt lgkmcnt(0)
  s_barrier
  ds_read_b32 v240, v249 offset:0
  ds_read_b32 v241, v249 offset:128
  ds_read_b32 v242, v249 offset:256
  ds_read_b32 v243, v249 offset:384
  ds_read_b32 v244, v249 offset:512
  ds_read_b32 v245, v249 offset:640
  ds_read_b32 v246, v249 offset:768
  ds_read_b32 v247, v249 offset:896
  s_waitcnt lgkmcnt(0)
  v_add_f32 v240, v240, v241
  v_add_f32 v240, v240, v242
  v_add_f32 v240, v240, v243
  v_add_f32 v240, v240, v244
  v_add_f32 v240, v240, v245
  v_add_f32 v240, v240, v246
  v_add_f32 v240, v240, v247
  ds_write_b32 v250, v240 offset:24576
  s_waitcnt lgkmcnt(0)
  s_barrier
  v_cmp_gt_u32 vcc, 32, v0
  s_nop 0
  s_and_saveexec_b64 s[30:31], vcc
  s_cbranch_execz G3_mq01
  ds_read_b32 v240, v250 offset:24576
  ds_read_b32 v241, v250 offset:24704
  ds_read_b32 v242, v250 offset:24832
  ds_read_b32 v243, v250 offset:24960
  ds_read_b32 v244, v250 offset:25088
  ds_read_b32 v245, v250 offset:25216
  ds_read_b32 v246, v250 offset:25344
  ds_read_b32 v247, v250 offset:25472
  s_waitcnt lgkmcnt(0)
  v_add_f32 v240, v240, v241
  v_add_f32 v240, v240, v242
  v_add_f32 v240, v240, v243
  v_add_f32 v240, v240, v244
  v_add_f32 v240, v240, v245
  v_add_f32 v240, v240, v246
  v_add_f32 v240, v240, v247
  v_cvt_pk_bf16_f32 v240, v240, v240
  v_lshlrev_b32 v240, 16, v240
  s_add_u32 s28, s5, 72
  s_mul_i32 s29, s28, 52429
  s_lshr_b32 s29, s29, 20
  s_cmp_eq_u32 s29, 1
  s_cselect_b32 s58, 1, 0
  s_cmp_eq_u32 s29, 4
  s_cselect_b32 s58, 1, s58
  s_cmp_eq_u32 s58, 0
  s_cbranch_scc1 G3_nq01
  v_add_f32 v240, 1.0, v240
  v_cvt_pk_bf16_f32 v240, v240, v240
  v_lshlrev_b32 v240, 16, v240
G3_nq01:
  s_lshl_b32 s28, s28, 7
  v_add_u32 v5, s28, v250
  buffer_store_dword v240, v5, s[8:11], 0 offen offset:0 sc1
G3_mq01:
  s_mov_b64 exec, s[30:31]
  v_mov_b32 v240, 0
  v_mov_b32 v241, 0
  v_mov_b32 v242, 0
  v_mov_b32 v243, 0
  v_mov_b32 v244, 0
  v_mov_b32 v245, 0
  v_mov_b32 v246, 0
  v_mov_b32 v247, 0
  s_waitcnt vmcnt(9)
  v_lshlrev_b32 v5, 16, v100
  v_and_b32 v6, 0xffff0000, v100
  v_fmac_f32 v240, v10, v5
  v_fmac_f32 v241, v10, v6
  v_lshlrev_b32 v5, 16, v101
  v_and_b32 v6, 0xffff0000, v101
  v_fmac_f32 v242, v10, v5
  v_fmac_f32 v243, v10, v6
  v_lshlrev_b32 v5, 16, v102
  v_and_b32 v6, 0xffff0000, v102
  v_fmac_f32 v244, v10, v5
  v_fmac_f32 v245, v10, v6
  v_lshlrev_b32 v5, 16, v103
  v_and_b32 v6, 0xffff0000, v103
  v_fmac_f32 v246, v10, v5
  v_fmac_f32 v247, v10, v6
  s_waitcnt vmcnt(8)
  v_lshlrev_b32 v5, 16, v104
  v_and_b32 v6, 0xffff0000, v104
  v_fmac_f32 v240, v11, v5
  v_fmac_f32 v241, v11, v6
  v_lshlrev_b32 v5, 16, v105
  v_and_b32 v6, 0xffff0000, v105
  v_fmac_f32 v242, v11, v5
  v_fmac_f32 v243, v11, v6
  v_lshlrev_b32 v5, 16, v106
  v_and_b32 v6, 0xffff0000, v106
  v_fmac_f32 v244, v11, v5
  v_fmac_f32 v245, v11, v6
  v_lshlrev_b32 v5, 16, v107
  v_and_b32 v6, 0xffff0000, v107
  v_fmac_f32 v246, v11, v5
  v_fmac_f32 v247, v11, v6
  s_waitcnt vmcnt(7)
  v_lshlrev_b32 v5, 16, v108
  v_and_b32 v6, 0xffff0000, v108
  v_fmac_f32 v240, v12, v5
  v_fmac_f32 v241, v12, v6
  v_lshlrev_b32 v5, 16, v109
  v_and_b32 v6, 0xffff0000, v109
  v_fmac_f32 v242, v12, v5
  v_fmac_f32 v243, v12, v6
  v_lshlrev_b32 v5, 16, v110
  v_and_b32 v6, 0xffff0000, v110
  v_fmac_f32 v244, v12, v5
  v_fmac_f32 v245, v12, v6
  v_lshlrev_b32 v5, 16, v111
  v_and_b32 v6, 0xffff0000, v111
  v_fmac_f32 v246, v12, v5
  v_fmac_f32 v247, v12, v6
  s_waitcnt vmcnt(6)
  v_lshlrev_b32 v5, 16, v112
  v_and_b32 v6, 0xffff0000, v112
  v_fmac_f32 v240, v13, v5
  v_fmac_f32 v241, v13, v6
  v_lshlrev_b32 v5, 16, v113
  v_and_b32 v6, 0xffff0000, v113
  v_fmac_f32 v242, v13, v5
  v_fmac_f32 v243, v13, v6
  v_lshlrev_b32 v5, 16, v114
  v_and_b32 v6, 0xffff0000, v114
  v_fmac_f32 v244, v13, v5
  v_fmac_f32 v245, v13, v6
  v_lshlrev_b32 v5, 16, v115
  v_and_b32 v6, 0xffff0000, v115
  v_fmac_f32 v246, v13, v5
  v_fmac_f32 v247, v13, v6
  s_waitcnt vmcnt(5)
  v_lshlrev_b32 v5, 16, v116
  v_and_b32 v6, 0xffff0000, v116
  v_fmac_f32 v240, v14, v5
  v_fmac_f32 v241, v14, v6
  v_lshlrev_b32 v5, 16, v117
  v_and_b32 v6, 0xffff0000, v117
  v_fmac_f32 v242, v14, v5
  v_fmac_f32 v243, v14, v6
  v_lshlrev_b32 v5, 16, v118
  v_and_b32 v6, 0xffff0000, v118
  v_fmac_f32 v244, v14, v5
  v_fmac_f32 v245, v14, v6
  v_lshlrev_b32 v5, 16, v119
  v_and_b32 v6, 0xffff0000, v119
  v_fmac_f32 v246, v14, v5
  v_fmac_f32 v247, v14, v6
  s_waitcnt vmcnt(4)
  v_lshlrev_b32 v5, 16, v120
  v_and_b32 v6, 0xffff0000, v120
  v_fmac_f32 v240, v15, v5
  v_fmac_f32 v241, v15, v6
  v_lshlrev_b32 v5, 16, v121
  v_and_b32 v6, 0xffff0000, v121
  v_fmac_f32 v242, v15, v5
  v_fmac_f32 v243, v15, v6
  v_lshlrev_b32 v5, 16, v122
  v_and_b32 v6, 0xffff0000, v122
  v_fmac_f32 v244, v15, v5
  v_fmac_f32 v245, v15, v6
  v_lshlrev_b32 v5, 16, v123
  v_and_b32 v6, 0xffff0000, v123
  v_fmac_f32 v246, v15, v5
  v_fmac_f32 v247, v15, v6
  s_waitcnt vmcnt(3)
  v_lshlrev_b32 v5, 16, v124
  v_and_b32 v6, 0xffff0000, v124
  v_fmac_f32 v240, v16, v5
  v_fmac_f32 v241, v16, v6
  v_lshlrev_b32 v5, 16, v125
  v_and_b32 v6, 0xffff0000, v125
  v_fmac_f32 v242, v16, v5
  v_fmac_f32 v243, v16, v6
  v_lshlrev_b32 v5, 16, v126
  v_and_b32 v6, 0xffff0000, v126
  v_fmac_f32 v244, v16, v5
  v_fmac_f32 v245, v16, v6
  v_lshlrev_b32 v5, 16, v127
  v_and_b32 v6, 0xffff0000, v127
  v_fmac_f32 v246, v16, v5
  v_fmac_f32 v247, v16, v6
  s_waitcnt vmcnt(2)
  v_lshlrev_b32 v5, 16, v128
  v_and_b32 v6, 0xffff0000, v128
  v_fmac_f32 v240, v17, v5
  v_fmac_f32 v241, v17, v6
  v_lshlrev_b32 v5, 16, v129
  v_and_b32 v6, 0xffff0000, v129
  v_fmac_f32 v242, v17, v5
  v_fmac_f32 v243, v17, v6
  v_lshlrev_b32 v5, 16, v130
  v_and_b32 v6, 0xffff0000, v130
  v_fmac_f32 v244, v17, v5
  v_fmac_f32 v245, v17, v6
  v_lshlrev_b32 v5, 16, v131
  v_and_b32 v6, 0xffff0000, v131
  v_fmac_f32 v246, v17, v5
  v_fmac_f32 v247, v17, v6
  s_waitcnt vmcnt(1)
  v_lshlrev_b32 v5, 16, v132
  v_and_b32 v6, 0xffff0000, v132
  v_fmac_f32 v240, v18, v5
  v_fmac_f32 v241, v18, v6
  v_lshlrev_b32 v5, 16, v133
  v_and_b32 v6, 0xffff0000, v133
  v_fmac_f32 v242, v18, v5
  v_fmac_f32 v243, v18, v6
  v_lshlrev_b32 v5, 16, v134
  v_and_b32 v6, 0xffff0000, v134
  v_fmac_f32 v244, v18, v5
  v_fmac_f32 v245, v18, v6
  v_lshlrev_b32 v5, 16, v135
  v_and_b32 v6, 0xffff0000, v135
  v_fmac_f32 v246, v18, v5
  v_fmac_f32 v247, v18, v6
  s_waitcnt vmcnt(0)
  v_lshlrev_b32 v5, 16, v136
  v_and_b32 v6, 0xffff0000, v136
  v_fmac_f32 v240, v19, v5
  v_fmac_f32 v241, v19, v6
  v_lshlrev_b32 v5, 16, v137
  v_and_b32 v6, 0xffff0000, v137
  v_fmac_f32 v242, v19, v5
  v_fmac_f32 v243, v19, v6
  v_lshlrev_b32 v5, 16, v138
  v_and_b32 v6, 0xffff0000, v138
  v_fmac_f32 v244, v19, v5
  v_fmac_f32 v245, v19, v6
  v_lshlrev_b32 v5, 16, v139
  v_and_b32 v6, 0xffff0000, v139
  v_fmac_f32 v246, v19, v5
  v_fmac_f32 v247, v19, v6
  ds_write_b128 v248, v[240:243]
  ds_write_b128 v248, v[244:247] offset:16
  s_waitcnt lgkmcnt(0)
  s_barrier
  ds_read_b32 v240, v249 offset:0
  ds_read_b32 v241, v249 offset:128
  ds_read_b32 v242, v249 offset:256
  ds_read_b32 v243, v249 offset:384
  ds_read_b32 v244, v249 offset:512
  ds_read_b32 v245, v249 offset:640
  ds_read_b32 v246, v249 offset:768
  ds_read_b32 v247, v249 offset:896
  s_waitcnt lgkmcnt(0)
  v_add_f32 v240, v240, v241
  v_add_f32 v240, v240, v242
  v_add_f32 v240, v240, v243
  v_add_f32 v240, v240, v244
  v_add_f32 v240, v240, v245
  v_add_f32 v240, v240, v246
  v_add_f32 v240, v240, v247
  ds_write_b32 v250, v240 offset:24576
  s_waitcnt lgkmcnt(0)
  s_barrier
  v_cmp_gt_u32 vcc, 32, v0
  s_nop 0
  s_and_saveexec_b64 s[30:31], vcc
  s_cbranch_execz G3_mq02
  ds_read_b32 v240, v250 offset:24576
  ds_read_b32 v241, v250 offset:24704
  ds_read_b32 v242, v250 offset:24832
  ds_read_b32 v243, v250 offset:24960
  ds_read_b32 v244, v250 offset:25088
  ds_read_b32 v245, v250 offset:25216
  ds_read_b32 v246, v250 offset:25344
  ds_read_b32 v247, v250 offset:25472
  s_waitcnt lgkmcnt(0)
  v_add_f32 v240, v240, v241
  v_add_f32 v240, v240, v242
  v_add_f32 v240, v240, v243
  v_add_f32 v240, v240, v244
  v_add_f32 v240, v240, v245
  v_add_f32 v240, v240, v246
  v_add_f32 v240, v240, v247
  v_cvt_pk_bf16_f32 v240, v240, v240
  v_lshlrev_b32 v240, 16, v240
  s_add_u32 s28, s5, 104
  s_mul_i32 s29, s28, 52429
  s_lshr_b32 s29, s29, 20
  s_cmp_eq_u32 s29, 1
  s_cselect_b32 s58, 1, 0
  s_cmp_eq_u32 s29, 4
  s_cselect_b32 s58, 1, s58
  s_cmp_eq_u32 s58, 0
  s_cbranch_scc1 G3_nq02
  v_add_f32 v240, 1.0, v240
  v_cvt_pk_bf16_f32 v240, v240, v240
  v_lshlrev_b32 v240, 16, v240
G3_nq02:
  s_lshl_b32 s28, s28, 7
  v_add_u32 v5, s28, v250
  buffer_store_dword v240, v5, s[8:11], 0 offen offset:0 sc1
G3_mq02:
  s_mov_b64 exec, s[30:31]
  s_branch G2_d
G2_v1:
  s_mov_b32 s28, 2560
  buffer_load_dwordx4 v[20:23], v7, s[52:55], s28 offen
  s_mov_b32 s28, 494080
  buffer_load_dwordx4 v[24:27], v7, s[52:55], s28 offen
  s_mov_b32 s28, 985600
  buffer_load_dwordx4 v[28:31], v7, s[52:55], s28 offen
  s_mov_b32 s28, 1477120
  buffer_load_dwordx4 v[32:35], v7, s[52:55], s28 offen
  s_mov_b32 s28, 1968640
  buffer_load_dwordx4 v[36:39], v7, s[52:55], s28 offen
  s_mov_b32 s28, 2460160
  buffer_load_dwordx4 v[40:43], v7, s[52:55], s28 offen
  s_mov_b32 s28, 2951680
  buffer_load_dwordx4 v[44:47], v7, s[52:55], s28 offen
  s_mov_b32 s28, 3443200
  buffer_load_dwordx4 v[48:51], v7, s[52:55], s28 offen
  s_mov_b32 s28, 3934720
  buffer_load_dwordx4 v[52:55], v7, s[52:55], s28 offen
  s_mov_b32 s28, 4426240
  buffer_load_dwordx4 v[56:59], v7, s[52:55], s28 offen
  s_mov_b32 s28, 4608
  buffer_load_dwordx4 v[60:63], v7, s[52:55], s28 offen
  s_mov_b32 s28, 496128
  buffer_load_dwordx4 v[64:67], v7, s[52:55], s28 offen
  s_mov_b32 s28, 987648
  buffer_load_dwordx4 v[68:71], v7, s[52:55], s28 offen
  s_mov_b32 s28, 1479168
  buffer_load_dwordx4 v[72:75], v7, s[52:55], s28 offen
  s_mov_b32 s28, 1970688
  buffer_load_dwordx4 v[76:79], v7, s[52:55], s28 offen
  s_mov_b32 s28, 2462208
  buffer_load_dwordx4 v[80:83], v7, s[52:55], s28 offen
  s_mov_b32 s28, 2953728
  buffer_load_dwordx4 v[84:87], v7, s[52:55], s28 offen
  s_mov_b32 s28, 3445248
  buffer_load_dwordx4 v[88:91], v7, s[52:55], s28 offen
  s_mov_b32 s28, 3936768
  buffer_load_dwordx4 v[92:95], v7, s[52:55], s28 offen
  s_mov_b32 s28, 4428288
  buffer_load_dwordx4 v[96:99], v7, s[52:55], s28 offen
  s_waitcnt vmcnt(20)
  v_lshlrev_b32 v10, 16, v10
  v_mul_f32 v5, 0xbfb8aa3b, v10
  v_exp_f32 v5, v5
  s_nop 0
  v_add_f32 v5, 1.0, v5
  v_rcp_f32 v5, v5
  s_nop 0
  v_mul_f32 v10, v10, v5
  v_cvt_pk_bf16_f32 v10, v10, v10
  v_lshlrev_b32 v10, 16, v10
  v_lshlrev_b32 v11, 16, v11
  v_mul_f32 v5, 0xbfb8aa3b, v11
  v_exp_f32 v5, v5
  s_nop 0
  v_add_f32 v5, 1.0, v5
  v_rcp_f32 v5, v5
  s_nop 0
  v_mul_f32 v11, v11, v5
  v_cvt_pk_bf16_f32 v11, v11, v11
  v_lshlrev_b32 v11, 16, v11
  v_lshlrev_b32 v12, 16, v12
  v_mul_f32 v5, 0xbfb8aa3b, v12
  v_exp_f32 v5, v5
  s_nop 0
  v_add_f32 v5, 1.0, v5
  v_rcp_f32 v5, v5
  s_nop 0
  v_mul_f32 v12, v12, v5
  v_cvt_pk_bf16_f32 v12, v12, v12
  v_lshlrev_b32 v12, 16, v12
  v_lshlrev_b32 v13, 16, v13
  v_mul_f32 v5, 0xbfb8aa3b, v13
  v_exp_f32 v5, v5
  s_nop 0
  v_add_f32 v5, 1.0, v5
  v_rcp_f32 v5, v5
  s_nop 0
  v_mul_f32 v13, v13, v5
  v_cvt_pk_bf16_f32 v13, v13, v13
  v_lshlrev_b32 v13, 16, v13
  v_lshlrev_b32 v14, 16, v14
  v_mul_f32 v5, 0xbfb8aa3b, v14
  v_exp_f32 v5, v5
  s_nop 0
  v_add_f32 v5, 1.0, v5
  v_rcp_f32 v5, v5
  s_nop 0
  v_mul_f32 v14, v14, v5
  v_cvt_pk_bf16_f32 v14, v14, v14
  v_lshlrev_b32 v14, 16, v14
  v_lshlrev_b32 v15, 16, v15
  v_mul_f32 v5, 0xbfb8aa3b, v15
  v_exp_f32 v5, v5
  s_nop 0
  v_add_f32 v5, 1.0, v5
  v_rcp_f32 v5, v5
  s_nop 0
  v_mul_f32 v15, v15, v5
  v_cvt_pk_bf16_f32 v15, v15, v15
  v_lshlrev_b32 v15, 16, v15
  v_lshlrev_b32 v16, 16, v16
  v_mul_f32 v5, 0xbfb8aa3b, v16
  v_exp_f32 v5, v5
  s_nop 0
  v_add_f32 v5, 1.0, v5
  v_rcp_f32 v5, v5
  s_nop 0
  v_mul_f32 v16, v16, v5
  v_cvt_pk_bf16_f32 v16, v16, v16
  v_lshlrev_b32 v16, 16, v16
  v_lshlrev_b32 v17, 16, v17
  v_mul_f32 v5, 0xbfb8aa3b, v17
  v_exp_f32 v5, v5
  s_nop 0
  v_add_f32 v5, 1.0, v5
  v_rcp_f32 v5, v5
  s_nop 0
  v_mul_f32 v17, v17, v5
  v_cvt_pk_bf16_f32 v17, v17, v17
  v_lshlrev_b32 v17, 16, v17
  v_lshlrev_b32 v18, 16, v18
  v_mul_f32 v5, 0xbfb8aa3b, v18
  v_exp_f32 v5, v5
  s_nop 0
  v_add_f32 v5, 1.0, v5
  v_rcp_f32 v5, v5
  s_nop 0
  v_mul_f32 v18, v18, v5
  v_cvt_pk_bf16_f32 v18, v18, v18
  v_lshlrev_b32 v18, 16, v18
  v_lshlrev_b32 v19, 16, v19
  v_mul_f32 v5, 0xbfb8aa3b, v19
  v_exp_f32 v5, v5
  s_nop 0
  v_add_f32 v5, 1.0, v5
  v_rcp_f32 v5, v5
  s_nop 0
  v_mul_f32 v19, v19, v5
  v_cvt_pk_bf16_f32 v19, v19, v19
  v_lshlrev_b32 v19, 16, v19
  v_lshlrev_b32 v248, 7, v1
  v_lshl_add_u32 v248, v9, 5, v248
  v_add_u32 v248, 16384, v248
  v_and_b32 v6, 31, v0
  v_lshrrev_b32 v249, 5, v0
  v_lshlrev_b32 v249, 10, v249
  v_lshl_add_u32 v249, v6, 2, v249
  v_add_u32 v249, 16384, v249
  v_lshlrev_b32 v250, 2, v0
  v_mov_b32 v240, 0
  v_mov_b32 v241, 0
  v_mov_b32 v242, 0
  v_mov_b32 v243, 0
  v_mov_b32 v244, 0
  v_mov_b32 v245, 0
  v_mov_b32 v246, 0
  v_mov_b32 v247, 0
  s_waitcnt vmcnt(19)
  v_lshlrev_b32 v5, 16, v20
  v_and_b32 v6, 0xffff0000, v20
  v_fmac_f32 v240, v10, v5
  v_fmac_f32 v241, v10, v6
  v_lshlrev_b32 v5, 16, v21
  v_and_b32 v6, 0xffff0000, v21
  v_fmac_f32 v242, v10, v5
  v_fmac_f32 v243, v10, v6
  v_lshlrev_b32 v5, 16, v22
  v_and_b32 v6, 0xffff0000, v22
  v_fmac_f32 v244, v10, v5
  v_fmac_f32 v245, v10, v6
  v_lshlrev_b32 v5, 16, v23
  v_and_b32 v6, 0xffff0000, v23
  v_fmac_f32 v246, v10, v5
  v_fmac_f32 v247, v10, v6
  s_waitcnt vmcnt(18)
  v_lshlrev_b32 v5, 16, v24
  v_and_b32 v6, 0xffff0000, v24
  v_fmac_f32 v240, v11, v5
  v_fmac_f32 v241, v11, v6
  v_lshlrev_b32 v5, 16, v25
  v_and_b32 v6, 0xffff0000, v25
  v_fmac_f32 v242, v11, v5
  v_fmac_f32 v243, v11, v6
  v_lshlrev_b32 v5, 16, v26
  v_and_b32 v6, 0xffff0000, v26
  v_fmac_f32 v244, v11, v5
  v_fmac_f32 v245, v11, v6
  v_lshlrev_b32 v5, 16, v27
  v_and_b32 v6, 0xffff0000, v27
  v_fmac_f32 v246, v11, v5
  v_fmac_f32 v247, v11, v6
  s_waitcnt vmcnt(17)
  v_lshlrev_b32 v5, 16, v28
  v_and_b32 v6, 0xffff0000, v28
  v_fmac_f32 v240, v12, v5
  v_fmac_f32 v241, v12, v6
  v_lshlrev_b32 v5, 16, v29
  v_and_b32 v6, 0xffff0000, v29
  v_fmac_f32 v242, v12, v5
  v_fmac_f32 v243, v12, v6
  v_lshlrev_b32 v5, 16, v30
  v_and_b32 v6, 0xffff0000, v30
  v_fmac_f32 v244, v12, v5
  v_fmac_f32 v245, v12, v6
  v_lshlrev_b32 v5, 16, v31
  v_and_b32 v6, 0xffff0000, v31
  v_fmac_f32 v246, v12, v5
  v_fmac_f32 v247, v12, v6
  s_waitcnt vmcnt(16)
  v_lshlrev_b32 v5, 16, v32
  v_and_b32 v6, 0xffff0000, v32
  v_fmac_f32 v240, v13, v5
  v_fmac_f32 v241, v13, v6
  v_lshlrev_b32 v5, 16, v33
  v_and_b32 v6, 0xffff0000, v33
  v_fmac_f32 v242, v13, v5
  v_fmac_f32 v243, v13, v6
  v_lshlrev_b32 v5, 16, v34
  v_and_b32 v6, 0xffff0000, v34
  v_fmac_f32 v244, v13, v5
  v_fmac_f32 v245, v13, v6
  v_lshlrev_b32 v5, 16, v35
  v_and_b32 v6, 0xffff0000, v35
  v_fmac_f32 v246, v13, v5
  v_fmac_f32 v247, v13, v6
  s_waitcnt vmcnt(15)
  v_lshlrev_b32 v5, 16, v36
  v_and_b32 v6, 0xffff0000, v36
  v_fmac_f32 v240, v14, v5
  v_fmac_f32 v241, v14, v6
  v_lshlrev_b32 v5, 16, v37
  v_and_b32 v6, 0xffff0000, v37
  v_fmac_f32 v242, v14, v5
  v_fmac_f32 v243, v14, v6
  v_lshlrev_b32 v5, 16, v38
  v_and_b32 v6, 0xffff0000, v38
  v_fmac_f32 v244, v14, v5
  v_fmac_f32 v245, v14, v6
  v_lshlrev_b32 v5, 16, v39
  v_and_b32 v6, 0xffff0000, v39
  v_fmac_f32 v246, v14, v5
  v_fmac_f32 v247, v14, v6
  s_waitcnt vmcnt(14)
  v_lshlrev_b32 v5, 16, v40
  v_and_b32 v6, 0xffff0000, v40
  v_fmac_f32 v240, v15, v5
  v_fmac_f32 v241, v15, v6
  v_lshlrev_b32 v5, 16, v41
  v_and_b32 v6, 0xffff0000, v41
  v_fmac_f32 v242, v15, v5
  v_fmac_f32 v243, v15, v6
  v_lshlrev_b32 v5, 16, v42
  v_and_b32 v6, 0xffff0000, v42
  v_fmac_f32 v244, v15, v5
  v_fmac_f32 v245, v15, v6
  v_lshlrev_b32 v5, 16, v43
  v_and_b32 v6, 0xffff0000, v43
  v_fmac_f32 v246, v15, v5
  v_fmac_f32 v247, v15, v6
  s_waitcnt vmcnt(13)
  v_lshlrev_b32 v5, 16, v44
  v_and_b32 v6, 0xffff0000, v44
  v_fmac_f32 v240, v16, v5
  v_fmac_f32 v241, v16, v6
  v_lshlrev_b32 v5, 16, v45
  v_and_b32 v6, 0xffff0000, v45
  v_fmac_f32 v242, v16, v5
  v_fmac_f32 v243, v16, v6
  v_lshlrev_b32 v5, 16, v46
  v_and_b32 v6, 0xffff0000, v46
  v_fmac_f32 v244, v16, v5
  v_fmac_f32 v245, v16, v6
  v_lshlrev_b32 v5, 16, v47
  v_and_b32 v6, 0xffff0000, v47
  v_fmac_f32 v246, v16, v5
  v_fmac_f32 v247, v16, v6
  s_waitcnt vmcnt(12)
  v_lshlrev_b32 v5, 16, v48
  v_and_b32 v6, 0xffff0000, v48
  v_fmac_f32 v240, v17, v5
  v_fmac_f32 v241, v17, v6
  v_lshlrev_b32 v5, 16, v49
  v_and_b32 v6, 0xffff0000, v49
  v_fmac_f32 v242, v17, v5
  v_fmac_f32 v243, v17, v6
  v_lshlrev_b32 v5, 16, v50
  v_and_b32 v6, 0xffff0000, v50
  v_fmac_f32 v244, v17, v5
  v_fmac_f32 v245, v17, v6
  v_lshlrev_b32 v5, 16, v51
  v_and_b32 v6, 0xffff0000, v51
  v_fmac_f32 v246, v17, v5
  v_fmac_f32 v247, v17, v6
  s_waitcnt vmcnt(11)
  v_lshlrev_b32 v5, 16, v52
  v_and_b32 v6, 0xffff0000, v52
  v_fmac_f32 v240, v18, v5
  v_fmac_f32 v241, v18, v6
  v_lshlrev_b32 v5, 16, v53
  v_and_b32 v6, 0xffff0000, v53
  v_fmac_f32 v242, v18, v5
  v_fmac_f32 v243, v18, v6
  v_lshlrev_b32 v5, 16, v54
  v_and_b32 v6, 0xffff0000, v54
  v_fmac_f32 v244, v18, v5
  v_fmac_f32 v245, v18, v6
  v_lshlrev_b32 v5, 16, v55
  v_and_b32 v6, 0xffff0000, v55
  v_fmac_f32 v246, v18, v5
  v_fmac_f32 v247, v18, v6
  s_waitcnt vmcnt(10)
  v_lshlrev_b32 v5, 16, v56
  v_and_b32 v6, 0xffff0000, v56
  v_fmac_f32 v240, v19, v5
  v_fmac_f32 v241, v19, v6
  v_lshlrev_b32 v5, 16, v57
  v_and_b32 v6, 0xffff0000, v57
  v_fmac_f32 v242, v19, v5
  v_fmac_f32 v243, v19, v6
  v_lshlrev_b32 v5, 16, v58
  v_and_b32 v6, 0xffff0000, v58
  v_fmac_f32 v244, v19, v5
  v_fmac_f32 v245, v19, v6
  v_lshlrev_b32 v5, 16, v59
  v_and_b32 v6, 0xffff0000, v59
  v_fmac_f32 v246, v19, v5
  v_fmac_f32 v247, v19, v6
  ds_write_b128 v248, v[240:243]
  ds_write_b128 v248, v[244:247] offset:16
  s_waitcnt lgkmcnt(0)
  s_barrier
  ds_read_b32 v240, v249 offset:0
  ds_read_b32 v241, v249 offset:128
  ds_read_b32 v242, v249 offset:256
  ds_read_b32 v243, v249 offset:384
  ds_read_b32 v244, v249 offset:512
  ds_read_b32 v245, v249 offset:640
  ds_read_b32 v246, v249 offset:768
  ds_read_b32 v247, v249 offset:896
  s_waitcnt lgkmcnt(0)
  v_add_f32 v240, v240, v241
  v_add_f32 v240, v240, v242
  v_add_f32 v240, v240, v243
  v_add_f32 v240, v240, v244
  v_add_f32 v240, v240, v245
  v_add_f32 v240, v240, v246
  v_add_f32 v240, v240, v247
  ds_write_b32 v250, v240 offset:24576
  s_waitcnt lgkmcnt(0)
  s_barrier
  v_cmp_gt_u32 vcc, 32, v0
  s_nop 0
  s_and_saveexec_b64 s[30:31], vcc
  s_cbranch_execz G3_mq10
  ds_read_b32 v240, v250 offset:24576
  ds_read_b32 v241, v250 offset:24704
  ds_read_b32 v242, v250 offset:24832
  ds_read_b32 v243, v250 offset:24960
  ds_read_b32 v244, v250 offset:25088
  ds_read_b32 v245, v250 offset:25216
  ds_read_b32 v246, v250 offset:25344
  ds_read_b32 v247, v250 offset:25472
  s_waitcnt lgkmcnt(0)
  v_add_f32 v240, v240, v241
  v_add_f32 v240, v240, v242
  v_add_f32 v240, v240, v243
  v_add_f32 v240, v240, v244
  v_add_f32 v240, v240, v245
  v_add_f32 v240, v240, v246
  v_add_f32 v240, v240, v247
  v_cvt_pk_bf16_f32 v240, v240, v240
  v_lshlrev_b32 v240, 16, v240
  s_add_u32 s28, s5, 40
  s_mul_i32 s29, s28, 52429
  s_lshr_b32 s29, s29, 20
  s_cmp_eq_u32 s29, 1
  s_cselect_b32 s58, 1, 0
  s_cmp_eq_u32 s29, 4
  s_cselect_b32 s58, 1, s58
  s_cmp_eq_u32 s58, 0
  s_cbranch_scc1 G3_nq10
  v_add_f32 v240, 1.0, v240
  v_cvt_pk_bf16_f32 v240, v240, v240
  v_lshlrev_b32 v240, 16, v240
G3_nq10:
  s_lshl_b32 s28, s28, 7
  v_add_u32 v5, s28, v250
  buffer_store_dword v240, v5, s[8:11], 0 offen offset:0 sc1
G3_mq10:
  s_mov_b64 exec, s[30:31]
  v_mov_b32 v240, 0
  v_mov_b32 v241, 0
  v_mov_b32 v242, 0
  v_mov_b32 v243, 0
  v_mov_b32 v244, 0
  v_mov_b32 v245, 0
  v_mov_b32 v246, 0
  v_mov_b32 v247, 0
  s_waitcnt vmcnt(9)
  v_lshlrev_b32 v5, 16, v60
  v_and_b32 v6, 0xffff0000, v60
  v_fmac_f32 v240, v10, v5
  v_fmac_f32 v241, v10, v6
  v_lshlrev_b32 v5, 16, v61
  v_and_b32 v6, 0xffff0000, v61
  v_fmac_f32 v242, v10, v5
  v_fmac_f32 v243, v10, v6
  v_lshlrev_b32 v5, 16, v62
  v_and_b32 v6, 0xffff0000, v62
  v_fmac_f32 v244, v10, v5
  v_fmac_f32 v245, v10, v6
  v_lshlrev_b32 v5, 16, v63
  v_and_b32 v6, 0xffff0000, v63
  v_fmac_f32 v246, v10, v5
  v_fmac_f32 v247, v10, v6
  s_waitcnt vmcnt(8)
  v_lshlrev_b32 v5, 16, v64
  v_and_b32 v6, 0xffff0000, v64
  v_fmac_f32 v240, v11, v5
  v_fmac_f32 v241, v11, v6
  v_lshlrev_b32 v5, 16, v65
  v_and_b32 v6, 0xffff0000, v65
  v_fmac_f32 v242, v11, v5
  v_fmac_f32 v243, v11, v6
  v_lshlrev_b32 v5, 16, v66
  v_and_b32 v6, 0xffff0000, v66
  v_fmac_f32 v244, v11, v5
  v_fmac_f32 v245, v11, v6
  v_lshlrev_b32 v5, 16, v67
  v_and_b32 v6, 0xffff0000, v67
  v_fmac_f32 v246, v11, v5
  v_fmac_f32 v247, v11, v6
  s_waitcnt vmcnt(7)
  v_lshlrev_b32 v5, 16, v68
  v_and_b32 v6, 0xffff0000, v68
  v_fmac_f32 v240, v12, v5
  v_fmac_f32 v241, v12, v6
  v_lshlrev_b32 v5, 16, v69
  v_and_b32 v6, 0xffff0000, v69
  v_fmac_f32 v242, v12, v5
  v_fmac_f32 v243, v12, v6
  v_lshlrev_b32 v5, 16, v70
  v_and_b32 v6, 0xffff0000, v70
  v_fmac_f32 v244, v12, v5
  v_fmac_f32 v245, v12, v6
  v_lshlrev_b32 v5, 16, v71
  v_and_b32 v6, 0xffff0000, v71
  v_fmac_f32 v246, v12, v5
  v_fmac_f32 v247, v12, v6
  s_waitcnt vmcnt(6)
  v_lshlrev_b32 v5, 16, v72
  v_and_b32 v6, 0xffff0000, v72
  v_fmac_f32 v240, v13, v5
  v_fmac_f32 v241, v13, v6
  v_lshlrev_b32 v5, 16, v73
  v_and_b32 v6, 0xffff0000, v73
  v_fmac_f32 v242, v13, v5
  v_fmac_f32 v243, v13, v6
  v_lshlrev_b32 v5, 16, v74
  v_and_b32 v6, 0xffff0000, v74
  v_fmac_f32 v244, v13, v5
  v_fmac_f32 v245, v13, v6
  v_lshlrev_b32 v5, 16, v75
  v_and_b32 v6, 0xffff0000, v75
  v_fmac_f32 v246, v13, v5
  v_fmac_f32 v247, v13, v6
  s_waitcnt vmcnt(5)
  v_lshlrev_b32 v5, 16, v76
  v_and_b32 v6, 0xffff0000, v76
  v_fmac_f32 v240, v14, v5
  v_fmac_f32 v241, v14, v6
  v_lshlrev_b32 v5, 16, v77
  v_and_b32 v6, 0xffff0000, v77
  v_fmac_f32 v242, v14, v5
  v_fmac_f32 v243, v14, v6
  v_lshlrev_b32 v5, 16, v78
  v_and_b32 v6, 0xffff0000, v78
  v_fmac_f32 v244, v14, v5
  v_fmac_f32 v245, v14, v6
  v_lshlrev_b32 v5, 16, v79
  v_and_b32 v6, 0xffff0000, v79
  v_fmac_f32 v246, v14, v5
  v_fmac_f32 v247, v14, v6
  s_waitcnt vmcnt(4)
  v_lshlrev_b32 v5, 16, v80
  v_and_b32 v6, 0xffff0000, v80
  v_fmac_f32 v240, v15, v5
  v_fmac_f32 v241, v15, v6
  v_lshlrev_b32 v5, 16, v81
  v_and_b32 v6, 0xffff0000, v81
  v_fmac_f32 v242, v15, v5
  v_fmac_f32 v243, v15, v6
  v_lshlrev_b32 v5, 16, v82
  v_and_b32 v6, 0xffff0000, v82
  v_fmac_f32 v244, v15, v5
  v_fmac_f32 v245, v15, v6
  v_lshlrev_b32 v5, 16, v83
  v_and_b32 v6, 0xffff0000, v83
  v_fmac_f32 v246, v15, v5
  v_fmac_f32 v247, v15, v6
  s_waitcnt vmcnt(3)
  v_lshlrev_b32 v5, 16, v84
  v_and_b32 v6, 0xffff0000, v84
  v_fmac_f32 v240, v16, v5
  v_fmac_f32 v241, v16, v6
  v_lshlrev_b32 v5, 16, v85
  v_and_b32 v6, 0xffff0000, v85
  v_fmac_f32 v242, v16, v5
  v_fmac_f32 v243, v16, v6
  v_lshlrev_b32 v5, 16, v86
  v_and_b32 v6, 0xffff0000, v86
  v_fmac_f32 v244, v16, v5
  v_fmac_f32 v245, v16, v6
  v_lshlrev_b32 v5, 16, v87
  v_and_b32 v6, 0xffff0000, v87
  v_fmac_f32 v246, v16, v5
  v_fmac_f32 v247, v16, v6
  s_waitcnt vmcnt(2)
  v_lshlrev_b32 v5, 16, v88
  v_and_b32 v6, 0xffff0000, v88
  v_fmac_f32 v240, v17, v5
  v_fmac_f32 v241, v17, v6
  v_lshlrev_b32 v5, 16, v89
  v_and_b32 v6, 0xffff0000, v89
  v_fmac_f32 v242, v17, v5
  v_fmac_f32 v243, v17, v6
  v_lshlrev_b32 v5, 16, v90
  v_and_b32 v6, 0xffff0000, v90
  v_fmac_f32 v244, v17, v5
  v_fmac_f32 v245, v17, v6
  v_lshlrev_b32 v5, 16, v91
  v_and_b32 v6, 0xffff0000, v91
  v_fmac_f32 v246, v17, v5
  v_fmac_f32 v247, v17, v6
  s_waitcnt vmcnt(1)
  v_lshlrev_b32 v5, 16, v92
  v_and_b32 v6, 0xffff0000, v92
  v_fmac_f32 v240, v18, v5
  v_fmac_f32 v241, v18, v6
  v_lshlrev_b32 v5, 16, v93
  v_and_b32 v6, 0xffff0000, v93
  v_fmac_f32 v242, v18, v5
  v_fmac_f32 v243, v18, v6
  v_lshlrev_b32 v5, 16, v94
  v_and_b32 v6, 0xffff0000, v94
  v_fmac_f32 v244, v18, v5
  v_fmac_f32 v245, v18, v6
  v_lshlrev_b32 v5, 16, v95
  v_and_b32 v6, 0xffff0000, v95
  v_fmac_f32 v246, v18, v5
  v_fmac_f32 v247, v18, v6
  s_waitcnt vmcnt(0)
  v_lshlrev_b32 v5, 16, v96
  v_and_b32 v6, 0xffff0000, v96
  v_fmac_f32 v240, v19, v5
  v_fmac_f32 v241, v19, v6
  v_lshlrev_b32 v5, 16, v97
  v_and_b32 v6, 0xffff0000, v97
  v_fmac_f32 v242, v19, v5
  v_fmac_f32 v243, v19, v6
  v_lshlrev_b32 v5, 16, v98
  v_and_b32 v6, 0xffff0000, v98
  v_fmac_f32 v244, v19, v5
  v_fmac_f32 v245, v19, v6
  v_lshlrev_b32 v5, 16, v99
  v_and_b32 v6, 0xffff0000, v99
  v_fmac_f32 v246, v19, v5
  v_fmac_f32 v247, v19, v6
  ds_write_b128 v248, v[240:243]
  ds_write_b128 v248, v[244:247] offset:16
  s_waitcnt lgkmcnt(0)
  s_barrier
  ds_read_b32 v240, v249 offset:0
  ds_read_b32 v241, v249 offset:128
  ds_read_b32 v242, v249 offset:256
  ds_read_b32 v243, v249 offset:384
  ds_read_b32 v244, v249 offset:512
  ds_read_b32 v245, v249 offset:640
  ds_read_b32 v246, v249 offset:768
  ds_read_b32 v247, v249 offset:896
  s_waitcnt lgkmcnt(0)
  v_add_f32 v240, v240, v241
  v_add_f32 v240, v240, v242
  v_add_f32 v240, v240, v243
  v_add_f32 v240, v240, v244
  v_add_f32 v240, v240, v245
  v_add_f32 v240, v240, v246
  v_add_f32 v240, v240, v247
  ds_write_b32 v250, v240 offset:24576
  s_waitcnt lgkmcnt(0)
  s_barrier
  v_cmp_gt_u32 vcc, 32, v0
  s_nop 0
  s_and_saveexec_b64 s[30:31], vcc
  s_cbranch_execz G3_mq11
  ds_read_b32 v240, v250 offset:24576
  ds_read_b32 v241, v250 offset:24704
  ds_read_b32 v242, v250 offset:24832
  ds_read_b32 v243, v250 offset:24960
  ds_read_b32 v244, v250 offset:25088
  ds_read_b32 v245, v250 offset:25216
  ds_read_b32 v246, v250 offset:25344
  ds_read_b32 v247, v250 offset:25472
  s_waitcnt lgkmcnt(0)
  v_add_f32 v240, v240, v241
  v_add_f32 v240, v240, v242
  v_add_f32 v240, v240, v243
  v_add_f32 v240, v240, v244
  v_add_f32 v240, v240, v245
  v_add_f32 v240, v240, v246
  v_add_f32 v240, v240, v247
  v_cvt_pk_bf16_f32 v240, v240, v240
  v_lshlrev_b32 v240, 16, v240
  s_add_u32 s28, s5, 72
  s_mul_i32 s29, s28, 52429
  s_lshr_b32 s29, s29, 20
  s_cmp_eq_u32 s29, 1
  s_cselect_b32 s58, 1, 0
  s_cmp_eq_u32 s29, 4
  s_cselect_b32 s58, 1, s58
  s_cmp_eq_u32 s58, 0
  s_cbranch_scc1 G3_nq11
  v_add_f32 v240, 1.0, v240
  v_cvt_pk_bf16_f32 v240, v240, v240
  v_lshlrev_b32 v240, 16, v240
G3_nq11:
  s_lshl_b32 s28, s28, 7
  v_add_u32 v5, s28, v250
  buffer_store_dword v240, v5, s[8:11], 0 offen offset:0 sc1
G3_mq11:
  s_mov_b64 exec, s[30:31]
G2_d:
  s_waitcnt vmcnt(0)
  s_barrier
  s_cmp_eq_u32 s91, 0
  s_cbranch_scc0 G2_a
  s_mov_b64 exec, 1
  v_mov_b32 v252, 32
  v_mov_b32 v251, 1
  buffer_atomic_add v251, v252, s[12:15], 0 offen sc1
  s_mov_b64 exec, -1
G2_a:
  s_branch XQ_start
G3_start:
  v_and_b32 v2, 63, v0
  v_and_b32 v3, 15, v2
  v_lshrrev_b32 v4, 4, v2
  s_lshl_b32 s28, s5, 4
  v_add_u32 v8, s28, v3
  v_mul_u32_u24 v8, 1280, v8
  v_lshl_add_u32 v8, v4, 3, v8
  s_mul_i32 s29, s91, 320
  v_add_u32 v8, s29, v8
  v_lshrrev_b32 v1, 2, v0
  v_and_b32 v9, 3, v0
  v_mul_u32_u24 v7, 7680, v1
  v_lshl_add_u32 v7, v9, 4, v7
  s_lshl_b32 s29, s5, 6
  v_add_u32 v7, s29, v7
  v_lshlrev_b32 v6, 1, v1
  buffer_load_ushort v10, v6, s[48:51], 0 offen offset:0
  buffer_load_ushort v11, v6, s[48:51], 0 offen offset:128
  buffer_load_ushort v12, v6, s[48:51], 0 offen offset:256
  buffer_load_ushort v13, v6, s[48:51], 0 offen offset:384
  buffer_load_ushort v14, v6, s[48:51], 0 offen offset:512
  buffer_load_ushort v15, v6, s[48:51], 0 offen offset:640
  buffer_load_ushort v16, v6, s[48:51], 0 offen offset:768
  buffer_load_ushort v17, v6, s[48:51], 0 offen offset:896
  buffer_load_ushort v18, v6, s[48:51], 0 offen offset:1024
  buffer_load_ushort v19, v6, s[48:51], 0 offen offset:1152
  s_cmp_ge_u32 s5, 8
  s_cbranch_scc1 G3_v1
  s_mov_b32 s28, 0
  buffer_load_dwordx4 v[20:23], v7, s[52:55], s28 offen
  s_mov_b32 s28, 491520
  buffer_load_dwordx4 v[24:27], v7, s[52:55], s28 offen
  s_mov_b32 s28, 983040
  buffer_load_dwordx4 v[28:31], v7, s[52:55], s28 offen
  s_mov_b32 s28, 1474560
  buffer_load_dwordx4 v[32:35], v7, s[52:55], s28 offen
  s_mov_b32 s28, 1966080
  buffer_load_dwordx4 v[36:39], v7, s[52:55], s28 offen
  s_mov_b32 s28, 2457600
  buffer_load_dwordx4 v[40:43], v7, s[52:55], s28 offen
  s_mov_b32 s28, 2949120
  buffer_load_dwordx4 v[44:47], v7, s[52:55], s28 offen
  s_mov_b32 s28, 3440640
  buffer_load_dwordx4 v[48:51], v7, s[52:55], s28 offen
  s_mov_b32 s28, 3932160
  buffer_load_dwordx4 v[52:55], v7, s[52:55], s28 offen
  s_mov_b32 s28, 4423680
  buffer_load_dwordx4 v[56:59], v7, s[52:55], s28 offen
  s_mov_b32 s28, 2048
  buffer_load_dwordx4 v[60:63], v7, s[52:55], s28 offen
  s_mov_b32 s28, 493568
  buffer_load_dwordx4 v[64:67], v7, s[52:55], s28 offen
  s_mov_b32 s28, 985088
  buffer_load_dwordx4 v[68:71], v7, s[52:55], s28 offen
  s_mov_b32 s28, 1476608
  buffer_load_dwordx4 v[72:75], v7, s[52:55], s28 offen
  s_mov_b32 s28, 1968128
  buffer_load_dwordx4 v[76:79], v7, s[52:55], s28 offen
  s_mov_b32 s28, 2459648
  buffer_load_dwordx4 v[80:83], v7, s[52:55], s28 offen
  s_mov_b32 s28, 2951168
  buffer_load_dwordx4 v[84:87], v7, s[52:55], s28 offen
  s_mov_b32 s28, 3442688
  buffer_load_dwordx4 v[88:91], v7, s[52:55], s28 offen
  s_mov_b32 s28, 3934208
  buffer_load_dwordx4 v[92:95], v7, s[52:55], s28 offen
  s_mov_b32 s28, 4425728
  buffer_load_dwordx4 v[96:99], v7, s[52:55], s28 offen
  s_mov_b32 s28, 0
  buffer_load_dwordx2 v[160:161], v8, s[44:47], s28 offen offset:0
  buffer_load_dwordx2 v[162:163], v8, s[44:47], s28 offen offset:32
  buffer_load_dwordx2 v[164:165], v8, s[44:47], s28 offen offset:64
  buffer_load_dwordx2 v[166:167], v8, s[44:47], s28 offen offset:96
  buffer_load_dwordx2 v[168:169], v8, s[44:47], s28 offen offset:128
  buffer_load_dwordx2 v[170:171], v8, s[44:47], s28 offen offset:160
  buffer_load_dwordx2 v[172:173], v8, s[44:47], s28 offen offset:192
  buffer_load_dwordx2 v[174:175], v8, s[44:47], s28 offen offset:224
  buffer_load_dwordx2 v[176:177], v8, s[44:47], s28 offen offset:256
  buffer_load_dwordx2 v[178:179], v8, s[44:47], s28 offen offset:288
  s_waitcnt vmcnt(30)
  v_lshlrev_b32 v10, 16, v10
  v_mul_f32 v5, 0xbfb8aa3b, v10
  v_exp_f32 v5, v5
  s_nop 0
  v_add_f32 v5, 1.0, v5
  v_rcp_f32 v5, v5
  s_nop 0
  v_mul_f32 v10, v10, v5
  v_cvt_pk_bf16_f32 v10, v10, v10
  v_lshlrev_b32 v10, 16, v10
  v_lshlrev_b32 v11, 16, v11
  v_mul_f32 v5, 0xbfb8aa3b, v11
  v_exp_f32 v5, v5
  s_nop 0
  v_add_f32 v5, 1.0, v5
  v_rcp_f32 v5, v5
  s_nop 0
  v_mul_f32 v11, v11, v5
  v_cvt_pk_bf16_f32 v11, v11, v11
  v_lshlrev_b32 v11, 16, v11
  v_lshlrev_b32 v12, 16, v12
  v_mul_f32 v5, 0xbfb8aa3b, v12
  v_exp_f32 v5, v5
  s_nop 0
  v_add_f32 v5, 1.0, v5
  v_rcp_f32 v5, v5
  s_nop 0
  v_mul_f32 v12, v12, v5
  v_cvt_pk_bf16_f32 v12, v12, v12
  v_lshlrev_b32 v12, 16, v12
  v_lshlrev_b32 v13, 16, v13
  v_mul_f32 v5, 0xbfb8aa3b, v13
  v_exp_f32 v5, v5
  s_nop 0
  v_add_f32 v5, 1.0, v5
  v_rcp_f32 v5, v5
  s_nop 0
  v_mul_f32 v13, v13, v5
  v_cvt_pk_bf16_f32 v13, v13, v13
  v_lshlrev_b32 v13, 16, v13
  v_lshlrev_b32 v14, 16, v14
  v_mul_f32 v5, 0xbfb8aa3b, v14
  v_exp_f32 v5, v5
  s_nop 0
  v_add_f32 v5, 1.0, v5
  v_rcp_f32 v5, v5
  s_nop 0
  v_mul_f32 v14, v14, v5
  v_cvt_pk_bf16_f32 v14, v14, v14
  v_lshlrev_b32 v14, 16, v14
  v_lshlrev_b32 v15, 16, v15
  v_mul_f32 v5, 0xbfb8aa3b, v15
  v_exp_f32 v5, v5
  s_nop 0
  v_add_f32 v5, 1.0, v5
  v_rcp_f32 v5, v5
  s_nop 0
  v_mul_f32 v15, v15, v5
  v_cvt_pk_bf16_f32 v15, v15, v15
  v_lshlrev_b32 v15, 16, v15
  v_lshlrev_b32 v16, 16, v16
  v_mul_f32 v5, 0xbfb8aa3b, v16
  v_exp_f32 v5, v5
  s_nop 0
  v_add_f32 v5, 1.0, v5
  v_rcp_f32 v5, v5
  s_nop 0
  v_mul_f32 v16, v16, v5
  v_cvt_pk_bf16_f32 v16, v16, v16
  v_lshlrev_b32 v16, 16, v16
  v_lshlrev_b32 v17, 16, v17
  v_mul_f32 v5, 0xbfb8aa3b, v17
  v_exp_f32 v5, v5
  s_nop 0
  v_add_f32 v5, 1.0, v5
  v_rcp_f32 v5, v5
  s_nop 0
  v_mul_f32 v17, v17, v5
  v_cvt_pk_bf16_f32 v17, v17, v17
  v_lshlrev_b32 v17, 16, v17
  v_lshlrev_b32 v18, 16, v18
  v_mul_f32 v5, 0xbfb8aa3b, v18
  v_exp_f32 v5, v5
  s_nop 0
  v_add_f32 v5, 1.0, v5
  v_rcp_f32 v5, v5
  s_nop 0
  v_mul_f32 v18, v18, v5
  v_cvt_pk_bf16_f32 v18, v18, v18
  v_lshlrev_b32 v18, 16, v18
  v_lshlrev_b32 v19, 16, v19
  v_mul_f32 v5, 0xbfb8aa3b, v19
  v_exp_f32 v5, v5
  s_nop 0
  v_add_f32 v5, 1.0, v5
  v_rcp_f32 v5, v5
  s_nop 0
  v_mul_f32 v19, v19, v5
  v_cvt_pk_bf16_f32 v19, v19, v19
  v_lshlrev_b32 v19, 16, v19
  v_lshlrev_b32 v248, 7, v1
  v_lshl_add_u32 v248, v9, 5, v248
  v_add_u32 v248, 16384, v248
  v_and_b32 v6, 31, v0
  v_lshrrev_b32 v249, 5, v0
  v_lshlrev_b32 v249, 10, v249
  v_lshl_add_u32 v249, v6, 2, v249
  v_add_u32 v249, 16384, v249
  v_lshlrev_b32 v250, 2, v0
  v_mov_b32 v240, 0
  v_mov_b32 v241, 0
  v_mov_b32 v242, 0
  v_mov_b32 v243, 0
  v_mov_b32 v244, 0
  v_mov_b32 v245, 0
  v_mov_b32 v246, 0
  v_mov_b32 v247, 0
  s_waitcnt vmcnt(29)
  v_lshlrev_b32 v5, 16, v20
  v_and_b32 v6, 0xffff0000, v20
  v_fmac_f32 v240, v10, v5
  v_fmac_f32 v241, v10, v6
  v_lshlrev_b32 v5, 16, v21
  v_and_b32 v6, 0xffff0000, v21
  v_fmac_f32 v242, v10, v5
  v_fmac_f32 v243, v10, v6
  v_lshlrev_b32 v5, 16, v22
  v_and_b32 v6, 0xffff0000, v22
  v_fmac_f32 v244, v10, v5
  v_fmac_f32 v245, v10, v6
  v_lshlrev_b32 v5, 16, v23
  v_and_b32 v6, 0xffff0000, v23
  v_fmac_f32 v246, v10, v5
  v_fmac_f32 v247, v10, v6
  s_waitcnt vmcnt(28)
  v_lshlrev_b32 v5, 16, v24
  v_and_b32 v6, 0xffff0000, v24
  v_fmac_f32 v240, v11, v5
  v_fmac_f32 v241, v11, v6
  v_lshlrev_b32 v5, 16, v25
  v_and_b32 v6, 0xffff0000, v25
  v_fmac_f32 v242, v11, v5
  v_fmac_f32 v243, v11, v6
  v_lshlrev_b32 v5, 16, v26
  v_and_b32 v6, 0xffff0000, v26
  v_fmac_f32 v244, v11, v5
  v_fmac_f32 v245, v11, v6
  v_lshlrev_b32 v5, 16, v27
  v_and_b32 v6, 0xffff0000, v27
  v_fmac_f32 v246, v11, v5
  v_fmac_f32 v247, v11, v6
  s_waitcnt vmcnt(27)
  v_lshlrev_b32 v5, 16, v28
  v_and_b32 v6, 0xffff0000, v28
  v_fmac_f32 v240, v12, v5
  v_fmac_f32 v241, v12, v6
  v_lshlrev_b32 v5, 16, v29
  v_and_b32 v6, 0xffff0000, v29
  v_fmac_f32 v242, v12, v5
  v_fmac_f32 v243, v12, v6
  v_lshlrev_b32 v5, 16, v30
  v_and_b32 v6, 0xffff0000, v30
  v_fmac_f32 v244, v12, v5
  v_fmac_f32 v245, v12, v6
  v_lshlrev_b32 v5, 16, v31
  v_and_b32 v6, 0xffff0000, v31
  v_fmac_f32 v246, v12, v5
  v_fmac_f32 v247, v12, v6
  s_waitcnt vmcnt(26)
  v_lshlrev_b32 v5, 16, v32
  v_and_b32 v6, 0xffff0000, v32
  v_fmac_f32 v240, v13, v5
  v_fmac_f32 v241, v13, v6
  v_lshlrev_b32 v5, 16, v33
  v_and_b32 v6, 0xffff0000, v33
  v_fmac_f32 v242, v13, v5
  v_fmac_f32 v243, v13, v6
  v_lshlrev_b32 v5, 16, v34
  v_and_b32 v6, 0xffff0000, v34
  v_fmac_f32 v244, v13, v5
  v_fmac_f32 v245, v13, v6
  v_lshlrev_b32 v5, 16, v35
  v_and_b32 v6, 0xffff0000, v35
  v_fmac_f32 v246, v13, v5
  v_fmac_f32 v247, v13, v6
  s_waitcnt vmcnt(25)
  v_lshlrev_b32 v5, 16, v36
  v_and_b32 v6, 0xffff0000, v36
  v_fmac_f32 v240, v14, v5
  v_fmac_f32 v241, v14, v6
  v_lshlrev_b32 v5, 16, v37
  v_and_b32 v6, 0xffff0000, v37
  v_fmac_f32 v242, v14, v5
  v_fmac_f32 v243, v14, v6
  v_lshlrev_b32 v5, 16, v38
  v_and_b32 v6, 0xffff0000, v38
  v_fmac_f32 v244, v14, v5
  v_fmac_f32 v245, v14, v6
  v_lshlrev_b32 v5, 16, v39
  v_and_b32 v6, 0xffff0000, v39
  v_fmac_f32 v246, v14, v5
  v_fmac_f32 v247, v14, v6
  s_waitcnt vmcnt(24)
  v_lshlrev_b32 v5, 16, v40
  v_and_b32 v6, 0xffff0000, v40
  v_fmac_f32 v240, v15, v5
  v_fmac_f32 v241, v15, v6
  v_lshlrev_b32 v5, 16, v41
  v_and_b32 v6, 0xffff0000, v41
  v_fmac_f32 v242, v15, v5
  v_fmac_f32 v243, v15, v6
  v_lshlrev_b32 v5, 16, v42
  v_and_b32 v6, 0xffff0000, v42
  v_fmac_f32 v244, v15, v5
  v_fmac_f32 v245, v15, v6
  v_lshlrev_b32 v5, 16, v43
  v_and_b32 v6, 0xffff0000, v43
  v_fmac_f32 v246, v15, v5
  v_fmac_f32 v247, v15, v6
  s_waitcnt vmcnt(23)
  v_lshlrev_b32 v5, 16, v44
  v_and_b32 v6, 0xffff0000, v44
  v_fmac_f32 v240, v16, v5
  v_fmac_f32 v241, v16, v6
  v_lshlrev_b32 v5, 16, v45
  v_and_b32 v6, 0xffff0000, v45
  v_fmac_f32 v242, v16, v5
  v_fmac_f32 v243, v16, v6
  v_lshlrev_b32 v5, 16, v46
  v_and_b32 v6, 0xffff0000, v46
  v_fmac_f32 v244, v16, v5
  v_fmac_f32 v245, v16, v6
  v_lshlrev_b32 v5, 16, v47
  v_and_b32 v6, 0xffff0000, v47
  v_fmac_f32 v246, v16, v5
  v_fmac_f32 v247, v16, v6
  s_waitcnt vmcnt(22)
  v_lshlrev_b32 v5, 16, v48
  v_and_b32 v6, 0xffff0000, v48
  v_fmac_f32 v240, v17, v5
  v_fmac_f32 v241, v17, v6
  v_lshlrev_b32 v5, 16, v49
  v_and_b32 v6, 0xffff0000, v49
  v_fmac_f32 v242, v17, v5
  v_fmac_f32 v243, v17, v6
  v_lshlrev_b32 v5, 16, v50
  v_and_b32 v6, 0xffff0000, v50
  v_fmac_f32 v244, v17, v5
  v_fmac_f32 v245, v17, v6
  v_lshlrev_b32 v5, 16, v51
  v_and_b32 v6, 0xffff0000, v51
  v_fmac_f32 v246, v17, v5
  v_fmac_f32 v247, v17, v6
  s_waitcnt vmcnt(21)
  v_lshlrev_b32 v5, 16, v52
  v_and_b32 v6, 0xffff0000, v52
  v_fmac_f32 v240, v18, v5
  v_fmac_f32 v241, v18, v6
  v_lshlrev_b32 v5, 16, v53
  v_and_b32 v6, 0xffff0000, v53
  v_fmac_f32 v242, v18, v5
  v_fmac_f32 v243, v18, v6
  v_lshlrev_b32 v5, 16, v54
  v_and_b32 v6, 0xffff0000, v54
  v_fmac_f32 v244, v18, v5
  v_fmac_f32 v245, v18, v6
  v_lshlrev_b32 v5, 16, v55
  v_and_b32 v6, 0xffff0000, v55
  v_fmac_f32 v246, v18, v5
  v_fmac_f32 v247, v18, v6
  s_waitcnt vmcnt(20)
  v_lshlrev_b32 v5, 16, v56
  v_and_b32 v6, 0xffff0000, v56
  v_fmac_f32 v240, v19, v5
  v_fmac_f32 v241, v19, v6
  v_lshlrev_b32 v5, 16, v57
  v_and_b32 v6, 0xffff0000, v57
  v_fmac_f32 v242, v19, v5
  v_fmac_f32 v243, v19, v6
  v_lshlrev_b32 v5, 16, v58
  v_and_b32 v6, 0xffff0000, v58
  v_fmac_f32 v244, v19, v5
  v_fmac_f32 v245, v19, v6
  v_lshlrev_b32 v5, 16, v59
  v_and_b32 v6, 0xffff0000, v59
  v_fmac_f32 v246, v19, v5
  v_fmac_f32 v247, v19, v6
  ds_write_b128 v248, v[240:243]
  ds_write_b128 v248, v[244:247] offset:16
  s_waitcnt lgkmcnt(0)
  s_barrier
  ds_read_b32 v240, v249 offset:0
  ds_read_b32 v241, v249 offset:128
  ds_read_b32 v242, v249 offset:256
  ds_read_b32 v243, v249 offset:384
  ds_read_b32 v244, v249 offset:512
  ds_read_b32 v245, v249 offset:640
  ds_read_b32 v246, v249 offset:768
  ds_read_b32 v247, v249 offset:896
  s_waitcnt lgkmcnt(0)
  v_add_f32 v240, v240, v241
  v_add_f32 v240, v240, v242
  v_add_f32 v240, v240, v243
  v_add_f32 v240, v240, v244
  v_add_f32 v240, v240, v245
  v_add_f32 v240, v240, v246
  v_add_f32 v240, v240, v247
  ds_write_b32 v250, v240 offset:24576
  s_waitcnt lgkmcnt(0)
  s_barrier
  v_cmp_gt_u32 vcc, 32, v0
  s_nop 0
  s_and_saveexec_b64 s[30:31], vcc
  s_cbranch_execz G3_m00
  ds_read_b32 v240, v250 offset:24576
  ds_read_b32 v241, v250 offset:24704
  ds_read_b32 v242, v250 offset:24832
  ds_read_b32 v243, v250 offset:24960
  ds_read_b32 v244, v250 offset:25088
  ds_read_b32 v245, v250 offset:25216
  ds_read_b32 v246, v250 offset:25344
  ds_read_b32 v247, v250 offset:25472
  s_waitcnt lgkmcnt(0)
  v_add_f32 v240, v240, v241
  v_add_f32 v240, v240, v242
  v_add_f32 v240, v240, v243
  v_add_f32 v240, v240, v244
  v_add_f32 v240, v240, v245
  v_add_f32 v240, v240, v246
  v_add_f32 v240, v240, v247
  v_cvt_pk_bf16_f32 v240, v240, v240
  v_lshlrev_b32 v240, 16, v240
  s_add_u32 s28, s5, 0
  s_mul_i32 s29, s28, 52429
  s_lshr_b32 s29, s29, 20
  s_cmp_eq_u32 s29, 1
  s_cselect_b32 s58, 1, 0
  s_cmp_eq_u32 s29, 4
  s_cselect_b32 s58, 1, s58
  s_cmp_eq_u32 s58, 0
  s_cbranch_scc1 G3_n00
  v_add_f32 v240, 1.0, v240
  v_cvt_pk_bf16_f32 v240, v240, v240
  v_lshlrev_b32 v240, 16, v240
G3_n00:
  s_lshl_b32 s28, s28, 7
  v_add_u32 v5, s28, v250
  buffer_store_dword v240, v5, s[8:11], 0 offen offset:0 sc1
G3_m00:
  s_mov_b64 exec, s[30:31]
  v_mov_b32 v240, 0
  v_mov_b32 v241, 0
  v_mov_b32 v242, 0
  v_mov_b32 v243, 0
  v_mov_b32 v244, 0
  v_mov_b32 v245, 0
  v_mov_b32 v246, 0
  v_mov_b32 v247, 0
  s_waitcnt vmcnt(19)
  v_lshlrev_b32 v5, 16, v60
  v_and_b32 v6, 0xffff0000, v60
  v_fmac_f32 v240, v10, v5
  v_fmac_f32 v241, v10, v6
  v_lshlrev_b32 v5, 16, v61
  v_and_b32 v6, 0xffff0000, v61
  v_fmac_f32 v242, v10, v5
  v_fmac_f32 v243, v10, v6
  v_lshlrev_b32 v5, 16, v62
  v_and_b32 v6, 0xffff0000, v62
  v_fmac_f32 v244, v10, v5
  v_fmac_f32 v245, v10, v6
  v_lshlrev_b32 v5, 16, v63
  v_and_b32 v6, 0xffff0000, v63
  v_fmac_f32 v246, v10, v5
  v_fmac_f32 v247, v10, v6
  s_waitcnt vmcnt(18)
  v_lshlrev_b32 v5, 16, v64
  v_and_b32 v6, 0xffff0000, v64
  v_fmac_f32 v240, v11, v5
  v_fmac_f32 v241, v11, v6
  v_lshlrev_b32 v5, 16, v65
  v_and_b32 v6, 0xffff0000, v65
  v_fmac_f32 v242, v11, v5
  v_fmac_f32 v243, v11, v6
  v_lshlrev_b32 v5, 16, v66
  v_and_b32 v6, 0xffff0000, v66
  v_fmac_f32 v244, v11, v5
  v_fmac_f32 v245, v11, v6
  v_lshlrev_b32 v5, 16, v67
  v_and_b32 v6, 0xffff0000, v67
  v_fmac_f32 v246, v11, v5
  v_fmac_f32 v247, v11, v6
  s_waitcnt vmcnt(17)
  v_lshlrev_b32 v5, 16, v68
  v_and_b32 v6, 0xffff0000, v68
  v_fmac_f32 v240, v12, v5
  v_fmac_f32 v241, v12, v6
  v_lshlrev_b32 v5, 16, v69
  v_and_b32 v6, 0xffff0000, v69
  v_fmac_f32 v242, v12, v5
  v_fmac_f32 v243, v12, v6
  v_lshlrev_b32 v5, 16, v70
  v_and_b32 v6, 0xffff0000, v70
  v_fmac_f32 v244, v12, v5
  v_fmac_f32 v245, v12, v6
  v_lshlrev_b32 v5, 16, v71
  v_and_b32 v6, 0xffff0000, v71
  v_fmac_f32 v246, v12, v5
  v_fmac_f32 v247, v12, v6
  s_waitcnt vmcnt(16)
  v_lshlrev_b32 v5, 16, v72
  v_and_b32 v6, 0xffff0000, v72
  v_fmac_f32 v240, v13, v5
  v_fmac_f32 v241, v13, v6
  v_lshlrev_b32 v5, 16, v73
  v_and_b32 v6, 0xffff0000, v73
  v_fmac_f32 v242, v13, v5
  v_fmac_f32 v243, v13, v6
  v_lshlrev_b32 v5, 16, v74
  v_and_b32 v6, 0xffff0000, v74
  v_fmac_f32 v244, v13, v5
  v_fmac_f32 v245, v13, v6
  v_lshlrev_b32 v5, 16, v75
  v_and_b32 v6, 0xffff0000, v75
  v_fmac_f32 v246, v13, v5
  v_fmac_f32 v247, v13, v6
  s_waitcnt vmcnt(15)
  v_lshlrev_b32 v5, 16, v76
  v_and_b32 v6, 0xffff0000, v76
  v_fmac_f32 v240, v14, v5
  v_fmac_f32 v241, v14, v6
  v_lshlrev_b32 v5, 16, v77
  v_and_b32 v6, 0xffff0000, v77
  v_fmac_f32 v242, v14, v5
  v_fmac_f32 v243, v14, v6
  v_lshlrev_b32 v5, 16, v78
  v_and_b32 v6, 0xffff0000, v78
  v_fmac_f32 v244, v14, v5
  v_fmac_f32 v245, v14, v6
  v_lshlrev_b32 v5, 16, v79
  v_and_b32 v6, 0xffff0000, v79
  v_fmac_f32 v246, v14, v5
  v_fmac_f32 v247, v14, v6
  s_waitcnt vmcnt(14)
  v_lshlrev_b32 v5, 16, v80
  v_and_b32 v6, 0xffff0000, v80
  v_fmac_f32 v240, v15, v5
  v_fmac_f32 v241, v15, v6
  v_lshlrev_b32 v5, 16, v81
  v_and_b32 v6, 0xffff0000, v81
  v_fmac_f32 v242, v15, v5
  v_fmac_f32 v243, v15, v6
  v_lshlrev_b32 v5, 16, v82
  v_and_b32 v6, 0xffff0000, v82
  v_fmac_f32 v244, v15, v5
  v_fmac_f32 v245, v15, v6
  v_lshlrev_b32 v5, 16, v83
  v_and_b32 v6, 0xffff0000, v83
  v_fmac_f32 v246, v15, v5
  v_fmac_f32 v247, v15, v6
  s_waitcnt vmcnt(13)
  v_lshlrev_b32 v5, 16, v84
  v_and_b32 v6, 0xffff0000, v84
  v_fmac_f32 v240, v16, v5
  v_fmac_f32 v241, v16, v6
  v_lshlrev_b32 v5, 16, v85
  v_and_b32 v6, 0xffff0000, v85
  v_fmac_f32 v242, v16, v5
  v_fmac_f32 v243, v16, v6
  v_lshlrev_b32 v5, 16, v86
  v_and_b32 v6, 0xffff0000, v86
  v_fmac_f32 v244, v16, v5
  v_fmac_f32 v245, v16, v6
  v_lshlrev_b32 v5, 16, v87
  v_and_b32 v6, 0xffff0000, v87
  v_fmac_f32 v246, v16, v5
  v_fmac_f32 v247, v16, v6
  s_waitcnt vmcnt(12)
  v_lshlrev_b32 v5, 16, v88
  v_and_b32 v6, 0xffff0000, v88
  v_fmac_f32 v240, v17, v5
  v_fmac_f32 v241, v17, v6
  v_lshlrev_b32 v5, 16, v89
  v_and_b32 v6, 0xffff0000, v89
  v_fmac_f32 v242, v17, v5
  v_fmac_f32 v243, v17, v6
  v_lshlrev_b32 v5, 16, v90
  v_and_b32 v6, 0xffff0000, v90
  v_fmac_f32 v244, v17, v5
  v_fmac_f32 v245, v17, v6
  v_lshlrev_b32 v5, 16, v91
  v_and_b32 v6, 0xffff0000, v91
  v_fmac_f32 v246, v17, v5
  v_fmac_f32 v247, v17, v6
  s_waitcnt vmcnt(11)
  v_lshlrev_b32 v5, 16, v92
  v_and_b32 v6, 0xffff0000, v92
  v_fmac_f32 v240, v18, v5
  v_fmac_f32 v241, v18, v6
  v_lshlrev_b32 v5, 16, v93
  v_and_b32 v6, 0xffff0000, v93
  v_fmac_f32 v242, v18, v5
  v_fmac_f32 v243, v18, v6
  v_lshlrev_b32 v5, 16, v94
  v_and_b32 v6, 0xffff0000, v94
  v_fmac_f32 v244, v18, v5
  v_fmac_f32 v245, v18, v6
  v_lshlrev_b32 v5, 16, v95
  v_and_b32 v6, 0xffff0000, v95
  v_fmac_f32 v246, v18, v5
  v_fmac_f32 v247, v18, v6
  s_waitcnt vmcnt(10)
  v_lshlrev_b32 v5, 16, v96
  v_and_b32 v6, 0xffff0000, v96
  v_fmac_f32 v240, v19, v5
  v_fmac_f32 v241, v19, v6
  v_lshlrev_b32 v5, 16, v97
  v_and_b32 v6, 0xffff0000, v97
  v_fmac_f32 v242, v19, v5
  v_fmac_f32 v243, v19, v6
  v_lshlrev_b32 v5, 16, v98
  v_and_b32 v6, 0xffff0000, v98
  v_fmac_f32 v244, v19, v5
  v_fmac_f32 v245, v19, v6
  v_lshlrev_b32 v5, 16, v99
  v_and_b32 v6, 0xffff0000, v99
  v_fmac_f32 v246, v19, v5
  v_fmac_f32 v247, v19, v6
  ds_write_b128 v248, v[240:243]
  ds_write_b128 v248, v[244:247] offset:16
  s_waitcnt lgkmcnt(0)
  s_barrier
  ds_read_b32 v240, v249 offset:0
  ds_read_b32 v241, v249 offset:128
  ds_read_b32 v242, v249 offset:256
  ds_read_b32 v243, v249 offset:384
  ds_read_b32 v244, v249 offset:512
  ds_read_b32 v245, v249 offset:640
  ds_read_b32 v246, v249 offset:768
  ds_read_b32 v247, v249 offset:896
  s_waitcnt lgkmcnt(0)
  v_add_f32 v240, v240, v241
  v_add_f32 v240, v240, v242
  v_add_f32 v240, v240, v243
  v_add_f32 v240, v240, v244
  v_add_f32 v240, v240, v245
  v_add_f32 v240, v240, v246
  v_add_f32 v240, v240, v247
  ds_write_b32 v250, v240 offset:24576
  s_waitcnt lgkmcnt(0)
  s_barrier
  v_cmp_gt_u32 vcc, 32, v0
  s_nop 0
  s_and_saveexec_b64 s[30:31], vcc
  s_cbranch_execz G3_m01
  ds_read_b32 v240, v250 offset:24576
  ds_read_b32 v241, v250 offset:24704
  ds_read_b32 v242, v250 offset:24832
  ds_read_b32 v243, v250 offset:24960
  ds_read_b32 v244, v250 offset:25088
  ds_read_b32 v245, v250 offset:25216
  ds_read_b32 v246, v250 offset:25344
  ds_read_b32 v247, v250 offset:25472
  s_waitcnt lgkmcnt(0)
  v_add_f32 v240, v240, v241
  v_add_f32 v240, v240, v242
  v_add_f32 v240, v240, v243
  v_add_f32 v240, v240, v244
  v_add_f32 v240, v240, v245
  v_add_f32 v240, v240, v246
  v_add_f32 v240, v240, v247
  v_cvt_pk_bf16_f32 v240, v240, v240
  v_lshlrev_b32 v240, 16, v240
  s_add_u32 s28, s5, 32
  s_mul_i32 s29, s28, 52429
  s_lshr_b32 s29, s29, 20
  s_cmp_eq_u32 s29, 1
  s_cselect_b32 s58, 1, 0
  s_cmp_eq_u32 s29, 4
  s_cselect_b32 s58, 1, s58
  s_cmp_eq_u32 s58, 0
  s_cbranch_scc1 G3_n01
  v_add_f32 v240, 1.0, v240
  v_cvt_pk_bf16_f32 v240, v240, v240
  v_lshlrev_b32 v240, 16, v240
G3_n01:
  s_lshl_b32 s28, s28, 7
  v_add_u32 v5, s28, v250
  buffer_store_dword v240, v5, s[8:11], 0 offen offset:0 sc1
G3_m01:
  s_mov_b64 exec, s[30:31]
  s_branch G3_d
G3_v1:
  s_mov_b32 s28, 0
  buffer_load_dwordx4 v[20:23], v7, s[52:55], s28 offen
  s_mov_b32 s28, 491520
  buffer_load_dwordx4 v[24:27], v7, s[52:55], s28 offen
  s_mov_b32 s28, 983040
  buffer_load_dwordx4 v[28:31], v7, s[52:55], s28 offen
  s_mov_b32 s28, 1474560
  buffer_load_dwordx4 v[32:35], v7, s[52:55], s28 offen
  s_mov_b32 s28, 1966080
  buffer_load_dwordx4 v[36:39], v7, s[52:55], s28 offen
  s_mov_b32 s28, 2457600
  buffer_load_dwordx4 v[40:43], v7, s[52:55], s28 offen
  s_mov_b32 s28, 2949120
  buffer_load_dwordx4 v[44:47], v7, s[52:55], s28 offen
  s_mov_b32 s28, 3440640
  buffer_load_dwordx4 v[48:51], v7, s[52:55], s28 offen
  s_mov_b32 s28, 3932160
  buffer_load_dwordx4 v[52:55], v7, s[52:55], s28 offen
  s_mov_b32 s28, 4423680
  buffer_load_dwordx4 v[56:59], v7, s[52:55], s28 offen
  s_mov_b32 s28, 0
  buffer_load_dwordx2 v[160:161], v8, s[44:47], s28 offen offset:0
  buffer_load_dwordx2 v[162:163], v8, s[44:47], s28 offen offset:32
  buffer_load_dwordx2 v[164:165], v8, s[44:47], s28 offen offset:64
  buffer_load_dwordx2 v[166:167], v8, s[44:47], s28 offen offset:96
  buffer_load_dwordx2 v[168:169], v8, s[44:47], s28 offen offset:128
  buffer_load_dwordx2 v[170:171], v8, s[44:47], s28 offen offset:160
  buffer_load_dwordx2 v[172:173], v8, s[44:47], s28 offen offset:192
  buffer_load_dwordx2 v[174:175], v8, s[44:47], s28 offen offset:224
  buffer_load_dwordx2 v[176:177], v8, s[44:47], s28 offen offset:256
  buffer_load_dwordx2 v[178:179], v8, s[44:47], s28 offen offset:288
  s_waitcnt vmcnt(20)
  v_lshlrev_b32 v10, 16, v10
  v_mul_f32 v5, 0xbfb8aa3b, v10
  v_exp_f32 v5, v5
  s_nop 0
  v_add_f32 v5, 1.0, v5
  v_rcp_f32 v5, v5
  s_nop 0
  v_mul_f32 v10, v10, v5
  v_cvt_pk_bf16_f32 v10, v10, v10
  v_lshlrev_b32 v10, 16, v10
  v_lshlrev_b32 v11, 16, v11
  v_mul_f32 v5, 0xbfb8aa3b, v11
  v_exp_f32 v5, v5
  s_nop 0
  v_add_f32 v5, 1.0, v5
  v_rcp_f32 v5, v5
  s_nop 0
  v_mul_f32 v11, v11, v5
  v_cvt_pk_bf16_f32 v11, v11, v11
  v_lshlrev_b32 v11, 16, v11
  v_lshlrev_b32 v12, 16, v12
  v_mul_f32 v5, 0xbfb8aa3b, v12
  v_exp_f32 v5, v5
  s_nop 0
  v_add_f32 v5, 1.0, v5
  v_rcp_f32 v5, v5
  s_nop 0
  v_mul_f32 v12, v12, v5
  v_cvt_pk_bf16_f32 v12, v12, v12
  v_lshlrev_b32 v12, 16, v12
  v_lshlrev_b32 v13, 16, v13
  v_mul_f32 v5, 0xbfb8aa3b, v13
  v_exp_f32 v5, v5
  s_nop 0
  v_add_f32 v5, 1.0, v5
  v_rcp_f32 v5, v5
  s_nop 0
  v_mul_f32 v13, v13, v5
  v_cvt_pk_bf16_f32 v13, v13, v13
  v_lshlrev_b32 v13, 16, v13
  v_lshlrev_b32 v14, 16, v14
  v_mul_f32 v5, 0xbfb8aa3b, v14
  v_exp_f32 v5, v5
  s_nop 0
  v_add_f32 v5, 1.0, v5
  v_rcp_f32 v5, v5
  s_nop 0
  v_mul_f32 v14, v14, v5
  v_cvt_pk_bf16_f32 v14, v14, v14
  v_lshlrev_b32 v14, 16, v14
  v_lshlrev_b32 v15, 16, v15
  v_mul_f32 v5, 0xbfb8aa3b, v15
  v_exp_f32 v5, v5
  s_nop 0
  v_add_f32 v5, 1.0, v5
  v_rcp_f32 v5, v5
  s_nop 0
  v_mul_f32 v15, v15, v5
  v_cvt_pk_bf16_f32 v15, v15, v15
  v_lshlrev_b32 v15, 16, v15
  v_lshlrev_b32 v16, 16, v16
  v_mul_f32 v5, 0xbfb8aa3b, v16
  v_exp_f32 v5, v5
  s_nop 0
  v_add_f32 v5, 1.0, v5
  v_rcp_f32 v5, v5
  s_nop 0
  v_mul_f32 v16, v16, v5
  v_cvt_pk_bf16_f32 v16, v16, v16
  v_lshlrev_b32 v16, 16, v16
  v_lshlrev_b32 v17, 16, v17
  v_mul_f32 v5, 0xbfb8aa3b, v17
  v_exp_f32 v5, v5
  s_nop 0
  v_add_f32 v5, 1.0, v5
  v_rcp_f32 v5, v5
  s_nop 0
  v_mul_f32 v17, v17, v5
  v_cvt_pk_bf16_f32 v17, v17, v17
  v_lshlrev_b32 v17, 16, v17
  v_lshlrev_b32 v18, 16, v18
  v_mul_f32 v5, 0xbfb8aa3b, v18
  v_exp_f32 v5, v5
  s_nop 0
  v_add_f32 v5, 1.0, v5
  v_rcp_f32 v5, v5
  s_nop 0
  v_mul_f32 v18, v18, v5
  v_cvt_pk_bf16_f32 v18, v18, v18
  v_lshlrev_b32 v18, 16, v18
  v_lshlrev_b32 v19, 16, v19
  v_mul_f32 v5, 0xbfb8aa3b, v19
  v_exp_f32 v5, v5
  s_nop 0
  v_add_f32 v5, 1.0, v5
  v_rcp_f32 v5, v5
  s_nop 0
  v_mul_f32 v19, v19, v5
  v_cvt_pk_bf16_f32 v19, v19, v19
  v_lshlrev_b32 v19, 16, v19
  v_lshlrev_b32 v248, 7, v1
  v_lshl_add_u32 v248, v9, 5, v248
  v_add_u32 v248, 16384, v248
  v_and_b32 v6, 31, v0
  v_lshrrev_b32 v249, 5, v0
  v_lshlrev_b32 v249, 10, v249
  v_lshl_add_u32 v249, v6, 2, v249
  v_add_u32 v249, 16384, v249
  v_lshlrev_b32 v250, 2, v0
  v_mov_b32 v240, 0
  v_mov_b32 v241, 0
  v_mov_b32 v242, 0
  v_mov_b32 v243, 0
  v_mov_b32 v244, 0
  v_mov_b32 v245, 0
  v_mov_b32 v246, 0
  v_mov_b32 v247, 0
  s_waitcnt vmcnt(19)
  v_lshlrev_b32 v5, 16, v20
  v_and_b32 v6, 0xffff0000, v20
  v_fmac_f32 v240, v10, v5
  v_fmac_f32 v241, v10, v6
  v_lshlrev_b32 v5, 16, v21
  v_and_b32 v6, 0xffff0000, v21
  v_fmac_f32 v242, v10, v5
  v_fmac_f32 v243, v10, v6
  v_lshlrev_b32 v5, 16, v22
  v_and_b32 v6, 0xffff0000, v22
  v_fmac_f32 v244, v10, v5
  v_fmac_f32 v245, v10, v6
  v_lshlrev_b32 v5, 16, v23
  v_and_b32 v6, 0xffff0000, v23
  v_fmac_f32 v246, v10, v5
  v_fmac_f32 v247, v10, v6
  s_waitcnt vmcnt(18)
  v_lshlrev_b32 v5, 16, v24
  v_and_b32 v6, 0xffff0000, v24
  v_fmac_f32 v240, v11, v5
  v_fmac_f32 v241, v11, v6
  v_lshlrev_b32 v5, 16, v25
  v_and_b32 v6, 0xffff0000, v25
  v_fmac_f32 v242, v11, v5
  v_fmac_f32 v243, v11, v6
  v_lshlrev_b32 v5, 16, v26
  v_and_b32 v6, 0xffff0000, v26
  v_fmac_f32 v244, v11, v5
  v_fmac_f32 v245, v11, v6
  v_lshlrev_b32 v5, 16, v27
  v_and_b32 v6, 0xffff0000, v27
  v_fmac_f32 v246, v11, v5
  v_fmac_f32 v247, v11, v6
  s_waitcnt vmcnt(17)
  v_lshlrev_b32 v5, 16, v28
  v_and_b32 v6, 0xffff0000, v28
  v_fmac_f32 v240, v12, v5
  v_fmac_f32 v241, v12, v6
  v_lshlrev_b32 v5, 16, v29
  v_and_b32 v6, 0xffff0000, v29
  v_fmac_f32 v242, v12, v5
  v_fmac_f32 v243, v12, v6
  v_lshlrev_b32 v5, 16, v30
  v_and_b32 v6, 0xffff0000, v30
  v_fmac_f32 v244, v12, v5
  v_fmac_f32 v245, v12, v6
  v_lshlrev_b32 v5, 16, v31
  v_and_b32 v6, 0xffff0000, v31
  v_fmac_f32 v246, v12, v5
  v_fmac_f32 v247, v12, v6
  s_waitcnt vmcnt(16)
  v_lshlrev_b32 v5, 16, v32
  v_and_b32 v6, 0xffff0000, v32
  v_fmac_f32 v240, v13, v5
  v_fmac_f32 v241, v13, v6
  v_lshlrev_b32 v5, 16, v33
  v_and_b32 v6, 0xffff0000, v33
  v_fmac_f32 v242, v13, v5
  v_fmac_f32 v243, v13, v6
  v_lshlrev_b32 v5, 16, v34
  v_and_b32 v6, 0xffff0000, v34
  v_fmac_f32 v244, v13, v5
  v_fmac_f32 v245, v13, v6
  v_lshlrev_b32 v5, 16, v35
  v_and_b32 v6, 0xffff0000, v35
  v_fmac_f32 v246, v13, v5
  v_fmac_f32 v247, v13, v6
  s_waitcnt vmcnt(15)
  v_lshlrev_b32 v5, 16, v36
  v_and_b32 v6, 0xffff0000, v36
  v_fmac_f32 v240, v14, v5
  v_fmac_f32 v241, v14, v6
  v_lshlrev_b32 v5, 16, v37
  v_and_b32 v6, 0xffff0000, v37
  v_fmac_f32 v242, v14, v5
  v_fmac_f32 v243, v14, v6
  v_lshlrev_b32 v5, 16, v38
  v_and_b32 v6, 0xffff0000, v38
  v_fmac_f32 v244, v14, v5
  v_fmac_f32 v245, v14, v6
  v_lshlrev_b32 v5, 16, v39
  v_and_b32 v6, 0xffff0000, v39
  v_fmac_f32 v246, v14, v5
  v_fmac_f32 v247, v14, v6
  s_waitcnt vmcnt(14)
  v_lshlrev_b32 v5, 16, v40
  v_and_b32 v6, 0xffff0000, v40
  v_fmac_f32 v240, v15, v5
  v_fmac_f32 v241, v15, v6
  v_lshlrev_b32 v5, 16, v41
  v_and_b32 v6, 0xffff0000, v41
  v_fmac_f32 v242, v15, v5
  v_fmac_f32 v243, v15, v6
  v_lshlrev_b32 v5, 16, v42
  v_and_b32 v6, 0xffff0000, v42
  v_fmac_f32 v244, v15, v5
  v_fmac_f32 v245, v15, v6
  v_lshlrev_b32 v5, 16, v43
  v_and_b32 v6, 0xffff0000, v43
  v_fmac_f32 v246, v15, v5
  v_fmac_f32 v247, v15, v6
  s_waitcnt vmcnt(13)
  v_lshlrev_b32 v5, 16, v44
  v_and_b32 v6, 0xffff0000, v44
  v_fmac_f32 v240, v16, v5
  v_fmac_f32 v241, v16, v6
  v_lshlrev_b32 v5, 16, v45
  v_and_b32 v6, 0xffff0000, v45
  v_fmac_f32 v242, v16, v5
  v_fmac_f32 v243, v16, v6
  v_lshlrev_b32 v5, 16, v46
  v_and_b32 v6, 0xffff0000, v46
  v_fmac_f32 v244, v16, v5
  v_fmac_f32 v245, v16, v6
  v_lshlrev_b32 v5, 16, v47
  v_and_b32 v6, 0xffff0000, v47
  v_fmac_f32 v246, v16, v5
  v_fmac_f32 v247, v16, v6
  s_waitcnt vmcnt(12)
  v_lshlrev_b32 v5, 16, v48
  v_and_b32 v6, 0xffff0000, v48
  v_fmac_f32 v240, v17, v5
  v_fmac_f32 v241, v17, v6
  v_lshlrev_b32 v5, 16, v49
  v_and_b32 v6, 0xffff0000, v49
  v_fmac_f32 v242, v17, v5
  v_fmac_f32 v243, v17, v6
  v_lshlrev_b32 v5, 16, v50
  v_and_b32 v6, 0xffff0000, v50
  v_fmac_f32 v244, v17, v5
  v_fmac_f32 v245, v17, v6
  v_lshlrev_b32 v5, 16, v51
  v_and_b32 v6, 0xffff0000, v51
  v_fmac_f32 v246, v17, v5
  v_fmac_f32 v247, v17, v6
  s_waitcnt vmcnt(11)
  v_lshlrev_b32 v5, 16, v52
  v_and_b32 v6, 0xffff0000, v52
  v_fmac_f32 v240, v18, v5
  v_fmac_f32 v241, v18, v6
  v_lshlrev_b32 v5, 16, v53
  v_and_b32 v6, 0xffff0000, v53
  v_fmac_f32 v242, v18, v5
  v_fmac_f32 v243, v18, v6
  v_lshlrev_b32 v5, 16, v54
  v_and_b32 v6, 0xffff0000, v54
  v_fmac_f32 v244, v18, v5
  v_fmac_f32 v245, v18, v6
  v_lshlrev_b32 v5, 16, v55
  v_and_b32 v6, 0xffff0000, v55
  v_fmac_f32 v246, v18, v5
  v_fmac_f32 v247, v18, v6
  s_waitcnt vmcnt(10)
  v_lshlrev_b32 v5, 16, v56
  v_and_b32 v6, 0xffff0000, v56
  v_fmac_f32 v240, v19, v5
  v_fmac_f32 v241, v19, v6
  v_lshlrev_b32 v5, 16, v57
  v_and_b32 v6, 0xffff0000, v57
  v_fmac_f32 v242, v19, v5
  v_fmac_f32 v243, v19, v6
  v_lshlrev_b32 v5, 16, v58
  v_and_b32 v6, 0xffff0000, v58
  v_fmac_f32 v244, v19, v5
  v_fmac_f32 v245, v19, v6
  v_lshlrev_b32 v5, 16, v59
  v_and_b32 v6, 0xffff0000, v59
  v_fmac_f32 v246, v19, v5
  v_fmac_f32 v247, v19, v6
  ds_write_b128 v248, v[240:243]
  ds_write_b128 v248, v[244:247] offset:16
  s_waitcnt lgkmcnt(0)
  s_barrier
  ds_read_b32 v240, v249 offset:0
  ds_read_b32 v241, v249 offset:128
  ds_read_b32 v242, v249 offset:256
  ds_read_b32 v243, v249 offset:384
  ds_read_b32 v244, v249 offset:512
  ds_read_b32 v245, v249 offset:640
  ds_read_b32 v246, v249 offset:768
  ds_read_b32 v247, v249 offset:896
  s_waitcnt lgkmcnt(0)
  v_add_f32 v240, v240, v241
  v_add_f32 v240, v240, v242
  v_add_f32 v240, v240, v243
  v_add_f32 v240, v240, v244
  v_add_f32 v240, v240, v245
  v_add_f32 v240, v240, v246
  v_add_f32 v240, v240, v247
  ds_write_b32 v250, v240 offset:24576
  s_waitcnt lgkmcnt(0)
  s_barrier
  v_cmp_gt_u32 vcc, 32, v0
  s_nop 0
  s_and_saveexec_b64 s[30:31], vcc
  s_cbranch_execz G3_m10
  ds_read_b32 v240, v250 offset:24576
  ds_read_b32 v241, v250 offset:24704
  ds_read_b32 v242, v250 offset:24832
  ds_read_b32 v243, v250 offset:24960
  ds_read_b32 v244, v250 offset:25088
  ds_read_b32 v245, v250 offset:25216
  ds_read_b32 v246, v250 offset:25344
  ds_read_b32 v247, v250 offset:25472
  s_waitcnt lgkmcnt(0)
  v_add_f32 v240, v240, v241
  v_add_f32 v240, v240, v242
  v_add_f32 v240, v240, v243
  v_add_f32 v240, v240, v244
  v_add_f32 v240, v240, v245
  v_add_f32 v240, v240, v246
  v_add_f32 v240, v240, v247
  v_cvt_pk_bf16_f32 v240, v240, v240
  v_lshlrev_b32 v240, 16, v240
  s_add_u32 s28, s5, 0
  s_mul_i32 s29, s28, 52429
  s_lshr_b32 s29, s29, 20
  s_cmp_eq_u32 s29, 1
  s_cselect_b32 s58, 1, 0
  s_cmp_eq_u32 s29, 4
  s_cselect_b32 s58, 1, s58
  s_cmp_eq_u32 s58, 0
  s_cbranch_scc1 G3_n10
  v_add_f32 v240, 1.0, v240
  v_cvt_pk_bf16_f32 v240, v240, v240
  v_lshlrev_b32 v240, 16, v240
G3_n10:
  s_lshl_b32 s28, s28, 7
  v_add_u32 v5, s28, v250
  buffer_store_dword v240, v5, s[8:11], 0 offen offset:0 sc1
G3_m10:
  s_mov_b64 exec, s[30:31]
G3_d:
  s_mov_b32 s28, 655360
  buffer_load_dwordx2 v[180:181], v8, s[44:47], s28 offen offset:0
  buffer_load_dwordx2 v[182:183], v8, s[44:47], s28 offen offset:32
  buffer_load_dwordx2 v[184:185], v8, s[44:47], s28 offen offset:64
  buffer_load_dwordx2 v[186:187], v8, s[44:47], s28 offen offset:96
  buffer_load_dwordx2 v[188:189], v8, s[44:47], s28 offen offset:128
  buffer_load_dwordx2 v[190:191], v8, s[44:47], s28 offen offset:160
  buffer_load_dwordx2 v[192:193], v8, s[44:47], s28 offen offset:192
  buffer_load_dwordx2 v[194:195], v8, s[44:47], s28 offen offset:224
  buffer_load_dwordx2 v[196:197], v8, s[44:47], s28 offen offset:256
  buffer_load_dwordx2 v[198:199], v8, s[44:47], s28 offen offset:288
  s_mov_b32 s28, 1310720
  buffer_load_dwordx2 v[200:201], v8, s[44:47], s28 offen offset:0
  buffer_load_dwordx2 v[202:203], v8, s[44:47], s28 offen offset:32
  buffer_load_dwordx2 v[204:205], v8, s[44:47], s28 offen offset:64
  buffer_load_dwordx2 v[206:207], v8, s[44:47], s28 offen offset:96
  buffer_load_dwordx2 v[208:209], v8, s[44:47], s28 offen offset:128
  buffer_load_dwordx2 v[210:211], v8, s[44:47], s28 offen offset:160
  buffer_load_dwordx2 v[212:213], v8, s[44:47], s28 offen offset:192
  buffer_load_dwordx2 v[214:215], v8, s[44:47], s28 offen offset:224
  buffer_load_dwordx2 v[216:217], v8, s[44:47], s28 offen offset:256
  buffer_load_dwordx2 v[218:219], v8, s[44:47], s28 offen offset:288
  s_mov_b32 s28, 1966080
  buffer_load_dwordx2 v[220:221], v8, s[44:47], s28 offen offset:0
  buffer_load_dwordx2 v[222:223], v8, s[44:47], s28 offen offset:32
  buffer_load_dwordx2 v[224:225], v8, s[44:47], s28 offen offset:64
  buffer_load_dwordx2 v[226:227], v8, s[44:47], s28 offen offset:96
  buffer_load_dwordx2 v[228:229], v8, s[44:47], s28 offen offset:128
  buffer_load_dwordx2 v[230:231], v8, s[44:47], s28 offen offset:160
  buffer_load_dwordx2 v[232:233], v8, s[44:47], s28 offen offset:192
  buffer_load_dwordx2 v[234:235], v8, s[44:47], s28 offen offset:224
  buffer_load_dwordx2 v[236:237], v8, s[44:47], s28 offen offset:256
  buffer_load_dwordx2 v[238:239], v8, s[44:47], s28 offen offset:288
  s_waitcnt vmcnt(30)
  s_barrier
  s_mov_b32 s41, 0
  s_cmp_eq_u32 s91, 0
  s_cbranch_scc0 G3_d2
  s_mov_b64 exec, 1
  v_mov_b32 v252, 128
  v_mov_b32 v251, 1
  buffer_atomic_add v251, v252, s[12:15], 0 offen sc1
  s_mov_b64 exec, -1
G3_d2:
  v_lshlrev_b32 v120, 16, v160
  v_and_b32 v121, 0xffff0000, v160
  v_lshlrev_b32 v122, 16, v161
  v_and_b32 v123, 0xffff0000, v161
  v_lshlrev_b32 v124, 16, v162
  v_and_b32 v125, 0xffff0000, v162
  v_lshlrev_b32 v126, 16, v163
  v_and_b32 v127, 0xffff0000, v163
  v_lshlrev_b32 v128, 16, v164
  v_and_b32 v129, 0xffff0000, v164
  v_lshlrev_b32 v130, 16, v165
  v_and_b32 v131, 0xffff0000, v165
  v_lshlrev_b32 v132, 16, v166
  v_and_b32 v133, 0xffff0000, v166
  v_lshlrev_b32 v134, 16, v167
  v_and_b32 v135, 0xffff0000, v167
  v_lshlrev_b32 v136, 16, v168
  v_and_b32 v137, 0xffff0000, v168
  v_lshlrev_b32 v138, 16, v169
  v_and_b32 v139, 0xffff0000, v169
  v_lshlrev_b32 v140, 16, v170
  v_and_b32 v141, 0xffff0000, v170
  v_lshlrev_b32 v142, 16, v171
  v_and_b32 v143, 0xffff0000, v171
  v_lshlrev_b32 v144, 16, v172
  v_and_b32 v145, 0xffff0000, v172
  v_lshlrev_b32 v146, 16, v173
  v_and_b32 v147, 0xffff0000, v173
  v_lshlrev_b32 v148, 16, v174
  v_and_b32 v149, 0xffff0000, v174
  v_lshlrev_b32 v150, 16, v175
  v_and_b32 v151, 0xffff0000, v175
  v_lshlrev_b32 v152, 16, v176
  v_and_b32 v153, 0xffff0000, v176
  v_lshlrev_b32 v154, 16, v177
  v_and_b32 v155, 0xffff0000, v177
  v_lshlrev_b32 v156, 16, v178
  v_and_b32 v157, 0xffff0000, v178
  v_lshlrev_b32 v158, 16, v179
  v_and_b32 v159, 0xffff0000, v179
  v_add_f32 v70, v120, v121
  v_add_f32 v70, v70, v122
  v_add_f32 v70, v70, v123
  v_add_f32 v70, v70, v124
  v_add_f32 v70, v70, v125
  v_add_f32 v70, v70, v126
  v_add_f32 v70, v70, v127
  v_add_f32 v70, v70, v128
  v_add_f32 v70, v70, v129
  v_add_f32 v70, v70, v130
  v_add_f32 v70, v70, v131
  v_add_f32 v70, v70, v132
  v_add_f32 v70, v70, v133
  v_add_f32 v70, v70, v134
  v_add_f32 v70, v70, v135
  v_add_f32 v70, v70, v136
  v_add_f32 v70, v70, v137
  v_add_f32 v70, v70, v138
  v_add_f32 v70, v70, v139
  v_add_f32 v70, v70, v140
  v_add_f32 v70, v70, v141
  v_add_f32 v70, v70, v142
  v_add_f32 v70, v70, v143
  v_add_f32 v70, v70, v144
  v_add_f32 v70, v70, v145
  v_add_f32 v70, v70, v146
  v_add_f32 v70, v70, v147
  v_add_f32 v70, v70, v148
  v_add_f32 v70, v70, v149
  v_add_f32 v70, v70, v150
  v_add_f32 v70, v70, v151
  v_add_f32 v70, v70, v152
  v_add_f32 v70, v70, v153
  v_add_f32 v70, v70, v154
  v_add_f32 v70, v70, v155
  v_add_f32 v70, v70, v156
  v_add_f32 v70, v70, v157
  v_add_f32 v70, v70, v158
  v_add_f32 v70, v70, v159
  v_mov_b32 v71, v70
  s_nop 1
  v_permlane32_swap_b32 v70, v71
  v_add_f32 v70, v70, v71
  v_mov_b32 v71, v70
  s_nop 1
  v_permlane16_swap_b32 v70, v71
  v_add_f32 v70, v70, v71
  s_lshl_b32 s30, s91, 6
  v_lshlrev_b32 v72, 2, v3
  v_add_u32 v73, s30, v72
  ds_write_b32 v73, v70
  s_waitcnt lgkmcnt(0)
  s_barrier
  ds_read_b32 v74, v72
  ds_read_b32 v75, v72 offset:64
  ds_read_b32 v76, v72 offset:128
  ds_read_b32 v77, v72 offset:192
  s_waitcnt lgkmcnt(0)
  v_add_f32 v74, v74, v75
  v_add_f32 v76, v76, v77
  v_add_f32 v74, v74, v76
  v_mul_f32 v74, 0x3acccccd, v74
  v_sub_f32 v71, v120, v74
  v_mul_f32 v70, v71, v71
  v_sub_f32 v71, v121, v74
  v_fmac_f32 v70, v71, v71
  v_sub_f32 v71, v122, v74
  v_fmac_f32 v70, v71, v71
  v_sub_f32 v71, v123, v74
  v_fmac_f32 v70, v71, v71
  v_sub_f32 v71, v124, v74
  v_fmac_f32 v70, v71, v71
  v_sub_f32 v71, v125, v74
  v_fmac_f32 v70, v71, v71
  v_sub_f32 v71, v126, v74
  v_fmac_f32 v70, v71, v71
  v_sub_f32 v71, v127, v74
  v_fmac_f32 v70, v71, v71
  v_sub_f32 v71, v128, v74
  v_fmac_f32 v70, v71, v71
  v_sub_f32 v71, v129, v74
  v_fmac_f32 v70, v71, v71
  v_sub_f32 v71, v130, v74
  v_fmac_f32 v70, v71, v71
  v_sub_f32 v71, v131, v74
  v_fmac_f32 v70, v71, v71
  v_sub_f32 v71, v132, v74
  v_fmac_f32 v70, v71, v71
  v_sub_f32 v71, v133, v74
  v_fmac_f32 v70, v71, v71
  v_sub_f32 v71, v134, v74
  v_fmac_f32 v70, v71, v71
  v_sub_f32 v71, v135, v74
  v_fmac_f32 v70, v71, v71
  v_sub_f32 v71, v136, v74
  v_fmac_f32 v70, v71, v71
  v_sub_f32 v71, v137, v74
  v_fmac_f32 v70, v71, v71
  v_sub_f32 v71, v138, v74
  v_fmac_f32 v70, v71, v71
  v_sub_f32 v71, v139, v74
  v_fmac_f32 v70, v71, v71
  v_sub_f32 v71, v140, v74
  v_fmac_f32 v70, v71, v71
  v_sub_f32 v71, v141, v74
  v_fmac_f32 v70, v71, v71
  v_sub_f32 v71, v142, v74
  v_fmac_f32 v70, v71, v71
  v_sub_f32 v71, v143, v74
  v_fmac_f32 v70, v71, v71
  v_sub_f32 v71, v144, v74
  v_fmac_f32 v70, v71, v71
  v_sub_f32 v71, v145, v74
  v_fmac_f32 v70, v71, v71
  v_sub_f32 v71, v146, v74
  v_fmac_f32 v70, v71, v71
  v_sub_f32 v71, v147, v74
  v_fmac_f32 v70, v71, v71
  v_sub_f32 v71, v148, v74
  v_fmac_f32 v70, v71, v71
  v_sub_f32 v71, v149, v74
  v_fmac_f32 v70, v71, v71
  v_sub_f32 v71, v150, v74
  v_fmac_f32 v70, v71, v71
  v_sub_f32 v71, v151, v74
  v_fmac_f32 v70, v71, v71
  v_sub_f32 v71, v152, v74
  v_fmac_f32 v70, v71, v71
  v_sub_f32 v71, v153, v74
  v_fmac_f32 v70, v71, v71
  v_sub_f32 v71, v154, v74
  v_fmac_f32 v70, v71, v71
  v_sub_f32 v71, v155, v74
  v_fmac_f32 v70, v71, v71
  v_sub_f32 v71, v156, v74
  v_fmac_f32 v70, v71, v71
  v_sub_f32 v71, v157, v74
  v_fmac_f32 v70, v71, v71
  v_sub_f32 v71, v158, v74
  v_fmac_f32 v70, v71, v71
  v_sub_f32 v71, v159, v74
  v_fmac_f32 v70, v71, v71
  v_mov_b32 v71, v70
  s_nop 1
  v_permlane32_swap_b32 v70, v71
  v_add_f32 v70, v70, v71
  v_mov_b32 v71, v70
  s_nop 1
  v_permlane16_swap_b32 v70, v71
  v_add_f32 v70, v70, v71
  ds_write_b32 v73, v70 offset:256
  s_waitcnt lgkmcnt(0)
  s_barrier
  ds_read_b32 v75, v72 offset:256
  ds_read_b32 v76, v72 offset:320
  ds_read_b32 v77, v72 offset:384
  ds_read_b32 v78, v72 offset:448
  s_waitcnt lgkmcnt(0)
  v_add_f32 v75, v75, v76
  v_add_f32 v77, v77, v78
  v_add_f32 v75, v75, v77
  v_mul_f32 v75, 0x3acccccd, v75
  v_cvt_pk_bf16_f32 v74, v74, v74
  v_lshlrev_b32 v74, 16, v74
  v_cvt_pk_bf16_f32 v75, v75, v75
  v_lshlrev_b32 v75, 16, v75
  v_add_f32 v75, 0x3727c5ac, v75
  v_cvt_pk_bf16_f32 v75, v75, v75
  v_lshlrev_b32 v75, 16, v75
  v_sqrt_f32 v75, v75
  s_nop 0
  v_cvt_pk_bf16_f32 v75, v75, v75
  v_lshlrev_b32 v75, 16, v75
  v_rcp_f32 v76, v75
  v_sub_f32 v120, v120, v74
  v_sub_f32 v121, v121, v74
  v_cvt_pk_bf16_f32 v71, v120, v121
  v_lshlrev_b32 v120, 16, v71
  v_and_b32 v121, 0xffff0000, v71
  v_mul_f32 v77, v120, v76
  v_fma_f32 v78, -v77, v75, v120
  v_fma_f32 v120, v78, v76, v77
  v_mul_f32 v77, v121, v76
  v_fma_f32 v78, -v77, v75, v121
  v_fma_f32 v121, v78, v76, v77
  v_cvt_pk_bf16_f32 v71, v120, v121
  v_lshlrev_b32 v120, 16, v71
  v_and_b32 v121, 0xffff0000, v71
  v_sub_f32 v122, v122, v74
  v_sub_f32 v123, v123, v74
  v_cvt_pk_bf16_f32 v71, v122, v123
  v_lshlrev_b32 v122, 16, v71
  v_and_b32 v123, 0xffff0000, v71
  v_mul_f32 v77, v122, v76
  v_fma_f32 v78, -v77, v75, v122
  v_fma_f32 v122, v78, v76, v77
  v_mul_f32 v77, v123, v76
  v_fma_f32 v78, -v77, v75, v123
  v_fma_f32 v123, v78, v76, v77
  v_cvt_pk_bf16_f32 v71, v122, v123
  v_lshlrev_b32 v122, 16, v71
  v_and_b32 v123, 0xffff0000, v71
  v_sub_f32 v124, v124, v74
  v_sub_f32 v125, v125, v74
  v_cvt_pk_bf16_f32 v71, v124, v125
  v_lshlrev_b32 v124, 16, v71
  v_and_b32 v125, 0xffff0000, v71
  v_mul_f32 v77, v124, v76
  v_fma_f32 v78, -v77, v75, v124
  v_fma_f32 v124, v78, v76, v77
  v_mul_f32 v77, v125, v76
  v_fma_f32 v78, -v77, v75, v125
  v_fma_f32 v125, v78, v76, v77
  v_cvt_pk_bf16_f32 v71, v124, v125
  v_lshlrev_b32 v124, 16, v71
  v_and_b32 v125, 0xffff0000, v71
  v_sub_f32 v126, v126, v74
  v_sub_f32 v127, v127, v74
  v_cvt_pk_bf16_f32 v71, v126, v127
  v_lshlrev_b32 v126, 16, v71
  v_and_b32 v127, 0xffff0000, v71
  v_mul_f32 v77, v126, v76
  v_fma_f32 v78, -v77, v75, v126
  v_fma_f32 v126, v78, v76, v77
  v_mul_f32 v77, v127, v76
  v_fma_f32 v78, -v77, v75, v127
  v_fma_f32 v127, v78, v76, v77
  v_cvt_pk_bf16_f32 v71, v126, v127
  v_lshlrev_b32 v126, 16, v71
  v_and_b32 v127, 0xffff0000, v71
  v_sub_f32 v128, v128, v74
  v_sub_f32 v129, v129, v74
  v_cvt_pk_bf16_f32 v71, v128, v129
  v_lshlrev_b32 v128, 16, v71
  v_and_b32 v129, 0xffff0000, v71
  v_mul_f32 v77, v128, v76
  v_fma_f32 v78, -v77, v75, v128
  v_fma_f32 v128, v78, v76, v77
  v_mul_f32 v77, v129, v76
  v_fma_f32 v78, -v77, v75, v129
  v_fma_f32 v129, v78, v76, v77
  v_cvt_pk_bf16_f32 v71, v128, v129
  v_lshlrev_b32 v128, 16, v71
  v_and_b32 v129, 0xffff0000, v71
  v_sub_f32 v130, v130, v74
  v_sub_f32 v131, v131, v74
  v_cvt_pk_bf16_f32 v71, v130, v131
  v_lshlrev_b32 v130, 16, v71
  v_and_b32 v131, 0xffff0000, v71
  v_mul_f32 v77, v130, v76
  v_fma_f32 v78, -v77, v75, v130
  v_fma_f32 v130, v78, v76, v77
  v_mul_f32 v77, v131, v76
  v_fma_f32 v78, -v77, v75, v131
  v_fma_f32 v131, v78, v76, v77
  v_cvt_pk_bf16_f32 v71, v130, v131
  v_lshlrev_b32 v130, 16, v71
  v_and_b32 v131, 0xffff0000, v71
  v_sub_f32 v132, v132, v74
  v_sub_f32 v133, v133, v74
  v_cvt_pk_bf16_f32 v71, v132, v133
  v_lshlrev_b32 v132, 16, v71
  v_and_b32 v133, 0xffff0000, v71
  v_mul_f32 v77, v132, v76
  v_fma_f32 v78, -v77, v75, v132
  v_fma_f32 v132, v78, v76, v77
  v_mul_f32 v77, v133, v76
  v_fma_f32 v78, -v77, v75, v133
  v_fma_f32 v133, v78, v76, v77
  v_cvt_pk_bf16_f32 v71, v132, v133
  v_lshlrev_b32 v132, 16, v71
  v_and_b32 v133, 0xffff0000, v71
  v_sub_f32 v134, v134, v74
  v_sub_f32 v135, v135, v74
  v_cvt_pk_bf16_f32 v71, v134, v135
  v_lshlrev_b32 v134, 16, v71
  v_and_b32 v135, 0xffff0000, v71
  v_mul_f32 v77, v134, v76
  v_fma_f32 v78, -v77, v75, v134
  v_fma_f32 v134, v78, v76, v77
  v_mul_f32 v77, v135, v76
  v_fma_f32 v78, -v77, v75, v135
  v_fma_f32 v135, v78, v76, v77
  v_cvt_pk_bf16_f32 v71, v134, v135
  v_lshlrev_b32 v134, 16, v71
  v_and_b32 v135, 0xffff0000, v71
  v_sub_f32 v136, v136, v74
  v_sub_f32 v137, v137, v74
  v_cvt_pk_bf16_f32 v71, v136, v137
  v_lshlrev_b32 v136, 16, v71
  v_and_b32 v137, 0xffff0000, v71
  v_mul_f32 v77, v136, v76
  v_fma_f32 v78, -v77, v75, v136
  v_fma_f32 v136, v78, v76, v77
  v_mul_f32 v77, v137, v76
  v_fma_f32 v78, -v77, v75, v137
  v_fma_f32 v137, v78, v76, v77
  v_cvt_pk_bf16_f32 v71, v136, v137
  v_lshlrev_b32 v136, 16, v71
  v_and_b32 v137, 0xffff0000, v71
  v_sub_f32 v138, v138, v74
  v_sub_f32 v139, v139, v74
  v_cvt_pk_bf16_f32 v71, v138, v139
  v_lshlrev_b32 v138, 16, v71
  v_and_b32 v139, 0xffff0000, v71
  v_mul_f32 v77, v138, v76
  v_fma_f32 v78, -v77, v75, v138
  v_fma_f32 v138, v78, v76, v77
  v_mul_f32 v77, v139, v76
  v_fma_f32 v78, -v77, v75, v139
  v_fma_f32 v139, v78, v76, v77
  v_cvt_pk_bf16_f32 v71, v138, v139
  v_lshlrev_b32 v138, 16, v71
  v_and_b32 v139, 0xffff0000, v71
  v_sub_f32 v140, v140, v74
  v_sub_f32 v141, v141, v74
  v_cvt_pk_bf16_f32 v71, v140, v141
  v_lshlrev_b32 v140, 16, v71
  v_and_b32 v141, 0xffff0000, v71
  v_mul_f32 v77, v140, v76
  v_fma_f32 v78, -v77, v75, v140
  v_fma_f32 v140, v78, v76, v77
  v_mul_f32 v77, v141, v76
  v_fma_f32 v78, -v77, v75, v141
  v_fma_f32 v141, v78, v76, v77
  v_cvt_pk_bf16_f32 v71, v140, v141
  v_lshlrev_b32 v140, 16, v71
  v_and_b32 v141, 0xffff0000, v71
  v_sub_f32 v142, v142, v74
  v_sub_f32 v143, v143, v74
  v_cvt_pk_bf16_f32 v71, v142, v143
  v_lshlrev_b32 v142, 16, v71
  v_and_b32 v143, 0xffff0000, v71
  v_mul_f32 v77, v142, v76
  v_fma_f32 v78, -v77, v75, v142
  v_fma_f32 v142, v78, v76, v77
  v_mul_f32 v77, v143, v76
  v_fma_f32 v78, -v77, v75, v143
  v_fma_f32 v143, v78, v76, v77
  v_cvt_pk_bf16_f32 v71, v142, v143
  v_lshlrev_b32 v142, 16, v71
  v_and_b32 v143, 0xffff0000, v71
  v_sub_f32 v144, v144, v74
  v_sub_f32 v145, v145, v74
  v_cvt_pk_bf16_f32 v71, v144, v145
  v_lshlrev_b32 v144, 16, v71
  v_and_b32 v145, 0xffff0000, v71
  v_mul_f32 v77, v144, v76
  v_fma_f32 v78, -v77, v75, v144
  v_fma_f32 v144, v78, v76, v77
  v_mul_f32 v77, v145, v76
  v_fma_f32 v78, -v77, v75, v145
  v_fma_f32 v145, v78, v76, v77
  v_cvt_pk_bf16_f32 v71, v144, v145
  v_lshlrev_b32 v144, 16, v71
  v_and_b32 v145, 0xffff0000, v71
  v_sub_f32 v146, v146, v74
  v_sub_f32 v147, v147, v74
  v_cvt_pk_bf16_f32 v71, v146, v147
  v_lshlrev_b32 v146, 16, v71
  v_and_b32 v147, 0xffff0000, v71
  v_mul_f32 v77, v146, v76
  v_fma_f32 v78, -v77, v75, v146
  v_fma_f32 v146, v78, v76, v77
  v_mul_f32 v77, v147, v76
  v_fma_f32 v78, -v77, v75, v147
  v_fma_f32 v147, v78, v76, v77
  v_cvt_pk_bf16_f32 v71, v146, v147
  v_lshlrev_b32 v146, 16, v71
  v_and_b32 v147, 0xffff0000, v71
  v_sub_f32 v148, v148, v74
  v_sub_f32 v149, v149, v74
  v_cvt_pk_bf16_f32 v71, v148, v149
  v_lshlrev_b32 v148, 16, v71
  v_and_b32 v149, 0xffff0000, v71
  v_mul_f32 v77, v148, v76
  v_fma_f32 v78, -v77, v75, v148
  v_fma_f32 v148, v78, v76, v77
  v_mul_f32 v77, v149, v76
  v_fma_f32 v78, -v77, v75, v149
  v_fma_f32 v149, v78, v76, v77
  v_cvt_pk_bf16_f32 v71, v148, v149
  v_lshlrev_b32 v148, 16, v71
  v_and_b32 v149, 0xffff0000, v71
  v_sub_f32 v150, v150, v74
  v_sub_f32 v151, v151, v74
  v_cvt_pk_bf16_f32 v71, v150, v151
  v_lshlrev_b32 v150, 16, v71
  v_and_b32 v151, 0xffff0000, v71
  v_mul_f32 v77, v150, v76
  v_fma_f32 v78, -v77, v75, v150
  v_fma_f32 v150, v78, v76, v77
  v_mul_f32 v77, v151, v76
  v_fma_f32 v78, -v77, v75, v151
  v_fma_f32 v151, v78, v76, v77
  v_cvt_pk_bf16_f32 v71, v150, v151
  v_lshlrev_b32 v150, 16, v71
  v_and_b32 v151, 0xffff0000, v71
  v_sub_f32 v152, v152, v74
  v_sub_f32 v153, v153, v74
  v_cvt_pk_bf16_f32 v71, v152, v153
  v_lshlrev_b32 v152, 16, v71
  v_and_b32 v153, 0xffff0000, v71
  v_mul_f32 v77, v152, v76
  v_fma_f32 v78, -v77, v75, v152
  v_fma_f32 v152, v78, v76, v77
  v_mul_f32 v77, v153, v76
  v_fma_f32 v78, -v77, v75, v153
  v_fma_f32 v153, v78, v76, v77
  v_cvt_pk_bf16_f32 v71, v152, v153
  v_lshlrev_b32 v152, 16, v71
  v_and_b32 v153, 0xffff0000, v71
  v_sub_f32 v154, v154, v74
  v_sub_f32 v155, v155, v74
  v_cvt_pk_bf16_f32 v71, v154, v155
  v_lshlrev_b32 v154, 16, v71
  v_and_b32 v155, 0xffff0000, v71
  v_mul_f32 v77, v154, v76
  v_fma_f32 v78, -v77, v75, v154
  v_fma_f32 v154, v78, v76, v77
  v_mul_f32 v77, v155, v76
  v_fma_f32 v78, -v77, v75, v155
  v_fma_f32 v155, v78, v76, v77
  v_cvt_pk_bf16_f32 v71, v154, v155
  v_lshlrev_b32 v154, 16, v71
  v_and_b32 v155, 0xffff0000, v71
  v_sub_f32 v156, v156, v74
  v_sub_f32 v157, v157, v74
  v_cvt_pk_bf16_f32 v71, v156, v157
  v_lshlrev_b32 v156, 16, v71
  v_and_b32 v157, 0xffff0000, v71
  v_mul_f32 v77, v156, v76
  v_fma_f32 v78, -v77, v75, v156
  v_fma_f32 v156, v78, v76, v77
  v_mul_f32 v77, v157, v76
  v_fma_f32 v78, -v77, v75, v157
  v_fma_f32 v157, v78, v76, v77
  v_cvt_pk_bf16_f32 v71, v156, v157
  v_lshlrev_b32 v156, 16, v71
  v_and_b32 v157, 0xffff0000, v71
  v_sub_f32 v158, v158, v74
  v_sub_f32 v159, v159, v74
  v_cvt_pk_bf16_f32 v71, v158, v159
  v_lshlrev_b32 v158, 16, v71
  v_and_b32 v159, 0xffff0000, v71
  v_mul_f32 v77, v158, v76
  v_fma_f32 v78, -v77, v75, v158
  v_fma_f32 v158, v78, v76, v77
  v_mul_f32 v77, v159, v76
  v_fma_f32 v78, -v77, v75, v159
  v_fma_f32 v159, v78, v76, v77
  v_cvt_pk_bf16_f32 v71, v158, v159
  v_lshlrev_b32 v158, 16, v71
  v_and_b32 v159, 0xffff0000, v71
  s_cmp_eq_u32 s91, 0
  s_cbranch_scc0 G3_w_ok
  v_mov_b32 v252, 128
G3_w_w:
  buffer_load_dword v253, v252, s[12:15], 0 offen sc1
  s_waitcnt vmcnt(0)
  v_readfirstlane_b32 s57, v253
  s_nop 0
  s_cmp_ge_u32 s57, 32
  s_cbranch_scc1 G3_w_ok
  s_sleep 36
  s_add_u32 s41, s41, 64
  s_cmp_lt_u32 s41, 4000000
  s_cbranch_scc1 G3_w_w
G3_w_ok:
  s_barrier
  v_lshlrev_b32 v6, 4, v4
  s_mul_i32 s28, s91, 640
  v_add_u32 v6, s28, v6
  v_lshlrev_b32 v7, 4, v2
  buffer_load_dwordx4 v[10:13], v6, s[8:11], 0 offen offset:2560 sc1
  buffer_load_dwordx4 v[80:83], v6, s[8:11], 0 offen offset:0 sc1
  buffer_load_dwordx4 v[14:17], v6, s[8:11], 0 offen offset:2624 sc1
  buffer_load_dwordx4 v[84:87], v6, s[8:11], 0 offen offset:64 sc1
  buffer_load_dwordx4 v[18:21], v6, s[8:11], 0 offen offset:2688 sc1
  buffer_load_dwordx4 v[88:91], v6, s[8:11], 0 offen offset:128 sc1
  buffer_load_dwordx4 v[22:25], v6, s[8:11], 0 offen offset:2752 sc1
  buffer_load_dwordx4 v[92:95], v6, s[8:11], 0 offen offset:192 sc1
  buffer_load_dwordx4 v[26:29], v6, s[8:11], 0 offen offset:2816 sc1
  buffer_load_dwordx4 v[96:99], v6, s[8:11], 0 offen offset:256 sc1
  buffer_load_dwordx4 v[30:33], v6, s[8:11], 0 offen offset:2880 sc1
  buffer_load_dwordx4 v[100:103], v6, s[8:11], 0 offen offset:320 sc1
  buffer_load_dwordx4 v[34:37], v6, s[8:11], 0 offen offset:2944 sc1
  buffer_load_dwordx4 v[104:107], v6, s[8:11], 0 offen offset:384 sc1
  buffer_load_dwordx4 v[38:41], v6, s[8:11], 0 offen offset:3008 sc1
  buffer_load_dwordx4 v[108:111], v6, s[8:11], 0 offen offset:448 sc1
  buffer_load_dwordx4 v[42:45], v6, s[8:11], 0 offen offset:3072 sc1
  buffer_load_dwordx4 v[112:115], v6, s[8:11], 0 offen offset:512 sc1
  buffer_load_dwordx4 v[46:49], v6, s[8:11], 0 offen offset:3136 sc1
  buffer_load_dwordx4 v[116:119], v6, s[8:11], 0 offen offset:576 sc1
  s_add_u32 s28, s5, 0
  s_mul_i32 s28, s28, 20480
  s_mul_i32 s29, s91, 5120
  s_add_u32 s28, s28, s29
  s_add_u32 s28, s28, 19922944
  s_waitcnt vmcnt(0)
  v_mul_f32 v120, v120, v10
  v_mul_f32 v121, v121, v11
  v_cvt_pk_bf16_f32 v71, v120, v121
  v_lshlrev_b32 v120, 16, v71
  v_and_b32 v121, 0xffff0000, v71
  v_add_f32 v120, v120, v80
  v_add_f32 v121, v121, v81
  v_cvt_pk_bf16_f32 v50, v120, v121
  v_mul_f32 v122, v122, v12
  v_mul_f32 v123, v123, v13
  v_cvt_pk_bf16_f32 v71, v122, v123
  v_lshlrev_b32 v122, 16, v71
  v_and_b32 v123, 0xffff0000, v71
  v_add_f32 v122, v122, v82
  v_add_f32 v123, v123, v83
  v_cvt_pk_bf16_f32 v51, v122, v123
  v_mul_f32 v124, v124, v14
  v_mul_f32 v125, v125, v15
  v_cvt_pk_bf16_f32 v71, v124, v125
  v_lshlrev_b32 v124, 16, v71
  v_and_b32 v125, 0xffff0000, v71
  v_add_f32 v124, v124, v84
  v_add_f32 v125, v125, v85
  v_cvt_pk_bf16_f32 v52, v124, v125
  v_mul_f32 v126, v126, v16
  v_mul_f32 v127, v127, v17
  v_cvt_pk_bf16_f32 v71, v126, v127
  v_lshlrev_b32 v126, 16, v71
  v_and_b32 v127, 0xffff0000, v71
  v_add_f32 v126, v126, v86
  v_add_f32 v127, v127, v87
  v_cvt_pk_bf16_f32 v53, v126, v127
  buffer_store_dwordx4 v[50:53], v7, s[8:11], s28 offen offset:0 sc1
  v_mul_f32 v128, v128, v18
  v_mul_f32 v129, v129, v19
  v_cvt_pk_bf16_f32 v71, v128, v129
  v_lshlrev_b32 v128, 16, v71
  v_and_b32 v129, 0xffff0000, v71
  v_add_f32 v128, v128, v88
  v_add_f32 v129, v129, v89
  v_cvt_pk_bf16_f32 v54, v128, v129
  v_mul_f32 v130, v130, v20
  v_mul_f32 v131, v131, v21
  v_cvt_pk_bf16_f32 v71, v130, v131
  v_lshlrev_b32 v130, 16, v71
  v_and_b32 v131, 0xffff0000, v71
  v_add_f32 v130, v130, v90
  v_add_f32 v131, v131, v91
  v_cvt_pk_bf16_f32 v55, v130, v131
  v_mul_f32 v132, v132, v22
  v_mul_f32 v133, v133, v23
  v_cvt_pk_bf16_f32 v71, v132, v133
  v_lshlrev_b32 v132, 16, v71
  v_and_b32 v133, 0xffff0000, v71
  v_add_f32 v132, v132, v92
  v_add_f32 v133, v133, v93
  v_cvt_pk_bf16_f32 v56, v132, v133
  v_mul_f32 v134, v134, v24
  v_mul_f32 v135, v135, v25
  v_cvt_pk_bf16_f32 v71, v134, v135
  v_lshlrev_b32 v134, 16, v71
  v_and_b32 v135, 0xffff0000, v71
  v_add_f32 v134, v134, v94
  v_add_f32 v135, v135, v95
  v_cvt_pk_bf16_f32 v57, v134, v135
  buffer_store_dwordx4 v[54:57], v7, s[8:11], s28 offen offset:1024 sc1
  v_mul_f32 v136, v136, v26
  v_mul_f32 v137, v137, v27
  v_cvt_pk_bf16_f32 v71, v136, v137
  v_lshlrev_b32 v136, 16, v71
  v_and_b32 v137, 0xffff0000, v71
  v_add_f32 v136, v136, v96
  v_add_f32 v137, v137, v97
  v_cvt_pk_bf16_f32 v58, v136, v137
  v_mul_f32 v138, v138, v28
  v_mul_f32 v139, v139, v29
  v_cvt_pk_bf16_f32 v71, v138, v139
  v_lshlrev_b32 v138, 16, v71
  v_and_b32 v139, 0xffff0000, v71
  v_add_f32 v138, v138, v98
  v_add_f32 v139, v139, v99
  v_cvt_pk_bf16_f32 v59, v138, v139
  v_mul_f32 v140, v140, v30
  v_mul_f32 v141, v141, v31
  v_cvt_pk_bf16_f32 v71, v140, v141
  v_lshlrev_b32 v140, 16, v71
  v_and_b32 v141, 0xffff0000, v71
  v_add_f32 v140, v140, v100
  v_add_f32 v141, v141, v101
  v_cvt_pk_bf16_f32 v60, v140, v141
  v_mul_f32 v142, v142, v32
  v_mul_f32 v143, v143, v33
  v_cvt_pk_bf16_f32 v71, v142, v143
  v_lshlrev_b32 v142, 16, v71
  v_and_b32 v143, 0xffff0000, v71
  v_add_f32 v142, v142, v102
  v_add_f32 v143, v143, v103
  v_cvt_pk_bf16_f32 v61, v142, v143
  buffer_store_dwordx4 v[58:61], v7, s[8:11], s28 offen offset:2048 sc1
  v_mul_f32 v144, v144, v34
  v_mul_f32 v145, v145, v35
  v_cvt_pk_bf16_f32 v71, v144, v145
  v_lshlrev_b32 v144, 16, v71
  v_and_b32 v145, 0xffff0000, v71
  v_add_f32 v144, v144, v104
  v_add_f32 v145, v145, v105
  v_cvt_pk_bf16_f32 v62, v144, v145
  v_mul_f32 v146, v146, v36
  v_mul_f32 v147, v147, v37
  v_cvt_pk_bf16_f32 v71, v146, v147
  v_lshlrev_b32 v146, 16, v71
  v_and_b32 v147, 0xffff0000, v71
  v_add_f32 v146, v146, v106
  v_add_f32 v147, v147, v107
  v_cvt_pk_bf16_f32 v63, v146, v147
  v_mul_f32 v148, v148, v38
  v_mul_f32 v149, v149, v39
  v_cvt_pk_bf16_f32 v71, v148, v149
  v_lshlrev_b32 v148, 16, v71
  v_and_b32 v149, 0xffff0000, v71
  v_add_f32 v148, v148, v108
  v_add_f32 v149, v149, v109
  v_cvt_pk_bf16_f32 v64, v148, v149
  v_mul_f32 v150, v150, v40
  v_mul_f32 v151, v151, v41
  v_cvt_pk_bf16_f32 v71, v150, v151
  v_lshlrev_b32 v150, 16, v71
  v_and_b32 v151, 0xffff0000, v71
  v_add_f32 v150, v150, v110
  v_add_f32 v151, v151, v111
  v_cvt_pk_bf16_f32 v65, v150, v151
  buffer_store_dwordx4 v[62:65], v7, s[8:11], s28 offen offset:3072 sc1
  v_mul_f32 v152, v152, v42
  v_mul_f32 v153, v153, v43
  v_cvt_pk_bf16_f32 v71, v152, v153
  v_lshlrev_b32 v152, 16, v71
  v_and_b32 v153, 0xffff0000, v71
  v_add_f32 v152, v152, v112
  v_add_f32 v153, v153, v113
  v_cvt_pk_bf16_f32 v66, v152, v153
  v_mul_f32 v154, v154, v44
  v_mul_f32 v155, v155, v45
  v_cvt_pk_bf16_f32 v71, v154, v155
  v_lshlrev_b32 v154, 16, v71
  v_and_b32 v155, 0xffff0000, v71
  v_add_f32 v154, v154, v114
  v_add_f32 v155, v155, v115
  v_cvt_pk_bf16_f32 v67, v154, v155
  v_mul_f32 v156, v156, v46
  v_mul_f32 v157, v157, v47
  v_cvt_pk_bf16_f32 v71, v156, v157
  v_lshlrev_b32 v156, 16, v71
  v_and_b32 v157, 0xffff0000, v71
  v_add_f32 v156, v156, v116
  v_add_f32 v157, v157, v117
  v_cvt_pk_bf16_f32 v68, v156, v157
  v_mul_f32 v158, v158, v48
  v_mul_f32 v159, v159, v49
  v_cvt_pk_bf16_f32 v71, v158, v159
  v_lshlrev_b32 v158, 16, v71
  v_and_b32 v159, 0xffff0000, v71
  v_add_f32 v158, v158, v118
  v_add_f32 v159, v159, v119
  v_cvt_pk_bf16_f32 v69, v158, v159
  s_add_u32 s28, s28, 4096
  buffer_store_dwordx4 v[66:69], v7, s[8:11], s28 offen offset:0 sc1
  s_waitcnt vmcnt(0)
  s_barrier
  s_cmp_eq_u32 s91, 0
  s_cbranch_scc0 G3_h0
  s_mov_b64 exec, 1
  v_mov_b32 v252, 192
  v_mov_b32 v251, 1
  buffer_atomic_add v251, v252, s[12:15], 0 offen sc1
  s_mov_b64 exec, -1
G3_h0:
  v_lshlrev_b32 v120, 16, v180
  v_and_b32 v121, 0xffff0000, v180
  v_lshlrev_b32 v122, 16, v181
  v_and_b32 v123, 0xffff0000, v181
  v_lshlrev_b32 v124, 16, v182
  v_and_b32 v125, 0xffff0000, v182
  v_lshlrev_b32 v126, 16, v183
  v_and_b32 v127, 0xffff0000, v183
  v_lshlrev_b32 v128, 16, v184
  v_and_b32 v129, 0xffff0000, v184
  v_lshlrev_b32 v130, 16, v185
  v_and_b32 v131, 0xffff0000, v185
  v_lshlrev_b32 v132, 16, v186
  v_and_b32 v133, 0xffff0000, v186
  v_lshlrev_b32 v134, 16, v187
  v_and_b32 v135, 0xffff0000, v187
  v_lshlrev_b32 v136, 16, v188
  v_and_b32 v137, 0xffff0000, v188
  v_lshlrev_b32 v138, 16, v189
  v_and_b32 v139, 0xffff0000, v189
  v_lshlrev_b32 v140, 16, v190
  v_and_b32 v141, 0xffff0000, v190
  v_lshlrev_b32 v142, 16, v191
  v_and_b32 v143, 0xffff0000, v191
  v_lshlrev_b32 v144, 16, v192
  v_and_b32 v145, 0xffff0000, v192
  v_lshlrev_b32 v146, 16, v193
  v_and_b32 v147, 0xffff0000, v193
  v_lshlrev_b32 v148, 16, v194
  v_and_b32 v149, 0xffff0000, v194
  v_lshlrev_b32 v150, 16, v195
  v_and_b32 v151, 0xffff0000, v195
  v_lshlrev_b32 v152, 16, v196
  v_and_b32 v153, 0xffff0000, v196
  v_lshlrev_b32 v154, 16, v197
  v_and_b32 v155, 0xffff0000, v197
  v_lshlrev_b32 v156, 16, v198
  v_and_b32 v157, 0xffff0000, v198
  v_lshlrev_b32 v158, 16, v199
  v_and_b32 v159, 0xffff0000, v199
  v_add_f32 v70, v120, v121
  v_add_f32 v70, v70, v122
  v_add_f32 v70, v70, v123
  v_add_f32 v70, v70, v124
  v_add_f32 v70, v70, v125
  v_add_f32 v70, v70, v126
  v_add_f32 v70, v70, v127
  v_add_f32 v70, v70, v128
  v_add_f32 v70, v70, v129
  v_add_f32 v70, v70, v130
  v_add_f32 v70, v70, v131
  v_add_f32 v70, v70, v132
  v_add_f32 v70, v70, v133
  v_add_f32 v70, v70, v134
  v_add_f32 v70, v70, v135
  v_add_f32 v70, v70, v136
  v_add_f32 v70, v70, v137
  v_add_f32 v70, v70, v138
  v_add_f32 v70, v70, v139
  v_add_f32 v70, v70, v140
  v_add_f32 v70, v70, v141
  v_add_f32 v70, v70, v142
  v_add_f32 v70, v70, v143
  v_add_f32 v70, v70, v144
  v_add_f32 v70, v70, v145
  v_add_f32 v70, v70, v146
  v_add_f32 v70, v70, v147
  v_add_f32 v70, v70, v148
  v_add_f32 v70, v70, v149
  v_add_f32 v70, v70, v150
  v_add_f32 v70, v70, v151
  v_add_f32 v70, v70, v152
  v_add_f32 v70, v70, v153
  v_add_f32 v70, v70, v154
  v_add_f32 v70, v70, v155
  v_add_f32 v70, v70, v156
  v_add_f32 v70, v70, v157
  v_add_f32 v70, v70, v158
  v_add_f32 v70, v70, v159
  v_mov_b32 v71, v70
  s_nop 1
  v_permlane32_swap_b32 v70, v71
  v_add_f32 v70, v70, v71
  v_mov_b32 v71, v70
  s_nop 1
  v_permlane16_swap_b32 v70, v71
  v_add_f32 v70, v70, v71
  s_lshl_b32 s30, s91, 6
  v_lshlrev_b32 v72, 2, v3
  v_add_u32 v73, s30, v72
  ds_write_b32 v73, v70
  s_waitcnt lgkmcnt(0)
  s_barrier
  ds_read_b32 v74, v72
  ds_read_b32 v75, v72 offset:64
  ds_read_b32 v76, v72 offset:128
  ds_read_b32 v77, v72 offset:192
  s_waitcnt lgkmcnt(0)
  v_add_f32 v74, v74, v75
  v_add_f32 v76, v76, v77
  v_add_f32 v74, v74, v76
  v_mul_f32 v74, 0x3acccccd, v74
  v_sub_f32 v71, v120, v74
  v_mul_f32 v70, v71, v71
  v_sub_f32 v71, v121, v74
  v_fmac_f32 v70, v71, v71
  v_sub_f32 v71, v122, v74
  v_fmac_f32 v70, v71, v71
  v_sub_f32 v71, v123, v74
  v_fmac_f32 v70, v71, v71
  v_sub_f32 v71, v124, v74
  v_fmac_f32 v70, v71, v71
  v_sub_f32 v71, v125, v74
  v_fmac_f32 v70, v71, v71
  v_sub_f32 v71, v126, v74
  v_fmac_f32 v70, v71, v71
  v_sub_f32 v71, v127, v74
  v_fmac_f32 v70, v71, v71
  v_sub_f32 v71, v128, v74
  v_fmac_f32 v70, v71, v71
  v_sub_f32 v71, v129, v74
  v_fmac_f32 v70, v71, v71
  v_sub_f32 v71, v130, v74
  v_fmac_f32 v70, v71, v71
  v_sub_f32 v71, v131, v74
  v_fmac_f32 v70, v71, v71
  v_sub_f32 v71, v132, v74
  v_fmac_f32 v70, v71, v71
  v_sub_f32 v71, v133, v74
  v_fmac_f32 v70, v71, v71
  v_sub_f32 v71, v134, v74
  v_fmac_f32 v70, v71, v71
  v_sub_f32 v71, v135, v74
  v_fmac_f32 v70, v71, v71
  v_sub_f32 v71, v136, v74
  v_fmac_f32 v70, v71, v71
  v_sub_f32 v71, v137, v74
  v_fmac_f32 v70, v71, v71
  v_sub_f32 v71, v138, v74
  v_fmac_f32 v70, v71, v71
  v_sub_f32 v71, v139, v74
  v_fmac_f32 v70, v71, v71
  v_sub_f32 v71, v140, v74
  v_fmac_f32 v70, v71, v71
  v_sub_f32 v71, v141, v74
  v_fmac_f32 v70, v71, v71
  v_sub_f32 v71, v142, v74
  v_fmac_f32 v70, v71, v71
  v_sub_f32 v71, v143, v74
  v_fmac_f32 v70, v71, v71
  v_sub_f32 v71, v144, v74
  v_fmac_f32 v70, v71, v71
  v_sub_f32 v71, v145, v74
  v_fmac_f32 v70, v71, v71
  v_sub_f32 v71, v146, v74
  v_fmac_f32 v70, v71, v71
  v_sub_f32 v71, v147, v74
  v_fmac_f32 v70, v71, v71
  v_sub_f32 v71, v148, v74
  v_fmac_f32 v70, v71, v71
  v_sub_f32 v71, v149, v74
  v_fmac_f32 v70, v71, v71
  v_sub_f32 v71, v150, v74
  v_fmac_f32 v70, v71, v71
  v_sub_f32 v71, v151, v74
  v_fmac_f32 v70, v71, v71
  v_sub_f32 v71, v152, v74
  v_fmac_f32 v70, v71, v71
  v_sub_f32 v71, v153, v74
  v_fmac_f32 v70, v71, v71
  v_sub_f32 v71, v154, v74
  v_fmac_f32 v70, v71, v71
  v_sub_f32 v71, v155, v74
  v_fmac_f32 v70, v71, v71
  v_sub_f32 v71, v156, v74
  v_fmac_f32 v70, v71, v71
  v_sub_f32 v71, v157, v74
  v_fmac_f32 v70, v71, v71
  v_sub_f32 v71, v158, v74
  v_fmac_f32 v70, v71, v71
  v_sub_f32 v71, v159, v74
  v_fmac_f32 v70, v71, v71
  v_mov_b32 v71, v70
  s_nop 1
  v_permlane32_swap_b32 v70, v71
  v_add_f32 v70, v70, v71
  v_mov_b32 v71, v70
  s_nop 1
  v_permlane16_swap_b32 v70, v71
  v_add_f32 v70, v70, v71
  ds_write_b32 v73, v70 offset:256
  s_waitcnt lgkmcnt(0)
  s_barrier
  ds_read_b32 v75, v72 offset:256
  ds_read_b32 v76, v72 offset:320
  ds_read_b32 v77, v72 offset:384
  ds_read_b32 v78, v72 offset:448
  s_waitcnt lgkmcnt(0)
  v_add_f32 v75, v75, v76
  v_add_f32 v77, v77, v78
  v_add_f32 v75, v75, v77
  v_mul_f32 v75, 0x3acccccd, v75
  v_cvt_pk_bf16_f32 v74, v74, v74
  v_lshlrev_b32 v74, 16, v74
  v_cvt_pk_bf16_f32 v75, v75, v75
  v_lshlrev_b32 v75, 16, v75
  v_add_f32 v75, 0x3727c5ac, v75
  v_cvt_pk_bf16_f32 v75, v75, v75
  v_lshlrev_b32 v75, 16, v75
  v_sqrt_f32 v75, v75
  s_nop 0
  v_cvt_pk_bf16_f32 v75, v75, v75
  v_lshlrev_b32 v75, 16, v75
  v_rcp_f32 v76, v75
  v_sub_f32 v120, v120, v74
  v_sub_f32 v121, v121, v74
  v_cvt_pk_bf16_f32 v71, v120, v121
  v_lshlrev_b32 v120, 16, v71
  v_and_b32 v121, 0xffff0000, v71
  v_mul_f32 v77, v120, v76
  v_fma_f32 v78, -v77, v75, v120
  v_fma_f32 v120, v78, v76, v77
  v_mul_f32 v77, v121, v76
  v_fma_f32 v78, -v77, v75, v121
  v_fma_f32 v121, v78, v76, v77
  v_cvt_pk_bf16_f32 v71, v120, v121
  v_lshlrev_b32 v120, 16, v71
  v_and_b32 v121, 0xffff0000, v71
  v_sub_f32 v122, v122, v74
  v_sub_f32 v123, v123, v74
  v_cvt_pk_bf16_f32 v71, v122, v123
  v_lshlrev_b32 v122, 16, v71
  v_and_b32 v123, 0xffff0000, v71
  v_mul_f32 v77, v122, v76
  v_fma_f32 v78, -v77, v75, v122
  v_fma_f32 v122, v78, v76, v77
  v_mul_f32 v77, v123, v76
  v_fma_f32 v78, -v77, v75, v123
  v_fma_f32 v123, v78, v76, v77
  v_cvt_pk_bf16_f32 v71, v122, v123
  v_lshlrev_b32 v122, 16, v71
  v_and_b32 v123, 0xffff0000, v71
  v_sub_f32 v124, v124, v74
  v_sub_f32 v125, v125, v74
  v_cvt_pk_bf16_f32 v71, v124, v125
  v_lshlrev_b32 v124, 16, v71
  v_and_b32 v125, 0xffff0000, v71
  v_mul_f32 v77, v124, v76
  v_fma_f32 v78, -v77, v75, v124
  v_fma_f32 v124, v78, v76, v77
  v_mul_f32 v77, v125, v76
  v_fma_f32 v78, -v77, v75, v125
  v_fma_f32 v125, v78, v76, v77
  v_cvt_pk_bf16_f32 v71, v124, v125
  v_lshlrev_b32 v124, 16, v71
  v_and_b32 v125, 0xffff0000, v71
  v_sub_f32 v126, v126, v74
  v_sub_f32 v127, v127, v74
  v_cvt_pk_bf16_f32 v71, v126, v127
  v_lshlrev_b32 v126, 16, v71
  v_and_b32 v127, 0xffff0000, v71
  v_mul_f32 v77, v126, v76
  v_fma_f32 v78, -v77, v75, v126
  v_fma_f32 v126, v78, v76, v77
  v_mul_f32 v77, v127, v76
  v_fma_f32 v78, -v77, v75, v127
  v_fma_f32 v127, v78, v76, v77
  v_cvt_pk_bf16_f32 v71, v126, v127
  v_lshlrev_b32 v126, 16, v71
  v_and_b32 v127, 0xffff0000, v71
  v_sub_f32 v128, v128, v74
  v_sub_f32 v129, v129, v74
  v_cvt_pk_bf16_f32 v71, v128, v129
  v_lshlrev_b32 v128, 16, v71
  v_and_b32 v129, 0xffff0000, v71
  v_mul_f32 v77, v128, v76
  v_fma_f32 v78, -v77, v75, v128
  v_fma_f32 v128, v78, v76, v77
  v_mul_f32 v77, v129, v76
  v_fma_f32 v78, -v77, v75, v129
  v_fma_f32 v129, v78, v76, v77
  v_cvt_pk_bf16_f32 v71, v128, v129
  v_lshlrev_b32 v128, 16, v71
  v_and_b32 v129, 0xffff0000, v71
  v_sub_f32 v130, v130, v74
  v_sub_f32 v131, v131, v74
  v_cvt_pk_bf16_f32 v71, v130, v131
  v_lshlrev_b32 v130, 16, v71
  v_and_b32 v131, 0xffff0000, v71
  v_mul_f32 v77, v130, v76
  v_fma_f32 v78, -v77, v75, v130
  v_fma_f32 v130, v78, v76, v77
  v_mul_f32 v77, v131, v76
  v_fma_f32 v78, -v77, v75, v131
  v_fma_f32 v131, v78, v76, v77
  v_cvt_pk_bf16_f32 v71, v130, v131
  v_lshlrev_b32 v130, 16, v71
  v_and_b32 v131, 0xffff0000, v71
  v_sub_f32 v132, v132, v74
  v_sub_f32 v133, v133, v74
  v_cvt_pk_bf16_f32 v71, v132, v133
  v_lshlrev_b32 v132, 16, v71
  v_and_b32 v133, 0xffff0000, v71
  v_mul_f32 v77, v132, v76
  v_fma_f32 v78, -v77, v75, v132
  v_fma_f32 v132, v78, v76, v77
  v_mul_f32 v77, v133, v76
  v_fma_f32 v78, -v77, v75, v133
  v_fma_f32 v133, v78, v76, v77
  v_cvt_pk_bf16_f32 v71, v132, v133
  v_lshlrev_b32 v132, 16, v71
  v_and_b32 v133, 0xffff0000, v71
  v_sub_f32 v134, v134, v74
  v_sub_f32 v135, v135, v74
  v_cvt_pk_bf16_f32 v71, v134, v135
  v_lshlrev_b32 v134, 16, v71
  v_and_b32 v135, 0xffff0000, v71
  v_mul_f32 v77, v134, v76
  v_fma_f32 v78, -v77, v75, v134
  v_fma_f32 v134, v78, v76, v77
  v_mul_f32 v77, v135, v76
  v_fma_f32 v78, -v77, v75, v135
  v_fma_f32 v135, v78, v76, v77
  v_cvt_pk_bf16_f32 v71, v134, v135
  v_lshlrev_b32 v134, 16, v71
  v_and_b32 v135, 0xffff0000, v71
  v_sub_f32 v136, v136, v74
  v_sub_f32 v137, v137, v74
  v_cvt_pk_bf16_f32 v71, v136, v137
  v_lshlrev_b32 v136, 16, v71
  v_and_b32 v137, 0xffff0000, v71
  v_mul_f32 v77, v136, v76
  v_fma_f32 v78, -v77, v75, v136
  v_fma_f32 v136, v78, v76, v77
  v_mul_f32 v77, v137, v76
  v_fma_f32 v78, -v77, v75, v137
  v_fma_f32 v137, v78, v76, v77
  v_cvt_pk_bf16_f32 v71, v136, v137
  v_lshlrev_b32 v136, 16, v71
  v_and_b32 v137, 0xffff0000, v71
  v_sub_f32 v138, v138, v74
  v_sub_f32 v139, v139, v74
  v_cvt_pk_bf16_f32 v71, v138, v139
  v_lshlrev_b32 v138, 16, v71
  v_and_b32 v139, 0xffff0000, v71
  v_mul_f32 v77, v138, v76
  v_fma_f32 v78, -v77, v75, v138
  v_fma_f32 v138, v78, v76, v77
  v_mul_f32 v77, v139, v76
  v_fma_f32 v78, -v77, v75, v139
  v_fma_f32 v139, v78, v76, v77
  v_cvt_pk_bf16_f32 v71, v138, v139
  v_lshlrev_b32 v138, 16, v71
  v_and_b32 v139, 0xffff0000, v71
  v_sub_f32 v140, v140, v74
  v_sub_f32 v141, v141, v74
  v_cvt_pk_bf16_f32 v71, v140, v141
  v_lshlrev_b32 v140, 16, v71
  v_and_b32 v141, 0xffff0000, v71
  v_mul_f32 v77, v140, v76
  v_fma_f32 v78, -v77, v75, v140
  v_fma_f32 v140, v78, v76, v77
  v_mul_f32 v77, v141, v76
  v_fma_f32 v78, -v77, v75, v141
  v_fma_f32 v141, v78, v76, v77
  v_cvt_pk_bf16_f32 v71, v140, v141
  v_lshlrev_b32 v140, 16, v71
  v_and_b32 v141, 0xffff0000, v71
  v_sub_f32 v142, v142, v74
  v_sub_f32 v143, v143, v74
  v_cvt_pk_bf16_f32 v71, v142, v143
  v_lshlrev_b32 v142, 16, v71
  v_and_b32 v143, 0xffff0000, v71
  v_mul_f32 v77, v142, v76
  v_fma_f32 v78, -v77, v75, v142
  v_fma_f32 v142, v78, v76, v77
  v_mul_f32 v77, v143, v76
  v_fma_f32 v78, -v77, v75, v143
  v_fma_f32 v143, v78, v76, v77
  v_cvt_pk_bf16_f32 v71, v142, v143
  v_lshlrev_b32 v142, 16, v71
  v_and_b32 v143, 0xffff0000, v71
  v_sub_f32 v144, v144, v74
  v_sub_f32 v145, v145, v74
  v_cvt_pk_bf16_f32 v71, v144, v145
  v_lshlrev_b32 v144, 16, v71
  v_and_b32 v145, 0xffff0000, v71
  v_mul_f32 v77, v144, v76
  v_fma_f32 v78, -v77, v75, v144
  v_fma_f32 v144, v78, v76, v77
  v_mul_f32 v77, v145, v76
  v_fma_f32 v78, -v77, v75, v145
  v_fma_f32 v145, v78, v76, v77
  v_cvt_pk_bf16_f32 v71, v144, v145
  v_lshlrev_b32 v144, 16, v71
  v_and_b32 v145, 0xffff0000, v71
  v_sub_f32 v146, v146, v74
  v_sub_f32 v147, v147, v74
  v_cvt_pk_bf16_f32 v71, v146, v147
  v_lshlrev_b32 v146, 16, v71
  v_and_b32 v147, 0xffff0000, v71
  v_mul_f32 v77, v146, v76
  v_fma_f32 v78, -v77, v75, v146
  v_fma_f32 v146, v78, v76, v77
  v_mul_f32 v77, v147, v76
  v_fma_f32 v78, -v77, v75, v147
  v_fma_f32 v147, v78, v76, v77
  v_cvt_pk_bf16_f32 v71, v146, v147
  v_lshlrev_b32 v146, 16, v71
  v_and_b32 v147, 0xffff0000, v71
  v_sub_f32 v148, v148, v74
  v_sub_f32 v149, v149, v74
  v_cvt_pk_bf16_f32 v71, v148, v149
  v_lshlrev_b32 v148, 16, v71
  v_and_b32 v149, 0xffff0000, v71
  v_mul_f32 v77, v148, v76
  v_fma_f32 v78, -v77, v75, v148
  v_fma_f32 v148, v78, v76, v77
  v_mul_f32 v77, v149, v76
  v_fma_f32 v78, -v77, v75, v149
  v_fma_f32 v149, v78, v76, v77
  v_cvt_pk_bf16_f32 v71, v148, v149
  v_lshlrev_b32 v148, 16, v71
  v_and_b32 v149, 0xffff0000, v71
  v_sub_f32 v150, v150, v74
  v_sub_f32 v151, v151, v74
  v_cvt_pk_bf16_f32 v71, v150, v151
  v_lshlrev_b32 v150, 16, v71
  v_and_b32 v151, 0xffff0000, v71
  v_mul_f32 v77, v150, v76
  v_fma_f32 v78, -v77, v75, v150
  v_fma_f32 v150, v78, v76, v77
  v_mul_f32 v77, v151, v76
  v_fma_f32 v78, -v77, v75, v151
  v_fma_f32 v151, v78, v76, v77
  v_cvt_pk_bf16_f32 v71, v150, v151
  v_lshlrev_b32 v150, 16, v71
  v_and_b32 v151, 0xffff0000, v71
  v_sub_f32 v152, v152, v74
  v_sub_f32 v153, v153, v74
  v_cvt_pk_bf16_f32 v71, v152, v153
  v_lshlrev_b32 v152, 16, v71
  v_and_b32 v153, 0xffff0000, v71
  v_mul_f32 v77, v152, v76
  v_fma_f32 v78, -v77, v75, v152
  v_fma_f32 v152, v78, v76, v77
  v_mul_f32 v77, v153, v76
  v_fma_f32 v78, -v77, v75, v153
  v_fma_f32 v153, v78, v76, v77
  v_cvt_pk_bf16_f32 v71, v152, v153
  v_lshlrev_b32 v152, 16, v71
  v_and_b32 v153, 0xffff0000, v71
  v_sub_f32 v154, v154, v74
  v_sub_f32 v155, v155, v74
  v_cvt_pk_bf16_f32 v71, v154, v155
  v_lshlrev_b32 v154, 16, v71
  v_and_b32 v155, 0xffff0000, v71
  v_mul_f32 v77, v154, v76
  v_fma_f32 v78, -v77, v75, v154
  v_fma_f32 v154, v78, v76, v77
  v_mul_f32 v77, v155, v76
  v_fma_f32 v78, -v77, v75, v155
  v_fma_f32 v155, v78, v76, v77
  v_cvt_pk_bf16_f32 v71, v154, v155
  v_lshlrev_b32 v154, 16, v71
  v_and_b32 v155, 0xffff0000, v71
  v_sub_f32 v156, v156, v74
  v_sub_f32 v157, v157, v74
  v_cvt_pk_bf16_f32 v71, v156, v157
  v_lshlrev_b32 v156, 16, v71
  v_and_b32 v157, 0xffff0000, v71
  v_mul_f32 v77, v156, v76
  v_fma_f32 v78, -v77, v75, v156
  v_fma_f32 v156, v78, v76, v77
  v_mul_f32 v77, v157, v76
  v_fma_f32 v78, -v77, v75, v157
  v_fma_f32 v157, v78, v76, v77
  v_cvt_pk_bf16_f32 v71, v156, v157
  v_lshlrev_b32 v156, 16, v71
  v_and_b32 v157, 0xffff0000, v71
  v_sub_f32 v158, v158, v74
  v_sub_f32 v159, v159, v74
  v_cvt_pk_bf16_f32 v71, v158, v159
  v_lshlrev_b32 v158, 16, v71
  v_and_b32 v159, 0xffff0000, v71
  v_mul_f32 v77, v158, v76
  v_fma_f32 v78, -v77, v75, v158
  v_fma_f32 v158, v78, v76, v77
  v_mul_f32 v77, v159, v76
  v_fma_f32 v78, -v77, v75, v159
  v_fma_f32 v159, v78, v76, v77
  v_cvt_pk_bf16_f32 v71, v158, v159
  v_lshlrev_b32 v158, 16, v71
  v_and_b32 v159, 0xffff0000, v71
  s_add_u32 s28, s5, 32
  s_mul_i32 s28, s28, 20480
  s_mul_i32 s29, s91, 5120
  s_add_u32 s28, s28, s29
  s_add_u32 s28, s28, 19922944
  v_mul_f32 v120, v120, v10
  v_mul_f32 v121, v121, v11
  v_cvt_pk_bf16_f32 v71, v120, v121
  v_lshlrev_b32 v120, 16, v71
  v_and_b32 v121, 0xffff0000, v71
  v_add_f32 v120, v120, v80
  v_add_f32 v121, v121, v81
  v_cvt_pk_bf16_f32 v50, v120, v121
  v_mul_f32 v122, v122, v12
  v_mul_f32 v123, v123, v13
  v_cvt_pk_bf16_f32 v71, v122, v123
  v_lshlrev_b32 v122, 16, v71
  v_and_b32 v123, 0xffff0000, v71
  v_add_f32 v122, v122, v82
  v_add_f32 v123, v123, v83
  v_cvt_pk_bf16_f32 v51, v122, v123
  v_mul_f32 v124, v124, v14
  v_mul_f32 v125, v125, v15
  v_cvt_pk_bf16_f32 v71, v124, v125
  v_lshlrev_b32 v124, 16, v71
  v_and_b32 v125, 0xffff0000, v71
  v_add_f32 v124, v124, v84
  v_add_f32 v125, v125, v85
  v_cvt_pk_bf16_f32 v52, v124, v125
  v_mul_f32 v126, v126, v16
  v_mul_f32 v127, v127, v17
  v_cvt_pk_bf16_f32 v71, v126, v127
  v_lshlrev_b32 v126, 16, v71
  v_and_b32 v127, 0xffff0000, v71
  v_add_f32 v126, v126, v86
  v_add_f32 v127, v127, v87
  v_cvt_pk_bf16_f32 v53, v126, v127
  buffer_store_dwordx4 v[50:53], v7, s[8:11], s28 offen offset:0 sc1
  v_mul_f32 v128, v128, v18
  v_mul_f32 v129, v129, v19
  v_cvt_pk_bf16_f32 v71, v128, v129
  v_lshlrev_b32 v128, 16, v71
  v_and_b32 v129, 0xffff0000, v71
  v_add_f32 v128, v128, v88
  v_add_f32 v129, v129, v89
  v_cvt_pk_bf16_f32 v54, v128, v129
  v_mul_f32 v130, v130, v20
  v_mul_f32 v131, v131, v21
  v_cvt_pk_bf16_f32 v71, v130, v131
  v_lshlrev_b32 v130, 16, v71
  v_and_b32 v131, 0xffff0000, v71
  v_add_f32 v130, v130, v90
  v_add_f32 v131, v131, v91
  v_cvt_pk_bf16_f32 v55, v130, v131
  v_mul_f32 v132, v132, v22
  v_mul_f32 v133, v133, v23
  v_cvt_pk_bf16_f32 v71, v132, v133
  v_lshlrev_b32 v132, 16, v71
  v_and_b32 v133, 0xffff0000, v71
  v_add_f32 v132, v132, v92
  v_add_f32 v133, v133, v93
  v_cvt_pk_bf16_f32 v56, v132, v133
  v_mul_f32 v134, v134, v24
  v_mul_f32 v135, v135, v25
  v_cvt_pk_bf16_f32 v71, v134, v135
  v_lshlrev_b32 v134, 16, v71
  v_and_b32 v135, 0xffff0000, v71
  v_add_f32 v134, v134, v94
  v_add_f32 v135, v135, v95
  v_cvt_pk_bf16_f32 v57, v134, v135
  buffer_store_dwordx4 v[54:57], v7, s[8:11], s28 offen offset:1024 sc1
  v_mul_f32 v136, v136, v26
  v_mul_f32 v137, v137, v27
  v_cvt_pk_bf16_f32 v71, v136, v137
  v_lshlrev_b32 v136, 16, v71
  v_and_b32 v137, 0xffff0000, v71
  v_add_f32 v136, v136, v96
  v_add_f32 v137, v137, v97
  v_cvt_pk_bf16_f32 v58, v136, v137
  v_mul_f32 v138, v138, v28
  v_mul_f32 v139, v139, v29
  v_cvt_pk_bf16_f32 v71, v138, v139
  v_lshlrev_b32 v138, 16, v71
  v_and_b32 v139, 0xffff0000, v71
  v_add_f32 v138, v138, v98
  v_add_f32 v139, v139, v99
  v_cvt_pk_bf16_f32 v59, v138, v139
  v_mul_f32 v140, v140, v30
  v_mul_f32 v141, v141, v31
  v_cvt_pk_bf16_f32 v71, v140, v141
  v_lshlrev_b32 v140, 16, v71
  v_and_b32 v141, 0xffff0000, v71
  v_add_f32 v140, v140, v100
  v_add_f32 v141, v141, v101
  v_cvt_pk_bf16_f32 v60, v140, v141
  v_mul_f32 v142, v142, v32
  v_mul_f32 v143, v143, v33
  v_cvt_pk_bf16_f32 v71, v142, v143
  v_lshlrev_b32 v142, 16, v71
  v_and_b32 v143, 0xffff0000, v71
  v_add_f32 v142, v142, v102
  v_add_f32 v143, v143, v103
  v_cvt_pk_bf16_f32 v61, v142, v143
  buffer_store_dwordx4 v[58:61], v7, s[8:11], s28 offen offset:2048 sc1
  v_mul_f32 v144, v144, v34
  v_mul_f32 v145, v145, v35
  v_cvt_pk_bf16_f32 v71, v144, v145
  v_lshlrev_b32 v144, 16, v71
  v_and_b32 v145, 0xffff0000, v71
  v_add_f32 v144, v144, v104
  v_add_f32 v145, v145, v105
  v_cvt_pk_bf16_f32 v62, v144, v145
  v_mul_f32 v146, v146, v36
  v_mul_f32 v147, v147, v37
  v_cvt_pk_bf16_f32 v71, v146, v147
  v_lshlrev_b32 v146, 16, v71
  v_and_b32 v147, 0xffff0000, v71
  v_add_f32 v146, v146, v106
  v_add_f32 v147, v147, v107
  v_cvt_pk_bf16_f32 v63, v146, v147
  v_mul_f32 v148, v148, v38
  v_mul_f32 v149, v149, v39
  v_cvt_pk_bf16_f32 v71, v148, v149
  v_lshlrev_b32 v148, 16, v71
  v_and_b32 v149, 0xffff0000, v71
  v_add_f32 v148, v148, v108
  v_add_f32 v149, v149, v109
  v_cvt_pk_bf16_f32 v64, v148, v149
  v_mul_f32 v150, v150, v40
  v_mul_f32 v151, v151, v41
  v_cvt_pk_bf16_f32 v71, v150, v151
  v_lshlrev_b32 v150, 16, v71
  v_and_b32 v151, 0xffff0000, v71
  v_add_f32 v150, v150, v110
  v_add_f32 v151, v151, v111
  v_cvt_pk_bf16_f32 v65, v150, v151
  buffer_store_dwordx4 v[62:65], v7, s[8:11], s28 offen offset:3072 sc1
  v_mul_f32 v152, v152, v42
  v_mul_f32 v153, v153, v43
  v_cvt_pk_bf16_f32 v71, v152, v153
  v_lshlrev_b32 v152, 16, v71
  v_and_b32 v153, 0xffff0000, v71
  v_add_f32 v152, v152, v112
  v_add_f32 v153, v153, v113
  v_cvt_pk_bf16_f32 v66, v152, v153
  v_mul_f32 v154, v154, v44
  v_mul_f32 v155, v155, v45
  v_cvt_pk_bf16_f32 v71, v154, v155
  v_lshlrev_b32 v154, 16, v71
  v_and_b32 v155, 0xffff0000, v71
  v_add_f32 v154, v154, v114
  v_add_f32 v155, v155, v115
  v_cvt_pk_bf16_f32 v67, v154, v155
  v_mul_f32 v156, v156, v46
  v_mul_f32 v157, v157, v47
  v_cvt_pk_bf16_f32 v71, v156, v157
  v_lshlrev_b32 v156, 16, v71
  v_and_b32 v157, 0xffff0000, v71
  v_add_f32 v156, v156, v116
  v_add_f32 v157, v157, v117
  v_cvt_pk_bf16_f32 v68, v156, v157
  v_mul_f32 v158, v158, v48
  v_mul_f32 v159, v159, v49
  v_cvt_pk_bf16_f32 v71, v158, v159
  v_lshlrev_b32 v158, 16, v71
  v_and_b32 v159, 0xffff0000, v71
  v_add_f32 v158, v158, v118
  v_add_f32 v159, v159, v119
  v_cvt_pk_bf16_f32 v69, v158, v159
  s_add_u32 s28, s28, 4096
  buffer_store_dwordx4 v[66:69], v7, s[8:11], s28 offen offset:0 sc1
  s_waitcnt vmcnt(0)
  s_barrier
  s_cmp_eq_u32 s91, 0
  s_cbranch_scc0 G3_h1
  s_mov_b64 exec, 1
  v_mov_b32 v252, 196
  v_mov_b32 v251, 1
  buffer_atomic_add v251, v252, s[12:15], 0 offen sc1
  s_mov_b64 exec, -1
G3_h1:
  v_lshlrev_b32 v120, 16, v200
  v_and_b32 v121, 0xffff0000, v200
  v_lshlrev_b32 v122, 16, v201
  v_and_b32 v123, 0xffff0000, v201
  v_lshlrev_b32 v124, 16, v202
  v_and_b32 v125, 0xffff0000, v202
  v_lshlrev_b32 v126, 16, v203
  v_and_b32 v127, 0xffff0000, v203
  v_lshlrev_b32 v128, 16, v204
  v_and_b32 v129, 0xffff0000, v204
  v_lshlrev_b32 v130, 16, v205
  v_and_b32 v131, 0xffff0000, v205
  v_lshlrev_b32 v132, 16, v206
  v_and_b32 v133, 0xffff0000, v206
  v_lshlrev_b32 v134, 16, v207
  v_and_b32 v135, 0xffff0000, v207
  v_lshlrev_b32 v136, 16, v208
  v_and_b32 v137, 0xffff0000, v208
  v_lshlrev_b32 v138, 16, v209
  v_and_b32 v139, 0xffff0000, v209
  v_lshlrev_b32 v140, 16, v210
  v_and_b32 v141, 0xffff0000, v210
  v_lshlrev_b32 v142, 16, v211
  v_and_b32 v143, 0xffff0000, v211
  v_lshlrev_b32 v144, 16, v212
  v_and_b32 v145, 0xffff0000, v212
  v_lshlrev_b32 v146, 16, v213
  v_and_b32 v147, 0xffff0000, v213
  v_lshlrev_b32 v148, 16, v214
  v_and_b32 v149, 0xffff0000, v214
  v_lshlrev_b32 v150, 16, v215
  v_and_b32 v151, 0xffff0000, v215
  v_lshlrev_b32 v152, 16, v216
  v_and_b32 v153, 0xffff0000, v216
  v_lshlrev_b32 v154, 16, v217
  v_and_b32 v155, 0xffff0000, v217
  v_lshlrev_b32 v156, 16, v218
  v_and_b32 v157, 0xffff0000, v218
  v_lshlrev_b32 v158, 16, v219
  v_and_b32 v159, 0xffff0000, v219
  v_add_f32 v70, v120, v121
  v_add_f32 v70, v70, v122
  v_add_f32 v70, v70, v123
  v_add_f32 v70, v70, v124
  v_add_f32 v70, v70, v125
  v_add_f32 v70, v70, v126
  v_add_f32 v70, v70, v127
  v_add_f32 v70, v70, v128
  v_add_f32 v70, v70, v129
  v_add_f32 v70, v70, v130
  v_add_f32 v70, v70, v131
  v_add_f32 v70, v70, v132
  v_add_f32 v70, v70, v133
  v_add_f32 v70, v70, v134
  v_add_f32 v70, v70, v135
  v_add_f32 v70, v70, v136
  v_add_f32 v70, v70, v137
  v_add_f32 v70, v70, v138
  v_add_f32 v70, v70, v139
  v_add_f32 v70, v70, v140
  v_add_f32 v70, v70, v141
  v_add_f32 v70, v70, v142
  v_add_f32 v70, v70, v143
  v_add_f32 v70, v70, v144
  v_add_f32 v70, v70, v145
  v_add_f32 v70, v70, v146
  v_add_f32 v70, v70, v147
  v_add_f32 v70, v70, v148
  v_add_f32 v70, v70, v149
  v_add_f32 v70, v70, v150
  v_add_f32 v70, v70, v151
  v_add_f32 v70, v70, v152
  v_add_f32 v70, v70, v153
  v_add_f32 v70, v70, v154
  v_add_f32 v70, v70, v155
  v_add_f32 v70, v70, v156
  v_add_f32 v70, v70, v157
  v_add_f32 v70, v70, v158
  v_add_f32 v70, v70, v159
  v_mov_b32 v71, v70
  s_nop 1
  v_permlane32_swap_b32 v70, v71
  v_add_f32 v70, v70, v71
  v_mov_b32 v71, v70
  s_nop 1
  v_permlane16_swap_b32 v70, v71
  v_add_f32 v70, v70, v71
  s_lshl_b32 s30, s91, 6
  v_lshlrev_b32 v72, 2, v3
  v_add_u32 v73, s30, v72
  ds_write_b32 v73, v70
  s_waitcnt lgkmcnt(0)
  s_barrier
  ds_read_b32 v74, v72
  ds_read_b32 v75, v72 offset:64
  ds_read_b32 v76, v72 offset:128
  ds_read_b32 v77, v72 offset:192
  s_waitcnt lgkmcnt(0)
  v_add_f32 v74, v74, v75
  v_add_f32 v76, v76, v77
  v_add_f32 v74, v74, v76
  v_mul_f32 v74, 0x3acccccd, v74
  v_sub_f32 v71, v120, v74
  v_mul_f32 v70, v71, v71
  v_sub_f32 v71, v121, v74
  v_fmac_f32 v70, v71, v71
  v_sub_f32 v71, v122, v74
  v_fmac_f32 v70, v71, v71
  v_sub_f32 v71, v123, v74
  v_fmac_f32 v70, v71, v71
  v_sub_f32 v71, v124, v74
  v_fmac_f32 v70, v71, v71
  v_sub_f32 v71, v125, v74
  v_fmac_f32 v70, v71, v71
  v_sub_f32 v71, v126, v74
  v_fmac_f32 v70, v71, v71
  v_sub_f32 v71, v127, v74
  v_fmac_f32 v70, v71, v71
  v_sub_f32 v71, v128, v74
  v_fmac_f32 v70, v71, v71
  v_sub_f32 v71, v129, v74
  v_fmac_f32 v70, v71, v71
  v_sub_f32 v71, v130, v74
  v_fmac_f32 v70, v71, v71
  v_sub_f32 v71, v131, v74
  v_fmac_f32 v70, v71, v71
  v_sub_f32 v71, v132, v74
  v_fmac_f32 v70, v71, v71
  v_sub_f32 v71, v133, v74
  v_fmac_f32 v70, v71, v71
  v_sub_f32 v71, v134, v74
  v_fmac_f32 v70, v71, v71
  v_sub_f32 v71, v135, v74
  v_fmac_f32 v70, v71, v71
  v_sub_f32 v71, v136, v74
  v_fmac_f32 v70, v71, v71
  v_sub_f32 v71, v137, v74
  v_fmac_f32 v70, v71, v71
  v_sub_f32 v71, v138, v74
  v_fmac_f32 v70, v71, v71
  v_sub_f32 v71, v139, v74
  v_fmac_f32 v70, v71, v71
  v_sub_f32 v71, v140, v74
  v_fmac_f32 v70, v71, v71
  v_sub_f32 v71, v141, v74
  v_fmac_f32 v70, v71, v71
  v_sub_f32 v71, v142, v74
  v_fmac_f32 v70, v71, v71
  v_sub_f32 v71, v143, v74
  v_fmac_f32 v70, v71, v71
  v_sub_f32 v71, v144, v74
  v_fmac_f32 v70, v71, v71
  v_sub_f32 v71, v145, v74
  v_fmac_f32 v70, v71, v71
  v_sub_f32 v71, v146, v74
  v_fmac_f32 v70, v71, v71
  v_sub_f32 v71, v147, v74
  v_fmac_f32 v70, v71, v71
  v_sub_f32 v71, v148, v74
  v_fmac_f32 v70, v71, v71
  v_sub_f32 v71, v149, v74
  v_fmac_f32 v70, v71, v71
  v_sub_f32 v71, v150, v74
  v_fmac_f32 v70, v71, v71
  v_sub_f32 v71, v151, v74
  v_fmac_f32 v70, v71, v71
  v_sub_f32 v71, v152, v74
  v_fmac_f32 v70, v71, v71
  v_sub_f32 v71, v153, v74
  v_fmac_f32 v70, v71, v71
  v_sub_f32 v71, v154, v74
  v_fmac_f32 v70, v71, v71
  v_sub_f32 v71, v155, v74
  v_fmac_f32 v70, v71, v71
  v_sub_f32 v71, v156, v74
  v_fmac_f32 v70, v71, v71
  v_sub_f32 v71, v157, v74
  v_fmac_f32 v70, v71, v71
  v_sub_f32 v71, v158, v74
  v_fmac_f32 v70, v71, v71
  v_sub_f32 v71, v159, v74
  v_fmac_f32 v70, v71, v71
  v_mov_b32 v71, v70
  s_nop 1
  v_permlane32_swap_b32 v70, v71
  v_add_f32 v70, v70, v71
  v_mov_b32 v71, v70
  s_nop 1
  v_permlane16_swap_b32 v70, v71
  v_add_f32 v70, v70, v71
  ds_write_b32 v73, v70 offset:256
  s_waitcnt lgkmcnt(0)
  s_barrier
  ds_read_b32 v75, v72 offset:256
  ds_read_b32 v76, v72 offset:320
  ds_read_b32 v77, v72 offset:384
  ds_read_b32 v78, v72 offset:448
  s_waitcnt lgkmcnt(0)
  v_add_f32 v75, v75, v76
  v_add_f32 v77, v77, v78
  v_add_f32 v75, v75, v77
  v_mul_f32 v75, 0x3acccccd, v75
  v_cvt_pk_bf16_f32 v74, v74, v74
  v_lshlrev_b32 v74, 16, v74
  v_cvt_pk_bf16_f32 v75, v75, v75
  v_lshlrev_b32 v75, 16, v75
  v_add_f32 v75, 0x3727c5ac, v75
  v_cvt_pk_bf16_f32 v75, v75, v75
  v_lshlrev_b32 v75, 16, v75
  v_sqrt_f32 v75, v75
  s_nop 0
  v_cvt_pk_bf16_f32 v75, v75, v75
  v_lshlrev_b32 v75, 16, v75
  v_rcp_f32 v76, v75
  v_sub_f32 v120, v120, v74
  v_sub_f32 v121, v121, v74
  v_cvt_pk_bf16_f32 v71, v120, v121
  v_lshlrev_b32 v120, 16, v71
  v_and_b32 v121, 0xffff0000, v71
  v_mul_f32 v77, v120, v76
  v_fma_f32 v78, -v77, v75, v120
  v_fma_f32 v120, v78, v76, v77
  v_mul_f32 v77, v121, v76
  v_fma_f32 v78, -v77, v75, v121
  v_fma_f32 v121, v78, v76, v77
  v_cvt_pk_bf16_f32 v71, v120, v121
  v_lshlrev_b32 v120, 16, v71
  v_and_b32 v121, 0xffff0000, v71
  v_sub_f32 v122, v122, v74
  v_sub_f32 v123, v123, v74
  v_cvt_pk_bf16_f32 v71, v122, v123
  v_lshlrev_b32 v122, 16, v71
  v_and_b32 v123, 0xffff0000, v71
  v_mul_f32 v77, v122, v76
  v_fma_f32 v78, -v77, v75, v122
  v_fma_f32 v122, v78, v76, v77
  v_mul_f32 v77, v123, v76
  v_fma_f32 v78, -v77, v75, v123
  v_fma_f32 v123, v78, v76, v77
  v_cvt_pk_bf16_f32 v71, v122, v123
  v_lshlrev_b32 v122, 16, v71
  v_and_b32 v123, 0xffff0000, v71
  v_sub_f32 v124, v124, v74
  v_sub_f32 v125, v125, v74
  v_cvt_pk_bf16_f32 v71, v124, v125
  v_lshlrev_b32 v124, 16, v71
  v_and_b32 v125, 0xffff0000, v71
  v_mul_f32 v77, v124, v76
  v_fma_f32 v78, -v77, v75, v124
  v_fma_f32 v124, v78, v76, v77
  v_mul_f32 v77, v125, v76
  v_fma_f32 v78, -v77, v75, v125
  v_fma_f32 v125, v78, v76, v77
  v_cvt_pk_bf16_f32 v71, v124, v125
  v_lshlrev_b32 v124, 16, v71
  v_and_b32 v125, 0xffff0000, v71
  v_sub_f32 v126, v126, v74
  v_sub_f32 v127, v127, v74
  v_cvt_pk_bf16_f32 v71, v126, v127
  v_lshlrev_b32 v126, 16, v71
  v_and_b32 v127, 0xffff0000, v71
  v_mul_f32 v77, v126, v76
  v_fma_f32 v78, -v77, v75, v126
  v_fma_f32 v126, v78, v76, v77
  v_mul_f32 v77, v127, v76
  v_fma_f32 v78, -v77, v75, v127
  v_fma_f32 v127, v78, v76, v77
  v_cvt_pk_bf16_f32 v71, v126, v127
  v_lshlrev_b32 v126, 16, v71
  v_and_b32 v127, 0xffff0000, v71
  v_sub_f32 v128, v128, v74
  v_sub_f32 v129, v129, v74
  v_cvt_pk_bf16_f32 v71, v128, v129
  v_lshlrev_b32 v128, 16, v71
  v_and_b32 v129, 0xffff0000, v71
  v_mul_f32 v77, v128, v76
  v_fma_f32 v78, -v77, v75, v128
  v_fma_f32 v128, v78, v76, v77
  v_mul_f32 v77, v129, v76
  v_fma_f32 v78, -v77, v75, v129
  v_fma_f32 v129, v78, v76, v77
  v_cvt_pk_bf16_f32 v71, v128, v129
  v_lshlrev_b32 v128, 16, v71
  v_and_b32 v129, 0xffff0000, v71
  v_sub_f32 v130, v130, v74
  v_sub_f32 v131, v131, v74
  v_cvt_pk_bf16_f32 v71, v130, v131
  v_lshlrev_b32 v130, 16, v71
  v_and_b32 v131, 0xffff0000, v71
  v_mul_f32 v77, v130, v76
  v_fma_f32 v78, -v77, v75, v130
  v_fma_f32 v130, v78, v76, v77
  v_mul_f32 v77, v131, v76
  v_fma_f32 v78, -v77, v75, v131
  v_fma_f32 v131, v78, v76, v77
  v_cvt_pk_bf16_f32 v71, v130, v131
  v_lshlrev_b32 v130, 16, v71
  v_and_b32 v131, 0xffff0000, v71
  v_sub_f32 v132, v132, v74
  v_sub_f32 v133, v133, v74
  v_cvt_pk_bf16_f32 v71, v132, v133
  v_lshlrev_b32 v132, 16, v71
  v_and_b32 v133, 0xffff0000, v71
  v_mul_f32 v77, v132, v76
  v_fma_f32 v78, -v77, v75, v132
  v_fma_f32 v132, v78, v76, v77
  v_mul_f32 v77, v133, v76
  v_fma_f32 v78, -v77, v75, v133
  v_fma_f32 v133, v78, v76, v77
  v_cvt_pk_bf16_f32 v71, v132, v133
  v_lshlrev_b32 v132, 16, v71
  v_and_b32 v133, 0xffff0000, v71
  v_sub_f32 v134, v134, v74
  v_sub_f32 v135, v135, v74
  v_cvt_pk_bf16_f32 v71, v134, v135
  v_lshlrev_b32 v134, 16, v71
  v_and_b32 v135, 0xffff0000, v71
  v_mul_f32 v77, v134, v76
  v_fma_f32 v78, -v77, v75, v134
  v_fma_f32 v134, v78, v76, v77
  v_mul_f32 v77, v135, v76
  v_fma_f32 v78, -v77, v75, v135
  v_fma_f32 v135, v78, v76, v77
  v_cvt_pk_bf16_f32 v71, v134, v135
  v_lshlrev_b32 v134, 16, v71
  v_and_b32 v135, 0xffff0000, v71
  v_sub_f32 v136, v136, v74
  v_sub_f32 v137, v137, v74
  v_cvt_pk_bf16_f32 v71, v136, v137
  v_lshlrev_b32 v136, 16, v71
  v_and_b32 v137, 0xffff0000, v71
  v_mul_f32 v77, v136, v76
  v_fma_f32 v78, -v77, v75, v136
  v_fma_f32 v136, v78, v76, v77
  v_mul_f32 v77, v137, v76
  v_fma_f32 v78, -v77, v75, v137
  v_fma_f32 v137, v78, v76, v77
  v_cvt_pk_bf16_f32 v71, v136, v137
  v_lshlrev_b32 v136, 16, v71
  v_and_b32 v137, 0xffff0000, v71
  v_sub_f32 v138, v138, v74
  v_sub_f32 v139, v139, v74
  v_cvt_pk_bf16_f32 v71, v138, v139
  v_lshlrev_b32 v138, 16, v71
  v_and_b32 v139, 0xffff0000, v71
  v_mul_f32 v77, v138, v76
  v_fma_f32 v78, -v77, v75, v138
  v_fma_f32 v138, v78, v76, v77
  v_mul_f32 v77, v139, v76
  v_fma_f32 v78, -v77, v75, v139
  v_fma_f32 v139, v78, v76, v77
  v_cvt_pk_bf16_f32 v71, v138, v139
  v_lshlrev_b32 v138, 16, v71
  v_and_b32 v139, 0xffff0000, v71
  v_sub_f32 v140, v140, v74
  v_sub_f32 v141, v141, v74
  v_cvt_pk_bf16_f32 v71, v140, v141
  v_lshlrev_b32 v140, 16, v71
  v_and_b32 v141, 0xffff0000, v71
  v_mul_f32 v77, v140, v76
  v_fma_f32 v78, -v77, v75, v140
  v_fma_f32 v140, v78, v76, v77
  v_mul_f32 v77, v141, v76
  v_fma_f32 v78, -v77, v75, v141
  v_fma_f32 v141, v78, v76, v77
  v_cvt_pk_bf16_f32 v71, v140, v141
  v_lshlrev_b32 v140, 16, v71
  v_and_b32 v141, 0xffff0000, v71
  v_sub_f32 v142, v142, v74
  v_sub_f32 v143, v143, v74
  v_cvt_pk_bf16_f32 v71, v142, v143
  v_lshlrev_b32 v142, 16, v71
  v_and_b32 v143, 0xffff0000, v71
  v_mul_f32 v77, v142, v76
  v_fma_f32 v78, -v77, v75, v142
  v_fma_f32 v142, v78, v76, v77
  v_mul_f32 v77, v143, v76
  v_fma_f32 v78, -v77, v75, v143
  v_fma_f32 v143, v78, v76, v77
  v_cvt_pk_bf16_f32 v71, v142, v143
  v_lshlrev_b32 v142, 16, v71
  v_and_b32 v143, 0xffff0000, v71
  v_sub_f32 v144, v144, v74
  v_sub_f32 v145, v145, v74
  v_cvt_pk_bf16_f32 v71, v144, v145
  v_lshlrev_b32 v144, 16, v71
  v_and_b32 v145, 0xffff0000, v71
  v_mul_f32 v77, v144, v76
  v_fma_f32 v78, -v77, v75, v144
  v_fma_f32 v144, v78, v76, v77
  v_mul_f32 v77, v145, v76
  v_fma_f32 v78, -v77, v75, v145
  v_fma_f32 v145, v78, v76, v77
  v_cvt_pk_bf16_f32 v71, v144, v145
  v_lshlrev_b32 v144, 16, v71
  v_and_b32 v145, 0xffff0000, v71
  v_sub_f32 v146, v146, v74
  v_sub_f32 v147, v147, v74
  v_cvt_pk_bf16_f32 v71, v146, v147
  v_lshlrev_b32 v146, 16, v71
  v_and_b32 v147, 0xffff0000, v71
  v_mul_f32 v77, v146, v76
  v_fma_f32 v78, -v77, v75, v146
  v_fma_f32 v146, v78, v76, v77
  v_mul_f32 v77, v147, v76
  v_fma_f32 v78, -v77, v75, v147
  v_fma_f32 v147, v78, v76, v77
  v_cvt_pk_bf16_f32 v71, v146, v147
  v_lshlrev_b32 v146, 16, v71
  v_and_b32 v147, 0xffff0000, v71
  v_sub_f32 v148, v148, v74
  v_sub_f32 v149, v149, v74
  v_cvt_pk_bf16_f32 v71, v148, v149
  v_lshlrev_b32 v148, 16, v71
  v_and_b32 v149, 0xffff0000, v71
  v_mul_f32 v77, v148, v76
  v_fma_f32 v78, -v77, v75, v148
  v_fma_f32 v148, v78, v76, v77
  v_mul_f32 v77, v149, v76
  v_fma_f32 v78, -v77, v75, v149
  v_fma_f32 v149, v78, v76, v77
  v_cvt_pk_bf16_f32 v71, v148, v149
  v_lshlrev_b32 v148, 16, v71
  v_and_b32 v149, 0xffff0000, v71
  v_sub_f32 v150, v150, v74
  v_sub_f32 v151, v151, v74
  v_cvt_pk_bf16_f32 v71, v150, v151
  v_lshlrev_b32 v150, 16, v71
  v_and_b32 v151, 0xffff0000, v71
  v_mul_f32 v77, v150, v76
  v_fma_f32 v78, -v77, v75, v150
  v_fma_f32 v150, v78, v76, v77
  v_mul_f32 v77, v151, v76
  v_fma_f32 v78, -v77, v75, v151
  v_fma_f32 v151, v78, v76, v77
  v_cvt_pk_bf16_f32 v71, v150, v151
  v_lshlrev_b32 v150, 16, v71
  v_and_b32 v151, 0xffff0000, v71
  v_sub_f32 v152, v152, v74
  v_sub_f32 v153, v153, v74
  v_cvt_pk_bf16_f32 v71, v152, v153
  v_lshlrev_b32 v152, 16, v71
  v_and_b32 v153, 0xffff0000, v71
  v_mul_f32 v77, v152, v76
  v_fma_f32 v78, -v77, v75, v152
  v_fma_f32 v152, v78, v76, v77
  v_mul_f32 v77, v153, v76
  v_fma_f32 v78, -v77, v75, v153
  v_fma_f32 v153, v78, v76, v77
  v_cvt_pk_bf16_f32 v71, v152, v153
  v_lshlrev_b32 v152, 16, v71
  v_and_b32 v153, 0xffff0000, v71
  v_sub_f32 v154, v154, v74
  v_sub_f32 v155, v155, v74
  v_cvt_pk_bf16_f32 v71, v154, v155
  v_lshlrev_b32 v154, 16, v71
  v_and_b32 v155, 0xffff0000, v71
  v_mul_f32 v77, v154, v76
  v_fma_f32 v78, -v77, v75, v154
  v_fma_f32 v154, v78, v76, v77
  v_mul_f32 v77, v155, v76
  v_fma_f32 v78, -v77, v75, v155
  v_fma_f32 v155, v78, v76, v77
  v_cvt_pk_bf16_f32 v71, v154, v155
  v_lshlrev_b32 v154, 16, v71
  v_and_b32 v155, 0xffff0000, v71
  v_sub_f32 v156, v156, v74
  v_sub_f32 v157, v157, v74
  v_cvt_pk_bf16_f32 v71, v156, v157
  v_lshlrev_b32 v156, 16, v71
  v_and_b32 v157, 0xffff0000, v71
  v_mul_f32 v77, v156, v76
  v_fma_f32 v78, -v77, v75, v156
  v_fma_f32 v156, v78, v76, v77
  v_mul_f32 v77, v157, v76
  v_fma_f32 v78, -v77, v75, v157
  v_fma_f32 v157, v78, v76, v77
  v_cvt_pk_bf16_f32 v71, v156, v157
  v_lshlrev_b32 v156, 16, v71
  v_and_b32 v157, 0xffff0000, v71
  v_sub_f32 v158, v158, v74
  v_sub_f32 v159, v159, v74
  v_cvt_pk_bf16_f32 v71, v158, v159
  v_lshlrev_b32 v158, 16, v71
  v_and_b32 v159, 0xffff0000, v71
  v_mul_f32 v77, v158, v76
  v_fma_f32 v78, -v77, v75, v158
  v_fma_f32 v158, v78, v76, v77
  v_mul_f32 v77, v159, v76
  v_fma_f32 v78, -v77, v75, v159
  v_fma_f32 v159, v78, v76, v77
  v_cvt_pk_bf16_f32 v71, v158, v159
  v_lshlrev_b32 v158, 16, v71
  v_and_b32 v159, 0xffff0000, v71
  s_add_u32 s28, s5, 64
  s_mul_i32 s28, s28, 20480
  s_mul_i32 s29, s91, 5120
  s_add_u32 s28, s28, s29
  s_add_u32 s28, s28, 19922944
  v_mul_f32 v120, v120, v10
  v_mul_f32 v121, v121, v11
  v_cvt_pk_bf16_f32 v71, v120, v121
  v_lshlrev_b32 v120, 16, v71
  v_and_b32 v121, 0xffff0000, v71
  v_add_f32 v120, v120, v80
  v_add_f32 v121, v121, v81
  v_cvt_pk_bf16_f32 v50, v120, v121
  v_mul_f32 v122, v122, v12
  v_mul_f32 v123, v123, v13
  v_cvt_pk_bf16_f32 v71, v122, v123
  v_lshlrev_b32 v122, 16, v71
  v_and_b32 v123, 0xffff0000, v71
  v_add_f32 v122, v122, v82
  v_add_f32 v123, v123, v83
  v_cvt_pk_bf16_f32 v51, v122, v123
  v_mul_f32 v124, v124, v14
  v_mul_f32 v125, v125, v15
  v_cvt_pk_bf16_f32 v71, v124, v125
  v_lshlrev_b32 v124, 16, v71
  v_and_b32 v125, 0xffff0000, v71
  v_add_f32 v124, v124, v84
  v_add_f32 v125, v125, v85
  v_cvt_pk_bf16_f32 v52, v124, v125
  v_mul_f32 v126, v126, v16
  v_mul_f32 v127, v127, v17
  v_cvt_pk_bf16_f32 v71, v126, v127
  v_lshlrev_b32 v126, 16, v71
  v_and_b32 v127, 0xffff0000, v71
  v_add_f32 v126, v126, v86
  v_add_f32 v127, v127, v87
  v_cvt_pk_bf16_f32 v53, v126, v127
  buffer_store_dwordx4 v[50:53], v7, s[8:11], s28 offen offset:0 sc1
  v_mul_f32 v128, v128, v18
  v_mul_f32 v129, v129, v19
  v_cvt_pk_bf16_f32 v71, v128, v129
  v_lshlrev_b32 v128, 16, v71
  v_and_b32 v129, 0xffff0000, v71
  v_add_f32 v128, v128, v88
  v_add_f32 v129, v129, v89
  v_cvt_pk_bf16_f32 v54, v128, v129
  v_mul_f32 v130, v130, v20
  v_mul_f32 v131, v131, v21
  v_cvt_pk_bf16_f32 v71, v130, v131
  v_lshlrev_b32 v130, 16, v71
  v_and_b32 v131, 0xffff0000, v71
  v_add_f32 v130, v130, v90
  v_add_f32 v131, v131, v91
  v_cvt_pk_bf16_f32 v55, v130, v131
  v_mul_f32 v132, v132, v22
  v_mul_f32 v133, v133, v23
  v_cvt_pk_bf16_f32 v71, v132, v133
  v_lshlrev_b32 v132, 16, v71
  v_and_b32 v133, 0xffff0000, v71
  v_add_f32 v132, v132, v92
  v_add_f32 v133, v133, v93
  v_cvt_pk_bf16_f32 v56, v132, v133
  v_mul_f32 v134, v134, v24
  v_mul_f32 v135, v135, v25
  v_cvt_pk_bf16_f32 v71, v134, v135
  v_lshlrev_b32 v134, 16, v71
  v_and_b32 v135, 0xffff0000, v71
  v_add_f32 v134, v134, v94
  v_add_f32 v135, v135, v95
  v_cvt_pk_bf16_f32 v57, v134, v135
  buffer_store_dwordx4 v[54:57], v7, s[8:11], s28 offen offset:1024 sc1
  v_mul_f32 v136, v136, v26
  v_mul_f32 v137, v137, v27
  v_cvt_pk_bf16_f32 v71, v136, v137
  v_lshlrev_b32 v136, 16, v71
  v_and_b32 v137, 0xffff0000, v71
  v_add_f32 v136, v136, v96
  v_add_f32 v137, v137, v97
  v_cvt_pk_bf16_f32 v58, v136, v137
  v_mul_f32 v138, v138, v28
  v_mul_f32 v139, v139, v29
  v_cvt_pk_bf16_f32 v71, v138, v139
  v_lshlrev_b32 v138, 16, v71
  v_and_b32 v139, 0xffff0000, v71
  v_add_f32 v138, v138, v98
  v_add_f32 v139, v139, v99
  v_cvt_pk_bf16_f32 v59, v138, v139
  v_mul_f32 v140, v140, v30
  v_mul_f32 v141, v141, v31
  v_cvt_pk_bf16_f32 v71, v140, v141
  v_lshlrev_b32 v140, 16, v71
  v_and_b32 v141, 0xffff0000, v71
  v_add_f32 v140, v140, v100
  v_add_f32 v141, v141, v101
  v_cvt_pk_bf16_f32 v60, v140, v141
  v_mul_f32 v142, v142, v32
  v_mul_f32 v143, v143, v33
  v_cvt_pk_bf16_f32 v71, v142, v143
  v_lshlrev_b32 v142, 16, v71
  v_and_b32 v143, 0xffff0000, v71
  v_add_f32 v142, v142, v102
  v_add_f32 v143, v143, v103
  v_cvt_pk_bf16_f32 v61, v142, v143
  buffer_store_dwordx4 v[58:61], v7, s[8:11], s28 offen offset:2048 sc1
  v_mul_f32 v144, v144, v34
  v_mul_f32 v145, v145, v35
  v_cvt_pk_bf16_f32 v71, v144, v145
  v_lshlrev_b32 v144, 16, v71
  v_and_b32 v145, 0xffff0000, v71
  v_add_f32 v144, v144, v104
  v_add_f32 v145, v145, v105
  v_cvt_pk_bf16_f32 v62, v144, v145
  v_mul_f32 v146, v146, v36
  v_mul_f32 v147, v147, v37
  v_cvt_pk_bf16_f32 v71, v146, v147
  v_lshlrev_b32 v146, 16, v71
  v_and_b32 v147, 0xffff0000, v71
  v_add_f32 v146, v146, v106
  v_add_f32 v147, v147, v107
  v_cvt_pk_bf16_f32 v63, v146, v147
  v_mul_f32 v148, v148, v38
  v_mul_f32 v149, v149, v39
  v_cvt_pk_bf16_f32 v71, v148, v149
  v_lshlrev_b32 v148, 16, v71
  v_and_b32 v149, 0xffff0000, v71
  v_add_f32 v148, v148, v108
  v_add_f32 v149, v149, v109
  v_cvt_pk_bf16_f32 v64, v148, v149
  v_mul_f32 v150, v150, v40
  v_mul_f32 v151, v151, v41
  v_cvt_pk_bf16_f32 v71, v150, v151
  v_lshlrev_b32 v150, 16, v71
  v_and_b32 v151, 0xffff0000, v71
  v_add_f32 v150, v150, v110
  v_add_f32 v151, v151, v111
  v_cvt_pk_bf16_f32 v65, v150, v151
  buffer_store_dwordx4 v[62:65], v7, s[8:11], s28 offen offset:3072 sc1
  v_mul_f32 v152, v152, v42
  v_mul_f32 v153, v153, v43
  v_cvt_pk_bf16_f32 v71, v152, v153
  v_lshlrev_b32 v152, 16, v71
  v_and_b32 v153, 0xffff0000, v71
  v_add_f32 v152, v152, v112
  v_add_f32 v153, v153, v113
  v_cvt_pk_bf16_f32 v66, v152, v153
  v_mul_f32 v154, v154, v44
  v_mul_f32 v155, v155, v45
  v_cvt_pk_bf16_f32 v71, v154, v155
  v_lshlrev_b32 v154, 16, v71
  v_and_b32 v155, 0xffff0000, v71
  v_add_f32 v154, v154, v114
  v_add_f32 v155, v155, v115
  v_cvt_pk_bf16_f32 v67, v154, v155
  v_mul_f32 v156, v156, v46
  v_mul_f32 v157, v157, v47
  v_cvt_pk_bf16_f32 v71, v156, v157
  v_lshlrev_b32 v156, 16, v71
  v_and_b32 v157, 0xffff0000, v71
  v_add_f32 v156, v156, v116
  v_add_f32 v157, v157, v117
  v_cvt_pk_bf16_f32 v68, v156, v157
  v_mul_f32 v158, v158, v48
  v_mul_f32 v159, v159, v49
  v_cvt_pk_bf16_f32 v71, v158, v159
  v_lshlrev_b32 v158, 16, v71
  v_and_b32 v159, 0xffff0000, v71
  v_add_f32 v158, v158, v118
  v_add_f32 v159, v159, v119
  v_cvt_pk_bf16_f32 v69, v158, v159
  s_add_u32 s28, s28, 4096
  buffer_store_dwordx4 v[66:69], v7, s[8:11], s28 offen offset:0 sc1
  s_waitcnt vmcnt(0)
  s_barrier
  s_cmp_eq_u32 s91, 0
  s_cbranch_scc0 G3_h2
  s_mov_b64 exec, 1
  v_mov_b32 v252, 200
  v_mov_b32 v251, 1
  buffer_atomic_add v251, v252, s[12:15], 0 offen sc1
  s_mov_b64 exec, -1
G3_h2:
  v_lshlrev_b32 v120, 16, v220
  v_and_b32 v121, 0xffff0000, v220
  v_lshlrev_b32 v122, 16, v221
  v_and_b32 v123, 0xffff0000, v221
  v_lshlrev_b32 v124, 16, v222
  v_and_b32 v125, 0xffff0000, v222
  v_lshlrev_b32 v126, 16, v223
  v_and_b32 v127, 0xffff0000, v223
  v_lshlrev_b32 v128, 16, v224
  v_and_b32 v129, 0xffff0000, v224
  v_lshlrev_b32 v130, 16, v225
  v_and_b32 v131, 0xffff0000, v225
  v_lshlrev_b32 v132, 16, v226
  v_and_b32 v133, 0xffff0000, v226
  v_lshlrev_b32 v134, 16, v227
  v_and_b32 v135, 0xffff0000, v227
  v_lshlrev_b32 v136, 16, v228
  v_and_b32 v137, 0xffff0000, v228
  v_lshlrev_b32 v138, 16, v229
  v_and_b32 v139, 0xffff0000, v229
  v_lshlrev_b32 v140, 16, v230
  v_and_b32 v141, 0xffff0000, v230
  v_lshlrev_b32 v142, 16, v231
  v_and_b32 v143, 0xffff0000, v231
  v_lshlrev_b32 v144, 16, v232
  v_and_b32 v145, 0xffff0000, v232
  v_lshlrev_b32 v146, 16, v233
  v_and_b32 v147, 0xffff0000, v233
  v_lshlrev_b32 v148, 16, v234
  v_and_b32 v149, 0xffff0000, v234
  v_lshlrev_b32 v150, 16, v235
  v_and_b32 v151, 0xffff0000, v235
  v_lshlrev_b32 v152, 16, v236
  v_and_b32 v153, 0xffff0000, v236
  v_lshlrev_b32 v154, 16, v237
  v_and_b32 v155, 0xffff0000, v237
  v_lshlrev_b32 v156, 16, v238
  v_and_b32 v157, 0xffff0000, v238
  v_lshlrev_b32 v158, 16, v239
  v_and_b32 v159, 0xffff0000, v239
  v_add_f32 v70, v120, v121
  v_add_f32 v70, v70, v122
  v_add_f32 v70, v70, v123
  v_add_f32 v70, v70, v124
  v_add_f32 v70, v70, v125
  v_add_f32 v70, v70, v126
  v_add_f32 v70, v70, v127
  v_add_f32 v70, v70, v128
  v_add_f32 v70, v70, v129
  v_add_f32 v70, v70, v130
  v_add_f32 v70, v70, v131
  v_add_f32 v70, v70, v132
  v_add_f32 v70, v70, v133
  v_add_f32 v70, v70, v134
  v_add_f32 v70, v70, v135
  v_add_f32 v70, v70, v136
  v_add_f32 v70, v70, v137
  v_add_f32 v70, v70, v138
  v_add_f32 v70, v70, v139
  v_add_f32 v70, v70, v140
  v_add_f32 v70, v70, v141
  v_add_f32 v70, v70, v142
  v_add_f32 v70, v70, v143
  v_add_f32 v70, v70, v144
  v_add_f32 v70, v70, v145
  v_add_f32 v70, v70, v146
  v_add_f32 v70, v70, v147
  v_add_f32 v70, v70, v148
  v_add_f32 v70, v70, v149
  v_add_f32 v70, v70, v150
  v_add_f32 v70, v70, v151
  v_add_f32 v70, v70, v152
  v_add_f32 v70, v70, v153
  v_add_f32 v70, v70, v154
  v_add_f32 v70, v70, v155
  v_add_f32 v70, v70, v156
  v_add_f32 v70, v70, v157
  v_add_f32 v70, v70, v158
  v_add_f32 v70, v70, v159
  v_mov_b32 v71, v70
  s_nop 1
  v_permlane32_swap_b32 v70, v71
  v_add_f32 v70, v70, v71
  v_mov_b32 v71, v70
  s_nop 1
  v_permlane16_swap_b32 v70, v71
  v_add_f32 v70, v70, v71
  s_lshl_b32 s30, s91, 6
  v_lshlrev_b32 v72, 2, v3
  v_add_u32 v73, s30, v72
  ds_write_b32 v73, v70
  s_waitcnt lgkmcnt(0)
  s_barrier
  ds_read_b32 v74, v72
  ds_read_b32 v75, v72 offset:64
  ds_read_b32 v76, v72 offset:128
  ds_read_b32 v77, v72 offset:192
  s_waitcnt lgkmcnt(0)
  v_add_f32 v74, v74, v75
  v_add_f32 v76, v76, v77
  v_add_f32 v74, v74, v76
  v_mul_f32 v74, 0x3acccccd, v74
  v_sub_f32 v71, v120, v74
  v_mul_f32 v70, v71, v71
  v_sub_f32 v71, v121, v74
  v_fmac_f32 v70, v71, v71
  v_sub_f32 v71, v122, v74
  v_fmac_f32 v70, v71, v71
  v_sub_f32 v71, v123, v74
  v_fmac_f32 v70, v71, v71
  v_sub_f32 v71, v124, v74
  v_fmac_f32 v70, v71, v71
  v_sub_f32 v71, v125, v74
  v_fmac_f32 v70, v71, v71
  v_sub_f32 v71, v126, v74
  v_fmac_f32 v70, v71, v71
  v_sub_f32 v71, v127, v74
  v_fmac_f32 v70, v71, v71
  v_sub_f32 v71, v128, v74
  v_fmac_f32 v70, v71, v71
  v_sub_f32 v71, v129, v74
  v_fmac_f32 v70, v71, v71
  v_sub_f32 v71, v130, v74
  v_fmac_f32 v70, v71, v71
  v_sub_f32 v71, v131, v74
  v_fmac_f32 v70, v71, v71
  v_sub_f32 v71, v132, v74
  v_fmac_f32 v70, v71, v71
  v_sub_f32 v71, v133, v74
  v_fmac_f32 v70, v71, v71
  v_sub_f32 v71, v134, v74
  v_fmac_f32 v70, v71, v71
  v_sub_f32 v71, v135, v74
  v_fmac_f32 v70, v71, v71
  v_sub_f32 v71, v136, v74
  v_fmac_f32 v70, v71, v71
  v_sub_f32 v71, v137, v74
  v_fmac_f32 v70, v71, v71
  v_sub_f32 v71, v138, v74
  v_fmac_f32 v70, v71, v71
  v_sub_f32 v71, v139, v74
  v_fmac_f32 v70, v71, v71
  v_sub_f32 v71, v140, v74
  v_fmac_f32 v70, v71, v71
  v_sub_f32 v71, v141, v74
  v_fmac_f32 v70, v71, v71
  v_sub_f32 v71, v142, v74
  v_fmac_f32 v70, v71, v71
  v_sub_f32 v71, v143, v74
  v_fmac_f32 v70, v71, v71
  v_sub_f32 v71, v144, v74
  v_fmac_f32 v70, v71, v71
  v_sub_f32 v71, v145, v74
  v_fmac_f32 v70, v71, v71
  v_sub_f32 v71, v146, v74
  v_fmac_f32 v70, v71, v71
  v_sub_f32 v71, v147, v74
  v_fmac_f32 v70, v71, v71
  v_sub_f32 v71, v148, v74
  v_fmac_f32 v70, v71, v71
  v_sub_f32 v71, v149, v74
  v_fmac_f32 v70, v71, v71
  v_sub_f32 v71, v150, v74
  v_fmac_f32 v70, v71, v71
  v_sub_f32 v71, v151, v74
  v_fmac_f32 v70, v71, v71
  v_sub_f32 v71, v152, v74
  v_fmac_f32 v70, v71, v71
  v_sub_f32 v71, v153, v74
  v_fmac_f32 v70, v71, v71
  v_sub_f32 v71, v154, v74
  v_fmac_f32 v70, v71, v71
  v_sub_f32 v71, v155, v74
  v_fmac_f32 v70, v71, v71
  v_sub_f32 v71, v156, v74
  v_fmac_f32 v70, v71, v71
  v_sub_f32 v71, v157, v74
  v_fmac_f32 v70, v71, v71
  v_sub_f32 v71, v158, v74
  v_fmac_f32 v70, v71, v71
  v_sub_f32 v71, v159, v74
  v_fmac_f32 v70, v71, v71
  v_mov_b32 v71, v70
  s_nop 1
  v_permlane32_swap_b32 v70, v71
  v_add_f32 v70, v70, v71
  v_mov_b32 v71, v70
  s_nop 1
  v_permlane16_swap_b32 v70, v71
  v_add_f32 v70, v70, v71
  ds_write_b32 v73, v70 offset:256
  s_waitcnt lgkmcnt(0)
  s_barrier
  ds_read_b32 v75, v72 offset:256
  ds_read_b32 v76, v72 offset:320
  ds_read_b32 v77, v72 offset:384
  ds_read_b32 v78, v72 offset:448
  s_waitcnt lgkmcnt(0)
  v_add_f32 v75, v75, v76
  v_add_f32 v77, v77, v78
  v_add_f32 v75, v75, v77
  v_mul_f32 v75, 0x3acccccd, v75
  v_cvt_pk_bf16_f32 v74, v74, v74
  v_lshlrev_b32 v74, 16, v74
  v_cvt_pk_bf16_f32 v75, v75, v75
  v_lshlrev_b32 v75, 16, v75
  v_add_f32 v75, 0x3727c5ac, v75
  v_cvt_pk_bf16_f32 v75, v75, v75
  v_lshlrev_b32 v75, 16, v75
  v_sqrt_f32 v75, v75
  s_nop 0
  v_cvt_pk_bf16_f32 v75, v75, v75
  v_lshlrev_b32 v75, 16, v75
  v_rcp_f32 v76, v75
  v_sub_f32 v120, v120, v74
  v_sub_f32 v121, v121, v74
  v_cvt_pk_bf16_f32 v71, v120, v121
  v_lshlrev_b32 v120, 16, v71
  v_and_b32 v121, 0xffff0000, v71
  v_mul_f32 v77, v120, v76
  v_fma_f32 v78, -v77, v75, v120
  v_fma_f32 v120, v78, v76, v77
  v_mul_f32 v77, v121, v76
  v_fma_f32 v78, -v77, v75, v121
  v_fma_f32 v121, v78, v76, v77
  v_cvt_pk_bf16_f32 v71, v120, v121
  v_lshlrev_b32 v120, 16, v71
  v_and_b32 v121, 0xffff0000, v71
  v_sub_f32 v122, v122, v74
  v_sub_f32 v123, v123, v74
  v_cvt_pk_bf16_f32 v71, v122, v123
  v_lshlrev_b32 v122, 16, v71
  v_and_b32 v123, 0xffff0000, v71
  v_mul_f32 v77, v122, v76
  v_fma_f32 v78, -v77, v75, v122
  v_fma_f32 v122, v78, v76, v77
  v_mul_f32 v77, v123, v76
  v_fma_f32 v78, -v77, v75, v123
  v_fma_f32 v123, v78, v76, v77
  v_cvt_pk_bf16_f32 v71, v122, v123
  v_lshlrev_b32 v122, 16, v71
  v_and_b32 v123, 0xffff0000, v71
  v_sub_f32 v124, v124, v74
  v_sub_f32 v125, v125, v74
  v_cvt_pk_bf16_f32 v71, v124, v125
  v_lshlrev_b32 v124, 16, v71
  v_and_b32 v125, 0xffff0000, v71
  v_mul_f32 v77, v124, v76
  v_fma_f32 v78, -v77, v75, v124
  v_fma_f32 v124, v78, v76, v77
  v_mul_f32 v77, v125, v76
  v_fma_f32 v78, -v77, v75, v125
  v_fma_f32 v125, v78, v76, v77
  v_cvt_pk_bf16_f32 v71, v124, v125
  v_lshlrev_b32 v124, 16, v71
  v_and_b32 v125, 0xffff0000, v71
  v_sub_f32 v126, v126, v74
  v_sub_f32 v127, v127, v74
  v_cvt_pk_bf16_f32 v71, v126, v127
  v_lshlrev_b32 v126, 16, v71
  v_and_b32 v127, 0xffff0000, v71
  v_mul_f32 v77, v126, v76
  v_fma_f32 v78, -v77, v75, v126
  v_fma_f32 v126, v78, v76, v77
  v_mul_f32 v77, v127, v76
  v_fma_f32 v78, -v77, v75, v127
  v_fma_f32 v127, v78, v76, v77
  v_cvt_pk_bf16_f32 v71, v126, v127
  v_lshlrev_b32 v126, 16, v71
  v_and_b32 v127, 0xffff0000, v71
  v_sub_f32 v128, v128, v74
  v_sub_f32 v129, v129, v74
  v_cvt_pk_bf16_f32 v71, v128, v129
  v_lshlrev_b32 v128, 16, v71
  v_and_b32 v129, 0xffff0000, v71
  v_mul_f32 v77, v128, v76
  v_fma_f32 v78, -v77, v75, v128
  v_fma_f32 v128, v78, v76, v77
  v_mul_f32 v77, v129, v76
  v_fma_f32 v78, -v77, v75, v129
  v_fma_f32 v129, v78, v76, v77
  v_cvt_pk_bf16_f32 v71, v128, v129
  v_lshlrev_b32 v128, 16, v71
  v_and_b32 v129, 0xffff0000, v71
  v_sub_f32 v130, v130, v74
  v_sub_f32 v131, v131, v74
  v_cvt_pk_bf16_f32 v71, v130, v131
  v_lshlrev_b32 v130, 16, v71
  v_and_b32 v131, 0xffff0000, v71
  v_mul_f32 v77, v130, v76
  v_fma_f32 v78, -v77, v75, v130
  v_fma_f32 v130, v78, v76, v77
  v_mul_f32 v77, v131, v76
  v_fma_f32 v78, -v77, v75, v131
  v_fma_f32 v131, v78, v76, v77
  v_cvt_pk_bf16_f32 v71, v130, v131
  v_lshlrev_b32 v130, 16, v71
  v_and_b32 v131, 0xffff0000, v71
  v_sub_f32 v132, v132, v74
  v_sub_f32 v133, v133, v74
  v_cvt_pk_bf16_f32 v71, v132, v133
  v_lshlrev_b32 v132, 16, v71
  v_and_b32 v133, 0xffff0000, v71
  v_mul_f32 v77, v132, v76
  v_fma_f32 v78, -v77, v75, v132
  v_fma_f32 v132, v78, v76, v77
  v_mul_f32 v77, v133, v76
  v_fma_f32 v78, -v77, v75, v133
  v_fma_f32 v133, v78, v76, v77
  v_cvt_pk_bf16_f32 v71, v132, v133
  v_lshlrev_b32 v132, 16, v71
  v_and_b32 v133, 0xffff0000, v71
  v_sub_f32 v134, v134, v74
  v_sub_f32 v135, v135, v74
  v_cvt_pk_bf16_f32 v71, v134, v135
  v_lshlrev_b32 v134, 16, v71
  v_and_b32 v135, 0xffff0000, v71
  v_mul_f32 v77, v134, v76
  v_fma_f32 v78, -v77, v75, v134
  v_fma_f32 v134, v78, v76, v77
  v_mul_f32 v77, v135, v76
  v_fma_f32 v78, -v77, v75, v135
  v_fma_f32 v135, v78, v76, v77
  v_cvt_pk_bf16_f32 v71, v134, v135
  v_lshlrev_b32 v134, 16, v71
  v_and_b32 v135, 0xffff0000, v71
  v_sub_f32 v136, v136, v74
  v_sub_f32 v137, v137, v74
  v_cvt_pk_bf16_f32 v71, v136, v137
  v_lshlrev_b32 v136, 16, v71
  v_and_b32 v137, 0xffff0000, v71
  v_mul_f32 v77, v136, v76
  v_fma_f32 v78, -v77, v75, v136
  v_fma_f32 v136, v78, v76, v77
  v_mul_f32 v77, v137, v76
  v_fma_f32 v78, -v77, v75, v137
  v_fma_f32 v137, v78, v76, v77
  v_cvt_pk_bf16_f32 v71, v136, v137
  v_lshlrev_b32 v136, 16, v71
  v_and_b32 v137, 0xffff0000, v71
  v_sub_f32 v138, v138, v74
  v_sub_f32 v139, v139, v74
  v_cvt_pk_bf16_f32 v71, v138, v139
  v_lshlrev_b32 v138, 16, v71
  v_and_b32 v139, 0xffff0000, v71
  v_mul_f32 v77, v138, v76
  v_fma_f32 v78, -v77, v75, v138
  v_fma_f32 v138, v78, v76, v77
  v_mul_f32 v77, v139, v76
  v_fma_f32 v78, -v77, v75, v139
  v_fma_f32 v139, v78, v76, v77
  v_cvt_pk_bf16_f32 v71, v138, v139
  v_lshlrev_b32 v138, 16, v71
  v_and_b32 v139, 0xffff0000, v71
  v_sub_f32 v140, v140, v74
  v_sub_f32 v141, v141, v74
  v_cvt_pk_bf16_f32 v71, v140, v141
  v_lshlrev_b32 v140, 16, v71
  v_and_b32 v141, 0xffff0000, v71
  v_mul_f32 v77, v140, v76
  v_fma_f32 v78, -v77, v75, v140
  v_fma_f32 v140, v78, v76, v77
  v_mul_f32 v77, v141, v76
  v_fma_f32 v78, -v77, v75, v141
  v_fma_f32 v141, v78, v76, v77
  v_cvt_pk_bf16_f32 v71, v140, v141
  v_lshlrev_b32 v140, 16, v71
  v_and_b32 v141, 0xffff0000, v71
  v_sub_f32 v142, v142, v74
  v_sub_f32 v143, v143, v74
  v_cvt_pk_bf16_f32 v71, v142, v143
  v_lshlrev_b32 v142, 16, v71
  v_and_b32 v143, 0xffff0000, v71
  v_mul_f32 v77, v142, v76
  v_fma_f32 v78, -v77, v75, v142
  v_fma_f32 v142, v78, v76, v77
  v_mul_f32 v77, v143, v76
  v_fma_f32 v78, -v77, v75, v143
  v_fma_f32 v143, v78, v76, v77
  v_cvt_pk_bf16_f32 v71, v142, v143
  v_lshlrev_b32 v142, 16, v71
  v_and_b32 v143, 0xffff0000, v71
  v_sub_f32 v144, v144, v74
  v_sub_f32 v145, v145, v74
  v_cvt_pk_bf16_f32 v71, v144, v145
  v_lshlrev_b32 v144, 16, v71
  v_and_b32 v145, 0xffff0000, v71
  v_mul_f32 v77, v144, v76
  v_fma_f32 v78, -v77, v75, v144
  v_fma_f32 v144, v78, v76, v77
  v_mul_f32 v77, v145, v76
  v_fma_f32 v78, -v77, v75, v145
  v_fma_f32 v145, v78, v76, v77
  v_cvt_pk_bf16_f32 v71, v144, v145
  v_lshlrev_b32 v144, 16, v71
  v_and_b32 v145, 0xffff0000, v71
  v_sub_f32 v146, v146, v74
  v_sub_f32 v147, v147, v74
  v_cvt_pk_bf16_f32 v71, v146, v147
  v_lshlrev_b32 v146, 16, v71
  v_and_b32 v147, 0xffff0000, v71
  v_mul_f32 v77, v146, v76
  v_fma_f32 v78, -v77, v75, v146
  v_fma_f32 v146, v78, v76, v77
  v_mul_f32 v77, v147, v76
  v_fma_f32 v78, -v77, v75, v147
  v_fma_f32 v147, v78, v76, v77
  v_cvt_pk_bf16_f32 v71, v146, v147
  v_lshlrev_b32 v146, 16, v71
  v_and_b32 v147, 0xffff0000, v71
  v_sub_f32 v148, v148, v74
  v_sub_f32 v149, v149, v74
  v_cvt_pk_bf16_f32 v71, v148, v149
  v_lshlrev_b32 v148, 16, v71
  v_and_b32 v149, 0xffff0000, v71
  v_mul_f32 v77, v148, v76
  v_fma_f32 v78, -v77, v75, v148
  v_fma_f32 v148, v78, v76, v77
  v_mul_f32 v77, v149, v76
  v_fma_f32 v78, -v77, v75, v149
  v_fma_f32 v149, v78, v76, v77
  v_cvt_pk_bf16_f32 v71, v148, v149
  v_lshlrev_b32 v148, 16, v71
  v_and_b32 v149, 0xffff0000, v71
  v_sub_f32 v150, v150, v74
  v_sub_f32 v151, v151, v74
  v_cvt_pk_bf16_f32 v71, v150, v151
  v_lshlrev_b32 v150, 16, v71
  v_and_b32 v151, 0xffff0000, v71
  v_mul_f32 v77, v150, v76
  v_fma_f32 v78, -v77, v75, v150
  v_fma_f32 v150, v78, v76, v77
  v_mul_f32 v77, v151, v76
  v_fma_f32 v78, -v77, v75, v151
  v_fma_f32 v151, v78, v76, v77
  v_cvt_pk_bf16_f32 v71, v150, v151
  v_lshlrev_b32 v150, 16, v71
  v_and_b32 v151, 0xffff0000, v71
  v_sub_f32 v152, v152, v74
  v_sub_f32 v153, v153, v74
  v_cvt_pk_bf16_f32 v71, v152, v153
  v_lshlrev_b32 v152, 16, v71
  v_and_b32 v153, 0xffff0000, v71
  v_mul_f32 v77, v152, v76
  v_fma_f32 v78, -v77, v75, v152
  v_fma_f32 v152, v78, v76, v77
  v_mul_f32 v77, v153, v76
  v_fma_f32 v78, -v77, v75, v153
  v_fma_f32 v153, v78, v76, v77
  v_cvt_pk_bf16_f32 v71, v152, v153
  v_lshlrev_b32 v152, 16, v71
  v_and_b32 v153, 0xffff0000, v71
  v_sub_f32 v154, v154, v74
  v_sub_f32 v155, v155, v74
  v_cvt_pk_bf16_f32 v71, v154, v155
  v_lshlrev_b32 v154, 16, v71
  v_and_b32 v155, 0xffff0000, v71
  v_mul_f32 v77, v154, v76
  v_fma_f32 v78, -v77, v75, v154
  v_fma_f32 v154, v78, v76, v77
  v_mul_f32 v77, v155, v76
  v_fma_f32 v78, -v77, v75, v155
  v_fma_f32 v155, v78, v76, v77
  v_cvt_pk_bf16_f32 v71, v154, v155
  v_lshlrev_b32 v154, 16, v71
  v_and_b32 v155, 0xffff0000, v71
  v_sub_f32 v156, v156, v74
  v_sub_f32 v157, v157, v74
  v_cvt_pk_bf16_f32 v71, v156, v157
  v_lshlrev_b32 v156, 16, v71
  v_and_b32 v157, 0xffff0000, v71
  v_mul_f32 v77, v156, v76
  v_fma_f32 v78, -v77, v75, v156
  v_fma_f32 v156, v78, v76, v77
  v_mul_f32 v77, v157, v76
  v_fma_f32 v78, -v77, v75, v157
  v_fma_f32 v157, v78, v76, v77
  v_cvt_pk_bf16_f32 v71, v156, v157
  v_lshlrev_b32 v156, 16, v71
  v_and_b32 v157, 0xffff0000, v71
  v_sub_f32 v158, v158, v74
  v_sub_f32 v159, v159, v74
  v_cvt_pk_bf16_f32 v71, v158, v159
  v_lshlrev_b32 v158, 16, v71
  v_and_b32 v159, 0xffff0000, v71
  v_mul_f32 v77, v158, v76
  v_fma_f32 v78, -v77, v75, v158
  v_fma_f32 v158, v78, v76, v77
  v_mul_f32 v77, v159, v76
  v_fma_f32 v78, -v77, v75, v159
  v_fma_f32 v159, v78, v76, v77
  v_cvt_pk_bf16_f32 v71, v158, v159
  v_lshlrev_b32 v158, 16, v71
  v_and_b32 v159, 0xffff0000, v71
  s_add_u32 s28, s5, 96
  s_mul_i32 s28, s28, 20480
  s_mul_i32 s29, s91, 5120
  s_add_u32 s28, s28, s29
  s_add_u32 s28, s28, 19922944
  v_mul_f32 v120, v120, v10
  v_mul_f32 v121, v121, v11
  v_cvt_pk_bf16_f32 v71, v120, v121
  v_lshlrev_b32 v120, 16, v71
  v_and_b32 v121, 0xffff0000, v71
  v_add_f32 v120, v120, v80
  v_add_f32 v121, v121, v81
  v_cvt_pk_bf16_f32 v50, v120, v121
  v_mul_f32 v122, v122, v12
  v_mul_f32 v123, v123, v13
  v_cvt_pk_bf16_f32 v71, v122, v123
  v_lshlrev_b32 v122, 16, v71
  v_and_b32 v123, 0xffff0000, v71
  v_add_f32 v122, v122, v82
  v_add_f32 v123, v123, v83
  v_cvt_pk_bf16_f32 v51, v122, v123
  v_mul_f32 v124, v124, v14
  v_mul_f32 v125, v125, v15
  v_cvt_pk_bf16_f32 v71, v124, v125
  v_lshlrev_b32 v124, 16, v71
  v_and_b32 v125, 0xffff0000, v71
  v_add_f32 v124, v124, v84
  v_add_f32 v125, v125, v85
  v_cvt_pk_bf16_f32 v52, v124, v125
  v_mul_f32 v126, v126, v16
  v_mul_f32 v127, v127, v17
  v_cvt_pk_bf16_f32 v71, v126, v127
  v_lshlrev_b32 v126, 16, v71
  v_and_b32 v127, 0xffff0000, v71
  v_add_f32 v126, v126, v86
  v_add_f32 v127, v127, v87
  v_cvt_pk_bf16_f32 v53, v126, v127
  buffer_store_dwordx4 v[50:53], v7, s[8:11], s28 offen offset:0 sc1
  v_mul_f32 v128, v128, v18
  v_mul_f32 v129, v129, v19
  v_cvt_pk_bf16_f32 v71, v128, v129
  v_lshlrev_b32 v128, 16, v71
  v_and_b32 v129, 0xffff0000, v71
  v_add_f32 v128, v128, v88
  v_add_f32 v129, v129, v89
  v_cvt_pk_bf16_f32 v54, v128, v129
  v_mul_f32 v130, v130, v20
  v_mul_f32 v131, v131, v21
  v_cvt_pk_bf16_f32 v71, v130, v131
  v_lshlrev_b32 v130, 16, v71
  v_and_b32 v131, 0xffff0000, v71
  v_add_f32 v130, v130, v90
  v_add_f32 v131, v131, v91
  v_cvt_pk_bf16_f32 v55, v130, v131
  v_mul_f32 v132, v132, v22
  v_mul_f32 v133, v133, v23
  v_cvt_pk_bf16_f32 v71, v132, v133
  v_lshlrev_b32 v132, 16, v71
  v_and_b32 v133, 0xffff0000, v71
  v_add_f32 v132, v132, v92
  v_add_f32 v133, v133, v93
  v_cvt_pk_bf16_f32 v56, v132, v133
  v_mul_f32 v134, v134, v24
  v_mul_f32 v135, v135, v25
  v_cvt_pk_bf16_f32 v71, v134, v135
  v_lshlrev_b32 v134, 16, v71
  v_and_b32 v135, 0xffff0000, v71
  v_add_f32 v134, v134, v94
  v_add_f32 v135, v135, v95
  v_cvt_pk_bf16_f32 v57, v134, v135
  buffer_store_dwordx4 v[54:57], v7, s[8:11], s28 offen offset:1024 sc1
  v_mul_f32 v136, v136, v26
  v_mul_f32 v137, v137, v27
  v_cvt_pk_bf16_f32 v71, v136, v137
  v_lshlrev_b32 v136, 16, v71
  v_and_b32 v137, 0xffff0000, v71
  v_add_f32 v136, v136, v96
  v_add_f32 v137, v137, v97
  v_cvt_pk_bf16_f32 v58, v136, v137
  v_mul_f32 v138, v138, v28
  v_mul_f32 v139, v139, v29
  v_cvt_pk_bf16_f32 v71, v138, v139
  v_lshlrev_b32 v138, 16, v71
  v_and_b32 v139, 0xffff0000, v71
  v_add_f32 v138, v138, v98
  v_add_f32 v139, v139, v99
  v_cvt_pk_bf16_f32 v59, v138, v139
  v_mul_f32 v140, v140, v30
  v_mul_f32 v141, v141, v31
  v_cvt_pk_bf16_f32 v71, v140, v141
  v_lshlrev_b32 v140, 16, v71
  v_and_b32 v141, 0xffff0000, v71
  v_add_f32 v140, v140, v100
  v_add_f32 v141, v141, v101
  v_cvt_pk_bf16_f32 v60, v140, v141
  v_mul_f32 v142, v142, v32
  v_mul_f32 v143, v143, v33
  v_cvt_pk_bf16_f32 v71, v142, v143
  v_lshlrev_b32 v142, 16, v71
  v_and_b32 v143, 0xffff0000, v71
  v_add_f32 v142, v142, v102
  v_add_f32 v143, v143, v103
  v_cvt_pk_bf16_f32 v61, v142, v143
  buffer_store_dwordx4 v[58:61], v7, s[8:11], s28 offen offset:2048 sc1
  v_mul_f32 v144, v144, v34
  v_mul_f32 v145, v145, v35
  v_cvt_pk_bf16_f32 v71, v144, v145
  v_lshlrev_b32 v144, 16, v71
  v_and_b32 v145, 0xffff0000, v71
  v_add_f32 v144, v144, v104
  v_add_f32 v145, v145, v105
  v_cvt_pk_bf16_f32 v62, v144, v145
  v_mul_f32 v146, v146, v36
  v_mul_f32 v147, v147, v37
  v_cvt_pk_bf16_f32 v71, v146, v147
  v_lshlrev_b32 v146, 16, v71
  v_and_b32 v147, 0xffff0000, v71
  v_add_f32 v146, v146, v106
  v_add_f32 v147, v147, v107
  v_cvt_pk_bf16_f32 v63, v146, v147
  v_mul_f32 v148, v148, v38
  v_mul_f32 v149, v149, v39
  v_cvt_pk_bf16_f32 v71, v148, v149
  v_lshlrev_b32 v148, 16, v71
  v_and_b32 v149, 0xffff0000, v71
  v_add_f32 v148, v148, v108
  v_add_f32 v149, v149, v109
  v_cvt_pk_bf16_f32 v64, v148, v149
  v_mul_f32 v150, v150, v40
  v_mul_f32 v151, v151, v41
  v_cvt_pk_bf16_f32 v71, v150, v151
  v_lshlrev_b32 v150, 16, v71
  v_and_b32 v151, 0xffff0000, v71
  v_add_f32 v150, v150, v110
  v_add_f32 v151, v151, v111
  v_cvt_pk_bf16_f32 v65, v150, v151
  buffer_store_dwordx4 v[62:65], v7, s[8:11], s28 offen offset:3072 sc1
  v_mul_f32 v152, v152, v42
  v_mul_f32 v153, v153, v43
  v_cvt_pk_bf16_f32 v71, v152, v153
  v_lshlrev_b32 v152, 16, v71
  v_and_b32 v153, 0xffff0000, v71
  v_add_f32 v152, v152, v112
  v_add_f32 v153, v153, v113
  v_cvt_pk_bf16_f32 v66, v152, v153
  v_mul_f32 v154, v154, v44
  v_mul_f32 v155, v155, v45
  v_cvt_pk_bf16_f32 v71, v154, v155
  v_lshlrev_b32 v154, 16, v71
  v_and_b32 v155, 0xffff0000, v71
  v_add_f32 v154, v154, v114
  v_add_f32 v155, v155, v115
  v_cvt_pk_bf16_f32 v67, v154, v155
  v_mul_f32 v156, v156, v46
  v_mul_f32 v157, v157, v47
  v_cvt_pk_bf16_f32 v71, v156, v157
  v_lshlrev_b32 v156, 16, v71
  v_and_b32 v157, 0xffff0000, v71
  v_add_f32 v156, v156, v116
  v_add_f32 v157, v157, v117
  v_cvt_pk_bf16_f32 v68, v156, v157
  v_mul_f32 v158, v158, v48
  v_mul_f32 v159, v159, v49
  v_cvt_pk_bf16_f32 v71, v158, v159
  v_lshlrev_b32 v158, 16, v71
  v_and_b32 v159, 0xffff0000, v71
  v_add_f32 v158, v158, v118
  v_add_f32 v159, v159, v119
  v_cvt_pk_bf16_f32 v69, v158, v159
  s_add_u32 s28, s28, 4096
  buffer_store_dwordx4 v[66:69], v7, s[8:11], s28 offen offset:0 sc1
  s_waitcnt vmcnt(0)
  s_barrier
  s_cmp_eq_u32 s91, 0
  s_cbranch_scc0 G3_h3
  s_mov_b64 exec, 1
  v_mov_b32 v252, 204
  v_mov_b32 v251, 1
  buffer_atomic_add v251, v252, s[12:15], 0 offen sc1
  s_mov_b64 exec, -1
G3_h3:
  s_branch XA_start
XQ_start:
  s_mov_b32 s31, 0
  v_and_b32 v2, 63, v0
  v_lshrrev_b32 v3, 4, v2
  v_and_b32 v4, 15, v2
  v_lshlrev_b32 v5, 4, v2
  s_mul_i32 s21, s91, 32768
  s_cmp_eq_u32 s80, 2
  s_cbranch_scc1 XQ_w
  s_mov_b32 s16, s64
  s_mov_b32 s17, s65
  s_cmp_eq_u32 s80, 0
  s_cbranch_scc1 XQ_w
  s_mov_b32 s16, s68
  s_mov_b32 s17, s69
XQ_w:
  v_add_u32 v7, 0, v2
  v_mul_u32_u24 v8, 10923, v7
  v_lshrrev_b32 v8, 16, v8
  v_mul_u32_u24 v9, 6, v8
  v_sub_u32 v9, v7, v9
  v_mul_u32_u24 v8, 12288, v8
  v_lshl_add_u32 v120, v9, 4, v8
  v_add_u32 v7, 64, v2
  v_mul_u32_u24 v8, 10923, v7
  v_lshrrev_b32 v8, 16, v8
  v_mul_u32_u24 v9, 6, v8
  v_sub_u32 v9, v7, v9
  v_mul_u32_u24 v8, 12288, v8
  v_lshl_add_u32 v121, v9, 4, v8
  v_add_u32 v7, 128, v2
  v_mul_u32_u24 v8, 10923, v7
  v_lshrrev_b32 v8, 16, v8
  v_mul_u32_u24 v9, 6, v8
  v_sub_u32 v9, v7, v9
  v_mul_u32_u24 v8, 12288, v8
  v_lshl_add_u32 v122, v9, 4, v8
  v_lshrrev_b32 v6, 2, v4
  v_lshl_add_u32 v6, v3, 2, v6
  v_mul_u32_u24 v6, 96, v6
  v_and_b32 v7, 3, v4
  v_lshl_add_u32 v6, v7, 3, v6
  v_add_u32 v10, s21, v6
  s_mul_i32 s25, s5, 384
  s_mul_i32 s26, s91, 96
  s_add_u32 s25, s25, s26
  s_add_u32 s24, s25, 0
  s_add_u32 m0, s21, 0
  s_nop 0
  buffer_load_dwordx4 v120, s[16:19], s24 offen lds
  s_add_u32 m0, s21, 1024
  s_nop 0
  buffer_load_dwordx4 v121, s[16:19], s24 offen lds
  s_add_u32 m0, s21, 2048
  s_nop 0
  buffer_load_dwordx4 v122, s[16:19], s24 offen lds
  s_add_u32 s24, s24, 393216
  s_add_u32 m0, s21, 3072
  s_nop 0
  buffer_load_dwordx4 v120, s[16:19], s24 offen lds
  s_add_u32 m0, s21, 4096
  s_nop 0
  buffer_load_dwordx4 v121, s[16:19], s24 offen lds
  s_add_u32 m0, s21, 5120
  s_nop 0
  buffer_load_dwordx4 v122, s[16:19], s24 offen lds
  s_add_u32 s24, s24, 393216
  s_add_u32 m0, s21, 6144
  s_nop 0
  buffer_load_dwordx4 v120, s[16:19], s24 offen lds
  s_add_u32 m0, s21, 7168
  s_nop 0
  buffer_load_dwordx4 v121, s[16:19], s24 offen lds
  s_add_u32 m0, s21, 8192
  s_nop 0
  buffer_load_dwordx4 v122, s[16:19], s24 offen lds
  s_add_u32 s24, s24, 393216
  s_add_u32 m0, s21, 9216
  s_nop 0
  buffer_load_dwordx4 v120, s[16:19], s24 offen lds
  s_add_u32 m0, s21, 10240
  s_nop 0
  buffer_load_dwordx4 v121, s[16:19], s24 offen lds
  s_add_u32 m0, s21, 11264
  s_nop 0
  buffer_load_dwordx4 v122, s[16:19], s24 offen lds
  s_add_u32 s24, s24, 393216
  s_add_u32 m0, s21, 12288
  s_nop 0
  buffer_load_dwordx4 v120, s[16:19], s24 offen lds
  s_add_u32 m0, s21, 13312
  s_nop 0
  buffer_load_dwordx4 v121, s[16:19], s24 offen lds
  s_add_u32 m0, s21, 14336
  s_nop 0
  buffer_load_dwordx4 v122, s[16:19], s24 offen lds
  s_add_u32 s24, s25, 1966080
  s_add_u32 m0, s21, 16384
  s_nop 0
  buffer_load_dwordx4 v120, s[16:19], s24 offen lds
  s_add_u32 m0, s21, 17408
  s_nop 0
  buffer_load_dwordx4 v121, s[16:19], s24 offen lds
  s_add_u32 m0, s21, 18432
  s_nop 0
  buffer_load_dwordx4 v122, s[16:19], s24 offen lds
  s_add_u32 s24, s24, 393216
  s_add_u32 m0, s21, 19456
  s_nop 0
  buffer_load_dwordx4 v120, s[16:19], s24 offen lds
  s_add_u32 m0, s21, 20480
  s_nop 0
  buffer_load_dwordx4 v121, s[16:19], s24 offen lds
  s_add_u32 m0, s21, 21504
  s_nop 0
  buffer_load_dwordx4 v122, s[16:19], s24 offen lds
  s_add_u32 s24, s24, 393216
  s_add_u32 m0, s21, 22528
  s_nop 0
  buffer_load_dwordx4 v120, s[16:19], s24 offen lds
  s_add_u32 m0, s21, 23552
  s_nop 0
  buffer_load_dwordx4 v121, s[16:19], s24 offen lds
  s_add_u32 m0, s21, 24576
  s_nop 0
  buffer_load_dwordx4 v122, s[16:19], s24 offen lds
  s_add_u32 s24, s24, 393216
  s_add_u32 m0, s21, 25600
  s_nop 0
  buffer_load_dwordx4 v120, s[16:19], s24 offen lds
  s_add_u32 m0, s21, 26624
  s_nop 0
  buffer_load_dwordx4 v121, s[16:19], s24 offen lds
  s_add_u32 m0, s21, 27648
  s_nop 0
  buffer_load_dwordx4 v122, s[16:19], s24 offen lds
  s_add_u32 s24, s24, 393216
  s_add_u32 m0, s21, 28672
  s_nop 0
  buffer_load_dwordx4 v120, s[16:19], s24 offen lds
  s_add_u32 m0, s21, 29696
  s_nop 0
  buffer_load_dwordx4 v121, s[16:19], s24 offen lds
  s_add_u32 m0, s21, 30720
  s_nop 0
  buffer_load_dwordx4 v122, s[16:19], s24 offen lds
  s_waitcnt vmcnt(15)
  ds_read_b64_tr_b16 a[0:1], v10 offset:0
  ds_read_b64_tr_b16 a[2:3], v10 offset:1536
  ds_read_b64_tr_b16 a[4:5], v10 offset:3072
  ds_read_b64_tr_b16 a[6:7], v10 offset:4608
  ds_read_b64_tr_b16 a[8:9], v10 offset:6144
  ds_read_b64_tr_b16 a[10:11], v10 offset:7680
  ds_read_b64_tr_b16 a[12:13], v10 offset:9216
  ds_read_b64_tr_b16 a[14:15], v10 offset:10752
  ds_read_b64_tr_b16 a[16:17], v10 offset:12288
  ds_read_b64_tr_b16 a[18:19], v10 offset:13824
  ds_read_b64_tr_b16 a[80:81], v10 offset:32
  ds_read_b64_tr_b16 a[82:83], v10 offset:1568
  ds_read_b64_tr_b16 a[84:85], v10 offset:3104
  ds_read_b64_tr_b16 a[86:87], v10 offset:4640
  ds_read_b64_tr_b16 a[88:89], v10 offset:6176
  ds_read_b64_tr_b16 a[90:91], v10 offset:7712
  ds_read_b64_tr_b16 a[92:93], v10 offset:9248
  ds_read_b64_tr_b16 a[94:95], v10 offset:10784
  ds_read_b64_tr_b16 a[96:97], v10 offset:12320
  ds_read_b64_tr_b16 a[98:99], v10 offset:13856
  ds_read_b64_tr_b16 a[160:161], v10 offset:64
  ds_read_b64_tr_b16 a[162:163], v10 offset:1600
  ds_read_b64_tr_b16 a[164:165], v10 offset:3136
  ds_read_b64_tr_b16 a[166:167], v10 offset:4672
  ds_read_b64_tr_b16 a[168:169], v10 offset:6208
  ds_read_b64_tr_b16 a[170:171], v10 offset:7744
  ds_read_b64_tr_b16 a[172:173], v10 offset:9280
  ds_read_b64_tr_b16 a[174:175], v10 offset:10816
  ds_read_b64_tr_b16 a[176:177], v10 offset:12352
  ds_read_b64_tr_b16 a[178:179], v10 offset:13888
  s_waitcnt lgkmcnt(0)
  s_add_u32 s24, s25, 3932160
  s_add_u32 m0, s21, 0
  s_nop 0
  buffer_load_dwordx4 v120, s[16:19], s24 offen lds
  s_add_u32 m0, s21, 1024
  s_nop 0
  buffer_load_dwordx4 v121, s[16:19], s24 offen lds
  s_add_u32 m0, s21, 2048
  s_nop 0
  buffer_load_dwordx4 v122, s[16:19], s24 offen lds
  s_add_u32 s24, s24, 393216
  s_add_u32 m0, s21, 3072
  s_nop 0
  buffer_load_dwordx4 v120, s[16:19], s24 offen lds
  s_add_u32 m0, s21, 4096
  s_nop 0
  buffer_load_dwordx4 v121, s[16:19], s24 offen lds
  s_add_u32 m0, s21, 5120
  s_nop 0
  buffer_load_dwordx4 v122, s[16:19], s24 offen lds
  s_add_u32 s24, s24, 393216
  s_add_u32 m0, s21, 6144
  s_nop 0
  buffer_load_dwordx4 v120, s[16:19], s24 offen lds
  s_add_u32 m0, s21, 7168
  s_nop 0
  buffer_load_dwordx4 v121, s[16:19], s24 offen lds
  s_add_u32 m0, s21, 8192
  s_nop 0
  buffer_load_dwordx4 v122, s[16:19], s24 offen lds
  s_add_u32 s24, s24, 393216
  s_add_u32 m0, s21, 9216
  s_nop 0
  buffer_load_dwordx4 v120, s[16:19], s24 offen lds
  s_add_u32 m0, s21, 10240
  s_nop 0
  buffer_load_dwordx4 v121, s[16:19], s24 offen lds
  s_add_u32 m0, s21, 11264
  s_nop 0
  buffer_load_dwordx4 v122, s[16:19], s24 offen lds
  s_add_u32 s24, s24, 393216
  s_add_u32 m0, s21, 12288
  s_nop 0
  buffer_load_dwordx4 v120, s[16:19], s24 offen lds
  s_add_u32 m0, s21, 13312
  s_nop 0
  buffer_load_dwordx4 v121, s[16:19], s24 offen lds
  s_add_u32 m0, s21, 14336
  s_nop 0
  buffer_load_dwordx4 v122, s[16:19], s24 offen lds
  s_waitcnt vmcnt(15)
  ds_read_b64_tr_b16 a[20:21], v10 offset:16384
  ds_read_b64_tr_b16 a[22:23], v10 offset:17920
  ds_read_b64_tr_b16 a[24:25], v10 offset:19456
  ds_read_b64_tr_b16 a[26:27], v10 offset:20992
  ds_read_b64_tr_b16 a[28:29], v10 offset:22528
  ds_read_b64_tr_b16 a[30:31], v10 offset:24064
  ds_read_b64_tr_b16 a[32:33], v10 offset:25600
  ds_read_b64_tr_b16 a[34:35], v10 offset:27136
  ds_read_b64_tr_b16 a[36:37], v10 offset:28672
  ds_read_b64_tr_b16 a[38:39], v10 offset:30208
  ds_read_b64_tr_b16 a[100:101], v10 offset:16416
  ds_read_b64_tr_b16 a[102:103], v10 offset:17952
  ds_read_b64_tr_b16 a[104:105], v10 offset:19488
  ds_read_b64_tr_b16 a[106:107], v10 offset:21024
  ds_read_b64_tr_b16 a[108:109], v10 offset:22560
  ds_read_b64_tr_b16 a[110:111], v10 offset:24096
  ds_read_b64_tr_b16 a[112:113], v10 offset:25632
  ds_read_b64_tr_b16 a[114:115], v10 offset:27168
  ds_read_b64_tr_b16 a[116:117], v10 offset:28704
  ds_read_b64_tr_b16 a[118:119], v10 offset:30240
  ds_read_b64_tr_b16 a[180:181], v10 offset:16448
  ds_read_b64_tr_b16 a[182:183], v10 offset:17984
  ds_read_b64_tr_b16 a[184:185], v10 offset:19520
  ds_read_b64_tr_b16 a[186:187], v10 offset:21056
  ds_read_b64_tr_b16 a[188:189], v10 offset:22592
  ds_read_b64_tr_b16 a[190:191], v10 offset:24128
  ds_read_b64_tr_b16 a[192:193], v10 offset:25664
  ds_read_b64_tr_b16 a[194:195], v10 offset:27200
  ds_read_b64_tr_b16 a[196:197], v10 offset:28736
  ds_read_b64_tr_b16 a[198:199], v10 offset:30272
  s_waitcnt lgkmcnt(0)
  s_add_u32 s24, s25, 5898240
  s_add_u32 m0, s21, 16384
  s_nop 0
  buffer_load_dwordx4 v120, s[16:19], s24 offen lds
  s_add_u32 m0, s21, 17408
  s_nop 0
  buffer_load_dwordx4 v121, s[16:19], s24 offen lds
  s_add_u32 m0, s21, 18432
  s_nop 0
  buffer_load_dwordx4 v122, s[16:19], s24 offen lds
  s_add_u32 s24, s24, 393216
  s_add_u32 m0, s21, 19456
  s_nop 0
  buffer_load_dwordx4 v120, s[16:19], s24 offen lds
  s_add_u32 m0, s21, 20480
  s_nop 0
  buffer_load_dwordx4 v121, s[16:19], s24 offen lds
  s_add_u32 m0, s21, 21504
  s_nop 0
  buffer_load_dwordx4 v122, s[16:19], s24 offen lds
  s_add_u32 s24, s24, 393216
  s_add_u32 m0, s21, 22528
  s_nop 0
  buffer_load_dwordx4 v120, s[16:19], s24 offen lds
  s_add_u32 m0, s21, 23552
  s_nop 0
  buffer_load_dwordx4 v121, s[16:19], s24 offen lds
  s_add_u32 m0, s21, 24576
  s_nop 0
  buffer_load_dwordx4 v122, s[16:19], s24 offen lds
  s_add_u32 s24, s24, 393216
  s_add_u32 m0, s21, 25600
  s_nop 0
  buffer_load_dwordx4 v120, s[16:19], s24 offen lds
  s_add_u32 m0, s21, 26624
  s_nop 0
  buffer_load_dwordx4 v121, s[16:19], s24 offen lds
  s_add_u32 m0, s21, 27648
  s_nop 0
  buffer_load_dwordx4 v122, s[16:19], s24 offen lds
  s_add_u32 s24, s24, 393216
  s_add_u32 m0, s21, 28672
  s_nop 0
  buffer_load_dwordx4 v120, s[16:19], s24 offen lds
  s_add_u32 m0, s21, 29696
  s_nop 0
  buffer_load_dwordx4 v121, s[16:19], s24 offen lds
  s_add_u32 m0, s21, 30720
  s_nop 0
  buffer_load_dwordx4 v122, s[16:19], s24 offen lds
  s_waitcnt vmcnt(15)
  ds_read_b64_tr_b16 a[40:41], v10 offset:0
  ds_read_b64_tr_b16 a[42:43], v10 offset:1536
  ds_read_b64_tr_b16 a[44:45], v10 offset:3072
  ds_read_b64_tr_b16 a[46:47], v10 offset:4608
  ds_read_b64_tr_b16 a[48:49], v10 offset:6144
  ds_read_b64_tr_b16 a[50:51], v10 offset:7680
  ds_read_b64_tr_b16 a[52:53], v10 offset:9216
  ds_read_b64_tr_b16 a[54:55], v10 offset:10752
  ds_read_b64_tr_b16 a[56:57], v10 offset:12288
  ds_read_b64_tr_b16 a[58:59], v10 offset:13824
  ds_read_b64_tr_b16 a[120:121], v10 offset:32
  ds_read_b64_tr_b16 a[122:123], v10 offset:1568
  ds_read_b64_tr_b16 a[124:125], v10 offset:3104
  ds_read_b64_tr_b16 a[126:127], v10 offset:4640
  ds_read_b64_tr_b16 a[128:129], v10 offset:6176
  ds_read_b64_tr_b16 a[130:131], v10 offset:7712
  ds_read_b64_tr_b16 a[132:133], v10 offset:9248
  ds_read_b64_tr_b16 a[134:135], v10 offset:10784
  ds_read_b64_tr_b16 a[136:137], v10 offset:12320
  ds_read_b64_tr_b16 a[138:139], v10 offset:13856
  ds_read_b64_tr_b16 a[200:201], v10 offset:64
  ds_read_b64_tr_b16 a[202:203], v10 offset:1600
  ds_read_b64_tr_b16 a[204:205], v10 offset:3136
  ds_read_b64_tr_b16 a[206:207], v10 offset:4672
  ds_read_b64_tr_b16 a[208:209], v10 offset:6208
  ds_read_b64_tr_b16 a[210:211], v10 offset:7744
  ds_read_b64_tr_b16 a[212:213], v10 offset:9280
  ds_read_b64_tr_b16 a[214:215], v10 offset:10816
  ds_read_b64_tr_b16 a[216:217], v10 offset:12352
  ds_read_b64_tr_b16 a[218:219], v10 offset:13888
  s_waitcnt lgkmcnt(0)
  s_waitcnt vmcnt(0)
  ds_read_b64_tr_b16 a[60:61], v10 offset:16384
  ds_read_b64_tr_b16 a[62:63], v10 offset:17920
  ds_read_b64_tr_b16 a[64:65], v10 offset:19456
  ds_read_b64_tr_b16 a[66:67], v10 offset:20992
  ds_read_b64_tr_b16 a[68:69], v10 offset:22528
  ds_read_b64_tr_b16 a[70:71], v10 offset:24064
  ds_read_b64_tr_b16 a[72:73], v10 offset:25600
  ds_read_b64_tr_b16 a[74:75], v10 offset:27136
  ds_read_b64_tr_b16 a[76:77], v10 offset:28672
  ds_read_b64_tr_b16 a[78:79], v10 offset:30208
  ds_read_b64_tr_b16 a[140:141], v10 offset:16416
  ds_read_b64_tr_b16 a[142:143], v10 offset:17952
  ds_read_b64_tr_b16 a[144:145], v10 offset:19488
  ds_read_b64_tr_b16 a[146:147], v10 offset:21024
  ds_read_b64_tr_b16 a[148:149], v10 offset:22560
  ds_read_b64_tr_b16 a[150:151], v10 offset:24096
  ds_read_b64_tr_b16 a[152:153], v10 offset:25632
  ds_read_b64_tr_b16 a[154:155], v10 offset:27168
  ds_read_b64_tr_b16 a[156:157], v10 offset:28704
  ds_read_b64_tr_b16 a[158:159], v10 offset:30240
  ds_read_b64_tr_b16 a[220:221], v10 offset:16448
  ds_read_b64_tr_b16 a[222:223], v10 offset:17984
  ds_read_b64_tr_b16 a[224:225], v10 offset:19520
  ds_read_b64_tr_b16 a[226:227], v10 offset:21056
  ds_read_b64_tr_b16 a[228:229], v10 offset:22592
  ds_read_b64_tr_b16 a[230:231], v10 offset:24128
  ds_read_b64_tr_b16 a[232:233], v10 offset:25664
  ds_read_b64_tr_b16 a[234:235], v10 offset:27200
  ds_read_b64_tr_b16 a[236:237], v10 offset:28736
  ds_read_b64_tr_b16 a[238:239], v10 offset:30272
  s_waitcnt lgkmcnt(0)
  s_waitcnt vmcnt(0)
  s_barrier
  s_or_b32 s22, s80, s5
  s_cmp_eq_u32 s22, 0
  s_cbranch_scc0 XQ_ncal
  s_cmp_eq_u32 s91, 1
  s_cbranch_scc0 XQ_ncal
  v_mov_b32 v236, 237379328
  v_mov_b32 v237, 237387520
  s_mov_b64 exec, 1
  s_mov_b32 s64, -1
  s_mov_b32 s65, -1
  s_waitcnt vmcnt(0)
  s_memtime s[60:61]
  s_waitcnt lgkmcnt(0)
  buffer_store_dword v236, v236, s[8:11], 0 offen sc1
  s_waitcnt vmcnt(0)
  s_memtime s[62:63]
  s_waitcnt lgkmcnt(0)
  s_sub_u32 s62, s62, s60
  s_min_u32 s64, s64, s62
  s_memtime s[60:61]
  s_waitcnt lgkmcnt(0)
  buffer_store_dword v236, v237, s[8:11], 0 offen sc1
  s_waitcnt vmcnt(0)
  s_memtime s[62:63]
  s_waitcnt lgkmcnt(0)
  s_sub_u32 s62, s62, s60
  s_min_u32 s65, s65, s62
  s_memtime s[60:61]
  s_waitcnt lgkmcnt(0)
  buffer_store_dword v236, v236, s[8:11], 0 offen sc1
  s_waitcnt vmcnt(0)
  s_memtime s[62:63]
  s_waitcnt lgkmcnt(0)
  s_sub_u32 s62, s62, s60
  s_min_u32 s64, s64, s62
  s_memtime s[60:61]
  s_waitcnt lgkmcnt(0)
  buffer_store_dword v236, v237, s[8:11], 0 offen sc1
  s_waitcnt vmcnt(0)
  s_memtime s[62:63]
  s_waitcnt lgkmcnt(0)
  s_sub_u32 s62, s62, s60
  s_min_u32 s65, s65, s62
  s_memtime s[60:61]
  s_waitcnt lgkmcnt(0)
  buffer_store_dword v236, v236, s[8:11], 0 offen sc1
  s_waitcnt vmcnt(0)
  s_memtime s[62:63]
  s_waitcnt lgkmcnt(0)
  s_sub_u32 s62, s62, s60
  s_min_u32 s64, s64, s62
  s_memtime s[60:61]
  s_waitcnt lgkmcnt(0)
  buffer_store_dword v236, v237, s[8:11], 0 offen sc1
  s_waitcnt vmcnt(0)
  s_memtime s[62:63]
  s_waitcnt lgkmcnt(0)
  s_sub_u32 s62, s62, s60
  s_min_u32 s65, s65, s62
  s_memtime s[60:61]
  s_waitcnt lgkmcnt(0)
  buffer_store_dword v236, v236, s[8:11], 0 offen sc1
  s_waitcnt vmcnt(0)
  s_memtime s[62:63]
  s_waitcnt lgkmcnt(0)
  s_sub_u32 s62, s62, s60
  s_min_u32 s64, s64, s62
  s_memtime s[60:61]
  s_waitcnt lgkmcnt(0)
  buffer_store_dword v236, v237, s[8:11], 0 offen sc1
  s_waitcnt vmcnt(0)
  s_memtime s[62:63]
  s_waitcnt lgkmcnt(0)
  s_sub_u32 s62, s62, s60
  s_min_u32 s65, s65, s62
  s_memtime s[60:61]
  s_waitcnt lgkmcnt(0)
  buffer_store_dword v236, v236, s[8:11], 0 offen sc1
  s_waitcnt vmcnt(0)
  s_memtime s[62:63]
  s_waitcnt lgkmcnt(0)
  s_sub_u32 s62, s62, s60
  s_min_u32 s64, s64, s62
  s_memtime s[60:61]
  s_waitcnt lgkmcnt(0)
  buffer_store_dword v236, v237, s[8:11], 0 offen sc1
  s_waitcnt vmcnt(0)
  s_memtime s[62:63]
  s_waitcnt lgkmcnt(0)
  s_sub_u32 s62, s62, s60
  s_min_u32 s65, s65, s62
  s_cmp_lt_u32 s65, s64
  s_cselect_b32 s62, 1, 2
  v_mov_b32 v238, s64
  v_mov_b32 v239, s65
  v_lshlrev_b32 v238, 16, v238
  v_or_b32 v237, v238, v239
  v_mov_b32 v239, 228
  buffer_store_dword v237, v239, s[12:15], 0 offen sc1
  v_mov_b32 v238, s62
  v_mov_b32 v239, 224
  buffer_store_dword v238, v239, s[12:15], 0 offen sc1
  s_mov_b64 exec, -1
XQ_ncal:
  v_mov_b32 v240, -1
  v_mov_b32 v241, -1
  v_mov_b32 v242, -1
  v_mov_b32 v243, -1
  s_cmp_eq_u32 s81, 2
  s_cbranch_scc1 XQ_iq
  s_mov_b32 s24, 5242880
  s_mov_b32 s25, 12582912
  s_cmp_eq_u32 s81, 1
  s_cselect_b32 s24, s25, s24
  s_mul_i32 s25, s5, 3072
  s_mul_i32 s26, s91, 768
  s_add_u32 s24, s24, s25
  s_add_u32 s24, s24, s26
  v_add_u32 v245, s24, v5
  s_mov_b32 s56, 98304
  s_mov_b32 s58, -1
  s_mov_b32 s59, 0xffff
  s_branch XQ_id
XQ_iq:
  s_mul_i32 s25, s5, 1280
  s_mul_i32 s26, s91, 320
  s_add_u32 s24, s25, s26
  s_add_u32 s24, s24, 23068672
  v_add_u32 v245, s24, v5
  v_add_u32 v246, 3145408, v245
  v_cmp_le_u32 vcc, 20, v2
  s_nop 1
  v_cndmask_b32 v245, v245, v246, vcc
  s_mov_b32 s56, 40960
  s_mov_b32 s58, -1
  s_mov_b32 s59, 0xff
XQ_id:
  s_mul_i32 s44, s91, 10240
  s_add_u32 s45, s44, 19922944
  s_mov_b32 s40, s82
  s_mov_b32 s42, 0
  s_mov_b32 s24, 75497472
  s_mov_b32 s25, 100663296
  s_mov_b32 s26, 50331648
  s_cmp_eq_u32 s81, 1
  s_cselect_b32 s24, s25, s24
  s_cmp_eq_u32 s81, 2
  s_cselect_b32 s24, s26, s24
  s_mul_i32 s25, s5, 12288
  s_add_u32 s46, s24, s25
  s_mov_b32 s24, 4587520
  s_mov_b32 s25, 4591616
  s_cmp_eq_u32 s81, 2
  s_cselect_b32 s47, s25, s24
  s_mul_i32 s24, s91, 3
  s_lshr_b32 s25, s24, 1
  s_lshl_b32 s25, s25, 10
  s_and_b32 s26, s91, 1
  s_add_u32 s27, s25, 1024
  s_add_u32 s28, s25, 8
  s_cmp_eq_u32 s26, 0
  s_cselect_b32 s48, s25, s27
  s_cselect_b32 s49, s27, s28
  s_mul_i32 s50, s91, 3072
  v_mov_b32 v8, 1
  s_mov_b32 s41, 0
  s_load_dwordx2 s[86:87], s[0:1], 64
  s_load_dwordx2 s[88:89], s[0:1], 72
  s_load_dwordx2 s[96:97], s[0:1], 80
  v_lshlrev_b32 v248, 7, v2
  s_lshl_b32 s29, s5, 2
  s_add_u32 s29, s29, s91
  s_lshl_b32 s29, s29, 13
  v_add_u32 v248, s29, v248
  s_mov_b32 s94, 1966080
  s_mov_b32 s95, 0x00020000
  s_mov_b32 s85, 1000
  s_cmp_eq_u32 s81, 2
  s_cselect_b32 s85, 41, s85
  s_waitcnt lgkmcnt(0)
  s_cmp_eq_u32 s82, 0
  s_cbranch_scc0 XQ_h0p2
  s_cmp_eq_u32 s91, 0
  s_cbranch_scc0 XQ_h0_ok
  v_and_b32 v251, 63, v0
  v_mov_b32 v252, 192
  v_mov_b32 v250, 32
  v_cmp_eq_u32 vcc, 1, v251
  v_mov_b32 v253, 64
  s_nop 0
  v_cndmask_b32 v252, v252, v253, vcc
  v_mov_b32 v253, 128
  v_cndmask_b32 v250, v250, v253, vcc
  s_mov_b64 exec, 3
XQ_h0_w:
  buffer_load_dword v253, v252, s[12:15], 0 offen sc1
  s_waitcnt vmcnt(0)
  v_cmp_gt_u32 vcc, v250, v253
  s_cbranch_vccz XQ_h0_x
  s_sleep 18
  s_add_u32 s41, s41, 64
  s_cmp_lt_u32 s41, 4000000
  s_cbranch_scc1 XQ_h0_w
XQ_h0_x:
  s_mov_b64 exec, -1
XQ_h0_ok:
  s_barrier
  s_branch XQ_h0d
XQ_h0p2:
  s_cmp_eq_u32 s91, 0
  s_cbranch_scc0 XQ_h1_ok
  v_and_b32 v251, 63, v0
  v_mov_b32 v252, 192
  v_mov_b32 v250, 32
  v_cmp_eq_u32 vcc, 1, v251
  v_mov_b32 v253, 196
  s_nop 0
  v_cndmask_b32 v252, v252, v253, vcc
  v_mov_b32 v253, 32
  v_cndmask_b32 v250, v250, v253, vcc
  v_cmp_eq_u32 vcc, 2, v251
  v_mov_b32 v253, 200
  s_nop 0
  v_cndmask_b32 v252, v252, v253, vcc
  v_mov_b32 v253, 32
  v_cndmask_b32 v250, v250, v253, vcc
  v_cmp_eq_u32 vcc, 3, v251
  v_mov_b32 v253, 204
  s_nop 0
  v_cndmask_b32 v252, v252, v253, vcc
  v_mov_b32 v253, 32
  v_cndmask_b32 v250, v250, v253, vcc
  s_mov_b64 exec, 15
XQ_h1_w:
  buffer_load_dword v253, v252, s[12:15], 0 offen sc1
  s_waitcnt vmcnt(0)
  v_cmp_gt_u32 vcc, v250, v253
  s_cbranch_vccz XQ_h1_x
  s_sleep 18
  s_add_u32 s41, s41, 64
  s_cmp_lt_u32 s41, 4000000
  s_cbranch_scc1 XQ_h1_w
XQ_h1_x:
  s_mov_b64 exec, -1
XQ_h1_ok:
  s_barrier
XQ_h0d:
  s_mov_b32 s51, s82
  s_mov_b32 s52, 0
  s_mul_i32 s22, s51, 40960
  s_add_u32 s22, s22, s45
  s_add_u32 s23, s52, s44
  s_mov_b32 m0, s23
  s_nop 0
  buffer_load_dwordx4 v5, s[8:11], s22 offen offset:0 lds
  buffer_load_dwordx4 v5, s[8:11], s22 offen offset:1024 lds
  buffer_load_dwordx4 v5, s[8:11], s22 offen offset:2048 lds
  buffer_load_dwordx4 v5, s[8:11], s22 offen offset:3072 lds
  s_add_u32 s22, s22, 4096
  s_add_u32 s23, s23, 4096
  s_mov_b32 m0, s23
  s_nop 0
  buffer_load_dwordx4 v5, s[8:11], s22 offen offset:0 lds
  buffer_load_dwordx4 v5, s[8:11], s22 offen offset:1024 lds
  buffer_load_dwordx4 v5, s[8:11], s22 offen offset:2048 lds
  buffer_load_dwordx4 v5, s[8:11], s22 offen offset:3072 lds
  s_add_u32 s22, s22, 4096
  s_add_u32 s23, s23, 4096
  s_mov_b32 m0, s23
  s_nop 0
  buffer_load_dwordx4 v5, s[8:11], s22 offen offset:0 lds
  buffer_load_dwordx4 v5, s[8:11], s22 offen offset:1024 lds
  s_add_u32 s51, s82, 1
  s_mov_b32 s52, 40960
  s_mul_i32 s22, s51, 40960
  s_add_u32 s22, s22, s45
  s_add_u32 s23, s52, s44
  s_mov_b32 m0, s23
  s_nop 0
  buffer_load_dwordx4 v5, s[8:11], s22 offen offset:0 lds
  buffer_load_dwordx4 v5, s[8:11], s22 offen offset:1024 lds
  buffer_load_dwordx4 v5, s[8:11], s22 offen offset:2048 lds
  buffer_load_dwordx4 v5, s[8:11], s22 offen offset:3072 lds
  s_add_u32 s22, s22, 4096
  s_add_u32 s23, s23, 4096
  s_mov_b32 m0, s23
  s_nop 0
  buffer_load_dwordx4 v5, s[8:11], s22 offen offset:0 lds
  buffer_load_dwordx4 v5, s[8:11], s22 offen offset:1024 lds
  buffer_load_dwordx4 v5, s[8:11], s22 offen offset:2048 lds
  buffer_load_dwordx4 v5, s[8:11], s22 offen offset:3072 lds
  s_add_u32 s22, s22, 4096
  s_add_u32 s23, s23, 4096
  s_mov_b32 m0, s23
  s_nop 0
  buffer_load_dwordx4 v5, s[8:11], s22 offen offset:0 lds
  buffer_load_dwordx4 v5, s[8:11], s22 offen offset:1024 lds
  s_cmp_eq_u32 s81, 1
  s_cbranch_scc1 XQV_0
XQK_0:
  s_waitcnt vmcnt(10)
  s_barrier
  v_add_u32 v6, s42, v5
  ds_read_b128 v[16:19], v6 offset:0
  ds_read_b128 v[20:23], v6 offset:20480
  ds_read_b128 v[24:27], v6 offset:1024
  ds_read_b128 v[28:31], v6 offset:21504
  ds_read_b128 v[32:35], v6 offset:2048
  ds_read_b128 v[36:39], v6 offset:22528
  ds_read_b128 v[40:43], v6 offset:3072
  ds_read_b128 v[44:47], v6 offset:23552
  s_cmp_eq_u32 s91, 0
  s_cbranch_scc0 XQK_0_s
  s_add_u32 s22, s82, 2
  s_cmp_lt_u32 s40, s22
  s_cbranch_scc1 XQK_0_s
  s_sub_u32 s22, s40, 2
  s_lshl_b32 s22, s22, 6
  s_add_u32 s22, s22, s47
  v_mov_b32 v7, s22
  s_mov_b64 exec, 1
  buffer_atomic_add v8, v7, s[8:11], 0 offen sc1
  s_mov_b64 exec, -1
XQK_0_s:
  s_add_u32 s51, s40, 2
  s_and_b32 s22, s51, 15
  s_cmp_eq_u32 s22, 0
  s_cbranch_scc0 XQK_0_hg
  s_cmp_ge_u32 s51, 64
  s_cbranch_scc1 XQK_0_hg
  s_lshr_b32 s22, s51, 4
  s_lshl_b32 s22, s22, 2
  s_add_u32 s22, s22, 192
  s_cmp_eq_u32 s91, 0
  s_cbranch_scc0 XQK_0_h_ok
  v_mov_b32 v252, s22
XQK_0_h_w:
  buffer_load_dword v253, v252, s[12:15], 0 offen sc1
  s_waitcnt vmcnt(0)
  v_readfirstlane_b32 s57, v253
  s_nop 0
  s_cmp_ge_u32 s57, 32
  s_cbranch_scc1 XQK_0_h_ok
  s_sleep 36
  s_add_u32 s41, s41, 64
  s_cmp_lt_u32 s41, 4000000
  s_cbranch_scc1 XQK_0_h_w
XQK_0_h_ok:
  s_barrier
XQK_0_hg:
  s_sub_u32 s53, s40, 1
  s_mul_i32 s53, s53, 393216
  s_add_u32 s53, s53, s46
  s_add_u32 s54, s53, s48
  s_add_u32 s55, s53, s49
  s_add_u32 s51, s40, 2
  s_sub_u32 s22, s83, 1
  s_cmp_ge_u32 s51, s83
  s_cselect_b32 s51, s22, s51
  s_add_u32 s52, s42, 81920
  s_cmp_ge_u32 s52, 122880
  s_cbranch_scc0 XQK_0_nb
  s_sub_u32 s52, s52, 122880
XQK_0_nb:
  s_mul_i32 s22, s51, 40960
  s_add_u32 s22, s22, s45
  s_add_u32 s23, s52, s44
  s_waitcnt lgkmcnt(7)
  v_mfma_f32_16x16x32_bf16 v[48:51], a[0:3], v[16:19], 0
  v_mfma_f32_16x16x32_bf16 v[56:59], a[80:83], v[16:19], 0
  v_mfma_f32_16x16x32_bf16 v[64:67], a[160:163], v[16:19], 0
  ds_read_b128 v[16:19], v6 offset:4096
  s_waitcnt lgkmcnt(7)
  v_mfma_f32_16x16x32_bf16 v[52:55], a[0:3], v[20:23], 0
  v_mfma_f32_16x16x32_bf16 v[60:63], a[80:83], v[20:23], 0
  v_mfma_f32_16x16x32_bf16 v[68:71], a[160:163], v[20:23], 0
  ds_read_b128 v[20:23], v6 offset:24576
  s_cmp_eq_u32 s40, s82
  s_cbranch_scc1 XQK_0_ne0
  v_cvt_pk_bf16_f32 v96, v72, v73
  v_cvt_pk_bf16_f32 v97, v74, v75
  v_cvt_pk_bf16_f32 v98, v80, v81
  v_cvt_pk_bf16_f32 v99, v82, v83
  v_cvt_pk_bf16_f32 v100, v88, v89
  v_cvt_pk_bf16_f32 v101, v90, v91
  s_bitcmp1_b32 s91, 0
  s_cbranch_scc1 XQ_e8994o
  buffer_store_dwordx4 v[96:99], v5, s[8:11], s54 offen sc1
  buffer_store_dwordx2 v[100:101], v5, s[8:11], s55 offen sc1
  s_branch XQ_e8994d
XQ_e8994o:
  buffer_store_dwordx2 v[96:97], v5, s[8:11], s55 offen sc1
  buffer_store_dwordx4 v[98:101], v5, s[8:11], s54 offen sc1
XQ_e8994d:
XQK_0_ne0:
  s_waitcnt lgkmcnt(7)
  v_mfma_f32_16x16x32_bf16 v[48:51], a[4:7], v[24:27], v[48:51]
  v_mfma_f32_16x16x32_bf16 v[56:59], a[84:87], v[24:27], v[56:59]
  v_mfma_f32_16x16x32_bf16 v[64:67], a[164:167], v[24:27], v[64:67]
  ds_read_b128 v[24:27], v6 offset:5120
  s_waitcnt lgkmcnt(7)
  v_mfma_f32_16x16x32_bf16 v[52:55], a[4:7], v[28:31], v[52:55]
  v_mfma_f32_16x16x32_bf16 v[60:63], a[84:87], v[28:31], v[60:63]
  v_mfma_f32_16x16x32_bf16 v[68:71], a[164:167], v[28:31], v[68:71]
  ds_read_b128 v[28:31], v6 offset:25600
  s_mul_i32 s57, s40, s56
  s_mov_b64 exec, s[58:59]
  buffer_store_dwordx4 v[240:243], v245, s[8:11], s57 offen sc1
  s_mov_b64 exec, -1
  s_sub_u32 s29, s40, s82
  s_sub_u32 s29, s29, s85
  s_cmp_lt_u32 s29, 6
  s_cbranch_scc0 XQK_0_wr
  s_cmp_lt_u32 s29, 2
  s_cselect_b32 s92, s86, s88
  s_cselect_b32 s93, s87, s89
  s_cmp_lt_u32 s29, 4
  s_cselect_b32 s92, s92, s96
  s_cselect_b32 s93, s93, s97
  s_and_b32 s93, s93, 0xffff
  s_and_b32 s29, s29, 1
  s_lshl_b32 s29, s29, 20
  buffer_load_dword v247, v248, s[92:95], s29 offen
XQK_0_wr:
  s_waitcnt lgkmcnt(7)
  v_mfma_f32_16x16x32_bf16 v[48:51], a[8:11], v[32:35], v[48:51]
  v_mfma_f32_16x16x32_bf16 v[56:59], a[88:91], v[32:35], v[56:59]
  v_mfma_f32_16x16x32_bf16 v[64:67], a[168:171], v[32:35], v[64:67]
  ds_read_b128 v[32:35], v6 offset:6144
  s_waitcnt lgkmcnt(7)
  v_mfma_f32_16x16x32_bf16 v[52:55], a[8:11], v[36:39], v[52:55]
  v_mfma_f32_16x16x32_bf16 v[60:63], a[88:91], v[36:39], v[60:63]
  v_mfma_f32_16x16x32_bf16 v[68:71], a[168:171], v[36:39], v[68:71]
  ds_read_b128 v[36:39], v6 offset:26624
  s_waitcnt lgkmcnt(7)
  v_mfma_f32_16x16x32_bf16 v[48:51], a[12:15], v[40:43], v[48:51]
  v_mfma_f32_16x16x32_bf16 v[56:59], a[92:95], v[40:43], v[56:59]
  v_mfma_f32_16x16x32_bf16 v[64:67], a[172:175], v[40:43], v[64:67]
  ds_read_b128 v[40:43], v6 offset:7168
  s_waitcnt lgkmcnt(7)
  v_mfma_f32_16x16x32_bf16 v[52:55], a[12:15], v[44:47], v[52:55]
  v_mfma_f32_16x16x32_bf16 v[60:63], a[92:95], v[44:47], v[60:63]
  v_mfma_f32_16x16x32_bf16 v[68:71], a[172:175], v[44:47], v[68:71]
  ds_read_b128 v[44:47], v6 offset:27648
  s_cmp_eq_u32 s40, s82
  s_cbranch_scc1 XQK_0_ne1
  v_cvt_pk_bf16_f32 v102, v76, v77
  v_cvt_pk_bf16_f32 v103, v78, v79
  v_cvt_pk_bf16_f32 v104, v84, v85
  v_cvt_pk_bf16_f32 v105, v86, v87
  v_cvt_pk_bf16_f32 v106, v92, v93
  v_cvt_pk_bf16_f32 v107, v94, v95
  s_add_u32 s54, s54, 6144
  s_add_u32 s55, s55, 6144
  s_bitcmp1_b32 s91, 0
  s_cbranch_scc1 XQ_e9061o
  buffer_store_dwordx4 v[102:105], v5, s[8:11], s54 offen sc1
  buffer_store_dwordx2 v[106:107], v5, s[8:11], s55 offen sc1
  s_branch XQ_e9061d
XQ_e9061o:
  buffer_store_dwordx2 v[102:103], v5, s[8:11], s55 offen sc1
  buffer_store_dwordx4 v[104:107], v5, s[8:11], s54 offen sc1
XQ_e9061d:
XQK_0_ne1:
  s_waitcnt lgkmcnt(7)
  v_mfma_f32_16x16x32_bf16 v[48:51], a[16:19], v[16:19], v[48:51]
  v_mfma_f32_16x16x32_bf16 v[56:59], a[96:99], v[16:19], v[56:59]
  v_mfma_f32_16x16x32_bf16 v[64:67], a[176:179], v[16:19], v[64:67]
  ds_read_b128 v[16:19], v6 offset:8192
  s_waitcnt lgkmcnt(7)
  v_mfma_f32_16x16x32_bf16 v[52:55], a[16:19], v[20:23], v[52:55]
  v_mfma_f32_16x16x32_bf16 v[60:63], a[96:99], v[20:23], v[60:63]
  v_mfma_f32_16x16x32_bf16 v[68:71], a[176:179], v[20:23], v[68:71]
  ds_read_b128 v[20:23], v6 offset:28672
  s_waitcnt lgkmcnt(7)
  v_mfma_f32_16x16x32_bf16 v[48:51], a[20:23], v[24:27], v[48:51]
  v_mfma_f32_16x16x32_bf16 v[56:59], a[100:103], v[24:27], v[56:59]
  v_mfma_f32_16x16x32_bf16 v[64:67], a[180:183], v[24:27], v[64:67]
  ds_read_b128 v[24:27], v6 offset:9216
  s_waitcnt lgkmcnt(7)
  v_mfma_f32_16x16x32_bf16 v[52:55], a[20:23], v[28:31], v[52:55]
  v_mfma_f32_16x16x32_bf16 v[60:63], a[100:103], v[28:31], v[60:63]
  v_mfma_f32_16x16x32_bf16 v[68:71], a[180:183], v[28:31], v[68:71]
  ds_read_b128 v[28:31], v6 offset:29696
  s_mov_b32 m0, s23
  s_nop 0
  buffer_load_dwordx4 v5, s[8:11], s22 offen offset:0 lds
  s_waitcnt lgkmcnt(7)
  v_mfma_f32_16x16x32_bf16 v[48:51], a[24:27], v[32:35], v[48:51]
  v_mfma_f32_16x16x32_bf16 v[56:59], a[104:107], v[32:35], v[56:59]
  v_mfma_f32_16x16x32_bf16 v[64:67], a[184:187], v[32:35], v[64:67]
  ds_read_b128 v[32:35], v6 offset:10240
  s_waitcnt lgkmcnt(7)
  v_mfma_f32_16x16x32_bf16 v[52:55], a[24:27], v[36:39], v[52:55]
  v_mfma_f32_16x16x32_bf16 v[60:63], a[104:107], v[36:39], v[60:63]
  v_mfma_f32_16x16x32_bf16 v[68:71], a[184:187], v[36:39], v[68:71]
  ds_read_b128 v[36:39], v6 offset:30720
  s_waitcnt lgkmcnt(7)
  v_mfma_f32_16x16x32_bf16 v[48:51], a[28:31], v[40:43], v[48:51]
  v_mfma_f32_16x16x32_bf16 v[56:59], a[108:111], v[40:43], v[56:59]
  v_mfma_f32_16x16x32_bf16 v[64:67], a[188:191], v[40:43], v[64:67]
  ds_read_b128 v[40:43], v6 offset:11264
  buffer_load_dwordx4 v5, s[8:11], s22 offen offset:1024 lds
  s_waitcnt lgkmcnt(7)
  v_mfma_f32_16x16x32_bf16 v[52:55], a[28:31], v[44:47], v[52:55]
  v_mfma_f32_16x16x32_bf16 v[60:63], a[108:111], v[44:47], v[60:63]
  v_mfma_f32_16x16x32_bf16 v[68:71], a[188:191], v[44:47], v[68:71]
  ds_read_b128 v[44:47], v6 offset:31744
  s_waitcnt lgkmcnt(7)
  v_mfma_f32_16x16x32_bf16 v[48:51], a[32:35], v[16:19], v[48:51]
  v_mfma_f32_16x16x32_bf16 v[56:59], a[112:115], v[16:19], v[56:59]
  v_mfma_f32_16x16x32_bf16 v[64:67], a[192:195], v[16:19], v[64:67]
  ds_read_b128 v[16:19], v6 offset:12288
  s_waitcnt lgkmcnt(7)
  v_mfma_f32_16x16x32_bf16 v[52:55], a[32:35], v[20:23], v[52:55]
  v_mfma_f32_16x16x32_bf16 v[60:63], a[112:115], v[20:23], v[60:63]
  v_mfma_f32_16x16x32_bf16 v[68:71], a[192:195], v[20:23], v[68:71]
  ds_read_b128 v[20:23], v6 offset:32768
  buffer_load_dwordx4 v5, s[8:11], s22 offen offset:2048 lds
  s_waitcnt lgkmcnt(7)
  v_mfma_f32_16x16x32_bf16 v[48:51], a[36:39], v[24:27], v[48:51]
  v_mfma_f32_16x16x32_bf16 v[56:59], a[116:119], v[24:27], v[56:59]
  v_mfma_f32_16x16x32_bf16 v[64:67], a[196:199], v[24:27], v[64:67]
  ds_read_b128 v[24:27], v6 offset:13312
  s_waitcnt lgkmcnt(7)
  v_mfma_f32_16x16x32_bf16 v[52:55], a[36:39], v[28:31], v[52:55]
  v_mfma_f32_16x16x32_bf16 v[60:63], a[116:119], v[28:31], v[60:63]
  v_mfma_f32_16x16x32_bf16 v[68:71], a[196:199], v[28:31], v[68:71]
  ds_read_b128 v[28:31], v6 offset:33792
  s_waitcnt lgkmcnt(7)
  v_mfma_f32_16x16x32_bf16 v[48:51], a[40:43], v[32:35], v[48:51]
  v_mfma_f32_16x16x32_bf16 v[56:59], a[120:123], v[32:35], v[56:59]
  v_mfma_f32_16x16x32_bf16 v[64:67], a[200:203], v[32:35], v[64:67]
  ds_read_b128 v[32:35], v6 offset:14336
  buffer_load_dwordx4 v5, s[8:11], s22 offen offset:3072 lds
  s_waitcnt lgkmcnt(7)
  v_mfma_f32_16x16x32_bf16 v[52:55], a[40:43], v[36:39], v[52:55]
  v_mfma_f32_16x16x32_bf16 v[60:63], a[120:123], v[36:39], v[60:63]
  v_mfma_f32_16x16x32_bf16 v[68:71], a[200:203], v[36:39], v[68:71]
  ds_read_b128 v[36:39], v6 offset:34816
  s_waitcnt lgkmcnt(7)
  v_mfma_f32_16x16x32_bf16 v[48:51], a[44:47], v[40:43], v[48:51]
  v_mfma_f32_16x16x32_bf16 v[56:59], a[124:127], v[40:43], v[56:59]
  v_mfma_f32_16x16x32_bf16 v[64:67], a[204:207], v[40:43], v[64:67]
  ds_read_b128 v[40:43], v6 offset:15360
  s_waitcnt lgkmcnt(7)
  v_mfma_f32_16x16x32_bf16 v[52:55], a[44:47], v[44:47], v[52:55]
  v_mfma_f32_16x16x32_bf16 v[60:63], a[124:127], v[44:47], v[60:63]
  v_mfma_f32_16x16x32_bf16 v[68:71], a[204:207], v[44:47], v[68:71]
  ds_read_b128 v[44:47], v6 offset:35840
  s_add_u32 s22, s22, 4096
  s_add_u32 s23, s23, 4096
  s_mov_b32 m0, s23
  s_nop 0
  buffer_load_dwordx4 v5, s[8:11], s22 offen offset:0 lds
  s_waitcnt lgkmcnt(7)
  v_mfma_f32_16x16x32_bf16 v[48:51], a[48:51], v[16:19], v[48:51]
  v_mfma_f32_16x16x32_bf16 v[56:59], a[128:131], v[16:19], v[56:59]
  v_mfma_f32_16x16x32_bf16 v[64:67], a[208:211], v[16:19], v[64:67]
  ds_read_b128 v[16:19], v6 offset:16384
  s_waitcnt lgkmcnt(7)
  v_mfma_f32_16x16x32_bf16 v[52:55], a[48:51], v[20:23], v[52:55]
  v_mfma_f32_16x16x32_bf16 v[60:63], a[128:131], v[20:23], v[60:63]
  v_mfma_f32_16x16x32_bf16 v[68:71], a[208:211], v[20:23], v[68:71]
  ds_read_b128 v[20:23], v6 offset:36864
  s_waitcnt lgkmcnt(7)
  v_mfma_f32_16x16x32_bf16 v[48:51], a[52:55], v[24:27], v[48:51]
  v_mfma_f32_16x16x32_bf16 v[56:59], a[132:135], v[24:27], v[56:59]
  v_mfma_f32_16x16x32_bf16 v[64:67], a[212:215], v[24:27], v[64:67]
  ds_read_b128 v[24:27], v6 offset:17408
  buffer_load_dwordx4 v5, s[8:11], s22 offen offset:1024 lds
  s_waitcnt lgkmcnt(7)
  v_mfma_f32_16x16x32_bf16 v[52:55], a[52:55], v[28:31], v[52:55]
  v_mfma_f32_16x16x32_bf16 v[60:63], a[132:135], v[28:31], v[60:63]
  v_mfma_f32_16x16x32_bf16 v[68:71], a[212:215], v[28:31], v[68:71]
  ds_read_b128 v[28:31], v6 offset:37888
  s_waitcnt lgkmcnt(7)
  v_mfma_f32_16x16x32_bf16 v[48:51], a[56:59], v[32:35], v[48:51]
  v_mfma_f32_16x16x32_bf16 v[56:59], a[136:139], v[32:35], v[56:59]
  v_mfma_f32_16x16x32_bf16 v[64:67], a[216:219], v[32:35], v[64:67]
  ds_read_b128 v[32:35], v6 offset:18432
  s_waitcnt lgkmcnt(7)
  v_mfma_f32_16x16x32_bf16 v[52:55], a[56:59], v[36:39], v[52:55]
  v_mfma_f32_16x16x32_bf16 v[60:63], a[136:139], v[36:39], v[60:63]
  v_mfma_f32_16x16x32_bf16 v[68:71], a[216:219], v[36:39], v[68:71]
  ds_read_b128 v[36:39], v6 offset:38912
  buffer_load_dwordx4 v5, s[8:11], s22 offen offset:2048 lds
  s_waitcnt lgkmcnt(7)
  v_mfma_f32_16x16x32_bf16 v[48:51], a[60:63], v[40:43], v[48:51]
  v_mfma_f32_16x16x32_bf16 v[56:59], a[140:143], v[40:43], v[56:59]
  v_mfma_f32_16x16x32_bf16 v[64:67], a[220:223], v[40:43], v[64:67]
  ds_read_b128 v[40:43], v6 offset:19456
  s_waitcnt lgkmcnt(7)
  v_mfma_f32_16x16x32_bf16 v[52:55], a[60:63], v[44:47], v[52:55]
  v_mfma_f32_16x16x32_bf16 v[60:63], a[140:143], v[44:47], v[60:63]
  v_mfma_f32_16x16x32_bf16 v[68:71], a[220:223], v[44:47], v[68:71]
  ds_read_b128 v[44:47], v6 offset:39936
  s_waitcnt lgkmcnt(7)
  v_mfma_f32_16x16x32_bf16 v[48:51], a[64:67], v[16:19], v[48:51]
  v_mfma_f32_16x16x32_bf16 v[56:59], a[144:147], v[16:19], v[56:59]
  v_mfma_f32_16x16x32_bf16 v[64:67], a[224:227], v[16:19], v[64:67]
  buffer_load_dwordx4 v5, s[8:11], s22 offen offset:3072 lds
  s_waitcnt lgkmcnt(6)
  v_mfma_f32_16x16x32_bf16 v[52:55], a[64:67], v[20:23], v[52:55]
  v_mfma_f32_16x16x32_bf16 v[60:63], a[144:147], v[20:23], v[60:63]
  v_mfma_f32_16x16x32_bf16 v[68:71], a[224:227], v[20:23], v[68:71]
  s_waitcnt lgkmcnt(5)
  v_mfma_f32_16x16x32_bf16 v[48:51], a[68:71], v[24:27], v[48:51]
  v_mfma_f32_16x16x32_bf16 v[56:59], a[148:151], v[24:27], v[56:59]
  v_mfma_f32_16x16x32_bf16 v[64:67], a[228:231], v[24:27], v[64:67]
  s_waitcnt lgkmcnt(4)
  v_mfma_f32_16x16x32_bf16 v[52:55], a[68:71], v[28:31], v[52:55]
  v_mfma_f32_16x16x32_bf16 v[60:63], a[148:151], v[28:31], v[60:63]
  v_mfma_f32_16x16x32_bf16 v[68:71], a[228:231], v[28:31], v[68:71]
  s_add_u32 s22, s22, 4096
  s_add_u32 s23, s23, 4096
  s_mov_b32 m0, s23
  s_nop 0
  buffer_load_dwordx4 v5, s[8:11], s22 offen offset:0 lds
  s_waitcnt lgkmcnt(3)
  v_mfma_f32_16x16x32_bf16 v[48:51], a[72:75], v[32:35], v[48:51]
  v_mfma_f32_16x16x32_bf16 v[56:59], a[152:155], v[32:35], v[56:59]
  v_mfma_f32_16x16x32_bf16 v[64:67], a[232:235], v[32:35], v[64:67]
  s_waitcnt lgkmcnt(2)
  v_mfma_f32_16x16x32_bf16 v[52:55], a[72:75], v[36:39], v[52:55]
  v_mfma_f32_16x16x32_bf16 v[60:63], a[152:155], v[36:39], v[60:63]
  v_mfma_f32_16x16x32_bf16 v[68:71], a[232:235], v[36:39], v[68:71]
  s_waitcnt lgkmcnt(1)
  v_mfma_f32_16x16x32_bf16 v[48:51], a[76:79], v[40:43], v[48:51]
  v_mfma_f32_16x16x32_bf16 v[56:59], a[156:159], v[40:43], v[56:59]
  v_mfma_f32_16x16x32_bf16 v[64:67], a[236:239], v[40:43], v[64:67]
  buffer_load_dwordx4 v5, s[8:11], s22 offen offset:1024 lds
  s_waitcnt lgkmcnt(0)
  v_mfma_f32_16x16x32_bf16 v[52:55], a[76:79], v[44:47], v[52:55]
  v_mfma_f32_16x16x32_bf16 v[60:63], a[156:159], v[44:47], v[60:63]
  v_mfma_f32_16x16x32_bf16 v[68:71], a[236:239], v[44:47], v[68:71]
  s_add_u32 s40, s40, 1
  s_add_u32 s42, s42, 40960
  s_cmp_ge_u32 s42, 122880
  s_cbranch_scc0 XQK_0_nc
  s_mov_b32 s42, 0
XQK_0_nc:
XQK_1:
  s_waitcnt vmcnt(10)
  s_barrier
  v_add_u32 v6, s42, v5
  ds_read_b128 v[16:19], v6 offset:0
  ds_read_b128 v[20:23], v6 offset:20480
  ds_read_b128 v[24:27], v6 offset:1024
  ds_read_b128 v[28:31], v6 offset:21504
  ds_read_b128 v[32:35], v6 offset:2048
  ds_read_b128 v[36:39], v6 offset:22528
  ds_read_b128 v[40:43], v6 offset:3072
  ds_read_b128 v[44:47], v6 offset:23552
  s_cmp_eq_u32 s91, 0
  s_cbranch_scc0 XQK_1_s
  s_add_u32 s22, s82, 2
  s_cmp_lt_u32 s40, s22
  s_cbranch_scc1 XQK_1_s
  s_sub_u32 s22, s40, 2
  s_lshl_b32 s22, s22, 6
  s_add_u32 s22, s22, s47
  v_mov_b32 v7, s22
  s_mov_b64 exec, 1
  buffer_atomic_add v8, v7, s[8:11], 0 offen sc1
  s_mov_b64 exec, -1
XQK_1_s:
  s_sub_u32 s53, s40, 1
  s_mul_i32 s53, s53, 393216
  s_add_u32 s53, s53, s46
  s_add_u32 s54, s53, s48
  s_add_u32 s55, s53, s49
  s_add_u32 s51, s40, 2
  s_sub_u32 s22, s83, 1
  s_cmp_ge_u32 s51, s83
  s_cselect_b32 s51, s22, s51
  s_add_u32 s52, s42, 81920
  s_cmp_ge_u32 s52, 122880
  s_cbranch_scc0 XQK_1_nb
  s_sub_u32 s52, s52, 122880
XQK_1_nb:
  s_mul_i32 s22, s51, 40960
  s_add_u32 s22, s22, s45
  s_add_u32 s23, s52, s44
  s_waitcnt lgkmcnt(7)
  v_mfma_f32_16x16x32_bf16 v[72:75], a[0:3], v[16:19], 0
  v_mfma_f32_16x16x32_bf16 v[80:83], a[80:83], v[16:19], 0
  v_mfma_f32_16x16x32_bf16 v[88:91], a[160:163], v[16:19], 0
  ds_read_b128 v[16:19], v6 offset:4096
  s_waitcnt lgkmcnt(7)
  v_mfma_f32_16x16x32_bf16 v[76:79], a[0:3], v[20:23], 0
  v_mfma_f32_16x16x32_bf16 v[84:87], a[80:83], v[20:23], 0
  v_mfma_f32_16x16x32_bf16 v[92:95], a[160:163], v[20:23], 0
  ds_read_b128 v[20:23], v6 offset:24576
  s_cmp_eq_u32 s40, s82
  s_cbranch_scc1 XQK_1_ne0
  v_cvt_pk_bf16_f32 v96, v48, v49
  v_cvt_pk_bf16_f32 v97, v50, v51
  v_cvt_pk_bf16_f32 v98, v56, v57
  v_cvt_pk_bf16_f32 v99, v58, v59
  v_cvt_pk_bf16_f32 v100, v64, v65
  v_cvt_pk_bf16_f32 v101, v66, v67
  s_bitcmp1_b32 s91, 0
  s_cbranch_scc1 XQ_e9308o
  buffer_store_dwordx4 v[96:99], v5, s[8:11], s54 offen sc1
  buffer_store_dwordx2 v[100:101], v5, s[8:11], s55 offen sc1
  s_branch XQ_e9308d
XQ_e9308o:
  buffer_store_dwordx2 v[96:97], v5, s[8:11], s55 offen sc1
  buffer_store_dwordx4 v[98:101], v5, s[8:11], s54 offen sc1
XQ_e9308d:
XQK_1_ne0:
  s_waitcnt lgkmcnt(7)
  v_mfma_f32_16x16x32_bf16 v[72:75], a[4:7], v[24:27], v[72:75]
  v_mfma_f32_16x16x32_bf16 v[80:83], a[84:87], v[24:27], v[80:83]
  v_mfma_f32_16x16x32_bf16 v[88:91], a[164:167], v[24:27], v[88:91]
  ds_read_b128 v[24:27], v6 offset:5120
  s_waitcnt lgkmcnt(7)
  v_mfma_f32_16x16x32_bf16 v[76:79], a[4:7], v[28:31], v[76:79]
  v_mfma_f32_16x16x32_bf16 v[84:87], a[84:87], v[28:31], v[84:87]
  v_mfma_f32_16x16x32_bf16 v[92:95], a[164:167], v[28:31], v[92:95]
  ds_read_b128 v[28:31], v6 offset:25600
  s_mul_i32 s57, s40, s56
  s_mov_b64 exec, s[58:59]
  buffer_store_dwordx4 v[240:243], v245, s[8:11], s57 offen sc1
  s_mov_b64 exec, -1
  s_sub_u32 s29, s40, s82
  s_sub_u32 s29, s29, s85
  s_cmp_lt_u32 s29, 6
  s_cbranch_scc0 XQK_1_wr
  s_cmp_lt_u32 s29, 2
  s_cselect_b32 s92, s86, s88
  s_cselect_b32 s93, s87, s89
  s_cmp_lt_u32 s29, 4
  s_cselect_b32 s92, s92, s96
  s_cselect_b32 s93, s93, s97
  s_and_b32 s93, s93, 0xffff
  s_and_b32 s29, s29, 1
  s_lshl_b32 s29, s29, 20
  buffer_load_dword v247, v248, s[92:95], s29 offen
XQK_1_wr:
  s_waitcnt lgkmcnt(7)
  v_mfma_f32_16x16x32_bf16 v[72:75], a[8:11], v[32:35], v[72:75]
  v_mfma_f32_16x16x32_bf16 v[80:83], a[88:91], v[32:35], v[80:83]
  v_mfma_f32_16x16x32_bf16 v[88:91], a[168:171], v[32:35], v[88:91]
  ds_read_b128 v[32:35], v6 offset:6144
  s_waitcnt lgkmcnt(7)
  v_mfma_f32_16x16x32_bf16 v[76:79], a[8:11], v[36:39], v[76:79]
  v_mfma_f32_16x16x32_bf16 v[84:87], a[88:91], v[36:39], v[84:87]
  v_mfma_f32_16x16x32_bf16 v[92:95], a[168:171], v[36:39], v[92:95]
  ds_read_b128 v[36:39], v6 offset:26624
  s_waitcnt lgkmcnt(7)
  v_mfma_f32_16x16x32_bf16 v[72:75], a[12:15], v[40:43], v[72:75]
  v_mfma_f32_16x16x32_bf16 v[80:83], a[92:95], v[40:43], v[80:83]
  v_mfma_f32_16x16x32_bf16 v[88:91], a[172:175], v[40:43], v[88:91]
  ds_read_b128 v[40:43], v6 offset:7168
  s_waitcnt lgkmcnt(7)
  v_mfma_f32_16x16x32_bf16 v[76:79], a[12:15], v[44:47], v[76:79]
  v_mfma_f32_16x16x32_bf16 v[84:87], a[92:95], v[44:47], v[84:87]
  v_mfma_f32_16x16x32_bf16 v[92:95], a[172:175], v[44:47], v[92:95]
  ds_read_b128 v[44:47], v6 offset:27648
  s_cmp_eq_u32 s40, s82
  s_cbranch_scc1 XQK_1_ne1
  v_cvt_pk_bf16_f32 v102, v52, v53
  v_cvt_pk_bf16_f32 v103, v54, v55
  v_cvt_pk_bf16_f32 v104, v60, v61
  v_cvt_pk_bf16_f32 v105, v62, v63
  v_cvt_pk_bf16_f32 v106, v68, v69
  v_cvt_pk_bf16_f32 v107, v70, v71
  s_add_u32 s54, s54, 6144
  s_add_u32 s55, s55, 6144
  s_bitcmp1_b32 s91, 0
  s_cbranch_scc1 XQ_e9375o
  buffer_store_dwordx4 v[102:105], v5, s[8:11], s54 offen sc1
  buffer_store_dwordx2 v[106:107], v5, s[8:11], s55 offen sc1
  s_branch XQ_e9375d
XQ_e9375o:
  buffer_store_dwordx2 v[102:103], v5, s[8:11], s55 offen sc1
  buffer_store_dwordx4 v[104:107], v5, s[8:11], s54 offen sc1
XQ_e9375d:
XQK_1_ne1:
  s_waitcnt lgkmcnt(7)
  v_mfma_f32_16x16x32_bf16 v[72:75], a[16:19], v[16:19], v[72:75]
  v_mfma_f32_16x16x32_bf16 v[80:83], a[96:99], v[16:19], v[80:83]
  v_mfma_f32_16x16x32_bf16 v[88:91], a[176:179], v[16:19], v[88:91]
  ds_read_b128 v[16:19], v6 offset:8192
  s_waitcnt lgkmcnt(7)
  v_mfma_f32_16x16x32_bf16 v[76:79], a[16:19], v[20:23], v[76:79]
  v_mfma_f32_16x16x32_bf16 v[84:87], a[96:99], v[20:23], v[84:87]
  v_mfma_f32_16x16x32_bf16 v[92:95], a[176:179], v[20:23], v[92:95]
  ds_read_b128 v[20:23], v6 offset:28672
  s_waitcnt lgkmcnt(7)
  v_mfma_f32_16x16x32_bf16 v[72:75], a[20:23], v[24:27], v[72:75]
  v_mfma_f32_16x16x32_bf16 v[80:83], a[100:103], v[24:27], v[80:83]
  v_mfma_f32_16x16x32_bf16 v[88:91], a[180:183], v[24:27], v[88:91]
  ds_read_b128 v[24:27], v6 offset:9216
  s_waitcnt lgkmcnt(7)
  v_mfma_f32_16x16x32_bf16 v[76:79], a[20:23], v[28:31], v[76:79]
  v_mfma_f32_16x16x32_bf16 v[84:87], a[100:103], v[28:31], v[84:87]
  v_mfma_f32_16x16x32_bf16 v[92:95], a[180:183], v[28:31], v[92:95]
  ds_read_b128 v[28:31], v6 offset:29696
  s_mov_b32 m0, s23
  s_nop 0
  buffer_load_dwordx4 v5, s[8:11], s22 offen offset:0 lds
  s_waitcnt lgkmcnt(7)
  v_mfma_f32_16x16x32_bf16 v[72:75], a[24:27], v[32:35], v[72:75]
  v_mfma_f32_16x16x32_bf16 v[80:83], a[104:107], v[32:35], v[80:83]
  v_mfma_f32_16x16x32_bf16 v[88:91], a[184:187], v[32:35], v[88:91]
  ds_read_b128 v[32:35], v6 offset:10240
  s_waitcnt lgkmcnt(7)
  v_mfma_f32_16x16x32_bf16 v[76:79], a[24:27], v[36:39], v[76:79]
  v_mfma_f32_16x16x32_bf16 v[84:87], a[104:107], v[36:39], v[84:87]
  v_mfma_f32_16x16x32_bf16 v[92:95], a[184:187], v[36:39], v[92:95]
  ds_read_b128 v[36:39], v6 offset:30720
  s_waitcnt lgkmcnt(7)
  v_mfma_f32_16x16x32_bf16 v[72:75], a[28:31], v[40:43], v[72:75]
  v_mfma_f32_16x16x32_bf16 v[80:83], a[108:111], v[40:43], v[80:83]
  v_mfma_f32_16x16x32_bf16 v[88:91], a[188:191], v[40:43], v[88:91]
  ds_read_b128 v[40:43], v6 offset:11264
  buffer_load_dwordx4 v5, s[8:11], s22 offen offset:1024 lds
  s_waitcnt lgkmcnt(7)
  v_mfma_f32_16x16x32_bf16 v[76:79], a[28:31], v[44:47], v[76:79]
  v_mfma_f32_16x16x32_bf16 v[84:87], a[108:111], v[44:47], v[84:87]
  v_mfma_f32_16x16x32_bf16 v[92:95], a[188:191], v[44:47], v[92:95]
  ds_read_b128 v[44:47], v6 offset:31744
  s_waitcnt lgkmcnt(7)
  v_mfma_f32_16x16x32_bf16 v[72:75], a[32:35], v[16:19], v[72:75]
  v_mfma_f32_16x16x32_bf16 v[80:83], a[112:115], v[16:19], v[80:83]
  v_mfma_f32_16x16x32_bf16 v[88:91], a[192:195], v[16:19], v[88:91]
  ds_read_b128 v[16:19], v6 offset:12288
  s_waitcnt lgkmcnt(7)
  v_mfma_f32_16x16x32_bf16 v[76:79], a[32:35], v[20:23], v[76:79]
  v_mfma_f32_16x16x32_bf16 v[84:87], a[112:115], v[20:23], v[84:87]
  v_mfma_f32_16x16x32_bf16 v[92:95], a[192:195], v[20:23], v[92:95]
  ds_read_b128 v[20:23], v6 offset:32768
  buffer_load_dwordx4 v5, s[8:11], s22 offen offset:2048 lds
  s_waitcnt lgkmcnt(7)
  v_mfma_f32_16x16x32_bf16 v[72:75], a[36:39], v[24:27], v[72:75]
  v_mfma_f32_16x16x32_bf16 v[80:83], a[116:119], v[24:27], v[80:83]
  v_mfma_f32_16x16x32_bf16 v[88:91], a[196:199], v[24:27], v[88:91]
  ds_read_b128 v[24:27], v6 offset:13312
  s_waitcnt lgkmcnt(7)
  v_mfma_f32_16x16x32_bf16 v[76:79], a[36:39], v[28:31], v[76:79]
  v_mfma_f32_16x16x32_bf16 v[84:87], a[116:119], v[28:31], v[84:87]
  v_mfma_f32_16x16x32_bf16 v[92:95], a[196:199], v[28:31], v[92:95]
  ds_read_b128 v[28:31], v6 offset:33792
  s_waitcnt lgkmcnt(7)
  v_mfma_f32_16x16x32_bf16 v[72:75], a[40:43], v[32:35], v[72:75]
  v_mfma_f32_16x16x32_bf16 v[80:83], a[120:123], v[32:35], v[80:83]
  v_mfma_f32_16x16x32_bf16 v[88:91], a[200:203], v[32:35], v[88:91]
  ds_read_b128 v[32:35], v6 offset:14336
  buffer_load_dwordx4 v5, s[8:11], s22 offen offset:3072 lds
  s_waitcnt lgkmcnt(7)
  v_mfma_f32_16x16x32_bf16 v[76:79], a[40:43], v[36:39], v[76:79]
  v_mfma_f32_16x16x32_bf16 v[84:87], a[120:123], v[36:39], v[84:87]
  v_mfma_f32_16x16x32_bf16 v[92:95], a[200:203], v[36:39], v[92:95]
  ds_read_b128 v[36:39], v6 offset:34816
  s_waitcnt lgkmcnt(7)
  v_mfma_f32_16x16x32_bf16 v[72:75], a[44:47], v[40:43], v[72:75]
  v_mfma_f32_16x16x32_bf16 v[80:83], a[124:127], v[40:43], v[80:83]
  v_mfma_f32_16x16x32_bf16 v[88:91], a[204:207], v[40:43], v[88:91]
  ds_read_b128 v[40:43], v6 offset:15360
  s_waitcnt lgkmcnt(7)
  v_mfma_f32_16x16x32_bf16 v[76:79], a[44:47], v[44:47], v[76:79]
  v_mfma_f32_16x16x32_bf16 v[84:87], a[124:127], v[44:47], v[84:87]
  v_mfma_f32_16x16x32_bf16 v[92:95], a[204:207], v[44:47], v[92:95]
  ds_read_b128 v[44:47], v6 offset:35840
  s_add_u32 s22, s22, 4096
  s_add_u32 s23, s23, 4096
  s_mov_b32 m0, s23
  s_nop 0
  buffer_load_dwordx4 v5, s[8:11], s22 offen offset:0 lds
  s_waitcnt lgkmcnt(7)
  v_mfma_f32_16x16x32_bf16 v[72:75], a[48:51], v[16:19], v[72:75]
  v_mfma_f32_16x16x32_bf16 v[80:83], a[128:131], v[16:19], v[80:83]
  v_mfma_f32_16x16x32_bf16 v[88:91], a[208:211], v[16:19], v[88:91]
  ds_read_b128 v[16:19], v6 offset:16384
  s_waitcnt lgkmcnt(7)
  v_mfma_f32_16x16x32_bf16 v[76:79], a[48:51], v[20:23], v[76:79]
  v_mfma_f32_16x16x32_bf16 v[84:87], a[128:131], v[20:23], v[84:87]
  v_mfma_f32_16x16x32_bf16 v[92:95], a[208:211], v[20:23], v[92:95]
  ds_read_b128 v[20:23], v6 offset:36864
  s_waitcnt lgkmcnt(7)
  v_mfma_f32_16x16x32_bf16 v[72:75], a[52:55], v[24:27], v[72:75]
  v_mfma_f32_16x16x32_bf16 v[80:83], a[132:135], v[24:27], v[80:83]
  v_mfma_f32_16x16x32_bf16 v[88:91], a[212:215], v[24:27], v[88:91]
  ds_read_b128 v[24:27], v6 offset:17408
  buffer_load_dwordx4 v5, s[8:11], s22 offen offset:1024 lds
  s_waitcnt lgkmcnt(7)
  v_mfma_f32_16x16x32_bf16 v[76:79], a[52:55], v[28:31], v[76:79]
  v_mfma_f32_16x16x32_bf16 v[84:87], a[132:135], v[28:31], v[84:87]
  v_mfma_f32_16x16x32_bf16 v[92:95], a[212:215], v[28:31], v[92:95]
  ds_read_b128 v[28:31], v6 offset:37888
  s_waitcnt lgkmcnt(7)
  v_mfma_f32_16x16x32_bf16 v[72:75], a[56:59], v[32:35], v[72:75]
  v_mfma_f32_16x16x32_bf16 v[80:83], a[136:139], v[32:35], v[80:83]
  v_mfma_f32_16x16x32_bf16 v[88:91], a[216:219], v[32:35], v[88:91]
  ds_read_b128 v[32:35], v6 offset:18432
  s_waitcnt lgkmcnt(7)
  v_mfma_f32_16x16x32_bf16 v[76:79], a[56:59], v[36:39], v[76:79]
  v_mfma_f32_16x16x32_bf16 v[84:87], a[136:139], v[36:39], v[84:87]
  v_mfma_f32_16x16x32_bf16 v[92:95], a[216:219], v[36:39], v[92:95]
  ds_read_b128 v[36:39], v6 offset:38912
  buffer_load_dwordx4 v5, s[8:11], s22 offen offset:2048 lds
  s_waitcnt lgkmcnt(7)
  v_mfma_f32_16x16x32_bf16 v[72:75], a[60:63], v[40:43], v[72:75]
  v_mfma_f32_16x16x32_bf16 v[80:83], a[140:143], v[40:43], v[80:83]
  v_mfma_f32_16x16x32_bf16 v[88:91], a[220:223], v[40:43], v[88:91]
  ds_read_b128 v[40:43], v6 offset:19456
  s_waitcnt lgkmcnt(7)
  v_mfma_f32_16x16x32_bf16 v[76:79], a[60:63], v[44:47], v[76:79]
  v_mfma_f32_16x16x32_bf16 v[84:87], a[140:143], v[44:47], v[84:87]
  v_mfma_f32_16x16x32_bf16 v[92:95], a[220:223], v[44:47], v[92:95]
  ds_read_b128 v[44:47], v6 offset:39936
  s_waitcnt lgkmcnt(7)
  v_mfma_f32_16x16x32_bf16 v[72:75], a[64:67], v[16:19], v[72:75]
  v_mfma_f32_16x16x32_bf16 v[80:83], a[144:147], v[16:19], v[80:83]
  v_mfma_f32_16x16x32_bf16 v[88:91], a[224:227], v[16:19], v[88:91]
  buffer_load_dwordx4 v5, s[8:11], s22 offen offset:3072 lds
  s_waitcnt lgkmcnt(6)
  v_mfma_f32_16x16x32_bf16 v[76:79], a[64:67], v[20:23], v[76:79]
  v_mfma_f32_16x16x32_bf16 v[84:87], a[144:147], v[20:23], v[84:87]
  v_mfma_f32_16x16x32_bf16 v[92:95], a[224:227], v[20:23], v[92:95]
  s_waitcnt lgkmcnt(5)
  v_mfma_f32_16x16x32_bf16 v[72:75], a[68:71], v[24:27], v[72:75]
  v_mfma_f32_16x16x32_bf16 v[80:83], a[148:151], v[24:27], v[80:83]
  v_mfma_f32_16x16x32_bf16 v[88:91], a[228:231], v[24:27], v[88:91]
  s_waitcnt lgkmcnt(4)
  v_mfma_f32_16x16x32_bf16 v[76:79], a[68:71], v[28:31], v[76:79]
  v_mfma_f32_16x16x32_bf16 v[84:87], a[148:151], v[28:31], v[84:87]
  v_mfma_f32_16x16x32_bf16 v[92:95], a[228:231], v[28:31], v[92:95]
  s_add_u32 s22, s22, 4096
  s_add_u32 s23, s23, 4096
  s_mov_b32 m0, s23
  s_nop 0
  buffer_load_dwordx4 v5, s[8:11], s22 offen offset:0 lds
  s_waitcnt lgkmcnt(3)
  v_mfma_f32_16x16x32_bf16 v[72:75], a[72:75], v[32:35], v[72:75]
  v_mfma_f32_16x16x32_bf16 v[80:83], a[152:155], v[32:35], v[80:83]
  v_mfma_f32_16x16x32_bf16 v[88:91], a[232:235], v[32:35], v[88:91]
  s_waitcnt lgkmcnt(2)
  v_mfma_f32_16x16x32_bf16 v[76:79], a[72:75], v[36:39], v[76:79]
  v_mfma_f32_16x16x32_bf16 v[84:87], a[152:155], v[36:39], v[84:87]
  v_mfma_f32_16x16x32_bf16 v[92:95], a[232:235], v[36:39], v[92:95]
  s_waitcnt lgkmcnt(1)
  v_mfma_f32_16x16x32_bf16 v[72:75], a[76:79], v[40:43], v[72:75]
  v_mfma_f32_16x16x32_bf16 v[80:83], a[156:159], v[40:43], v[80:83]
  v_mfma_f32_16x16x32_bf16 v[88:91], a[236:239], v[40:43], v[88:91]
  buffer_load_dwordx4 v5, s[8:11], s22 offen offset:1024 lds
  s_waitcnt lgkmcnt(0)
  v_mfma_f32_16x16x32_bf16 v[76:79], a[76:79], v[44:47], v[76:79]
  v_mfma_f32_16x16x32_bf16 v[84:87], a[156:159], v[44:47], v[84:87]
  v_mfma_f32_16x16x32_bf16 v[92:95], a[236:239], v[44:47], v[92:95]
  s_add_u32 s40, s40, 1
  s_add_u32 s42, s42, 40960
  s_cmp_ge_u32 s42, 122880
  s_cbranch_scc0 XQK_1_nc
  s_mov_b32 s42, 0
XQK_1_nc:
  s_cmp_lt_u32 s40, s83
  s_cbranch_scc1 XQK_0
  s_waitcnt vmcnt(10)
  s_barrier
  s_cmp_eq_u32 s91, 0
  s_cbranch_scc0 XQK_t2
  s_add_u32 s22, s82, 2
  s_cmp_lt_u32 s40, s22
  s_cbranch_scc1 XQK_t2
  s_sub_u32 s22, s40, 2
  s_lshl_b32 s22, s22, 6
  s_add_u32 s22, s22, s47
  v_mov_b32 v7, s22
  s_mov_b64 exec, 1
  buffer_atomic_add v8, v7, s[8:11], 0 offen sc1
  s_mov_b64 exec, -1
XQK_t2:
  s_sub_u32 s53, s40, 1
  s_mul_i32 s53, s53, 393216
  s_add_u32 s53, s53, s46
  s_add_u32 s54, s53, s48
  s_add_u32 s55, s53, s49
  v_cvt_pk_bf16_f32 v96, v72, v73
  v_cvt_pk_bf16_f32 v97, v74, v75
  v_cvt_pk_bf16_f32 v98, v80, v81
  v_cvt_pk_bf16_f32 v99, v82, v83
  v_cvt_pk_bf16_f32 v100, v88, v89
  v_cvt_pk_bf16_f32 v101, v90, v91
  s_bitcmp1_b32 s91, 0
  s_cbranch_scc1 XQ_e9590o
  buffer_store_dwordx4 v[96:99], v5, s[8:11], s54 offen sc1
  buffer_store_dwordx2 v[100:101], v5, s[8:11], s55 offen sc1
  s_branch XQ_e9590d
XQ_e9590o:
  buffer_store_dwordx2 v[96:97], v5, s[8:11], s55 offen sc1
  buffer_store_dwordx4 v[98:101], v5, s[8:11], s54 offen sc1
XQ_e9590d:
  v_cvt_pk_bf16_f32 v102, v76, v77
  v_cvt_pk_bf16_f32 v103, v78, v79
  v_cvt_pk_bf16_f32 v104, v84, v85
  v_cvt_pk_bf16_f32 v105, v86, v87
  v_cvt_pk_bf16_f32 v106, v92, v93
  v_cvt_pk_bf16_f32 v107, v94, v95
  s_add_u32 s54, s54, 6144
  s_add_u32 s55, s55, 6144
  s_bitcmp1_b32 s91, 0
  s_cbranch_scc1 XQ_e9605o
  buffer_store_dwordx4 v[102:105], v5, s[8:11], s54 offen sc1
  buffer_store_dwordx2 v[106:107], v5, s[8:11], s55 offen sc1
  s_branch XQ_e9605d
XQ_e9605o:
  buffer_store_dwordx2 v[102:103], v5, s[8:11], s55 offen sc1
  buffer_store_dwordx4 v[104:107], v5, s[8:11], s54 offen sc1
XQ_e9605d:
  s_waitcnt vmcnt(0)
  s_barrier
  s_cmp_eq_u32 s91, 0
  s_cbranch_scc0 XQK_t1
  s_add_u32 s22, s82, 1
  s_cmp_lt_u32 s40, s22
  s_cbranch_scc1 XQK_t1
  s_sub_u32 s22, s40, 1
  s_lshl_b32 s22, s22, 6
  s_add_u32 s22, s22, s47
  v_mov_b32 v7, s22
  s_mov_b64 exec, 1
  buffer_atomic_add v8, v7, s[8:11], 0 offen sc1
  s_mov_b64 exec, -1
XQK_t1:
  s_branch XQ_done
XQV_0:
  s_waitcnt vmcnt(10)
  s_barrier
  v_add_u32 v6, s42, v5
  ds_read_b128 v[16:19], v6 offset:0
  ds_read_b128 v[20:23], v6 offset:20480
  ds_read_b128 v[24:27], v6 offset:1024
  ds_read_b128 v[28:31], v6 offset:21504
  ds_read_b128 v[32:35], v6 offset:2048
  ds_read_b128 v[36:39], v6 offset:22528
  ds_read_b128 v[40:43], v6 offset:3072
  ds_read_b128 v[44:47], v6 offset:23552
  s_cmp_eq_u32 s91, 0
  s_cbranch_scc0 XQV_0_s
  s_add_u32 s22, s82, 2
  s_cmp_lt_u32 s40, s22
  s_cbranch_scc1 XQV_0_s
  s_sub_u32 s22, s40, 2
  s_lshl_b32 s22, s22, 6
  s_add_u32 s22, s22, s47
  v_mov_b32 v7, s22
  s_mov_b64 exec, 1
  buffer_atomic_add v8, v7, s[8:11], 0 offen sc1
  s_mov_b64 exec, -1
XQV_0_s:
  s_add_u32 s51, s40, 2
  s_and_b32 s22, s51, 15
  s_cmp_eq_u32 s22, 0
  s_cbranch_scc0 XQV_0_hg
  s_cmp_ge_u32 s51, 64
  s_cbranch_scc1 XQV_0_hg
  s_lshr_b32 s22, s51, 4
  s_lshl_b32 s22, s22, 2
  s_add_u32 s22, s22, 192
  s_cmp_eq_u32 s91, 0
  s_cbranch_scc0 XQV_0_h_ok
  v_mov_b32 v252, s22
XQV_0_h_w:
  buffer_load_dword v253, v252, s[12:15], 0 offen sc1
  s_waitcnt vmcnt(0)
  v_readfirstlane_b32 s57, v253
  s_nop 0
  s_cmp_ge_u32 s57, 32
  s_cbranch_scc1 XQV_0_h_ok
  s_sleep 36
  s_add_u32 s41, s41, 64
  s_cmp_lt_u32 s41, 4000000
  s_cbranch_scc1 XQV_0_h_w
XQV_0_h_ok:
  s_barrier
XQV_0_hg:
  s_sub_u32 s53, s40, 1
  s_mul_i32 s53, s53, 393216
  s_add_u32 s53, s53, s46
  s_add_u32 s54, s53, s50
  s_add_u32 s51, s40, 2
  s_sub_u32 s22, s83, 1
  s_cmp_ge_u32 s51, s83
  s_cselect_b32 s51, s22, s51
  s_add_u32 s52, s42, 81920
  s_cmp_ge_u32 s52, 122880
  s_cbranch_scc0 XQV_0_nb
  s_sub_u32 s52, s52, 122880
XQV_0_nb:
  s_mul_i32 s22, s51, 40960
  s_add_u32 s22, s22, s45
  s_add_u32 s23, s52, s44
  s_waitcnt lgkmcnt(7)
  v_mfma_f32_16x16x32_bf16 v[48:51], v[16:19], a[0:3], 0
  v_mfma_f32_16x16x32_bf16 v[56:59], v[16:19], a[80:83], 0
  v_mfma_f32_16x16x32_bf16 v[64:67], v[16:19], a[160:163], 0
  ds_read_b128 v[16:19], v6 offset:4096
  s_waitcnt lgkmcnt(7)
  v_mfma_f32_16x16x32_bf16 v[52:55], v[20:23], a[0:3], 0
  v_mfma_f32_16x16x32_bf16 v[60:63], v[20:23], a[80:83], 0
  v_mfma_f32_16x16x32_bf16 v[68:71], v[20:23], a[160:163], 0
  ds_read_b128 v[20:23], v6 offset:24576
  s_cmp_eq_u32 s40, s82
  s_cbranch_scc1 XQV_0_ne0
  v_cvt_pk_bf16_f32 v96, v72, v73
  v_cvt_pk_bf16_f32 v97, v74, v75
  v_cvt_pk_bf16_f32 v98, v76, v77
  v_cvt_pk_bf16_f32 v99, v78, v79
  buffer_store_dwordx4 v[96:99], v5, s[8:11], s54 offen offset:0 sc1
XQV_0_ne0:
  s_waitcnt lgkmcnt(7)
  v_mfma_f32_16x16x32_bf16 v[48:51], v[24:27], a[4:7], v[48:51]
  v_mfma_f32_16x16x32_bf16 v[56:59], v[24:27], a[84:87], v[56:59]
  v_mfma_f32_16x16x32_bf16 v[64:67], v[24:27], a[164:167], v[64:67]
  ds_read_b128 v[24:27], v6 offset:5120
  s_waitcnt lgkmcnt(7)
  v_mfma_f32_16x16x32_bf16 v[52:55], v[28:31], a[4:7], v[52:55]
  v_mfma_f32_16x16x32_bf16 v[60:63], v[28:31], a[84:87], v[60:63]
  v_mfma_f32_16x16x32_bf16 v[68:71], v[28:31], a[164:167], v[68:71]
  ds_read_b128 v[28:31], v6 offset:25600
  s_mul_i32 s57, s40, s56
  s_mov_b64 exec, s[58:59]
  buffer_store_dwordx4 v[240:243], v245, s[8:11], s57 offen sc1
  s_mov_b64 exec, -1
  s_sub_u32 s29, s40, s82
  s_sub_u32 s29, s29, s85
  s_cmp_lt_u32 s29, 6
  s_cbranch_scc0 XQV_0_wr
  s_cmp_lt_u32 s29, 2
  s_cselect_b32 s92, s86, s88
  s_cselect_b32 s93, s87, s89
  s_cmp_lt_u32 s29, 4
  s_cselect_b32 s92, s92, s96
  s_cselect_b32 s93, s93, s97
  s_and_b32 s93, s93, 0xffff
  s_and_b32 s29, s29, 1
  s_lshl_b32 s29, s29, 20
  buffer_load_dword v247, v248, s[92:95], s29 offen
XQV_0_wr:
  s_waitcnt lgkmcnt(7)
  v_mfma_f32_16x16x32_bf16 v[48:51], v[32:35], a[8:11], v[48:51]
  v_mfma_f32_16x16x32_bf16 v[56:59], v[32:35], a[88:91], v[56:59]
  v_mfma_f32_16x16x32_bf16 v[64:67], v[32:35], a[168:171], v[64:67]
  ds_read_b128 v[32:35], v6 offset:6144
  s_waitcnt lgkmcnt(7)
  v_mfma_f32_16x16x32_bf16 v[52:55], v[36:39], a[8:11], v[52:55]
  v_mfma_f32_16x16x32_bf16 v[60:63], v[36:39], a[88:91], v[60:63]
  v_mfma_f32_16x16x32_bf16 v[68:71], v[36:39], a[168:171], v[68:71]
  ds_read_b128 v[36:39], v6 offset:26624
  s_cmp_eq_u32 s40, s82
  s_cbranch_scc1 XQV_0_ne1
  v_cvt_pk_bf16_f32 v100, v80, v81
  v_cvt_pk_bf16_f32 v101, v82, v83
  v_cvt_pk_bf16_f32 v102, v84, v85
  v_cvt_pk_bf16_f32 v103, v86, v87
  buffer_store_dwordx4 v[100:103], v5, s[8:11], s54 offen offset:1024 sc1
XQV_0_ne1:
  s_waitcnt lgkmcnt(7)
  v_mfma_f32_16x16x32_bf16 v[48:51], v[40:43], a[12:15], v[48:51]
  v_mfma_f32_16x16x32_bf16 v[56:59], v[40:43], a[92:95], v[56:59]
  v_mfma_f32_16x16x32_bf16 v[64:67], v[40:43], a[172:175], v[64:67]
  ds_read_b128 v[40:43], v6 offset:7168
  s_waitcnt lgkmcnt(7)
  v_mfma_f32_16x16x32_bf16 v[52:55], v[44:47], a[12:15], v[52:55]
  v_mfma_f32_16x16x32_bf16 v[60:63], v[44:47], a[92:95], v[60:63]
  v_mfma_f32_16x16x32_bf16 v[68:71], v[44:47], a[172:175], v[68:71]
  ds_read_b128 v[44:47], v6 offset:27648
  s_waitcnt lgkmcnt(7)
  v_mfma_f32_16x16x32_bf16 v[48:51], v[16:19], a[16:19], v[48:51]
  v_mfma_f32_16x16x32_bf16 v[56:59], v[16:19], a[96:99], v[56:59]
  v_mfma_f32_16x16x32_bf16 v[64:67], v[16:19], a[176:179], v[64:67]
  ds_read_b128 v[16:19], v6 offset:8192
  s_waitcnt lgkmcnt(7)
  v_mfma_f32_16x16x32_bf16 v[52:55], v[20:23], a[16:19], v[52:55]
  v_mfma_f32_16x16x32_bf16 v[60:63], v[20:23], a[96:99], v[60:63]
  v_mfma_f32_16x16x32_bf16 v[68:71], v[20:23], a[176:179], v[68:71]
  ds_read_b128 v[20:23], v6 offset:28672
  s_cmp_eq_u32 s40, s82
  s_cbranch_scc1 XQV_0_ne2
  v_cvt_pk_bf16_f32 v104, v88, v89
  v_cvt_pk_bf16_f32 v105, v90, v91
  v_cvt_pk_bf16_f32 v106, v92, v93
  v_cvt_pk_bf16_f32 v107, v94, v95
  buffer_store_dwordx4 v[104:107], v5, s[8:11], s54 offen offset:2048 sc1
XQV_0_ne2:
  s_waitcnt lgkmcnt(7)
  v_mfma_f32_16x16x32_bf16 v[48:51], v[24:27], a[20:23], v[48:51]
  v_mfma_f32_16x16x32_bf16 v[56:59], v[24:27], a[100:103], v[56:59]
  v_mfma_f32_16x16x32_bf16 v[64:67], v[24:27], a[180:183], v[64:67]
  ds_read_b128 v[24:27], v6 offset:9216
  s_waitcnt lgkmcnt(7)
  v_mfma_f32_16x16x32_bf16 v[52:55], v[28:31], a[20:23], v[52:55]
  v_mfma_f32_16x16x32_bf16 v[60:63], v[28:31], a[100:103], v[60:63]
  v_mfma_f32_16x16x32_bf16 v[68:71], v[28:31], a[180:183], v[68:71]
  ds_read_b128 v[28:31], v6 offset:29696
  s_mov_b32 m0, s23
  s_nop 0
  buffer_load_dwordx4 v5, s[8:11], s22 offen offset:0 lds
  s_waitcnt lgkmcnt(7)
  v_mfma_f32_16x16x32_bf16 v[48:51], v[32:35], a[24:27], v[48:51]
  v_mfma_f32_16x16x32_bf16 v[56:59], v[32:35], a[104:107], v[56:59]
  v_mfma_f32_16x16x32_bf16 v[64:67], v[32:35], a[184:187], v[64:67]
  ds_read_b128 v[32:35], v6 offset:10240
  s_waitcnt lgkmcnt(7)
  v_mfma_f32_16x16x32_bf16 v[52:55], v[36:39], a[24:27], v[52:55]
  v_mfma_f32_16x16x32_bf16 v[60:63], v[36:39], a[104:107], v[60:63]
  v_mfma_f32_16x16x32_bf16 v[68:71], v[36:39], a[184:187], v[68:71]
  ds_read_b128 v[36:39], v6 offset:30720
  s_waitcnt lgkmcnt(7)
  v_mfma_f32_16x16x32_bf16 v[48:51], v[40:43], a[28:31], v[48:51]
  v_mfma_f32_16x16x32_bf16 v[56:59], v[40:43], a[108:111], v[56:59]
  v_mfma_f32_16x16x32_bf16 v[64:67], v[40:43], a[188:191], v[64:67]
  ds_read_b128 v[40:43], v6 offset:11264
  buffer_load_dwordx4 v5, s[8:11], s22 offen offset:1024 lds
  s_waitcnt lgkmcnt(7)
  v_mfma_f32_16x16x32_bf16 v[52:55], v[44:47], a[28:31], v[52:55]
  v_mfma_f32_16x16x32_bf16 v[60:63], v[44:47], a[108:111], v[60:63]
  v_mfma_f32_16x16x32_bf16 v[68:71], v[44:47], a[188:191], v[68:71]
  ds_read_b128 v[44:47], v6 offset:31744
  s_waitcnt lgkmcnt(7)
  v_mfma_f32_16x16x32_bf16 v[48:51], v[16:19], a[32:35], v[48:51]
  v_mfma_f32_16x16x32_bf16 v[56:59], v[16:19], a[112:115], v[56:59]
  v_mfma_f32_16x16x32_bf16 v[64:67], v[16:19], a[192:195], v[64:67]
  ds_read_b128 v[16:19], v6 offset:12288
  s_waitcnt lgkmcnt(7)
  v_mfma_f32_16x16x32_bf16 v[52:55], v[20:23], a[32:35], v[52:55]
  v_mfma_f32_16x16x32_bf16 v[60:63], v[20:23], a[112:115], v[60:63]
  v_mfma_f32_16x16x32_bf16 v[68:71], v[20:23], a[192:195], v[68:71]
  ds_read_b128 v[20:23], v6 offset:32768
  buffer_load_dwordx4 v5, s[8:11], s22 offen offset:2048 lds
  s_waitcnt lgkmcnt(7)
  v_mfma_f32_16x16x32_bf16 v[48:51], v[24:27], a[36:39], v[48:51]
  v_mfma_f32_16x16x32_bf16 v[56:59], v[24:27], a[116:119], v[56:59]
  v_mfma_f32_16x16x32_bf16 v[64:67], v[24:27], a[196:199], v[64:67]
  ds_read_b128 v[24:27], v6 offset:13312
  s_waitcnt lgkmcnt(7)
  v_mfma_f32_16x16x32_bf16 v[52:55], v[28:31], a[36:39], v[52:55]
  v_mfma_f32_16x16x32_bf16 v[60:63], v[28:31], a[116:119], v[60:63]
  v_mfma_f32_16x16x32_bf16 v[68:71], v[28:31], a[196:199], v[68:71]
  ds_read_b128 v[28:31], v6 offset:33792
  s_waitcnt lgkmcnt(7)
  v_mfma_f32_16x16x32_bf16 v[48:51], v[32:35], a[40:43], v[48:51]
  v_mfma_f32_16x16x32_bf16 v[56:59], v[32:35], a[120:123], v[56:59]
  v_mfma_f32_16x16x32_bf16 v[64:67], v[32:35], a[200:203], v[64:67]
  ds_read_b128 v[32:35], v6 offset:14336
  buffer_load_dwordx4 v5, s[8:11], s22 offen offset:3072 lds
  s_waitcnt lgkmcnt(7)
  v_mfma_f32_16x16x32_bf16 v[52:55], v[36:39], a[40:43], v[52:55]
  v_mfma_f32_16x16x32_bf16 v[60:63], v[36:39], a[120:123], v[60:63]
  v_mfma_f32_16x16x32_bf16 v[68:71], v[36:39], a[200:203], v[68:71]
  ds_read_b128 v[36:39], v6 offset:34816
  s_waitcnt lgkmcnt(7)
  v_mfma_f32_16x16x32_bf16 v[48:51], v[40:43], a[44:47], v[48:51]
  v_mfma_f32_16x16x32_bf16 v[56:59], v[40:43], a[124:127], v[56:59]
  v_mfma_f32_16x16x32_bf16 v[64:67], v[40:43], a[204:207], v[64:67]
  ds_read_b128 v[40:43], v6 offset:15360
  s_waitcnt lgkmcnt(7)
  v_mfma_f32_16x16x32_bf16 v[52:55], v[44:47], a[44:47], v[52:55]
  v_mfma_f32_16x16x32_bf16 v[60:63], v[44:47], a[124:127], v[60:63]
  v_mfma_f32_16x16x32_bf16 v[68:71], v[44:47], a[204:207], v[68:71]
  ds_read_b128 v[44:47], v6 offset:35840
  s_add_u32 s22, s22, 4096
  s_add_u32 s23, s23, 4096
  s_mov_b32 m0, s23
  s_nop 0
  buffer_load_dwordx4 v5, s[8:11], s22 offen offset:0 lds
  s_waitcnt lgkmcnt(7)
  v_mfma_f32_16x16x32_bf16 v[48:51], v[16:19], a[48:51], v[48:51]
  v_mfma_f32_16x16x32_bf16 v[56:59], v[16:19], a[128:131], v[56:59]
  v_mfma_f32_16x16x32_bf16 v[64:67], v[16:19], a[208:211], v[64:67]
  ds_read_b128 v[16:19], v6 offset:16384
  s_waitcnt lgkmcnt(7)
  v_mfma_f32_16x16x32_bf16 v[52:55], v[20:23], a[48:51], v[52:55]
  v_mfma_f32_16x16x32_bf16 v[60:63], v[20:23], a[128:131], v[60:63]
  v_mfma_f32_16x16x32_bf16 v[68:71], v[20:23], a[208:211], v[68:71]
  ds_read_b128 v[20:23], v6 offset:36864
  s_waitcnt lgkmcnt(7)
  v_mfma_f32_16x16x32_bf16 v[48:51], v[24:27], a[52:55], v[48:51]
  v_mfma_f32_16x16x32_bf16 v[56:59], v[24:27], a[132:135], v[56:59]
  v_mfma_f32_16x16x32_bf16 v[64:67], v[24:27], a[212:215], v[64:67]
  ds_read_b128 v[24:27], v6 offset:17408
  buffer_load_dwordx4 v5, s[8:11], s22 offen offset:1024 lds
  s_waitcnt lgkmcnt(7)
  v_mfma_f32_16x16x32_bf16 v[52:55], v[28:31], a[52:55], v[52:55]
  v_mfma_f32_16x16x32_bf16 v[60:63], v[28:31], a[132:135], v[60:63]
  v_mfma_f32_16x16x32_bf16 v[68:71], v[28:31], a[212:215], v[68:71]
  ds_read_b128 v[28:31], v6 offset:37888
  s_waitcnt lgkmcnt(7)
  v_mfma_f32_16x16x32_bf16 v[48:51], v[32:35], a[56:59], v[48:51]
  v_mfma_f32_16x16x32_bf16 v[56:59], v[32:35], a[136:139], v[56:59]
  v_mfma_f32_16x16x32_bf16 v[64:67], v[32:35], a[216:219], v[64:67]
  ds_read_b128 v[32:35], v6 offset:18432
  s_waitcnt lgkmcnt(7)
  v_mfma_f32_16x16x32_bf16 v[52:55], v[36:39], a[56:59], v[52:55]
  v_mfma_f32_16x16x32_bf16 v[60:63], v[36:39], a[136:139], v[60:63]
  v_mfma_f32_16x16x32_bf16 v[68:71], v[36:39], a[216:219], v[68:71]
  ds_read_b128 v[36:39], v6 offset:38912
  buffer_load_dwordx4 v5, s[8:11], s22 offen offset:2048 lds
  s_waitcnt lgkmcnt(7)
  v_mfma_f32_16x16x32_bf16 v[48:51], v[40:43], a[60:63], v[48:51]
  v_mfma_f32_16x16x32_bf16 v[56:59], v[40:43], a[140:143], v[56:59]
  v_mfma_f32_16x16x32_bf16 v[64:67], v[40:43], a[220:223], v[64:67]
  ds_read_b128 v[40:43], v6 offset:19456
  s_waitcnt lgkmcnt(7)
  v_mfma_f32_16x16x32_bf16 v[52:55], v[44:47], a[60:63], v[52:55]
  v_mfma_f32_16x16x32_bf16 v[60:63], v[44:47], a[140:143], v[60:63]
  v_mfma_f32_16x16x32_bf16 v[68:71], v[44:47], a[220:223], v[68:71]
  ds_read_b128 v[44:47], v6 offset:39936
  s_waitcnt lgkmcnt(7)
  v_mfma_f32_16x16x32_bf16 v[48:51], v[16:19], a[64:67], v[48:51]
  v_mfma_f32_16x16x32_bf16 v[56:59], v[16:19], a[144:147], v[56:59]
  v_mfma_f32_16x16x32_bf16 v[64:67], v[16:19], a[224:227], v[64:67]
  buffer_load_dwordx4 v5, s[8:11], s22 offen offset:3072 lds
  s_waitcnt lgkmcnt(6)
  v_mfma_f32_16x16x32_bf16 v[52:55], v[20:23], a[64:67], v[52:55]
  v_mfma_f32_16x16x32_bf16 v[60:63], v[20:23], a[144:147], v[60:63]
  v_mfma_f32_16x16x32_bf16 v[68:71], v[20:23], a[224:227], v[68:71]
  s_waitcnt lgkmcnt(5)
  v_mfma_f32_16x16x32_bf16 v[48:51], v[24:27], a[68:71], v[48:51]
  v_mfma_f32_16x16x32_bf16 v[56:59], v[24:27], a[148:151], v[56:59]
  v_mfma_f32_16x16x32_bf16 v[64:67], v[24:27], a[228:231], v[64:67]
  s_waitcnt lgkmcnt(4)
  v_mfma_f32_16x16x32_bf16 v[52:55], v[28:31], a[68:71], v[52:55]
  v_mfma_f32_16x16x32_bf16 v[60:63], v[28:31], a[148:151], v[60:63]
  v_mfma_f32_16x16x32_bf16 v[68:71], v[28:31], a[228:231], v[68:71]
  s_add_u32 s22, s22, 4096
  s_add_u32 s23, s23, 4096
  s_mov_b32 m0, s23
  s_nop 0
  buffer_load_dwordx4 v5, s[8:11], s22 offen offset:0 lds
  s_waitcnt lgkmcnt(3)
  v_mfma_f32_16x16x32_bf16 v[48:51], v[32:35], a[72:75], v[48:51]
  v_mfma_f32_16x16x32_bf16 v[56:59], v[32:35], a[152:155], v[56:59]
  v_mfma_f32_16x16x32_bf16 v[64:67], v[32:35], a[232:235], v[64:67]
  s_waitcnt lgkmcnt(2)
  v_mfma_f32_16x16x32_bf16 v[52:55], v[36:39], a[72:75], v[52:55]
  v_mfma_f32_16x16x32_bf16 v[60:63], v[36:39], a[152:155], v[60:63]
  v_mfma_f32_16x16x32_bf16 v[68:71], v[36:39], a[232:235], v[68:71]
  s_waitcnt lgkmcnt(1)
  v_mfma_f32_16x16x32_bf16 v[48:51], v[40:43], a[76:79], v[48:51]
  v_mfma_f32_16x16x32_bf16 v[56:59], v[40:43], a[156:159], v[56:59]
  v_mfma_f32_16x16x32_bf16 v[64:67], v[40:43], a[236:239], v[64:67]
  buffer_load_dwordx4 v5, s[8:11], s22 offen offset:1024 lds
  s_waitcnt lgkmcnt(0)
  v_mfma_f32_16x16x32_bf16 v[52:55], v[44:47], a[76:79], v[52:55]
  v_mfma_f32_16x16x32_bf16 v[60:63], v[44:47], a[156:159], v[60:63]
  v_mfma_f32_16x16x32_bf16 v[68:71], v[44:47], a[236:239], v[68:71]
  s_add_u32 s40, s40, 1
  s_add_u32 s42, s42, 40960
  s_cmp_ge_u32 s42, 122880
  s_cbranch_scc0 XQV_0_nc
  s_mov_b32 s42, 0
XQV_0_nc:
XQV_1:
  s_waitcnt vmcnt(10)
  s_barrier
  v_add_u32 v6, s42, v5
  ds_read_b128 v[16:19], v6 offset:0
  ds_read_b128 v[20:23], v6 offset:20480
  ds_read_b128 v[24:27], v6 offset:1024
  ds_read_b128 v[28:31], v6 offset:21504
  ds_read_b128 v[32:35], v6 offset:2048
  ds_read_b128 v[36:39], v6 offset:22528
  ds_read_b128 v[40:43], v6 offset:3072
  ds_read_b128 v[44:47], v6 offset:23552
  s_cmp_eq_u32 s91, 0
  s_cbranch_scc0 XQV_1_s
  s_add_u32 s22, s82, 2
  s_cmp_lt_u32 s40, s22
  s_cbranch_scc1 XQV_1_s
  s_sub_u32 s22, s40, 2
  s_lshl_b32 s22, s22, 6
  s_add_u32 s22, s22, s47
  v_mov_b32 v7, s22
  s_mov_b64 exec, 1
  buffer_atomic_add v8, v7, s[8:11], 0 offen sc1
  s_mov_b64 exec, -1
XQV_1_s:
  s_sub_u32 s53, s40, 1
  s_mul_i32 s53, s53, 393216
  s_add_u32 s53, s53, s46
  s_add_u32 s54, s53, s50
  s_add_u32 s51, s40, 2
  s_sub_u32 s22, s83, 1
  s_cmp_ge_u32 s51, s83
  s_cselect_b32 s51, s22, s51
  s_add_u32 s52, s42, 81920
  s_cmp_ge_u32 s52, 122880
  s_cbranch_scc0 XQV_1_nb
  s_sub_u32 s52, s52, 122880
XQV_1_nb:
  s_mul_i32 s22, s51, 40960
  s_add_u32 s22, s22, s45
  s_add_u32 s23, s52, s44
  s_waitcnt lgkmcnt(7)
  v_mfma_f32_16x16x32_bf16 v[72:75], v[16:19], a[0:3], 0
  v_mfma_f32_16x16x32_bf16 v[80:83], v[16:19], a[80:83], 0
  v_mfma_f32_16x16x32_bf16 v[88:91], v[16:19], a[160:163], 0
  ds_read_b128 v[16:19], v6 offset:4096
  s_waitcnt lgkmcnt(7)
  v_mfma_f32_16x16x32_bf16 v[76:79], v[20:23], a[0:3], 0
  v_mfma_f32_16x16x32_bf16 v[84:87], v[20:23], a[80:83], 0
  v_mfma_f32_16x16x32_bf16 v[92:95], v[20:23], a[160:163], 0
  ds_read_b128 v[20:23], v6 offset:24576
  s_cmp_eq_u32 s40, s82
  s_cbranch_scc1 XQV_1_ne0
  v_cvt_pk_bf16_f32 v96, v48, v49
  v_cvt_pk_bf16_f32 v97, v50, v51
  v_cvt_pk_bf16_f32 v98, v52, v53
  v_cvt_pk_bf16_f32 v99, v54, v55
  buffer_store_dwordx4 v[96:99], v5, s[8:11], s54 offen offset:0 sc1
XQV_1_ne0:
  s_waitcnt lgkmcnt(7)
  v_mfma_f32_16x16x32_bf16 v[72:75], v[24:27], a[4:7], v[72:75]
  v_mfma_f32_16x16x32_bf16 v[80:83], v[24:27], a[84:87], v[80:83]
  v_mfma_f32_16x16x32_bf16 v[88:91], v[24:27], a[164:167], v[88:91]
  ds_read_b128 v[24:27], v6 offset:5120
  s_waitcnt lgkmcnt(7)
  v_mfma_f32_16x16x32_bf16 v[76:79], v[28:31], a[4:7], v[76:79]
  v_mfma_f32_16x16x32_bf16 v[84:87], v[28:31], a[84:87], v[84:87]
  v_mfma_f32_16x16x32_bf16 v[92:95], v[28:31], a[164:167], v[92:95]
  ds_read_b128 v[28:31], v6 offset:25600
  s_mul_i32 s57, s40, s56
  s_mov_b64 exec, s[58:59]
  buffer_store_dwordx4 v[240:243], v245, s[8:11], s57 offen sc1
  s_mov_b64 exec, -1
  s_sub_u32 s29, s40, s82
  s_sub_u32 s29, s29, s85
  s_cmp_lt_u32 s29, 6
  s_cbranch_scc0 XQV_1_wr
  s_cmp_lt_u32 s29, 2
  s_cselect_b32 s92, s86, s88
  s_cselect_b32 s93, s87, s89
  s_cmp_lt_u32 s29, 4
  s_cselect_b32 s92, s92, s96
  s_cselect_b32 s93, s93, s97
  s_and_b32 s93, s93, 0xffff
  s_and_b32 s29, s29, 1
  s_lshl_b32 s29, s29, 20
  buffer_load_dword v247, v248, s[92:95], s29 offen
XQV_1_wr:
  s_waitcnt lgkmcnt(7)
  v_mfma_f32_16x16x32_bf16 v[72:75], v[32:35], a[8:11], v[72:75]
  v_mfma_f32_16x16x32_bf16 v[80:83], v[32:35], a[88:91], v[80:83]
  v_mfma_f32_16x16x32_bf16 v[88:91], v[32:35], a[168:171], v[88:91]
  ds_read_b128 v[32:35], v6 offset:6144
  s_waitcnt lgkmcnt(7)
  v_mfma_f32_16x16x32_bf16 v[76:79], v[36:39], a[8:11], v[76:79]
  v_mfma_f32_16x16x32_bf16 v[84:87], v[36:39], a[88:91], v[84:87]
  v_mfma_f32_16x16x32_bf16 v[92:95], v[36:39], a[168:171], v[92:95]
  ds_read_b128 v[36:39], v6 offset:26624
  s_cmp_eq_u32 s40, s82
  s_cbranch_scc1 XQV_1_ne1
  v_cvt_pk_bf16_f32 v100, v56, v57
  v_cvt_pk_bf16_f32 v101, v58, v59
  v_cvt_pk_bf16_f32 v102, v60, v61
  v_cvt_pk_bf16_f32 v103, v62, v63
  buffer_store_dwordx4 v[100:103], v5, s[8:11], s54 offen offset:1024 sc1
XQV_1_ne1:
  s_waitcnt lgkmcnt(7)
  v_mfma_f32_16x16x32_bf16 v[72:75], v[40:43], a[12:15], v[72:75]
  v_mfma_f32_16x16x32_bf16 v[80:83], v[40:43], a[92:95], v[80:83]
  v_mfma_f32_16x16x32_bf16 v[88:91], v[40:43], a[172:175], v[88:91]
  ds_read_b128 v[40:43], v6 offset:7168
  s_waitcnt lgkmcnt(7)
  v_mfma_f32_16x16x32_bf16 v[76:79], v[44:47], a[12:15], v[76:79]
  v_mfma_f32_16x16x32_bf16 v[84:87], v[44:47], a[92:95], v[84:87]
  v_mfma_f32_16x16x32_bf16 v[92:95], v[44:47], a[172:175], v[92:95]
  ds_read_b128 v[44:47], v6 offset:27648
  s_waitcnt lgkmcnt(7)
  v_mfma_f32_16x16x32_bf16 v[72:75], v[16:19], a[16:19], v[72:75]
  v_mfma_f32_16x16x32_bf16 v[80:83], v[16:19], a[96:99], v[80:83]
  v_mfma_f32_16x16x32_bf16 v[88:91], v[16:19], a[176:179], v[88:91]
  ds_read_b128 v[16:19], v6 offset:8192
  s_waitcnt lgkmcnt(7)
  v_mfma_f32_16x16x32_bf16 v[76:79], v[20:23], a[16:19], v[76:79]
  v_mfma_f32_16x16x32_bf16 v[84:87], v[20:23], a[96:99], v[84:87]
  v_mfma_f32_16x16x32_bf16 v[92:95], v[20:23], a[176:179], v[92:95]
  ds_read_b128 v[20:23], v6 offset:28672
  s_cmp_eq_u32 s40, s82
  s_cbranch_scc1 XQV_1_ne2
  v_cvt_pk_bf16_f32 v104, v64, v65
  v_cvt_pk_bf16_f32 v105, v66, v67
  v_cvt_pk_bf16_f32 v106, v68, v69
  v_cvt_pk_bf16_f32 v107, v70, v71
  buffer_store_dwordx4 v[104:107], v5, s[8:11], s54 offen offset:2048 sc1
XQV_1_ne2:
  s_waitcnt lgkmcnt(7)
  v_mfma_f32_16x16x32_bf16 v[72:75], v[24:27], a[20:23], v[72:75]
  v_mfma_f32_16x16x32_bf16 v[80:83], v[24:27], a[100:103], v[80:83]
  v_mfma_f32_16x16x32_bf16 v[88:91], v[24:27], a[180:183], v[88:91]
  ds_read_b128 v[24:27], v6 offset:9216
  s_waitcnt lgkmcnt(7)
  v_mfma_f32_16x16x32_bf16 v[76:79], v[28:31], a[20:23], v[76:79]
  v_mfma_f32_16x16x32_bf16 v[84:87], v[28:31], a[100:103], v[84:87]
  v_mfma_f32_16x16x32_bf16 v[92:95], v[28:31], a[180:183], v[92:95]
  ds_read_b128 v[28:31], v6 offset:29696
  s_mov_b32 m0, s23
  s_nop 0
  buffer_load_dwordx4 v5, s[8:11], s22 offen offset:0 lds
  s_waitcnt lgkmcnt(7)
  v_mfma_f32_16x16x32_bf16 v[72:75], v[32:35], a[24:27], v[72:75]
  v_mfma_f32_16x16x32_bf16 v[80:83], v[32:35], a[104:107], v[80:83]
  v_mfma_f32_16x16x32_bf16 v[88:91], v[32:35], a[184:187], v[88:91]
  ds_read_b128 v[32:35], v6 offset:10240
  s_waitcnt lgkmcnt(7)
  v_mfma_f32_16x16x32_bf16 v[76:79], v[36:39], a[24:27], v[76:79]
  v_mfma_f32_16x16x32_bf16 v[84:87], v[36:39], a[104:107], v[84:87]
  v_mfma_f32_16x16x32_bf16 v[92:95], v[36:39], a[184:187], v[92:95]
  ds_read_b128 v[36:39], v6 offset:30720
  s_waitcnt lgkmcnt(7)
  v_mfma_f32_16x16x32_bf16 v[72:75], v[40:43], a[28:31], v[72:75]
  v_mfma_f32_16x16x32_bf16 v[80:83], v[40:43], a[108:111], v[80:83]
  v_mfma_f32_16x16x32_bf16 v[88:91], v[40:43], a[188:191], v[88:91]
  ds_read_b128 v[40:43], v6 offset:11264
  buffer_load_dwordx4 v5, s[8:11], s22 offen offset:1024 lds
  s_waitcnt lgkmcnt(7)
  v_mfma_f32_16x16x32_bf16 v[76:79], v[44:47], a[28:31], v[76:79]
  v_mfma_f32_16x16x32_bf16 v[84:87], v[44:47], a[108:111], v[84:87]
  v_mfma_f32_16x16x32_bf16 v[92:95], v[44:47], a[188:191], v[92:95]
  ds_read_b128 v[44:47], v6 offset:31744
  s_waitcnt lgkmcnt(7)
  v_mfma_f32_16x16x32_bf16 v[72:75], v[16:19], a[32:35], v[72:75]
  v_mfma_f32_16x16x32_bf16 v[80:83], v[16:19], a[112:115], v[80:83]
  v_mfma_f32_16x16x32_bf16 v[88:91], v[16:19], a[192:195], v[88:91]
  ds_read_b128 v[16:19], v6 offset:12288
  s_waitcnt lgkmcnt(7)
  v_mfma_f32_16x16x32_bf16 v[76:79], v[20:23], a[32:35], v[76:79]
  v_mfma_f32_16x16x32_bf16 v[84:87], v[20:23], a[112:115], v[84:87]
  v_mfma_f32_16x16x32_bf16 v[92:95], v[20:23], a[192:195], v[92:95]
  ds_read_b128 v[20:23], v6 offset:32768
  buffer_load_dwordx4 v5, s[8:11], s22 offen offset:2048 lds
  s_waitcnt lgkmcnt(7)
  v_mfma_f32_16x16x32_bf16 v[72:75], v[24:27], a[36:39], v[72:75]
  v_mfma_f32_16x16x32_bf16 v[80:83], v[24:27], a[116:119], v[80:83]
  v_mfma_f32_16x16x32_bf16 v[88:91], v[24:27], a[196:199], v[88:91]
  ds_read_b128 v[24:27], v6 offset:13312
  s_waitcnt lgkmcnt(7)
  v_mfma_f32_16x16x32_bf16 v[76:79], v[28:31], a[36:39], v[76:79]
  v_mfma_f32_16x16x32_bf16 v[84:87], v[28:31], a[116:119], v[84:87]
  v_mfma_f32_16x16x32_bf16 v[92:95], v[28:31], a[196:199], v[92:95]
  ds_read_b128 v[28:31], v6 offset:33792
  s_waitcnt lgkmcnt(7)
  v_mfma_f32_16x16x32_bf16 v[72:75], v[32:35], a[40:43], v[72:75]
  v_mfma_f32_16x16x32_bf16 v[80:83], v[32:35], a[120:123], v[80:83]
  v_mfma_f32_16x16x32_bf16 v[88:91], v[32:35], a[200:203], v[88:91]
  ds_read_b128 v[32:35], v6 offset:14336
  buffer_load_dwordx4 v5, s[8:11], s22 offen offset:3072 lds
  s_waitcnt lgkmcnt(7)
  v_mfma_f32_16x16x32_bf16 v[76:79], v[36:39], a[40:43], v[76:79]
  v_mfma_f32_16x16x32_bf16 v[84:87], v[36:39], a[120:123], v[84:87]
  v_mfma_f32_16x16x32_bf16 v[92:95], v[36:39], a[200:203], v[92:95]
  ds_read_b128 v[36:39], v6 offset:34816
  s_waitcnt lgkmcnt(7)
  v_mfma_f32_16x16x32_bf16 v[72:75], v[40:43], a[44:47], v[72:75]
  v_mfma_f32_16x16x32_bf16 v[80:83], v[40:43], a[124:127], v[80:83]
  v_mfma_f32_16x16x32_bf16 v[88:91], v[40:43], a[204:207], v[88:91]
  ds_read_b128 v[40:43], v6 offset:15360
  s_waitcnt lgkmcnt(7)
  v_mfma_f32_16x16x32_bf16 v[76:79], v[44:47], a[44:47], v[76:79]
  v_mfma_f32_16x16x32_bf16 v[84:87], v[44:47], a[124:127], v[84:87]
  v_mfma_f32_16x16x32_bf16 v[92:95], v[44:47], a[204:207], v[92:95]
  ds_read_b128 v[44:47], v6 offset:35840
  s_add_u32 s22, s22, 4096
  s_add_u32 s23, s23, 4096
  s_mov_b32 m0, s23
  s_nop 0
  buffer_load_dwordx4 v5, s[8:11], s22 offen offset:0 lds
  s_waitcnt lgkmcnt(7)
  v_mfma_f32_16x16x32_bf16 v[72:75], v[16:19], a[48:51], v[72:75]
  v_mfma_f32_16x16x32_bf16 v[80:83], v[16:19], a[128:131], v[80:83]
  v_mfma_f32_16x16x32_bf16 v[88:91], v[16:19], a[208:211], v[88:91]
  ds_read_b128 v[16:19], v6 offset:16384
  s_waitcnt lgkmcnt(7)
  v_mfma_f32_16x16x32_bf16 v[76:79], v[20:23], a[48:51], v[76:79]
  v_mfma_f32_16x16x32_bf16 v[84:87], v[20:23], a[128:131], v[84:87]
  v_mfma_f32_16x16x32_bf16 v[92:95], v[20:23], a[208:211], v[92:95]
  ds_read_b128 v[20:23], v6 offset:36864
  s_waitcnt lgkmcnt(7)
  v_mfma_f32_16x16x32_bf16 v[72:75], v[24:27], a[52:55], v[72:75]
  v_mfma_f32_16x16x32_bf16 v[80:83], v[24:27], a[132:135], v[80:83]
  v_mfma_f32_16x16x32_bf16 v[88:91], v[24:27], a[212:215], v[88:91]
  ds_read_b128 v[24:27], v6 offset:17408
  buffer_load_dwordx4 v5, s[8:11], s22 offen offset:1024 lds
  s_waitcnt lgkmcnt(7)
  v_mfma_f32_16x16x32_bf16 v[76:79], v[28:31], a[52:55], v[76:79]
  v_mfma_f32_16x16x32_bf16 v[84:87], v[28:31], a[132:135], v[84:87]
  v_mfma_f32_16x16x32_bf16 v[92:95], v[28:31], a[212:215], v[92:95]
  ds_read_b128 v[28:31], v6 offset:37888
  s_waitcnt lgkmcnt(7)
  v_mfma_f32_16x16x32_bf16 v[72:75], v[32:35], a[56:59], v[72:75]
  v_mfma_f32_16x16x32_bf16 v[80:83], v[32:35], a[136:139], v[80:83]
  v_mfma_f32_16x16x32_bf16 v[88:91], v[32:35], a[216:219], v[88:91]
  ds_read_b128 v[32:35], v6 offset:18432
  s_waitcnt lgkmcnt(7)
  v_mfma_f32_16x16x32_bf16 v[76:79], v[36:39], a[56:59], v[76:79]
  v_mfma_f32_16x16x32_bf16 v[84:87], v[36:39], a[136:139], v[84:87]
  v_mfma_f32_16x16x32_bf16 v[92:95], v[36:39], a[216:219], v[92:95]
  ds_read_b128 v[36:39], v6 offset:38912
  buffer_load_dwordx4 v5, s[8:11], s22 offen offset:2048 lds
  s_waitcnt lgkmcnt(7)
  v_mfma_f32_16x16x32_bf16 v[72:75], v[40:43], a[60:63], v[72:75]
  v_mfma_f32_16x16x32_bf16 v[80:83], v[40:43], a[140:143], v[80:83]
  v_mfma_f32_16x16x32_bf16 v[88:91], v[40:43], a[220:223], v[88:91]
  ds_read_b128 v[40:43], v6 offset:19456
  s_waitcnt lgkmcnt(7)
  v_mfma_f32_16x16x32_bf16 v[76:79], v[44:47], a[60:63], v[76:79]
  v_mfma_f32_16x16x32_bf16 v[84:87], v[44:47], a[140:143], v[84:87]
  v_mfma_f32_16x16x32_bf16 v[92:95], v[44:47], a[220:223], v[92:95]
  ds_read_b128 v[44:47], v6 offset:39936
  s_waitcnt lgkmcnt(7)
  v_mfma_f32_16x16x32_bf16 v[72:75], v[16:19], a[64:67], v[72:75]
  v_mfma_f32_16x16x32_bf16 v[80:83], v[16:19], a[144:147], v[80:83]
  v_mfma_f32_16x16x32_bf16 v[88:91], v[16:19], a[224:227], v[88:91]
  buffer_load_dwordx4 v5, s[8:11], s22 offen offset:3072 lds
  s_waitcnt lgkmcnt(6)
  v_mfma_f32_16x16x32_bf16 v[76:79], v[20:23], a[64:67], v[76:79]
  v_mfma_f32_16x16x32_bf16 v[84:87], v[20:23], a[144:147], v[84:87]
  v_mfma_f32_16x16x32_bf16 v[92:95], v[20:23], a[224:227], v[92:95]
  s_waitcnt lgkmcnt(5)
  v_mfma_f32_16x16x32_bf16 v[72:75], v[24:27], a[68:71], v[72:75]
  v_mfma_f32_16x16x32_bf16 v[80:83], v[24:27], a[148:151], v[80:83]
  v_mfma_f32_16x16x32_bf16 v[88:91], v[24:27], a[228:231], v[88:91]
  s_waitcnt lgkmcnt(4)
  v_mfma_f32_16x16x32_bf16 v[76:79], v[28:31], a[68:71], v[76:79]
  v_mfma_f32_16x16x32_bf16 v[84:87], v[28:31], a[148:151], v[84:87]
  v_mfma_f32_16x16x32_bf16 v[92:95], v[28:31], a[228:231], v[92:95]
  s_add_u32 s22, s22, 4096
  s_add_u32 s23, s23, 4096
  s_mov_b32 m0, s23
  s_nop 0
  buffer_load_dwordx4 v5, s[8:11], s22 offen offset:0 lds
  s_waitcnt lgkmcnt(3)
  v_mfma_f32_16x16x32_bf16 v[72:75], v[32:35], a[72:75], v[72:75]
  v_mfma_f32_16x16x32_bf16 v[80:83], v[32:35], a[152:155], v[80:83]
  v_mfma_f32_16x16x32_bf16 v[88:91], v[32:35], a[232:235], v[88:91]
  s_waitcnt lgkmcnt(2)
  v_mfma_f32_16x16x32_bf16 v[76:79], v[36:39], a[72:75], v[76:79]
  v_mfma_f32_16x16x32_bf16 v[84:87], v[36:39], a[152:155], v[84:87]
  v_mfma_f32_16x16x32_bf16 v[92:95], v[36:39], a[232:235], v[92:95]
  s_waitcnt lgkmcnt(1)
  v_mfma_f32_16x16x32_bf16 v[72:75], v[40:43], a[76:79], v[72:75]
  v_mfma_f32_16x16x32_bf16 v[80:83], v[40:43], a[156:159], v[80:83]
  v_mfma_f32_16x16x32_bf16 v[88:91], v[40:43], a[236:239], v[88:91]
  buffer_load_dwordx4 v5, s[8:11], s22 offen offset:1024 lds
  s_waitcnt lgkmcnt(0)
  v_mfma_f32_16x16x32_bf16 v[76:79], v[44:47], a[76:79], v[76:79]
  v_mfma_f32_16x16x32_bf16 v[84:87], v[44:47], a[156:159], v[84:87]
  v_mfma_f32_16x16x32_bf16 v[92:95], v[44:47], a[236:239], v[92:95]
  s_add_u32 s40, s40, 1
  s_add_u32 s42, s42, 40960
  s_cmp_ge_u32 s42, 122880
  s_cbranch_scc0 XQV_1_nc
  s_mov_b32 s42, 0
XQV_1_nc:
  s_cmp_lt_u32 s40, s83
  s_cbranch_scc1 XQV_0
  s_waitcnt vmcnt(10)
  s_barrier
  s_cmp_eq_u32 s91, 0
  s_cbranch_scc0 XQV_t2
  s_add_u32 s22, s82, 2
  s_cmp_lt_u32 s40, s22
  s_cbranch_scc1 XQV_t2
  s_sub_u32 s22, s40, 2
  s_lshl_b32 s22, s22, 6
  s_add_u32 s22, s22, s47
  v_mov_b32 v7, s22
  s_mov_b64 exec, 1
  buffer_atomic_add v8, v7, s[8:11], 0 offen sc1
  s_mov_b64 exec, -1
XQV_t2:
  s_sub_u32 s53, s40, 1
  s_mul_i32 s53, s53, 393216
  s_add_u32 s53, s53, s46
  s_add_u32 s54, s53, s50
  v_cvt_pk_bf16_f32 v96, v72, v73
  v_cvt_pk_bf16_f32 v97, v74, v75
  v_cvt_pk_bf16_f32 v98, v76, v77
  v_cvt_pk_bf16_f32 v99, v78, v79
  buffer_store_dwordx4 v[96:99], v5, s[8:11], s54 offen offset:0 sc1
  v_cvt_pk_bf16_f32 v100, v80, v81
  v_cvt_pk_bf16_f32 v101, v82, v83
  v_cvt_pk_bf16_f32 v102, v84, v85
  v_cvt_pk_bf16_f32 v103, v86, v87
  buffer_store_dwordx4 v[100:103], v5, s[8:11], s54 offen offset:1024 sc1
  v_cvt_pk_bf16_f32 v104, v88, v89
  v_cvt_pk_bf16_f32 v105, v90, v91
  v_cvt_pk_bf16_f32 v106, v92, v93
  v_cvt_pk_bf16_f32 v107, v94, v95
  buffer_store_dwordx4 v[104:107], v5, s[8:11], s54 offen offset:2048 sc1
  s_waitcnt vmcnt(0)
  s_barrier
  s_cmp_eq_u32 s91, 0
  s_cbranch_scc0 XQV_t1
  s_add_u32 s22, s82, 1
  s_cmp_lt_u32 s40, s22
  s_cbranch_scc1 XQV_t1
  s_sub_u32 s22, s40, 1
  s_lshl_b32 s22, s22, 6
  s_add_u32 s22, s22, s47
  v_mov_b32 v7, s22
  s_mov_b64 exec, 1
  buffer_atomic_add v8, v7, s[8:11], 0 offen sc1
  s_mov_b64 exec, -1
XQV_t1:
  s_branch XQ_done
XQ_done:
  s_cmp_eq_u32 s80, 0
  s_cbranch_scc1 XA_start
  s_cmp_eq_u32 s80, 2
  s_cbranch_scc0 XQ_d1
  s_add_u32 s31, s31, 1
  s_cmp_eq_u32 s31, 3
  s_cbranch_scc1 XB_start
  s_mul_i32 s21, s91, 32768
  s_cmp_eq_u32 s31, 2
  s_cbranch_scc1 XQ_d2
  s_mov_b32 s81, 0
  s_mov_b32 s82, 26
  s_mov_b32 s83, 38
  s_load_dwordx2 s[16:17], s[0:1], 24
  s_waitcnt lgkmcnt(0)
  s_and_b32 s17, s17, 0xffff
  s_mov_b32 s18, 7864320
  s_mov_b32 s19, 0x00020000
  s_branch XQ_w
XQ_d2:
  s_mov_b32 s81, 2
  s_mov_b32 s82, 16
  s_mov_b32 s83, 64
  s_load_dwordx2 s[16:17], s[0:1], 16
  s_waitcnt lgkmcnt(0)
  s_and_b32 s17, s17, 0xffff
  s_mov_b32 s18, 7864320
  s_mov_b32 s19, 0x00020000
  s_branch XQ_w
XQ_d1:
  s_cmp_eq_u32 s81, 1
  s_cbranch_scc0 XB_start
  s_mov_b32 s81, 0
  s_mov_b32 s82, 38
  s_mov_b32 s83, 64
  s_mul_i32 s21, s91, 32768
  s_load_dwordx2 s[16:17], s[0:1], 24
  s_waitcnt lgkmcnt(0)
  s_and_b32 s17, s17, 0xffff
  s_mov_b32 s18, 7864320
  s_mov_b32 s19, 0x00020000
  s_branch XQ_w
  s_branch XB_start
XA_start:
  s_barrier
  v_and_b32 v2, 63, v0
  v_lshrrev_b32 v3, 4, v2
  v_and_b32 v4, 15, v2
  s_mul_i32 s21, s91, 32768
  s_load_dwordx2 s[16:17], s[0:1], 40
  s_waitcnt lgkmcnt(0)
  s_and_b32 s17, s17, 0xffff
  s_mov_b32 s18, 7864320
  s_mov_b32 s19, 0x00020000
  v_lshrrev_b32 v6, 2, v4
  v_lshl_add_u32 v6, v3, 2, v6
  v_mul_u32_u24 v6, 96, v6
  v_and_b32 v7, 3, v4
  v_lshl_add_u32 v6, v7, 3, v6
  v_add_u32 v10, s21, v6
  v_lshrrev_b32 v6, 2, v4
  v_lshl_add_u32 v6, v3, 2, v6
  v_mul_u32_u24 v6, 32, v6
  v_and_b32 v7, 3, v4
  v_lshl_add_u32 v6, v7, 3, v6
  v_add_u32 v11, s21, v6
  s_lshr_b32 s26, s5, 1
  s_and_b32 s27, s5, 1
  s_mul_i32 s24, s26, 491520
  s_mul_i32 s25, s27, 640
  s_add_u32 s24, s24, s25
  s_mul_i32 s25, s91, 160
  s_add_u32 s24, s24, s25
  s_and_b32 s28, s91, 1
  s_lshl_b32 s29, s28, 5
  s_add_u32 s30, s29, 96
  s_lshl_b32 s31, s28, 7
  s_sub_u32 s31, 128, s31
  v_add_u32 v7, 0, v2
  v_mul_u32_u24 v8, 10923, v7
  v_lshrrev_b32 v8, 16, v8
  v_mul_u32_u24 v9, 6, v8
  v_sub_u32 v9, v7, v9
  v_mul_u32_u24 v8, 1280, v8
  v_lshl_add_u32 v120, v9, 4, v8
  v_add_u32 v7, 64, v2
  v_mul_u32_u24 v8, 10923, v7
  v_lshrrev_b32 v8, 16, v8
  v_mul_u32_u24 v9, 6, v8
  v_sub_u32 v9, v7, v9
  v_mul_u32_u24 v8, 1280, v8
  v_lshl_add_u32 v121, v9, 4, v8
  v_add_u32 v7, 128, v2
  v_mul_u32_u24 v8, 10923, v7
  v_lshrrev_b32 v8, 16, v8
  v_mul_u32_u24 v9, 6, v8
  v_sub_u32 v9, v7, v9
  v_mul_u32_u24 v8, 1280, v8
  v_lshl_add_u32 v122, v9, 4, v8
  v_lshrrev_b32 v8, 1, v2
  v_and_b32 v9, 1, v2
  v_mul_u32_u24 v8, 1280, v8
  v_lshl_add_u32 v123, v9, 4, v8
  s_add_u32 s25, s24, s29
  s_add_u32 s25, s25, 0
  s_add_u32 m0, s21, 0
  s_nop 0
  buffer_load_dwordx4 v120, s[16:19], s25 offen lds
  s_add_u32 m0, s21, 1024
  s_nop 0
  buffer_load_dwordx4 v121, s[16:19], s25 offen lds
  s_add_u32 m0, s21, 2048
  s_nop 0
  buffer_load_dwordx4 v122, s[16:19], s25 offen lds
  s_add_u32 s25, s25, 40960
  s_add_u32 m0, s21, 3072
  s_nop 0
  buffer_load_dwordx4 v120, s[16:19], s25 offen lds
  s_add_u32 m0, s21, 4096
  s_nop 0
  buffer_load_dwordx4 v121, s[16:19], s25 offen lds
  s_add_u32 m0, s21, 5120
  s_nop 0
  buffer_load_dwordx4 v122, s[16:19], s25 offen lds
  s_add_u32 s25, s25, 40960
  s_add_u32 m0, s21, 6144
  s_nop 0
  buffer_load_dwordx4 v120, s[16:19], s25 offen lds
  s_add_u32 m0, s21, 7168
  s_nop 0
  buffer_load_dwordx4 v121, s[16:19], s25 offen lds
  s_add_u32 m0, s21, 8192
  s_nop 0
  buffer_load_dwordx4 v122, s[16:19], s25 offen lds
  s_add_u32 s25, s24, s30
  s_add_u32 s25, s25, 0
  s_add_u32 m0, s21, 9216
  s_nop 0
  buffer_load_dwordx4 v123, s[16:19], s25 offen lds
  s_add_u32 s25, s25, 40960
  s_add_u32 m0, s21, 10240
  s_nop 0
  buffer_load_dwordx4 v123, s[16:19], s25 offen lds
  s_add_u32 s25, s25, 40960
  s_add_u32 m0, s21, 11264
  s_nop 0
  buffer_load_dwordx4 v123, s[16:19], s25 offen lds
  s_add_u32 s25, s24, s31
  s_add_u32 s25, s25, 0
  s_add_u32 m0, s21, 12288
  s_nop 0
  buffer_load_dwordx4 v123, s[16:19], s25 offen lds
  s_add_u32 s25, s25, 40960
  s_add_u32 m0, s21, 13312
  s_nop 0
  buffer_load_dwordx4 v123, s[16:19], s25 offen lds
  s_add_u32 s25, s25, 40960
  s_add_u32 m0, s21, 14336
  s_nop 0
  buffer_load_dwordx4 v123, s[16:19], s25 offen lds
  s_add_u32 s25, s24, s29
  s_add_u32 s25, s25, 122880
  s_add_u32 m0, s21, 16384
  s_nop 0
  buffer_load_dwordx4 v120, s[16:19], s25 offen lds
  s_add_u32 m0, s21, 17408
  s_nop 0
  buffer_load_dwordx4 v121, s[16:19], s25 offen lds
  s_add_u32 m0, s21, 18432
  s_nop 0
  buffer_load_dwordx4 v122, s[16:19], s25 offen lds
  s_add_u32 s25, s25, 40960
  s_add_u32 m0, s21, 19456
  s_nop 0
  buffer_load_dwordx4 v120, s[16:19], s25 offen lds
  s_add_u32 m0, s21, 20480
  s_nop 0
  buffer_load_dwordx4 v121, s[16:19], s25 offen lds
  s_add_u32 m0, s21, 21504
  s_nop 0
  buffer_load_dwordx4 v122, s[16:19], s25 offen lds
  s_add_u32 s25, s25, 40960
  s_add_u32 m0, s21, 22528
  s_nop 0
  buffer_load_dwordx4 v120, s[16:19], s25 offen lds
  s_add_u32 m0, s21, 23552
  s_nop 0
  buffer_load_dwordx4 v121, s[16:19], s25 offen lds
  s_add_u32 m0, s21, 24576
  s_nop 0
  buffer_load_dwordx4 v122, s[16:19], s25 offen lds
  s_add_u32 s25, s24, s30
  s_add_u32 s25, s25, 122880
  s_add_u32 m0, s21, 25600
  s_nop 0
  buffer_load_dwordx4 v123, s[16:19], s25 offen lds
  s_add_u32 s25, s25, 40960
  s_add_u32 m0, s21, 26624
  s_nop 0
  buffer_load_dwordx4 v123, s[16:19], s25 offen lds
  s_add_u32 s25, s25, 40960
  s_add_u32 m0, s21, 27648
  s_nop 0
  buffer_load_dwordx4 v123, s[16:19], s25 offen lds
  s_add_u32 s25, s24, s31
  s_add_u32 s25, s25, 122880
  s_add_u32 m0, s21, 28672
  s_nop 0
  buffer_load_dwordx4 v123, s[16:19], s25 offen lds
  s_add_u32 s25, s25, 40960
  s_add_u32 m0, s21, 29696
  s_nop 0
  buffer_load_dwordx4 v123, s[16:19], s25 offen lds
  s_add_u32 s25, s25, 40960
  s_add_u32 m0, s21, 30720
  s_nop 0
  buffer_load_dwordx4 v123, s[16:19], s25 offen lds
  s_waitcnt vmcnt(15)
  ds_read_b64_tr_b16 a[0:1], v10 offset:0
  ds_read_b64_tr_b16 a[2:3], v10 offset:1536
  ds_read_b64_tr_b16 a[4:5], v10 offset:3072
  ds_read_b64_tr_b16 a[6:7], v10 offset:4608
  ds_read_b64_tr_b16 a[8:9], v10 offset:6144
  ds_read_b64_tr_b16 a[10:11], v10 offset:7680
  ds_read_b64_tr_b16 a[48:49], v10 offset:32
  ds_read_b64_tr_b16 a[50:51], v10 offset:1568
  ds_read_b64_tr_b16 a[52:53], v10 offset:3104
  ds_read_b64_tr_b16 a[54:55], v10 offset:4640
  ds_read_b64_tr_b16 a[56:57], v10 offset:6176
  ds_read_b64_tr_b16 a[58:59], v10 offset:7712
  ds_read_b64_tr_b16 a[96:97], v10 offset:64
  ds_read_b64_tr_b16 a[98:99], v10 offset:1600
  ds_read_b64_tr_b16 a[100:101], v10 offset:3136
  ds_read_b64_tr_b16 a[102:103], v10 offset:4672
  ds_read_b64_tr_b16 a[104:105], v10 offset:6208
  ds_read_b64_tr_b16 a[106:107], v10 offset:7744
  ds_read_b64_tr_b16 a[144:145], v11 offset:9216
  ds_read_b64_tr_b16 a[146:147], v11 offset:9728
  ds_read_b64_tr_b16 a[148:149], v11 offset:10240
  ds_read_b64_tr_b16 a[150:151], v11 offset:10752
  ds_read_b64_tr_b16 a[152:153], v11 offset:11264
  ds_read_b64_tr_b16 a[154:155], v11 offset:11776
  ds_read_b64_tr_b16 a[192:193], v11 offset:12288
  ds_read_b64_tr_b16 a[194:195], v11 offset:12800
  ds_read_b64_tr_b16 a[196:197], v11 offset:13312
  ds_read_b64_tr_b16 a[198:199], v11 offset:13824
  ds_read_b64_tr_b16 a[200:201], v11 offset:14336
  ds_read_b64_tr_b16 a[202:203], v11 offset:14848
  s_waitcnt lgkmcnt(0)
  s_add_u32 s25, s24, s29
  s_add_u32 s25, s25, 245760
  s_add_u32 m0, s21, 0
  s_nop 0
  buffer_load_dwordx4 v120, s[16:19], s25 offen lds
  s_add_u32 m0, s21, 1024
  s_nop 0
  buffer_load_dwordx4 v121, s[16:19], s25 offen lds
  s_add_u32 m0, s21, 2048
  s_nop 0
  buffer_load_dwordx4 v122, s[16:19], s25 offen lds
  s_add_u32 s25, s25, 40960
  s_add_u32 m0, s21, 3072
  s_nop 0
  buffer_load_dwordx4 v120, s[16:19], s25 offen lds
  s_add_u32 m0, s21, 4096
  s_nop 0
  buffer_load_dwordx4 v121, s[16:19], s25 offen lds
  s_add_u32 m0, s21, 5120
  s_nop 0
  buffer_load_dwordx4 v122, s[16:19], s25 offen lds
  s_add_u32 s25, s25, 40960
  s_add_u32 m0, s21, 6144
  s_nop 0
  buffer_load_dwordx4 v120, s[16:19], s25 offen lds
  s_add_u32 m0, s21, 7168
  s_nop 0
  buffer_load_dwordx4 v121, s[16:19], s25 offen lds
  s_add_u32 m0, s21, 8192
  s_nop 0
  buffer_load_dwordx4 v122, s[16:19], s25 offen lds
  s_add_u32 s25, s24, s30
  s_add_u32 s25, s25, 245760
  s_add_u32 m0, s21, 9216
  s_nop 0
  buffer_load_dwordx4 v123, s[16:19], s25 offen lds
  s_add_u32 s25, s25, 40960
  s_add_u32 m0, s21, 10240
  s_nop 0
  buffer_load_dwordx4 v123, s[16:19], s25 offen lds
  s_add_u32 s25, s25, 40960
  s_add_u32 m0, s21, 11264
  s_nop 0
  buffer_load_dwordx4 v123, s[16:19], s25 offen lds
  s_add_u32 s25, s24, s31
  s_add_u32 s25, s25, 245760
  s_add_u32 m0, s21, 12288
  s_nop 0
  buffer_load_dwordx4 v123, s[16:19], s25 offen lds
  s_add_u32 s25, s25, 40960
  s_add_u32 m0, s21, 13312
  s_nop 0
  buffer_load_dwordx4 v123, s[16:19], s25 offen lds
  s_add_u32 s25, s25, 40960
  s_add_u32 m0, s21, 14336
  s_nop 0
  buffer_load_dwordx4 v123, s[16:19], s25 offen lds
  s_waitcnt vmcnt(15)
  ds_read_b64_tr_b16 a[12:13], v10 offset:16384
  ds_read_b64_tr_b16 a[14:15], v10 offset:17920
  ds_read_b64_tr_b16 a[16:17], v10 offset:19456
  ds_read_b64_tr_b16 a[18:19], v10 offset:20992
  ds_read_b64_tr_b16 a[20:21], v10 offset:22528
  ds_read_b64_tr_b16 a[22:23], v10 offset:24064
  ds_read_b64_tr_b16 a[60:61], v10 offset:16416
  ds_read_b64_tr_b16 a[62:63], v10 offset:17952
  ds_read_b64_tr_b16 a[64:65], v10 offset:19488
  ds_read_b64_tr_b16 a[66:67], v10 offset:21024
  ds_read_b64_tr_b16 a[68:69], v10 offset:22560
  ds_read_b64_tr_b16 a[70:71], v10 offset:24096
  ds_read_b64_tr_b16 a[108:109], v10 offset:16448
  ds_read_b64_tr_b16 a[110:111], v10 offset:17984
  ds_read_b64_tr_b16 a[112:113], v10 offset:19520
  ds_read_b64_tr_b16 a[114:115], v10 offset:21056
  ds_read_b64_tr_b16 a[116:117], v10 offset:22592
  ds_read_b64_tr_b16 a[118:119], v10 offset:24128
  ds_read_b64_tr_b16 a[156:157], v11 offset:25600
  ds_read_b64_tr_b16 a[158:159], v11 offset:26112
  ds_read_b64_tr_b16 a[160:161], v11 offset:26624
  ds_read_b64_tr_b16 a[162:163], v11 offset:27136
  ds_read_b64_tr_b16 a[164:165], v11 offset:27648
  ds_read_b64_tr_b16 a[166:167], v11 offset:28160
  ds_read_b64_tr_b16 a[204:205], v11 offset:28672
  ds_read_b64_tr_b16 a[206:207], v11 offset:29184
  ds_read_b64_tr_b16 a[208:209], v11 offset:29696
  ds_read_b64_tr_b16 a[210:211], v11 offset:30208
  ds_read_b64_tr_b16 a[212:213], v11 offset:30720
  ds_read_b64_tr_b16 a[214:215], v11 offset:31232
  s_waitcnt lgkmcnt(0)
  s_add_u32 s25, s24, s29
  s_add_u32 s25, s25, 368640
  s_add_u32 m0, s21, 16384
  s_nop 0
  buffer_load_dwordx4 v120, s[16:19], s25 offen lds
  s_add_u32 m0, s21, 17408
  s_nop 0
  buffer_load_dwordx4 v121, s[16:19], s25 offen lds
  s_add_u32 m0, s21, 18432
  s_nop 0
  buffer_load_dwordx4 v122, s[16:19], s25 offen lds
  s_add_u32 s25, s25, 40960
  s_add_u32 m0, s21, 19456
  s_nop 0
  buffer_load_dwordx4 v120, s[16:19], s25 offen lds
  s_add_u32 m0, s21, 20480
  s_nop 0
  buffer_load_dwordx4 v121, s[16:19], s25 offen lds
  s_add_u32 m0, s21, 21504
  s_nop 0
  buffer_load_dwordx4 v122, s[16:19], s25 offen lds
  s_add_u32 s25, s25, 40960
  s_add_u32 m0, s21, 22528
  s_nop 0
  buffer_load_dwordx4 v120, s[16:19], s25 offen lds
  s_add_u32 m0, s21, 23552
  s_nop 0
  buffer_load_dwordx4 v121, s[16:19], s25 offen lds
  s_add_u32 m0, s21, 24576
  s_nop 0
  buffer_load_dwordx4 v122, s[16:19], s25 offen lds
  s_add_u32 s25, s24, s30
  s_add_u32 s25, s25, 368640
  s_add_u32 m0, s21, 25600
  s_nop 0
  buffer_load_dwordx4 v123, s[16:19], s25 offen lds
  s_add_u32 s25, s25, 40960
  s_add_u32 m0, s21, 26624
  s_nop 0
  buffer_load_dwordx4 v123, s[16:19], s25 offen lds
  s_add_u32 s25, s25, 40960
  s_add_u32 m0, s21, 27648
  s_nop 0
  buffer_load_dwordx4 v123, s[16:19], s25 offen lds
  s_add_u32 s25, s24, s31
  s_add_u32 s25, s25, 368640
  s_add_u32 m0, s21, 28672
  s_nop 0
  buffer_load_dwordx4 v123, s[16:19], s25 offen lds
  s_add_u32 s25, s25, 40960
  s_add_u32 m0, s21, 29696
  s_nop 0
  buffer_load_dwordx4 v123, s[16:19], s25 offen lds
  s_add_u32 s25, s25, 40960
  s_add_u32 m0, s21, 30720
  s_nop 0
  buffer_load_dwordx4 v123, s[16:19], s25 offen lds
  s_waitcnt vmcnt(15)
  ds_read_b64_tr_b16 a[24:25], v10 offset:0
  ds_read_b64_tr_b16 a[26:27], v10 offset:1536
  ds_read_b64_tr_b16 a[28:29], v10 offset:3072
  ds_read_b64_tr_b16 a[30:31], v10 offset:4608
  ds_read_b64_tr_b16 a[32:33], v10 offset:6144
  ds_read_b64_tr_b16 a[34:35], v10 offset:7680
  ds_read_b64_tr_b16 a[72:73], v10 offset:32
  ds_read_b64_tr_b16 a[74:75], v10 offset:1568
  ds_read_b64_tr_b16 a[76:77], v10 offset:3104
  ds_read_b64_tr_b16 a[78:79], v10 offset:4640
  ds_read_b64_tr_b16 a[80:81], v10 offset:6176
  ds_read_b64_tr_b16 a[82:83], v10 offset:7712
  ds_read_b64_tr_b16 a[120:121], v10 offset:64
  ds_read_b64_tr_b16 a[122:123], v10 offset:1600
  ds_read_b64_tr_b16 a[124:125], v10 offset:3136
  ds_read_b64_tr_b16 a[126:127], v10 offset:4672
  ds_read_b64_tr_b16 a[128:129], v10 offset:6208
  ds_read_b64_tr_b16 a[130:131], v10 offset:7744
  ds_read_b64_tr_b16 a[168:169], v11 offset:9216
  ds_read_b64_tr_b16 a[170:171], v11 offset:9728
  ds_read_b64_tr_b16 a[172:173], v11 offset:10240
  ds_read_b64_tr_b16 a[174:175], v11 offset:10752
  ds_read_b64_tr_b16 a[176:177], v11 offset:11264
  ds_read_b64_tr_b16 a[178:179], v11 offset:11776
  ds_read_b64_tr_b16 a[216:217], v11 offset:12288
  ds_read_b64_tr_b16 a[218:219], v11 offset:12800
  ds_read_b64_tr_b16 a[220:221], v11 offset:13312
  ds_read_b64_tr_b16 a[222:223], v11 offset:13824
  ds_read_b64_tr_b16 a[224:225], v11 offset:14336
  ds_read_b64_tr_b16 a[226:227], v11 offset:14848
  s_waitcnt lgkmcnt(0)
  s_waitcnt vmcnt(0)
  ds_read_b64_tr_b16 a[36:37], v10 offset:16384
  ds_read_b64_tr_b16 a[38:39], v10 offset:17920
  ds_read_b64_tr_b16 a[40:41], v10 offset:19456
  ds_read_b64_tr_b16 a[42:43], v10 offset:20992
  ds_read_b64_tr_b16 a[44:45], v10 offset:22528
  ds_read_b64_tr_b16 a[46:47], v10 offset:24064
  ds_read_b64_tr_b16 a[84:85], v10 offset:16416
  ds_read_b64_tr_b16 a[86:87], v10 offset:17952
  ds_read_b64_tr_b16 a[88:89], v10 offset:19488
  ds_read_b64_tr_b16 a[90:91], v10 offset:21024
  ds_read_b64_tr_b16 a[92:93], v10 offset:22560
  ds_read_b64_tr_b16 a[94:95], v10 offset:24096
  ds_read_b64_tr_b16 a[132:133], v10 offset:16448
  ds_read_b64_tr_b16 a[134:135], v10 offset:17984
  ds_read_b64_tr_b16 a[136:137], v10 offset:19520
  ds_read_b64_tr_b16 a[138:139], v10 offset:21056
  ds_read_b64_tr_b16 a[140:141], v10 offset:22592
  ds_read_b64_tr_b16 a[142:143], v10 offset:24128
  ds_read_b64_tr_b16 a[180:181], v11 offset:25600
  ds_read_b64_tr_b16 a[182:183], v11 offset:26112
  ds_read_b64_tr_b16 a[184:185], v11 offset:26624
  ds_read_b64_tr_b16 a[186:187], v11 offset:27136
  ds_read_b64_tr_b16 a[188:189], v11 offset:27648
  ds_read_b64_tr_b16 a[190:191], v11 offset:28160
  ds_read_b64_tr_b16 a[228:229], v11 offset:28672
  ds_read_b64_tr_b16 a[230:231], v11 offset:29184
  ds_read_b64_tr_b16 a[232:233], v11 offset:29696
  ds_read_b64_tr_b16 a[234:235], v11 offset:30208
  ds_read_b64_tr_b16 a[236:237], v11 offset:30720
  ds_read_b64_tr_b16 a[238:239], v11 offset:31232
  s_waitcnt lgkmcnt(0)
  s_waitcnt vmcnt(0)
  s_barrier
  s_cmp_eq_u32 s91, 0
  s_cbranch_scc0 XA_isw_ok
  v_and_b32 v251, 63, v0
  v_mov_b32 v252, 64
  v_mov_b32 v250, 128
  v_cmp_eq_u32 vcc, 1, v251
  v_mov_b32 v253, 32
  s_nop 0
  v_cndmask_b32 v252, v252, v253, vcc
  v_mov_b32 v253, 32
  v_cndmask_b32 v250, v250, v253, vcc
  s_mov_b64 exec, 3
XA_isw_w:
  buffer_load_dword v253, v252, s[12:15], 0 offen sc1
  s_waitcnt vmcnt(0)
  v_cmp_gt_u32 vcc, v250, v253
  s_cbranch_vccz XA_isw_x
  s_sleep 18
  s_add_u32 s41, s41, 64
  s_cmp_lt_u32 s41, 4000000
  s_cbranch_scc1 XA_isw_w
XA_isw_x:
  s_mov_b64 exec, -1
XA_isw_ok:
  s_barrier
  s_load_dwordx2 s[12:13], s[0:1], 0
  s_waitcnt lgkmcnt(0)
  s_and_b32 s13, s13, 0xffff
  s_mov_b32 s14, 2621440
  s_mov_b32 s15, 0x00020000
  v_lshlrev_b32 v6, 4, v0
  v_cmp_gt_u32 vcc, 160, v0
  s_nop 0
  s_and_saveexec_b64 s[22:23], vcc
  s_cbranch_execz XA_m
  s_mov_b32 s20, 5120
  buffer_load_dwordx4 v[16:19], v6, s[8:11], s20 offen
  s_mov_b32 s20, 10240
  buffer_load_dwordx4 v[20:23], v6, s[8:11], s20 offen
  s_mov_b32 s20, 7680
  buffer_load_dwordx4 v[24:27], v6, s[8:11], s20 offen
  s_waitcnt vmcnt(0)
  v_add_u32 v6, 94208, v6
  ds_write_b128 v6, v[16:19]
  ds_write_b128 v6, v[20:23] offset:2560
  ds_write_b128 v6, v[24:27] offset:5120
XA_m:
  s_mov_b64 exec, s[22:23]
  s_waitcnt lgkmcnt(0)
  v_lshlrev_b32 v5, 4, v2
  v_and_b32 v6, 7, v4
  v_lshlrev_b32 v7, 7, v3
  v_lshl_add_u32 v7, v6, 4, v7
  v_and_b32 v8, 1, v3
  v_lshlrev_b32 v8, 8, v8
  v_lshl_add_u32 v8, v4, 4, v8
  v_mul_u32_u24 v9, 40960, v6
  v_lshrrev_b32 v6, 3, v4
  v_lshl_add_u32 v9, v6, 6, v9
  v_lshl_add_u32 v9, v3, 4, v9
  v_mul_u32_u24 v1, 40960, v4
  v_lshl_add_u32 v1, v3, 4, v1
  v_lshlrev_b32 v10, 3, v2
  v_lshrrev_b32 v11, 3, v0
  v_lshlrev_b32 v11, 10, v11
  v_and_b32 v6, 3, v0
  v_lshl_add_u32 v11, v6, 8, v11
  v_bfe_u32 v6, v0, 2, 1
  v_lshl_add_u32 v11, v6, 3, v11
  v_lshlrev_b32 v200, 4, v0
  v_lshlrev_b32 v201, 3, v0
  v_mov_b32 v6, 160
  v_cmp_gt_u32 s[86:87], v6, v0
  s_and_b32 s20, s5, 15
  s_lshl_b32 s20, s20, 4
  v_add_u32 v11, s20, v11
  s_mul_i32 s20, s91, 5120
  s_add_u32 s20, s20, 73728
  v_add_u32 v12, s20, v5
  v_mov_b32 v13, 4587520
  v_mov_b32 v6, 4591616
  v_cmp_eq_u32 vcc, 1, v2
  s_nop 1
  v_cndmask_b32 v13, v13, v6, vcc
  v_mov_b32 v14, 64
  v_mov_b32 v6, 32
  v_cndmask_b32 v14, v14, v6, vcc
  s_mul_i32 s21, s80, 4194304
  s_add_u32 s21, s21, 177209344
  s_mul_i32 s22, s26, 2560
  s_mul_i32 s23, s27, 1280
  s_add_u32 s22, s22, s23
  s_mul_i32 s23, s91, 320
  s_add_u32 s22, s22, s23
  s_add_u32 s44, s21, s22
  s_lshl_b32 s23, s28, 6
  s_add_u32 s38, s44, s23
  s_lshl_b32 s23, s28, 8
  s_sub_u32 s23, 256, s23
  s_add_u32 s39, s44, s23
  s_mul_i32 s22, s5, 40960
  s_mul_i32 s23, s91, 10240
  s_add_u32 s22, s22, s23
  s_add_u32 s46, s21, s22
  s_lshl_b32 s47, s80, 10
  s_add_u32 s47, s47, 4612096
  s_lshl_b32 s48, s5, 4
  s_lshl_b32 s22, s91, 2
  s_add_u32 s48, s48, s22
  s_add_u32 s48, s48, s47
  s_and_b32 s49, s91, 1
  s_lshl_b32 s49, s49, 4
  s_lshl_b32 s45, s26, 1
  s_mov_b32 s41, 0
  s_mov_b32 s42, 0
  s_mov_b32 s43, 0
  s_mov_b32 s56, -1
  s_mov_b32 s58, 0
  s_mov_b32 s94, -2
  s_barrier
  s_mov_b32 s34, 0
  s_mov_b32 s35, 4026531840
  s_mov_b32 s24, 2863311488
  s_mov_b32 s25, 2863311530
  s_mov_b32 s26, 2863311528
  s_mov_b32 s27, 2863311530
  s_mov_b32 s28, 1431655767
  s_mov_b32 s29, 1431655765
  s_mov_b32 s30, 1431655807
  s_mov_b32 s31, 1431655765
  s_cmp_eq_u32 s80, 1
  s_cselect_b32 s36, s26, s24
  s_cselect_b32 s37, s27, s25
  s_cmp_eq_u32 s80, 2
  s_cselect_b32 s36, s28, s36
  s_cselect_b32 s37, s29, s37
  s_cmp_eq_u32 s80, 3
  s_cselect_b32 s36, s30, s36
  s_cselect_b32 s37, s31, s37
  s_ff1_i32_b64 s40, s[36:37]
  s_bitset0_b64 s[36:37], s40
XA_g0:
  s_lshl_b32 s22, s40, 6
  s_mov_b64 exec, 3
  buffer_load_dword v15, v13, s[8:11], s22 offen sc1
  s_mov_b64 exec, -1
  s_waitcnt vmcnt(0)
  s_mov_b64 exec, 3
  v_cmp_gt_u32 vcc, v14, v15
  s_mov_b64 exec, -1
  s_cbranch_vccz XA_g0ok
  s_sleep 8
  s_add_u32 s41, s41, 1
  s_cmp_lt_u32 s41, 3000000
  s_cbranch_scc1 XA_g0
  s_branch K3_end
XA_g0ok:
  s_lshl_b32 s50, s40, 5
  s_add_u32 s50, s50, s45
  s_mul_i32 s51, s50, 12288
  s_mul_i32 s92, s91, 3072
  s_add_u32 s51, s51, s92
  s_lshr_b32 s23, s91, 1
  s_add_u32 s50, s50, s23
  s_mul_i32 s52, s50, 3072
  s_add_u32 s52, s52, 5242880
  s_add_u32 s53, s51, 75497472
  s_add_u32 m0, s92, 0
  s_nop 0
  buffer_load_dwordx4 v5, s[8:11], s53 offen offset:0 lds
  buffer_load_dwordx4 v5, s[8:11], s53 offen offset:1024 lds
  buffer_load_dwordx4 v5, s[8:11], s53 offen offset:2048 lds
  s_add_u32 s53, s51, 100663296
  s_add_u32 m0, s92, 12288
  s_nop 0
  buffer_load_dwordx4 v5, s[8:11], s53 offen offset:0 lds
  buffer_load_dwordx4 v5, s[8:11], s53 offen offset:1024 lds
  buffer_load_dwordx4 v5, s[8:11], s53 offen offset:2048 lds
  s_add_u32 s53, s51, 75509760
  s_add_u32 m0, s92, 24576
  s_nop 0
  buffer_load_dwordx4 v5, s[8:11], s53 offen offset:0 lds
  buffer_load_dwordx4 v5, s[8:11], s53 offen offset:1024 lds
  buffer_load_dwordx4 v5, s[8:11], s53 offen offset:2048 lds
  s_add_u32 s53, s51, 100675584
  s_add_u32 m0, s92, 36864
  s_nop 0
  buffer_load_dwordx4 v5, s[8:11], s53 offen offset:0 lds
  buffer_load_dwordx4 v5, s[8:11], s53 offen offset:1024 lds
  buffer_load_dwordx4 v5, s[8:11], s53 offen offset:2048 lds
  s_mul_i32 s89, s50, 12288
  s_mul_i32 s53, s49, 384
  s_add_u32 s89, s89, s53
  s_add_u32 s89, s89, 50331648
  buffer_load_dwordx4 v[16:19], v5, s[8:11], s89 offen offset:0
  buffer_load_dwordx4 v[20:23], v5, s[8:11], s89 offen offset:1024
  buffer_load_dwordx4 v[24:27], v5, s[8:11], s89 offen offset:2048
  buffer_load_dwordx4 v[28:31], v5, s[8:11], s89 offen offset:3072
  s_add_u32 s89, s89, 4096
  buffer_load_dwordx4 v[32:35], v5, s[8:11], s89 offen offset:0
  buffer_load_dwordx4 v[36:39], v5, s[8:11], s89 offen offset:1024
  buffer_load_dwordx4 v[208:211], v7, s[8:11], s52 offen offset:0 sc1
  buffer_load_dwordx4 v[212:215], v7, s[8:11], s52 offen offset:512 sc1
  buffer_load_dwordx4 v[216:219], v7, s[8:11], s52 offen offset:1024 sc1
  buffer_load_dwordx4 v[220:223], v7, s[8:11], s52 offen offset:1536 sc1
  buffer_load_dwordx4 v[224:227], v7, s[8:11], s52 offen offset:2048 sc1
  buffer_load_dwordx4 v[228:231], v7, s[8:11], s52 offen offset:2560 sc1
  s_add_u32 s88, s52, 7340032
  buffer_load_dwordx4 v[232:235], v8, s[8:11], s88 offen offset:0 sc1
  buffer_load_dwordx4 v[236:239], v8, s[8:11], s88 offen offset:512 sc1
  buffer_load_dwordx4 v[240:243], v8, s[8:11], s88 offen offset:1024 sc1
  buffer_load_dwordx4 v[244:247], v8, s[8:11], s88 offen offset:1536 sc1
  buffer_load_dwordx4 v[248:251], v8, s[8:11], s88 offen offset:2048 sc1
  buffer_load_dwordx4 v[252:255], v8, s[8:11], s88 offen offset:2560 sc1
  s_mov_b32 s95, 0
  s_mov_b32 s96, 0
XA_loop:
  s_mov_b32 s85, s40
  s_ff1_i32_b64 s54, s[36:37]
  s_cmp_eq_u32 s95, 1
  s_cbranch_scc1 XA_lw
  s_waitcnt vmcnt(0)
XA_lw:
  s_mov_b32 s95, 0
  s_barrier
  buffer_load_dwordx2 v[206:207], v10, s[8:11], s47 offen sc1
  buffer_load_dwordx2 v[162:163], v10, s[8:11], s47 offen offset:512 sc1
  s_mov_b32 s93, 0
  s_cmp_eq_u32 s54, -1
  s_cbranch_scc1 XA_ng
  s_cmp_eq_u32 s94, s54
  s_cbranch_scc0 XA_ge
  s_mov_b64 exec, 3
  v_cmp_gt_u32 vcc, v14, v204
  s_mov_b64 exec, -1
  s_cbranch_vccnz XA_ge
  s_mov_b32 s93, 1
XA_ge:
  s_mov_b64 s[22:23], s[36:37]
  s_bitset0_b64 s[22:23], s54
  s_ff1_i32_b64 s94, s[22:23]
  s_cmp_eq_u32 s94, -1
  s_cbranch_scc1 XA_gf
  s_lshl_b32 s22, s94, 6
  s_mov_b64 exec, 3
  buffer_load_dword v204, v13, s[8:11], s22 offen sc1
  s_mov_b64 exec, -1
XA_gf:
  s_cmp_eq_u32 s93, 1
  s_cbranch_scc1 XA_ng
  s_lshl_b32 s22, s54, 6
  s_mov_b64 exec, 3
  buffer_load_dword v15, v13, s[8:11], s22 offen sc1
  s_mov_b64 exec, -1
XA_ng:
  s_lshr_b32 s22, s91, 1
  s_mul_i32 s22, s22, 24576
  s_add_u32 s22, s22, 0
  v_add_u32 v6, s22, v5
  ds_read_b128 v[40:43], v6 offset:0
  ds_read_b128 v[44:47], v6 offset:1024
  ds_read_b128 v[48:51], v6 offset:2048
  ds_read_b128 v[52:55], v6 offset:3072
  ds_read_b128 v[56:59], v6 offset:4096
  ds_read_b128 v[60:63], v6 offset:5120
  ds_read_b128 v[64:67], v6 offset:6144
  ds_read_b128 v[68:71], v6 offset:7168
  ds_read_b128 v[72:75], v6 offset:8192
  ds_read_b128 v[76:79], v6 offset:9216
  ds_read_b128 v[80:83], v6 offset:10240
  ds_read_b128 v[84:87], v6 offset:11264
  ds_read_b128 v[88:91], v6 offset:12288
  ds_read_b128 v[92:95], v6 offset:13312
  ds_read_b128 v[96:99], v6 offset:14336
  ds_read_b128 v[100:103], v6 offset:15360
  ds_read_b128 v[104:107], v6 offset:16384
  ds_read_b128 v[108:111], v6 offset:17408
  ds_read_b128 v[112:115], v6 offset:18432
  ds_read_b128 v[116:119], v6 offset:19456
  ds_read_b128 v[120:123], v6 offset:20480
  ds_read_b128 v[124:127], v6 offset:21504
  ds_read_b128 v[128:131], v6 offset:22528
  ds_read_b128 v[132:135], v6 offset:23552
  v_max3_u32 v149, v208, v209, v210
  v_max3_u32 v149, v149, v211, v212
  v_max3_u32 v149, v149, v213, v214
  v_max3_u32 v149, v149, v215, v216
  v_max3_u32 v149, v149, v217, v218
  v_max3_u32 v149, v149, v219, v220
  v_max3_u32 v149, v149, v221, v222
  v_max3_u32 v149, v149, v223, v224
  v_max3_u32 v149, v149, v225, v226
  v_max3_u32 v149, v149, v227, v228
  v_max3_u32 v149, v149, v229, v230
  v_max3_u32 v149, v149, v231, v232
  v_max3_u32 v149, v149, v233, v234
  v_max3_u32 v149, v149, v235, v236
  v_max3_u32 v149, v149, v237, v238
  v_max3_u32 v149, v149, v239, v240
  v_max3_u32 v149, v149, v241, v242
  v_max3_u32 v149, v149, v243, v244
  v_max3_u32 v149, v149, v245, v246
  v_max3_u32 v149, v149, v247, v248
  v_max3_u32 v149, v149, v249, v250
  v_max3_u32 v149, v149, v251, v252
  v_max3_u32 v149, v149, v253, v254
  v_max_u32 v149, v149, v255
  v_cmp_eq_u32 s[22:23], -1, v149
  s_waitcnt lgkmcnt(12)
  v_mfma_f32_16x16x32_bf16 v[136:139], v[40:43], v[16:19], 0
  v_mfma_f32_16x16x32_bf16 v[140:143], v[64:67], v[16:19], 0
  v_mfma_f32_16x16x32_bf16 v[136:139], v[44:47], v[20:23], v[136:139]
  v_mfma_f32_16x16x32_bf16 v[140:143], v[68:71], v[20:23], v[140:143]
  v_mfma_f32_16x16x32_bf16 v[136:139], v[48:51], v[24:27], v[136:139]
  v_mfma_f32_16x16x32_bf16 v[140:143], v[72:75], v[24:27], v[140:143]
  v_mfma_f32_16x16x32_bf16 v[136:139], v[52:55], v[28:31], v[136:139]
  v_mfma_f32_16x16x32_bf16 v[140:143], v[76:79], v[28:31], v[140:143]
  v_mfma_f32_16x16x32_bf16 v[136:139], v[56:59], v[32:35], v[136:139]
  v_mfma_f32_16x16x32_bf16 v[140:143], v[80:83], v[32:35], v[140:143]
  v_mfma_f32_16x16x32_bf16 v[136:139], v[60:63], v[36:39], v[136:139]
  v_mfma_f32_16x16x32_bf16 v[140:143], v[84:87], v[36:39], v[140:143]
  s_cmp_eq_u64 s[22:23], 0
  s_cbranch_scc1 XA_kmok
XA_km:
  buffer_load_dwordx4 v[208:211], v7, s[8:11], s52 offen offset:0 sc1
  buffer_load_dwordx4 v[212:215], v7, s[8:11], s52 offen offset:512 sc1
  buffer_load_dwordx4 v[216:219], v7, s[8:11], s52 offen offset:1024 sc1
  buffer_load_dwordx4 v[220:223], v7, s[8:11], s52 offen offset:1536 sc1
  buffer_load_dwordx4 v[224:227], v7, s[8:11], s52 offen offset:2048 sc1
  buffer_load_dwordx4 v[228:231], v7, s[8:11], s52 offen offset:2560 sc1
  s_add_u32 s88, s52, 7340032
  buffer_load_dwordx4 v[232:235], v8, s[8:11], s88 offen offset:0 sc1
  buffer_load_dwordx4 v[236:239], v8, s[8:11], s88 offen offset:512 sc1
  buffer_load_dwordx4 v[240:243], v8, s[8:11], s88 offen offset:1024 sc1
  buffer_load_dwordx4 v[244:247], v8, s[8:11], s88 offen offset:1536 sc1
  buffer_load_dwordx4 v[248:251], v8, s[8:11], s88 offen offset:2048 sc1
  buffer_load_dwordx4 v[252:255], v8, s[8:11], s88 offen offset:2560 sc1
  s_waitcnt vmcnt(0)
  v_max3_u32 v148, v208, v209, v210
  v_max3_u32 v148, v148, v211, v212
  v_max3_u32 v148, v148, v213, v214
  v_max3_u32 v148, v148, v215, v216
  v_max3_u32 v148, v148, v217, v218
  v_max3_u32 v148, v148, v219, v220
  v_max3_u32 v148, v148, v221, v222
  v_max3_u32 v148, v148, v223, v224
  v_max3_u32 v148, v148, v225, v226
  v_max3_u32 v148, v148, v227, v228
  v_max3_u32 v148, v148, v229, v230
  v_max3_u32 v148, v148, v231, v232
  v_max3_u32 v148, v148, v233, v234
  v_max3_u32 v148, v148, v235, v236
  v_max3_u32 v148, v148, v237, v238
  v_max3_u32 v148, v148, v239, v240
  v_max3_u32 v148, v148, v241, v242
  v_max3_u32 v148, v148, v243, v244
  v_max3_u32 v148, v148, v245, v246
  v_max3_u32 v148, v148, v247, v248
  v_max3_u32 v148, v148, v249, v250
  v_max3_u32 v148, v148, v251, v252
  v_max3_u32 v148, v148, v253, v254
  v_max_u32 v148, v148, v255
  v_cmp_eq_u32 vcc, -1, v148
  s_cbranch_vccz XA_kmok
  s_add_u32 s41, s41, 1
  s_cmp_lt_u32 s41, 3000000
  s_cbranch_scc1 XA_km
  s_branch K3_end
XA_kmok:
  v_mfma_f32_16x16x32_bf16 v[144:147], v[208:211], v[16:19], 0
  v_mfma_f32_16x16x32_bf16 v[144:147], v[212:215], v[20:23], v[144:147]
  v_mfma_f32_16x16x32_bf16 v[144:147], v[216:219], v[24:27], v[144:147]
  v_mfma_f32_16x16x32_bf16 v[144:147], v[220:223], v[28:31], v[144:147]
  v_mfma_f32_16x16x32_bf16 v[144:147], v[224:227], v[32:35], v[144:147]
  v_mfma_f32_16x16x32_bf16 v[144:147], v[228:231], v[36:39], v[144:147]
  s_waitcnt lgkmcnt(0)
  s_barrier
  s_cmp_eq_u32 s93, 1
  s_cbranch_scc0 XA_e0
  s_lshl_b32 s50, s54, 5
  s_add_u32 s50, s50, s45
  s_mul_i32 s51, s50, 12288
  s_mul_i32 s92, s91, 3072
  s_add_u32 s51, s51, s92
  s_lshr_b32 s23, s91, 1
  s_add_u32 s50, s50, s23
  s_mul_i32 s52, s50, 3072
  s_add_u32 s52, s52, 5242880
XA_e0:
  v_lshlrev_b32 v6, 2, v3
  s_cmp_eq_u32 s93, 1
  s_cbranch_scc0 XA_es11097
  s_add_u32 s53, s51, 75497472
  s_add_u32 m0, s92, 0
  s_nop 0
  buffer_load_dwordx4 v5, s[8:11], s53 offen offset:0 lds
  buffer_load_dwordx4 v5, s[8:11], s53 offen offset:1024 lds
  buffer_load_dwordx4 v5, s[8:11], s53 offen offset:2048 lds
XA_es11097:
  v_cvt_pk_bf16_f32 v148, v136, v137
  v_lshlrev_b32 v136, 16, v148
  v_and_b32 v137, 0xffff0000, v148
  v_cvt_pk_bf16_f32 v148, v138, v139
  v_lshlrev_b32 v138, 16, v148
  v_and_b32 v139, 0xffff0000, v148
  v_cvt_pk_bf16_f32 v148, v140, v141
  v_lshlrev_b32 v140, 16, v148
  v_and_b32 v141, 0xffff0000, v148
  v_cvt_pk_bf16_f32 v148, v142, v143
  v_lshlrev_b32 v142, 16, v148
  v_and_b32 v143, 0xffff0000, v148
  v_cvt_pk_bf16_f32 v148, v144, v145
  v_lshlrev_b32 v144, 16, v148
  v_and_b32 v145, 0xffff0000, v148
  v_cvt_pk_bf16_f32 v148, v146, v147
  v_lshlrev_b32 v146, 16, v148
  v_and_b32 v147, 0xffff0000, v148
  s_cmp_eq_u32 s93, 1
  s_cbranch_scc0 XA_es11123
  s_add_u32 s53, s51, 100663296
  s_add_u32 m0, s92, 12288
  s_nop 0
  buffer_load_dwordx4 v5, s[8:11], s53 offen offset:0 lds
  buffer_load_dwordx4 v5, s[8:11], s53 offen offset:1024 lds
  buffer_load_dwordx4 v5, s[8:11], s53 offen offset:2048 lds
XA_es11123:
  v_mul_f32 v136, 0x3d93cd3a, v136
  v_mul_f32 v137, 0x3d93cd3a, v137
  v_mul_f32 v138, 0x3d93cd3a, v138
  v_mul_f32 v139, 0x3d93cd3a, v139
  v_mul_f32 v140, 0x3d93cd3a, v140
  v_mul_f32 v141, 0x3d93cd3a, v141
  v_mul_f32 v142, 0x3d93cd3a, v142
  v_mul_f32 v143, 0x3d93cd3a, v143
  v_mul_f32 v144, 0x3d93cd3a, v144
  v_mul_f32 v145, 0x3d93cd3a, v145
  v_mul_f32 v146, 0x3d93cd3a, v146
  v_mul_f32 v147, 0x3d93cd3a, v147
  v_cvt_pk_bf16_f32 v148, v136, v137
  v_lshlrev_b32 v136, 16, v148
  v_and_b32 v137, 0xffff0000, v148
  v_cvt_pk_bf16_f32 v148, v138, v139
  v_lshlrev_b32 v138, 16, v148
  v_and_b32 v139, 0xffff0000, v148
  v_cvt_pk_bf16_f32 v148, v140, v141
  v_lshlrev_b32 v140, 16, v148
  v_and_b32 v141, 0xffff0000, v148
  v_cvt_pk_bf16_f32 v148, v142, v143
  v_lshlrev_b32 v142, 16, v148
  v_and_b32 v143, 0xffff0000, v148
  v_cvt_pk_bf16_f32 v148, v144, v145
  v_lshlrev_b32 v144, 16, v148
  v_and_b32 v145, 0xffff0000, v148
  v_cvt_pk_bf16_f32 v148, v146, v147
  v_lshlrev_b32 v146, 16, v148
  v_and_b32 v147, 0xffff0000, v148
  s_cmp_eq_u32 s93, 1
  s_cbranch_scc0 XA_es11161
  s_add_u32 s53, s51, 75509760
  s_add_u32 m0, s92, 24576
  s_nop 0
  buffer_load_dwordx4 v5, s[8:11], s53 offen offset:0 lds
  buffer_load_dwordx4 v5, s[8:11], s53 offen offset:1024 lds
  buffer_load_dwordx4 v5, s[8:11], s53 offen offset:2048 lds
XA_es11161:
  v_mov_b32 v149, 0xce6e6b28
  v_add_u32 v150, s49, v4
  v_add_u32 v151, 0, v6
  v_cmp_le_u32 vcc, v151, v150
  s_nop 1
  v_cndmask_b32 v136, v149, v136, vcc
  v_add_u32 v151, 1, v6
  v_cmp_le_u32 vcc, v151, v150
  s_nop 1
  v_cndmask_b32 v137, v149, v137, vcc
  v_add_u32 v151, 2, v6
  v_cmp_le_u32 vcc, v151, v150
  s_nop 1
  v_cndmask_b32 v138, v149, v138, vcc
  v_add_u32 v151, 3, v6
  v_cmp_le_u32 vcc, v151, v150
  s_nop 1
  v_cndmask_b32 v139, v149, v139, vcc
  v_add_u32 v151, 16, v6
  v_cmp_le_u32 vcc, v151, v150
  s_nop 1
  v_cndmask_b32 v140, v149, v140, vcc
  v_add_u32 v151, 17, v6
  v_cmp_le_u32 vcc, v151, v150
  s_nop 1
  v_cndmask_b32 v141, v149, v141, vcc
  v_add_u32 v151, 18, v6
  v_cmp_le_u32 vcc, v151, v150
  s_nop 1
  v_cndmask_b32 v142, v149, v142, vcc
  v_add_u32 v151, 19, v6
  v_cmp_le_u32 vcc, v151, v150
  s_nop 1
  v_cndmask_b32 v143, v149, v143, vcc
  s_cmp_eq_u32 s93, 1
  s_cbranch_scc0 XA_es11195
  s_add_u32 s53, s51, 100675584
  s_add_u32 m0, s92, 36864
  s_nop 0
  buffer_load_dwordx4 v5, s[8:11], s53 offen offset:0 lds
  buffer_load_dwordx4 v5, s[8:11], s53 offen offset:1024 lds
  buffer_load_dwordx4 v5, s[8:11], s53 offen offset:2048 lds
XA_es11195:
  v_cmp_gt_u32 vcc, 2, v3
  v_mov_b32 v152, 0xff800000
  s_nop 0
  v_cndmask_b32 v144, v152, v144, vcc
  v_cndmask_b32 v145, v152, v145, vcc
  v_cndmask_b32 v146, v152, v146, vcc
  v_cndmask_b32 v147, v152, v147, vcc
  v_max3_f32 v148, v136, v137, v138
  v_max3_f32 v148, v148, v139, v140
  v_max3_f32 v148, v148, v141, v142
  v_max3_f32 v148, v148, v143, v144
  v_max3_f32 v148, v148, v145, v146
  v_max_f32 v148, v148, v147
  v_mov_b32 v149, v148
  s_nop 1
  v_permlane32_swap_b32 v148, v149
  v_max_f32 v148, v148, v149
  v_mov_b32 v149, v148
  s_nop 1
  v_permlane16_swap_b32 v148, v149
  v_max_f32 v148, v148, v149
  v_sub_f32 v136, v136, v148
  v_mul_f32 v136, 0x3fb8aa3b, v136
  v_exp_f32 v136, v136
  v_sub_f32 v137, v137, v148
  v_mul_f32 v137, 0x3fb8aa3b, v137
  v_exp_f32 v137, v137
  v_sub_f32 v138, v138, v148
  v_mul_f32 v138, 0x3fb8aa3b, v138
  v_exp_f32 v138, v138
  v_sub_f32 v139, v139, v148
  v_mul_f32 v139, 0x3fb8aa3b, v139
  v_exp_f32 v139, v139
  v_sub_f32 v140, v140, v148
  v_mul_f32 v140, 0x3fb8aa3b, v140
  v_exp_f32 v140, v140
  v_sub_f32 v141, v141, v148
  v_mul_f32 v141, 0x3fb8aa3b, v141
  v_exp_f32 v141, v141
  v_sub_f32 v142, v142, v148
  v_mul_f32 v142, 0x3fb8aa3b, v142
  v_exp_f32 v142, v142
  v_sub_f32 v143, v143, v148
  v_mul_f32 v143, 0x3fb8aa3b, v143
  v_exp_f32 v143, v143
  v_sub_f32 v144, v144, v148
  v_mul_f32 v144, 0x3fb8aa3b, v144
  v_exp_f32 v144, v144
  v_sub_f32 v145, v145, v148
  v_mul_f32 v145, 0x3fb8aa3b, v145
  v_exp_f32 v145, v145
  v_sub_f32 v146, v146, v148
  v_mul_f32 v146, 0x3fb8aa3b, v146
  v_exp_f32 v146, v146
  v_sub_f32 v147, v147, v148
  v_mul_f32 v147, 0x3fb8aa3b, v147
  v_exp_f32 v147, v147
  s_cmp_eq_u32 s93, 1
  s_cbranch_scc0 XA_es11257
  s_mul_i32 s89, s50, 12288
  s_mul_i32 s53, s49, 384
  s_add_u32 s89, s89, s53
  s_add_u32 s89, s89, 50331648
  buffer_load_dwordx4 v[16:19], v5, s[8:11], s89 offen offset:0
  buffer_load_dwordx4 v[20:23], v5, s[8:11], s89 offen offset:1024
  buffer_load_dwordx4 v[24:27], v5, s[8:11], s89 offen offset:2048
XA_es11257:
  v_add_f32 v148, v136, v137
  v_add_f32 v148, v148, v138
  v_add_f32 v148, v148, v139
  v_add_f32 v148, v148, v140
  v_add_f32 v148, v148, v141
  v_add_f32 v148, v148, v142
  v_add_f32 v148, v148, v143
  v_add_f32 v148, v148, v144
  v_add_f32 v148, v148, v145
  v_add_f32 v148, v148, v146
  v_add_f32 v148, v148, v147
  s_cmp_eq_u32 s93, 1
  s_cbranch_scc0 XA_es11278
  buffer_load_dwordx4 v[28:31], v5, s[8:11], s89 offen offset:3072
  s_add_u32 s89, s89, 4096
  buffer_load_dwordx4 v[32:35], v5, s[8:11], s89 offen offset:0
  buffer_load_dwordx4 v[36:39], v5, s[8:11], s89 offen offset:1024
XA_es11278:
  v_mov_b32 v149, v148
  s_nop 1
  v_permlane32_swap_b32 v148, v149
  v_add_f32 v148, v148, v149
  v_mov_b32 v149, v148
  s_nop 1
  v_permlane16_swap_b32 v148, v149
  v_add_f32 v148, v148, v149
  v_rcp_f32 v148, v148
  s_nop 0
  v_mul_f32 v136, v136, v148
  v_mul_f32 v137, v137, v148
  v_mul_f32 v138, v138, v148
  v_mul_f32 v139, v139, v148
  v_mul_f32 v140, v140, v148
  v_mul_f32 v141, v141, v148
  v_mul_f32 v142, v142, v148
  v_mul_f32 v143, v143, v148
  v_mul_f32 v144, v144, v148
  v_mul_f32 v145, v145, v148
  v_mul_f32 v146, v146, v148
  v_mul_f32 v147, v147, v148
  v_cvt_pk_bf16_f32 v156, v136, v137
  v_cvt_pk_bf16_f32 v157, v138, v139
  v_cvt_pk_bf16_f32 v158, v140, v141
  v_cvt_pk_bf16_f32 v159, v142, v143
  v_cvt_pk_bf16_f32 v160, v144, v145
  v_cvt_pk_bf16_f32 v161, v146, v147
  s_mul_i32 s22, s49, 768
  s_lshr_b32 s23, s91, 1
  s_mul_i32 s23, s23, 6144
  s_add_u32 s22, s22, s23
  s_add_u32 s22, s22, 49152
  v_add_u32 v6, s22, v5
  s_waitcnt lgkmcnt(0)
  v_mfma_f32_16x16x32_bf16 v[40:43], v[88:91], v[156:159], 0
  v_mfma_f32_16x16x32_bf16 v[44:47], v[92:95], v[156:159], 0
  s_nop 4
  v_mfma_f32_16x16x16_bf16 v[40:43], v[232:233], v[160:161], v[40:43]
  v_mfma_f32_16x16x16_bf16 v[44:47], v[234:235], v[160:161], v[44:47]
  v_mfma_f32_16x16x32_bf16 v[52:55], v[96:99], v[156:159], 0
  v_mfma_f32_16x16x32_bf16 v[56:59], v[100:103], v[156:159], 0
  s_nop 4
  v_mfma_f32_16x16x16_bf16 v[52:55], v[236:237], v[160:161], v[52:55]
  v_mfma_f32_16x16x16_bf16 v[56:59], v[238:239], v[160:161], v[56:59]
  v_cvt_pk_bf16_f32 v48, v40, v41
  v_cvt_pk_bf16_f32 v49, v42, v43
  v_cvt_pk_bf16_f32 v50, v44, v45
  v_cvt_pk_bf16_f32 v51, v46, v47
  ds_write_b128 v6, v[48:51] offset:0
  v_mfma_f32_16x16x32_bf16 v[64:67], v[104:107], v[156:159], 0
  v_mfma_f32_16x16x32_bf16 v[68:71], v[108:111], v[156:159], 0
  s_nop 4
  v_mfma_f32_16x16x16_bf16 v[64:67], v[240:241], v[160:161], v[64:67]
  v_mfma_f32_16x16x16_bf16 v[68:71], v[242:243], v[160:161], v[68:71]
  v_cvt_pk_bf16_f32 v60, v52, v53
  v_cvt_pk_bf16_f32 v61, v54, v55
  v_cvt_pk_bf16_f32 v62, v56, v57
  v_cvt_pk_bf16_f32 v63, v58, v59
  ds_write_b128 v6, v[60:63] offset:1024
  v_mfma_f32_16x16x32_bf16 v[40:43], v[112:115], v[156:159], 0
  v_mfma_f32_16x16x32_bf16 v[44:47], v[116:119], v[156:159], 0
  s_nop 4
  v_mfma_f32_16x16x16_bf16 v[40:43], v[244:245], v[160:161], v[40:43]
  v_mfma_f32_16x16x16_bf16 v[44:47], v[246:247], v[160:161], v[44:47]
  v_cvt_pk_bf16_f32 v72, v64, v65
  v_cvt_pk_bf16_f32 v73, v66, v67
  v_cvt_pk_bf16_f32 v74, v68, v69
  v_cvt_pk_bf16_f32 v75, v70, v71
  ds_write_b128 v6, v[72:75] offset:2048
  v_mfma_f32_16x16x32_bf16 v[52:55], v[120:123], v[156:159], 0
  v_mfma_f32_16x16x32_bf16 v[56:59], v[124:127], v[156:159], 0
  s_nop 4
  v_mfma_f32_16x16x16_bf16 v[52:55], v[248:249], v[160:161], v[52:55]
  v_mfma_f32_16x16x16_bf16 v[56:59], v[250:251], v[160:161], v[56:59]
  v_cvt_pk_bf16_f32 v48, v40, v41
  v_cvt_pk_bf16_f32 v49, v42, v43
  v_cvt_pk_bf16_f32 v50, v44, v45
  v_cvt_pk_bf16_f32 v51, v46, v47
  ds_write_b128 v6, v[48:51] offset:3072
  v_mfma_f32_16x16x32_bf16 v[64:67], v[128:131], v[156:159], 0
  v_mfma_f32_16x16x32_bf16 v[68:71], v[132:135], v[156:159], 0
  s_nop 4
  v_mfma_f32_16x16x16_bf16 v[64:67], v[252:253], v[160:161], v[64:67]
  v_mfma_f32_16x16x16_bf16 v[68:71], v[254:255], v[160:161], v[68:71]
  v_cvt_pk_bf16_f32 v60, v52, v53
  v_cvt_pk_bf16_f32 v61, v54, v55
  v_cvt_pk_bf16_f32 v62, v56, v57
  v_cvt_pk_bf16_f32 v63, v58, v59
  ds_write_b128 v6, v[60:63] offset:4096
  s_nop 1
  v_cvt_pk_bf16_f32 v72, v64, v65
  v_cvt_pk_bf16_f32 v73, v66, v67
  v_cvt_pk_bf16_f32 v74, v68, v69
  v_cvt_pk_bf16_f32 v75, v70, v71
  ds_write_b128 v6, v[72:75] offset:5120
  s_cmp_eq_u32 s93, 1
  s_cbranch_scc0 XA_b1w
  s_waitcnt vmcnt(18) lgkmcnt(0)
  s_branch XA_b1x
XA_b1w:
  s_waitcnt vmcnt(0) lgkmcnt(0)
XA_b1x:
  s_barrier
  v_add_u32 v6, 49152, v5
  ds_read_b128 v[40:43], v6 offset:0
  ds_read_b128 v[44:47], v6 offset:1024
  ds_read_b128 v[48:51], v6 offset:2048
  ds_read_b128 v[52:55], v6 offset:3072
  ds_read_b128 v[56:59], v6 offset:4096
  ds_read_b128 v[60:63], v6 offset:5120
  ds_read_b128 v[64:67], v6 offset:6144
  ds_read_b128 v[68:71], v6 offset:7168
  s_cmp_lt_u32 s42, 2
  s_cbranch_scc1 XA_cfok
  s_sub_u32 s57, s42, 1
XA_cf:
  v_min_u32 v162, v162, v163
  v_cmp_gt_u32 vcc, s57, v162
  s_cbranch_vccz XA_cfok
  buffer_load_dwordx2 v[162:163], v10, s[8:11], s47 offen offset:512 sc1
  s_waitcnt vmcnt(0)
  s_add_u32 s41, s41, 1
  s_cmp_lt_u32 s41, 3000000
  s_cbranch_scc1 XA_cf
  s_branch K3_end
XA_cfok:
  s_mov_b32 s58, 0
  s_cmp_eq_u32 s56, -1
  s_cbranch_scc1 XA_npi
  v_min_u32 v206, v206, v207
  v_cmp_ge_u32 vcc, s43, v206
  s_cbranch_vccnz XA_npi
  s_mov_b32 s58, 1
  s_and_b32 s22, s43, 1
  s_mul_i32 s22, s22, 1310720
  s_add_u32 s22, s22, s46
  buffer_load_dwordx4 v[160:163], v5, s[8:11], s22 offen offset:0 sc1
  buffer_load_dwordx4 v[164:167], v5, s[8:11], s22 offen offset:1024 sc1
  buffer_load_dwordx4 v[168:171], v5, s[8:11], s22 offen offset:2048 sc1
  buffer_load_dwordx4 v[172:175], v5, s[8:11], s22 offen offset:3072 sc1
  s_add_u32 s22, s22, 4096
  buffer_load_dwordx4 v[176:179], v5, s[8:11], s22 offen offset:0 sc1
  buffer_load_dwordx4 v[180:183], v5, s[8:11], s22 offen offset:1024 sc1
  buffer_load_dwordx4 v[184:187], v5, s[8:11], s22 offen offset:2048 sc1
  buffer_load_dwordx4 v[188:191], v5, s[8:11], s22 offen offset:3072 sc1
  s_add_u32 s22, s22, 4096
  buffer_load_dwordx4 v[192:195], v5, s[8:11], s22 offen offset:0 sc1
  buffer_load_dwordx4 v[196:199], v5, s[8:11], s22 offen offset:1024 sc1
  s_lshl_b32 s22, s56, 5
  s_add_u32 s22, s22, s5
  s_mul_i32 s22, s22, 1280
  s_mov_b64 exec, s[86:87]
  s_cbranch_execz XA_xr11424
  buffer_load_dwordx2 v[202:203], v201, s[12:15], s22 offen
XA_xr11424:
  s_mov_b64 exec, -1
XA_npi:
  s_and_b32 s22, s42, 1
  s_mul_i32 s22, s22, 1310720
  s_add_u32 s59, s38, s22
  s_add_u32 s57, s39, s22
  s_mov_b32 s55, 0
  s_cmp_eq_u32 s54, -1
  s_cbranch_scc1 XA_wo0
  s_bitcmp1_b64 s[34:35], s40
  s_cbranch_scc1 XA_wo0
  s_mov_b32 s55, 1
  s_cmp_eq_u32 s93, 1
  s_cbranch_scc1 XA_wo2
  s_mov_b32 s55, 0
  s_mov_b64 exec, 3
  v_cmp_gt_u32 vcc, v14, v15
  s_mov_b64 exec, -1
  s_cbranch_vccnz XA_wo0
  s_mov_b32 s55, 1
  s_lshl_b32 s50, s54, 5
  s_add_u32 s50, s50, s45
  s_mul_i32 s51, s50, 12288
  s_mul_i32 s92, s91, 3072
  s_add_u32 s51, s51, s92
  s_lshr_b32 s23, s91, 1
  s_add_u32 s50, s50, s23
  s_mul_i32 s52, s50, 3072
  s_add_u32 s52, s52, 5242880
  s_waitcnt lgkmcnt(7)
  v_mfma_f32_16x16x32_bf16 v[112:115], a[0:3], v[40:43], 0
  v_mfma_f32_16x16x32_bf16 v[120:123], a[48:51], v[40:43], 0
  v_mfma_f32_16x16x32_bf16 v[128:131], a[96:99], v[40:43], 0
  v_mfma_f32_16x16x32_bf16 v[136:139], a[144:147], v[40:43], 0
  v_mfma_f32_16x16x32_bf16 v[144:147], a[192:195], v[40:43], 0
  ds_read_b128 v[40:43], v6 offset:8192
  s_add_u32 s53, s51, 75497472
  s_add_u32 m0, s92, 0
  s_nop 0
  buffer_load_dwordx4 v5, s[8:11], s53 offen offset:0 lds
  buffer_load_dwordx4 v5, s[8:11], s53 offen offset:1024 lds
  s_waitcnt lgkmcnt(7)
  v_mfma_f32_16x16x32_bf16 v[112:115], a[4:7], v[44:47], v[112:115]
  v_mfma_f32_16x16x32_bf16 v[120:123], a[52:55], v[44:47], v[120:123]
  v_mfma_f32_16x16x32_bf16 v[128:131], a[100:103], v[44:47], v[128:131]
  v_mfma_f32_16x16x32_bf16 v[136:139], a[148:151], v[44:47], v[136:139]
  v_mfma_f32_16x16x32_bf16 v[144:147], a[196:199], v[44:47], v[144:147]
  ds_read_b128 v[44:47], v6 offset:9216
  buffer_load_dwordx4 v5, s[8:11], s53 offen offset:2048 lds
  s_add_u32 s53, s51, 100663296
  s_add_u32 m0, s92, 12288
  s_nop 0
  buffer_load_dwordx4 v5, s[8:11], s53 offen offset:0 lds
  s_waitcnt lgkmcnt(7)
  v_mfma_f32_16x16x32_bf16 v[112:115], a[8:11], v[48:51], v[112:115]
  v_mfma_f32_16x16x32_bf16 v[120:123], a[56:59], v[48:51], v[120:123]
  v_mfma_f32_16x16x32_bf16 v[128:131], a[104:107], v[48:51], v[128:131]
  v_mfma_f32_16x16x32_bf16 v[136:139], a[152:155], v[48:51], v[136:139]
  v_mfma_f32_16x16x32_bf16 v[144:147], a[200:203], v[48:51], v[144:147]
  ds_read_b128 v[48:51], v6 offset:10240
  buffer_load_dwordx4 v5, s[8:11], s53 offen offset:1024 lds
  buffer_load_dwordx4 v5, s[8:11], s53 offen offset:2048 lds
  s_waitcnt lgkmcnt(7)
  v_mfma_f32_16x16x32_bf16 v[112:115], a[12:15], v[52:55], v[112:115]
  v_mfma_f32_16x16x32_bf16 v[120:123], a[60:63], v[52:55], v[120:123]
  v_mfma_f32_16x16x32_bf16 v[128:131], a[108:111], v[52:55], v[128:131]
  v_mfma_f32_16x16x32_bf16 v[136:139], a[156:159], v[52:55], v[136:139]
  v_mfma_f32_16x16x32_bf16 v[144:147], a[204:207], v[52:55], v[144:147]
  ds_read_b128 v[52:55], v6 offset:11264
  s_add_u32 s53, s51, 75509760
  s_add_u32 m0, s92, 24576
  s_nop 0
  buffer_load_dwordx4 v5, s[8:11], s53 offen offset:0 lds
  buffer_load_dwordx4 v5, s[8:11], s53 offen offset:1024 lds
  s_waitcnt lgkmcnt(7)
  v_mfma_f32_16x16x32_bf16 v[112:115], a[16:19], v[56:59], v[112:115]
  v_mfma_f32_16x16x32_bf16 v[120:123], a[64:67], v[56:59], v[120:123]
  v_mfma_f32_16x16x32_bf16 v[128:131], a[112:115], v[56:59], v[128:131]
  v_mfma_f32_16x16x32_bf16 v[136:139], a[160:163], v[56:59], v[136:139]
  v_mfma_f32_16x16x32_bf16 v[144:147], a[208:211], v[56:59], v[144:147]
  ds_read_b128 v[56:59], v6 offset:12288
  buffer_load_dwordx4 v5, s[8:11], s53 offen offset:2048 lds
  s_add_u32 s53, s51, 100675584
  s_add_u32 m0, s92, 36864
  s_nop 0
  buffer_load_dwordx4 v5, s[8:11], s53 offen offset:0 lds
  s_waitcnt lgkmcnt(7)
  v_mfma_f32_16x16x32_bf16 v[112:115], a[20:23], v[60:63], v[112:115]
  v_mfma_f32_16x16x32_bf16 v[120:123], a[68:71], v[60:63], v[120:123]
  v_mfma_f32_16x16x32_bf16 v[128:131], a[116:119], v[60:63], v[128:131]
  v_mfma_f32_16x16x32_bf16 v[136:139], a[164:167], v[60:63], v[136:139]
  v_mfma_f32_16x16x32_bf16 v[144:147], a[212:215], v[60:63], v[144:147]
  ds_read_b128 v[60:63], v6 offset:13312
  buffer_load_dwordx4 v5, s[8:11], s53 offen offset:1024 lds
  buffer_load_dwordx4 v5, s[8:11], s53 offen offset:2048 lds
  s_waitcnt lgkmcnt(7)
  v_mfma_f32_16x16x32_bf16 v[112:115], a[24:27], v[64:67], v[112:115]
  v_mfma_f32_16x16x32_bf16 v[120:123], a[72:75], v[64:67], v[120:123]
  v_mfma_f32_16x16x32_bf16 v[128:131], a[120:123], v[64:67], v[128:131]
  v_mfma_f32_16x16x32_bf16 v[136:139], a[168:171], v[64:67], v[136:139]
  v_mfma_f32_16x16x32_bf16 v[144:147], a[216:219], v[64:67], v[144:147]
  ds_read_b128 v[64:67], v6 offset:14336
  s_mul_i32 s89, s50, 12288
  s_mul_i32 s53, s49, 384
  s_add_u32 s89, s89, s53
  s_add_u32 s89, s89, 50331648
  buffer_load_dwordx4 v[16:19], v5, s[8:11], s89 offen offset:0
  buffer_load_dwordx4 v[20:23], v5, s[8:11], s89 offen offset:1024
  s_waitcnt lgkmcnt(7)
  v_mfma_f32_16x16x32_bf16 v[112:115], a[28:31], v[68:71], v[112:115]
  v_mfma_f32_16x16x32_bf16 v[120:123], a[76:79], v[68:71], v[120:123]
  v_mfma_f32_16x16x32_bf16 v[128:131], a[124:127], v[68:71], v[128:131]
  v_mfma_f32_16x16x32_bf16 v[136:139], a[172:175], v[68:71], v[136:139]
  v_mfma_f32_16x16x32_bf16 v[144:147], a[220:223], v[68:71], v[144:147]
  ds_read_b128 v[68:71], v6 offset:15360
  buffer_load_dwordx4 v[24:27], v5, s[8:11], s89 offen offset:2048
  buffer_load_dwordx4 v[28:31], v5, s[8:11], s89 offen offset:3072
  s_waitcnt lgkmcnt(7)
  v_mfma_f32_16x16x32_bf16 v[112:115], a[32:35], v[40:43], v[112:115]
  v_mfma_f32_16x16x32_bf16 v[120:123], a[80:83], v[40:43], v[120:123]
  v_mfma_f32_16x16x32_bf16 v[128:131], a[128:131], v[40:43], v[128:131]
  v_mfma_f32_16x16x32_bf16 v[136:139], a[176:179], v[40:43], v[136:139]
  v_mfma_f32_16x16x32_bf16 v[144:147], a[224:227], v[40:43], v[144:147]
  ds_read_b128 v[40:43], v6 offset:16384
  s_add_u32 s89, s89, 4096
  buffer_load_dwordx4 v[32:35], v5, s[8:11], s89 offen offset:0
  buffer_load_dwordx4 v[36:39], v5, s[8:11], s89 offen offset:1024
  s_waitcnt lgkmcnt(7)
  v_mfma_f32_16x16x32_bf16 v[112:115], a[36:39], v[44:47], v[112:115]
  v_mfma_f32_16x16x32_bf16 v[120:123], a[84:87], v[44:47], v[120:123]
  v_mfma_f32_16x16x32_bf16 v[128:131], a[132:135], v[44:47], v[128:131]
  v_mfma_f32_16x16x32_bf16 v[136:139], a[180:183], v[44:47], v[136:139]
  v_mfma_f32_16x16x32_bf16 v[144:147], a[228:231], v[44:47], v[144:147]
  ds_read_b128 v[44:47], v6 offset:17408
  buffer_load_dwordx4 v[208:211], v7, s[8:11], s52 offen offset:0 sc1
  buffer_load_dwordx4 v[212:215], v7, s[8:11], s52 offen offset:512 sc1
  s_waitcnt lgkmcnt(7)
  v_mfma_f32_16x16x32_bf16 v[112:115], a[40:43], v[48:51], v[112:115]
  v_mfma_f32_16x16x32_bf16 v[120:123], a[88:91], v[48:51], v[120:123]
  v_mfma_f32_16x16x32_bf16 v[128:131], a[136:139], v[48:51], v[128:131]
  v_mfma_f32_16x16x32_bf16 v[136:139], a[184:187], v[48:51], v[136:139]
  v_mfma_f32_16x16x32_bf16 v[144:147], a[232:235], v[48:51], v[144:147]
  ds_read_b128 v[48:51], v6 offset:18432
  buffer_load_dwordx4 v[216:219], v7, s[8:11], s52 offen offset:1024 sc1
  buffer_load_dwordx4 v[220:223], v7, s[8:11], s52 offen offset:1536 sc1
  s_waitcnt lgkmcnt(7)
  v_mfma_f32_16x16x32_bf16 v[112:115], a[44:47], v[52:55], v[112:115]
  v_mfma_f32_16x16x32_bf16 v[120:123], a[92:95], v[52:55], v[120:123]
  v_mfma_f32_16x16x32_bf16 v[128:131], a[140:143], v[52:55], v[128:131]
  v_mfma_f32_16x16x32_bf16 v[136:139], a[188:191], v[52:55], v[136:139]
  v_mfma_f32_16x16x32_bf16 v[144:147], a[236:239], v[52:55], v[144:147]
  ds_read_b128 v[52:55], v6 offset:19456
  buffer_load_dwordx4 v[224:227], v7, s[8:11], s52 offen offset:2048 sc1
  buffer_load_dwordx4 v[228:231], v7, s[8:11], s52 offen offset:2560 sc1
  s_waitcnt lgkmcnt(7)
  v_mfma_f32_16x16x32_bf16 v[116:119], a[0:3], v[56:59], 0
  v_mfma_f32_16x16x32_bf16 v[124:127], a[48:51], v[56:59], 0
  v_mfma_f32_16x16x32_bf16 v[132:135], a[96:99], v[56:59], 0
  v_mfma_f32_16x16x32_bf16 v[140:143], a[144:147], v[56:59], 0
  v_mfma_f32_16x16x32_bf16 v[148:151], a[192:195], v[56:59], 0
  ds_read_b128 v[56:59], v6 offset:20480
  s_add_u32 s88, s52, 7340032
  buffer_load_dwordx4 v[232:235], v8, s[8:11], s88 offen offset:0 sc1
  buffer_load_dwordx4 v[236:239], v8, s[8:11], s88 offen offset:512 sc1
  s_waitcnt lgkmcnt(7)
  v_mfma_f32_16x16x32_bf16 v[116:119], a[4:7], v[60:63], v[116:119]
  v_mfma_f32_16x16x32_bf16 v[124:127], a[52:55], v[60:63], v[124:127]
  v_mfma_f32_16x16x32_bf16 v[132:135], a[100:103], v[60:63], v[132:135]
  v_mfma_f32_16x16x32_bf16 v[140:143], a[148:151], v[60:63], v[140:143]
  v_mfma_f32_16x16x32_bf16 v[148:151], a[196:199], v[60:63], v[148:151]
  ds_read_b128 v[60:63], v6 offset:21504
  buffer_load_dwordx4 v[240:243], v8, s[8:11], s88 offen offset:1024 sc1
  buffer_load_dwordx4 v[244:247], v8, s[8:11], s88 offen offset:1536 sc1
  v_mov_b32 v152, v120
  v_mov_b32 v153, v121
  v_mov_b32 v154, v122
  v_mov_b32 v155, v123
  v_mov_b32_dpp v120, v112 row_ror:8 row_mask:0xf bank_mask:0x3
  v_mov_b32_dpp v121, v113 row_ror:8 row_mask:0xf bank_mask:0x3
  v_mov_b32_dpp v122, v114 row_ror:8 row_mask:0xf bank_mask:0x3
  v_mov_b32_dpp v123, v115 row_ror:8 row_mask:0xf bank_mask:0x3
  v_mov_b32_dpp v112, v152 row_ror:8 row_mask:0xf bank_mask:0xc
  v_mov_b32_dpp v113, v153 row_ror:8 row_mask:0xf bank_mask:0xc
  v_mov_b32_dpp v114, v154 row_ror:8 row_mask:0xf bank_mask:0xc
  v_mov_b32_dpp v115, v155 row_ror:8 row_mask:0xf bank_mask:0xc
  s_add_u32 s22, s59, 0
  buffer_store_dwordx4 v[112:115], v9, s[8:11], s22 offen offset:0
  s_add_u32 s23, s59, 327680
  buffer_store_dwordx4 v[120:123], v9, s[8:11], s23 offen offset:0
  s_waitcnt lgkmcnt(7)
  v_mfma_f32_16x16x32_bf16 v[116:119], a[8:11], v[64:67], v[116:119]
  v_mfma_f32_16x16x32_bf16 v[124:127], a[56:59], v[64:67], v[124:127]
  v_mfma_f32_16x16x32_bf16 v[132:135], a[104:107], v[64:67], v[132:135]
  v_mfma_f32_16x16x32_bf16 v[140:143], a[152:155], v[64:67], v[140:143]
  v_mfma_f32_16x16x32_bf16 v[148:151], a[200:203], v[64:67], v[148:151]
  ds_read_b128 v[64:67], v6 offset:22528
  buffer_load_dwordx4 v[248:251], v8, s[8:11], s88 offen offset:2048 sc1
  buffer_load_dwordx4 v[252:255], v8, s[8:11], s88 offen offset:2560 sc1
  s_waitcnt lgkmcnt(7)
  v_mfma_f32_16x16x32_bf16 v[116:119], a[12:15], v[68:71], v[116:119]
  v_mfma_f32_16x16x32_bf16 v[124:127], a[60:63], v[68:71], v[124:127]
  v_mfma_f32_16x16x32_bf16 v[132:135], a[108:111], v[68:71], v[132:135]
  v_mfma_f32_16x16x32_bf16 v[140:143], a[156:159], v[68:71], v[140:143]
  v_mfma_f32_16x16x32_bf16 v[148:151], a[204:207], v[68:71], v[148:151]
  ds_read_b128 v[68:71], v6 offset:23552
  s_waitcnt lgkmcnt(7)
  v_mfma_f32_16x16x32_bf16 v[116:119], a[16:19], v[40:43], v[116:119]
  v_mfma_f32_16x16x32_bf16 v[124:127], a[64:67], v[40:43], v[124:127]
  v_mfma_f32_16x16x32_bf16 v[132:135], a[112:115], v[40:43], v[132:135]
  v_mfma_f32_16x16x32_bf16 v[140:143], a[160:163], v[40:43], v[140:143]
  v_mfma_f32_16x16x32_bf16 v[148:151], a[208:211], v[40:43], v[148:151]
  v_mov_b32 v152, v136
  v_mov_b32 v153, v137
  v_mov_b32 v154, v138
  v_mov_b32 v155, v139
  v_mov_b32_dpp v136, v128 row_ror:8 row_mask:0xf bank_mask:0x3
  v_mov_b32_dpp v137, v129 row_ror:8 row_mask:0xf bank_mask:0x3
  v_mov_b32_dpp v138, v130 row_ror:8 row_mask:0xf bank_mask:0x3
  v_mov_b32_dpp v139, v131 row_ror:8 row_mask:0xf bank_mask:0x3
  v_mov_b32_dpp v128, v152 row_ror:8 row_mask:0xf bank_mask:0xc
  v_mov_b32_dpp v129, v153 row_ror:8 row_mask:0xf bank_mask:0xc
  v_mov_b32_dpp v130, v154 row_ror:8 row_mask:0xf bank_mask:0xc
  v_mov_b32_dpp v131, v155 row_ror:8 row_mask:0xf bank_mask:0xc
  s_add_u32 s22, s59, 0
  buffer_store_dwordx4 v[128:131], v9, s[8:11], s22 offen offset:128
  s_add_u32 s23, s59, 327680
  buffer_store_dwordx4 v[136:139], v9, s[8:11], s23 offen offset:128
  s_waitcnt lgkmcnt(6)
  v_mfma_f32_16x16x32_bf16 v[116:119], a[20:23], v[44:47], v[116:119]
  v_mfma_f32_16x16x32_bf16 v[124:127], a[68:71], v[44:47], v[124:127]
  v_mfma_f32_16x16x32_bf16 v[132:135], a[116:119], v[44:47], v[132:135]
  v_mfma_f32_16x16x32_bf16 v[140:143], a[164:167], v[44:47], v[140:143]
  v_mfma_f32_16x16x32_bf16 v[148:151], a[212:215], v[44:47], v[148:151]
  s_waitcnt lgkmcnt(5)
  v_mfma_f32_16x16x32_bf16 v[116:119], a[24:27], v[48:51], v[116:119]
  v_mfma_f32_16x16x32_bf16 v[124:127], a[72:75], v[48:51], v[124:127]
  v_mfma_f32_16x16x32_bf16 v[132:135], a[120:123], v[48:51], v[132:135]
  v_mfma_f32_16x16x32_bf16 v[140:143], a[168:171], v[48:51], v[140:143]
  v_mfma_f32_16x16x32_bf16 v[148:151], a[216:219], v[48:51], v[148:151]
  s_waitcnt lgkmcnt(4)
  v_mfma_f32_16x16x32_bf16 v[116:119], a[28:31], v[52:55], v[116:119]
  v_mfma_f32_16x16x32_bf16 v[124:127], a[76:79], v[52:55], v[124:127]
  v_mfma_f32_16x16x32_bf16 v[132:135], a[124:127], v[52:55], v[132:135]
  v_mfma_f32_16x16x32_bf16 v[140:143], a[172:175], v[52:55], v[140:143]
  v_mfma_f32_16x16x32_bf16 v[148:151], a[220:223], v[52:55], v[148:151]
  s_add_u32 s22, s57, 0
  buffer_store_dwordx4 v[144:147], v1, s[8:11], s22 offen
  s_waitcnt lgkmcnt(3)
  v_mfma_f32_16x16x32_bf16 v[116:119], a[32:35], v[56:59], v[116:119]
  v_mfma_f32_16x16x32_bf16 v[124:127], a[80:83], v[56:59], v[124:127]
  v_mfma_f32_16x16x32_bf16 v[132:135], a[128:131], v[56:59], v[132:135]
  v_mfma_f32_16x16x32_bf16 v[140:143], a[176:179], v[56:59], v[140:143]
  v_mfma_f32_16x16x32_bf16 v[148:151], a[224:227], v[56:59], v[148:151]
  s_waitcnt lgkmcnt(2)
  v_mfma_f32_16x16x32_bf16 v[116:119], a[36:39], v[60:63], v[116:119]
  v_mfma_f32_16x16x32_bf16 v[124:127], a[84:87], v[60:63], v[124:127]
  v_mfma_f32_16x16x32_bf16 v[132:135], a[132:135], v[60:63], v[132:135]
  v_mfma_f32_16x16x32_bf16 v[140:143], a[180:183], v[60:63], v[140:143]
  v_mfma_f32_16x16x32_bf16 v[148:151], a[228:231], v[60:63], v[148:151]
  s_waitcnt lgkmcnt(1)
  v_mfma_f32_16x16x32_bf16 v[116:119], a[40:43], v[64:67], v[116:119]
  v_mfma_f32_16x16x32_bf16 v[124:127], a[88:91], v[64:67], v[124:127]
  v_mfma_f32_16x16x32_bf16 v[132:135], a[136:139], v[64:67], v[132:135]
  v_mfma_f32_16x16x32_bf16 v[140:143], a[184:187], v[64:67], v[140:143]
  v_mfma_f32_16x16x32_bf16 v[148:151], a[232:235], v[64:67], v[148:151]
  s_waitcnt lgkmcnt(0)
  v_mfma_f32_16x16x32_bf16 v[116:119], a[44:47], v[68:71], v[116:119]
  v_mfma_f32_16x16x32_bf16 v[124:127], a[92:95], v[68:71], v[124:127]
  v_mfma_f32_16x16x32_bf16 v[132:135], a[140:143], v[68:71], v[132:135]
  v_mfma_f32_16x16x32_bf16 v[140:143], a[188:191], v[68:71], v[140:143]
  v_mfma_f32_16x16x32_bf16 v[148:151], a[236:239], v[68:71], v[148:151]
  s_nop 4
  v_mov_b32 v152, v124
  v_mov_b32 v153, v125
  v_mov_b32 v154, v126
  v_mov_b32 v155, v127
  v_mov_b32_dpp v124, v116 row_ror:8 row_mask:0xf bank_mask:0x3
  v_mov_b32_dpp v125, v117 row_ror:8 row_mask:0xf bank_mask:0x3
  v_mov_b32_dpp v126, v118 row_ror:8 row_mask:0xf bank_mask:0x3
  v_mov_b32_dpp v127, v119 row_ror:8 row_mask:0xf bank_mask:0x3
  v_mov_b32_dpp v116, v152 row_ror:8 row_mask:0xf bank_mask:0xc
  v_mov_b32_dpp v117, v153 row_ror:8 row_mask:0xf bank_mask:0xc
  v_mov_b32_dpp v118, v154 row_ror:8 row_mask:0xf bank_mask:0xc
  v_mov_b32_dpp v119, v155 row_ror:8 row_mask:0xf bank_mask:0xc
  s_add_u32 s22, s59, 655360
  buffer_store_dwordx4 v[116:119], v9, s[8:11], s22 offen offset:0
  s_add_u32 s23, s59, 983040
  buffer_store_dwordx4 v[124:127], v9, s[8:11], s23 offen offset:0
  v_mov_b32 v152, v140
  v_mov_b32 v153, v141
  v_mov_b32 v154, v142
  v_mov_b32 v155, v143
  v_mov_b32_dpp v140, v132 row_ror:8 row_mask:0xf bank_mask:0x3
  v_mov_b32_dpp v141, v133 row_ror:8 row_mask:0xf bank_mask:0x3
  v_mov_b32_dpp v142, v134 row_ror:8 row_mask:0xf bank_mask:0x3
  v_mov_b32_dpp v143, v135 row_ror:8 row_mask:0xf bank_mask:0x3
  v_mov_b32_dpp v132, v152 row_ror:8 row_mask:0xf bank_mask:0xc
  v_mov_b32_dpp v133, v153 row_ror:8 row_mask:0xf bank_mask:0xc
  v_mov_b32_dpp v134, v154 row_ror:8 row_mask:0xf bank_mask:0xc
  v_mov_b32_dpp v135, v155 row_ror:8 row_mask:0xf bank_mask:0xc
  s_add_u32 s22, s59, 655360
  buffer_store_dwordx4 v[132:135], v9, s[8:11], s22 offen offset:128
  s_add_u32 s23, s59, 983040
  buffer_store_dwordx4 v[140:143], v9, s[8:11], s23 offen offset:128
  s_add_u32 s22, s57, 655360
  buffer_store_dwordx4 v[148:151], v1, s[8:11], s22 offen
  s_add_u32 s42, s42, 1
  s_cmp_eq_u32 s58, 1
  s_cbranch_scc0 XA_sp1
  s_waitcnt vmcnt(40)
  v_pk_add_f32 v[160:161], v[160:161], v[180:181]
  v_pk_add_f32 v[162:163], v[162:163], v[182:183]
  v_pk_add_f32 v[164:165], v[164:165], v[184:185]
  v_pk_add_f32 v[166:167], v[166:167], v[186:187]
  v_pk_add_f32 v[168:169], v[168:169], v[188:189]
  v_pk_add_f32 v[170:171], v[170:171], v[190:191]
  v_pk_add_f32 v[172:173], v[172:173], v[192:193]
  v_pk_add_f32 v[174:175], v[174:175], v[194:195]
  v_pk_add_f32 v[176:177], v[176:177], v[196:197]
  v_pk_add_f32 v[178:179], v[178:179], v[198:199]
  ds_write_b128 v12, v[160:163] offset:0
  ds_write_b128 v12, v[164:167] offset:1024
  ds_write_b128 v12, v[168:171] offset:2048
  ds_write_b128 v12, v[172:175] offset:3072
  ds_write_b128 v12, v[176:179] offset:4096
  s_mov_b32 s96, 2
  s_branch XA_cl2
XA_sp1:
  s_waitcnt vmcnt(0)
  s_mov_b32 s95, 1
  v_mov_b32 v6, s48
  v_mov_b32 v152, s42
  s_mov_b64 exec, 1
  buffer_store_dword v152, v6, s[8:11], 0 offen offset:0
  s_mov_b64 exec, -1
  s_branch XA_cq
XA_wo2:
  s_lshl_b32 s50, s54, 5
  s_add_u32 s50, s50, s45
  s_mul_i32 s51, s50, 12288
  s_mul_i32 s92, s91, 3072
  s_add_u32 s51, s51, s92
  s_lshr_b32 s23, s91, 1
  s_add_u32 s50, s50, s23
  s_mul_i32 s52, s50, 3072
  s_add_u32 s52, s52, 5242880
  s_waitcnt lgkmcnt(7)
  v_mfma_f32_16x16x32_bf16 v[112:115], a[0:3], v[40:43], 0
  v_mfma_f32_16x16x32_bf16 v[120:123], a[48:51], v[40:43], 0
  v_mfma_f32_16x16x32_bf16 v[128:131], a[96:99], v[40:43], 0
  v_mfma_f32_16x16x32_bf16 v[136:139], a[144:147], v[40:43], 0
  v_mfma_f32_16x16x32_bf16 v[144:147], a[192:195], v[40:43], 0
  ds_read_b128 v[40:43], v6 offset:8192
  buffer_load_dwordx4 v[208:211], v7, s[8:11], s52 offen offset:0 sc1
  buffer_load_dwordx4 v[212:215], v7, s[8:11], s52 offen offset:512 sc1
  s_waitcnt lgkmcnt(7)
  v_mfma_f32_16x16x32_bf16 v[112:115], a[4:7], v[44:47], v[112:115]
  v_mfma_f32_16x16x32_bf16 v[120:123], a[52:55], v[44:47], v[120:123]
  v_mfma_f32_16x16x32_bf16 v[128:131], a[100:103], v[44:47], v[128:131]
  v_mfma_f32_16x16x32_bf16 v[136:139], a[148:151], v[44:47], v[136:139]
  v_mfma_f32_16x16x32_bf16 v[144:147], a[196:199], v[44:47], v[144:147]
  ds_read_b128 v[44:47], v6 offset:9216
  buffer_load_dwordx4 v[216:219], v7, s[8:11], s52 offen offset:1024 sc1
  buffer_load_dwordx4 v[220:223], v7, s[8:11], s52 offen offset:1536 sc1
  s_waitcnt lgkmcnt(7)
  v_mfma_f32_16x16x32_bf16 v[112:115], a[8:11], v[48:51], v[112:115]
  v_mfma_f32_16x16x32_bf16 v[120:123], a[56:59], v[48:51], v[120:123]
  v_mfma_f32_16x16x32_bf16 v[128:131], a[104:107], v[48:51], v[128:131]
  v_mfma_f32_16x16x32_bf16 v[136:139], a[152:155], v[48:51], v[136:139]
  v_mfma_f32_16x16x32_bf16 v[144:147], a[200:203], v[48:51], v[144:147]
  ds_read_b128 v[48:51], v6 offset:10240
  buffer_load_dwordx4 v[224:227], v7, s[8:11], s52 offen offset:2048 sc1
  buffer_load_dwordx4 v[228:231], v7, s[8:11], s52 offen offset:2560 sc1
  s_waitcnt lgkmcnt(7)
  v_mfma_f32_16x16x32_bf16 v[112:115], a[12:15], v[52:55], v[112:115]
  v_mfma_f32_16x16x32_bf16 v[120:123], a[60:63], v[52:55], v[120:123]
  v_mfma_f32_16x16x32_bf16 v[128:131], a[108:111], v[52:55], v[128:131]
  v_mfma_f32_16x16x32_bf16 v[136:139], a[156:159], v[52:55], v[136:139]
  v_mfma_f32_16x16x32_bf16 v[144:147], a[204:207], v[52:55], v[144:147]
  ds_read_b128 v[52:55], v6 offset:11264
  s_add_u32 s88, s52, 7340032
  buffer_load_dwordx4 v[232:235], v8, s[8:11], s88 offen offset:0 sc1
  buffer_load_dwordx4 v[236:239], v8, s[8:11], s88 offen offset:512 sc1
  s_waitcnt lgkmcnt(7)
  v_mfma_f32_16x16x32_bf16 v[112:115], a[16:19], v[56:59], v[112:115]
  v_mfma_f32_16x16x32_bf16 v[120:123], a[64:67], v[56:59], v[120:123]
  v_mfma_f32_16x16x32_bf16 v[128:131], a[112:115], v[56:59], v[128:131]
  v_mfma_f32_16x16x32_bf16 v[136:139], a[160:163], v[56:59], v[136:139]
  v_mfma_f32_16x16x32_bf16 v[144:147], a[208:211], v[56:59], v[144:147]
  ds_read_b128 v[56:59], v6 offset:12288
  buffer_load_dwordx4 v[240:243], v8, s[8:11], s88 offen offset:1024 sc1
  buffer_load_dwordx4 v[244:247], v8, s[8:11], s88 offen offset:1536 sc1
  s_waitcnt lgkmcnt(7)
  v_mfma_f32_16x16x32_bf16 v[112:115], a[20:23], v[60:63], v[112:115]
  v_mfma_f32_16x16x32_bf16 v[120:123], a[68:71], v[60:63], v[120:123]
  v_mfma_f32_16x16x32_bf16 v[128:131], a[116:119], v[60:63], v[128:131]
  v_mfma_f32_16x16x32_bf16 v[136:139], a[164:167], v[60:63], v[136:139]
  v_mfma_f32_16x16x32_bf16 v[144:147], a[212:215], v[60:63], v[144:147]
  ds_read_b128 v[60:63], v6 offset:13312
  buffer_load_dwordx4 v[248:251], v8, s[8:11], s88 offen offset:2048 sc1
  buffer_load_dwordx4 v[252:255], v8, s[8:11], s88 offen offset:2560 sc1
  s_waitcnt lgkmcnt(7)
  v_mfma_f32_16x16x32_bf16 v[112:115], a[24:27], v[64:67], v[112:115]
  v_mfma_f32_16x16x32_bf16 v[120:123], a[72:75], v[64:67], v[120:123]
  v_mfma_f32_16x16x32_bf16 v[128:131], a[120:123], v[64:67], v[128:131]
  v_mfma_f32_16x16x32_bf16 v[136:139], a[168:171], v[64:67], v[136:139]
  v_mfma_f32_16x16x32_bf16 v[144:147], a[216:219], v[64:67], v[144:147]
  ds_read_b128 v[64:67], v6 offset:14336
  s_waitcnt lgkmcnt(7)
  v_mfma_f32_16x16x32_bf16 v[112:115], a[28:31], v[68:71], v[112:115]
  v_mfma_f32_16x16x32_bf16 v[120:123], a[76:79], v[68:71], v[120:123]
  v_mfma_f32_16x16x32_bf16 v[128:131], a[124:127], v[68:71], v[128:131]
  v_mfma_f32_16x16x32_bf16 v[136:139], a[172:175], v[68:71], v[136:139]
  v_mfma_f32_16x16x32_bf16 v[144:147], a[220:223], v[68:71], v[144:147]
  ds_read_b128 v[68:71], v6 offset:15360
  s_waitcnt lgkmcnt(7)
  v_mfma_f32_16x16x32_bf16 v[112:115], a[32:35], v[40:43], v[112:115]
  v_mfma_f32_16x16x32_bf16 v[120:123], a[80:83], v[40:43], v[120:123]
  v_mfma_f32_16x16x32_bf16 v[128:131], a[128:131], v[40:43], v[128:131]
  v_mfma_f32_16x16x32_bf16 v[136:139], a[176:179], v[40:43], v[136:139]
  v_mfma_f32_16x16x32_bf16 v[144:147], a[224:227], v[40:43], v[144:147]
  ds_read_b128 v[40:43], v6 offset:16384
  s_waitcnt lgkmcnt(7)
  v_mfma_f32_16x16x32_bf16 v[112:115], a[36:39], v[44:47], v[112:115]
  v_mfma_f32_16x16x32_bf16 v[120:123], a[84:87], v[44:47], v[120:123]
  v_mfma_f32_16x16x32_bf16 v[128:131], a[132:135], v[44:47], v[128:131]
  v_mfma_f32_16x16x32_bf16 v[136:139], a[180:183], v[44:47], v[136:139]
  v_mfma_f32_16x16x32_bf16 v[144:147], a[228:231], v[44:47], v[144:147]
  ds_read_b128 v[44:47], v6 offset:17408
  s_waitcnt lgkmcnt(7)
  v_mfma_f32_16x16x32_bf16 v[112:115], a[40:43], v[48:51], v[112:115]
  v_mfma_f32_16x16x32_bf16 v[120:123], a[88:91], v[48:51], v[120:123]
  v_mfma_f32_16x16x32_bf16 v[128:131], a[136:139], v[48:51], v[128:131]
  v_mfma_f32_16x16x32_bf16 v[136:139], a[184:187], v[48:51], v[136:139]
  v_mfma_f32_16x16x32_bf16 v[144:147], a[232:235], v[48:51], v[144:147]
  ds_read_b128 v[48:51], v6 offset:18432
  s_waitcnt lgkmcnt(7)
  v_mfma_f32_16x16x32_bf16 v[112:115], a[44:47], v[52:55], v[112:115]
  v_mfma_f32_16x16x32_bf16 v[120:123], a[92:95], v[52:55], v[120:123]
  v_mfma_f32_16x16x32_bf16 v[128:131], a[140:143], v[52:55], v[128:131]
  v_mfma_f32_16x16x32_bf16 v[136:139], a[188:191], v[52:55], v[136:139]
  v_mfma_f32_16x16x32_bf16 v[144:147], a[236:239], v[52:55], v[144:147]
  ds_read_b128 v[52:55], v6 offset:19456
  s_waitcnt lgkmcnt(7)
  v_mfma_f32_16x16x32_bf16 v[116:119], a[0:3], v[56:59], 0
  v_mfma_f32_16x16x32_bf16 v[124:127], a[48:51], v[56:59], 0
  v_mfma_f32_16x16x32_bf16 v[132:135], a[96:99], v[56:59], 0
  v_mfma_f32_16x16x32_bf16 v[140:143], a[144:147], v[56:59], 0
  v_mfma_f32_16x16x32_bf16 v[148:151], a[192:195], v[56:59], 0
  ds_read_b128 v[56:59], v6 offset:20480
  s_waitcnt lgkmcnt(7)
  v_mfma_f32_16x16x32_bf16 v[116:119], a[4:7], v[60:63], v[116:119]
  v_mfma_f32_16x16x32_bf16 v[124:127], a[52:55], v[60:63], v[124:127]
  v_mfma_f32_16x16x32_bf16 v[132:135], a[100:103], v[60:63], v[132:135]
  v_mfma_f32_16x16x32_bf16 v[140:143], a[148:151], v[60:63], v[140:143]
  v_mfma_f32_16x16x32_bf16 v[148:151], a[196:199], v[60:63], v[148:151]
  ds_read_b128 v[60:63], v6 offset:21504
  v_mov_b32 v152, v120
  v_mov_b32 v153, v121
  v_mov_b32 v154, v122
  v_mov_b32 v155, v123
  v_mov_b32_dpp v120, v112 row_ror:8 row_mask:0xf bank_mask:0x3
  v_mov_b32_dpp v121, v113 row_ror:8 row_mask:0xf bank_mask:0x3
  v_mov_b32_dpp v122, v114 row_ror:8 row_mask:0xf bank_mask:0x3
  v_mov_b32_dpp v123, v115 row_ror:8 row_mask:0xf bank_mask:0x3
  v_mov_b32_dpp v112, v152 row_ror:8 row_mask:0xf bank_mask:0xc
  v_mov_b32_dpp v113, v153 row_ror:8 row_mask:0xf bank_mask:0xc
  v_mov_b32_dpp v114, v154 row_ror:8 row_mask:0xf bank_mask:0xc
  v_mov_b32_dpp v115, v155 row_ror:8 row_mask:0xf bank_mask:0xc
  s_add_u32 s22, s59, 0
  buffer_store_dwordx4 v[112:115], v9, s[8:11], s22 offen offset:0
  s_add_u32 s23, s59, 327680
  buffer_store_dwordx4 v[120:123], v9, s[8:11], s23 offen offset:0
  s_waitcnt lgkmcnt(7)
  v_mfma_f32_16x16x32_bf16 v[116:119], a[8:11], v[64:67], v[116:119]
  v_mfma_f32_16x16x32_bf16 v[124:127], a[56:59], v[64:67], v[124:127]
  v_mfma_f32_16x16x32_bf16 v[132:135], a[104:107], v[64:67], v[132:135]
  v_mfma_f32_16x16x32_bf16 v[140:143], a[152:155], v[64:67], v[140:143]
  v_mfma_f32_16x16x32_bf16 v[148:151], a[200:203], v[64:67], v[148:151]
  ds_read_b128 v[64:67], v6 offset:22528
  s_waitcnt lgkmcnt(7)
  v_mfma_f32_16x16x32_bf16 v[116:119], a[12:15], v[68:71], v[116:119]
  v_mfma_f32_16x16x32_bf16 v[124:127], a[60:63], v[68:71], v[124:127]
  v_mfma_f32_16x16x32_bf16 v[132:135], a[108:111], v[68:71], v[132:135]
  v_mfma_f32_16x16x32_bf16 v[140:143], a[156:159], v[68:71], v[140:143]
  v_mfma_f32_16x16x32_bf16 v[148:151], a[204:207], v[68:71], v[148:151]
  ds_read_b128 v[68:71], v6 offset:23552
  s_waitcnt lgkmcnt(7)
  v_mfma_f32_16x16x32_bf16 v[116:119], a[16:19], v[40:43], v[116:119]
  v_mfma_f32_16x16x32_bf16 v[124:127], a[64:67], v[40:43], v[124:127]
  v_mfma_f32_16x16x32_bf16 v[132:135], a[112:115], v[40:43], v[132:135]
  v_mfma_f32_16x16x32_bf16 v[140:143], a[160:163], v[40:43], v[140:143]
  v_mfma_f32_16x16x32_bf16 v[148:151], a[208:211], v[40:43], v[148:151]
  v_mov_b32 v152, v136
  v_mov_b32 v153, v137
  v_mov_b32 v154, v138
  v_mov_b32 v155, v139
  v_mov_b32_dpp v136, v128 row_ror:8 row_mask:0xf bank_mask:0x3
  v_mov_b32_dpp v137, v129 row_ror:8 row_mask:0xf bank_mask:0x3
  v_mov_b32_dpp v138, v130 row_ror:8 row_mask:0xf bank_mask:0x3
  v_mov_b32_dpp v139, v131 row_ror:8 row_mask:0xf bank_mask:0x3
  v_mov_b32_dpp v128, v152 row_ror:8 row_mask:0xf bank_mask:0xc
  v_mov_b32_dpp v129, v153 row_ror:8 row_mask:0xf bank_mask:0xc
  v_mov_b32_dpp v130, v154 row_ror:8 row_mask:0xf bank_mask:0xc
  v_mov_b32_dpp v131, v155 row_ror:8 row_mask:0xf bank_mask:0xc
  s_add_u32 s22, s59, 0
  buffer_store_dwordx4 v[128:131], v9, s[8:11], s22 offen offset:128
  s_add_u32 s23, s59, 327680
  buffer_store_dwordx4 v[136:139], v9, s[8:11], s23 offen offset:128
  s_waitcnt lgkmcnt(6)
  v_mfma_f32_16x16x32_bf16 v[116:119], a[20:23], v[44:47], v[116:119]
  v_mfma_f32_16x16x32_bf16 v[124:127], a[68:71], v[44:47], v[124:127]
  v_mfma_f32_16x16x32_bf16 v[132:135], a[116:119], v[44:47], v[132:135]
  v_mfma_f32_16x16x32_bf16 v[140:143], a[164:167], v[44:47], v[140:143]
  v_mfma_f32_16x16x32_bf16 v[148:151], a[212:215], v[44:47], v[148:151]
  s_waitcnt lgkmcnt(5)
  v_mfma_f32_16x16x32_bf16 v[116:119], a[24:27], v[48:51], v[116:119]
  v_mfma_f32_16x16x32_bf16 v[124:127], a[72:75], v[48:51], v[124:127]
  v_mfma_f32_16x16x32_bf16 v[132:135], a[120:123], v[48:51], v[132:135]
  v_mfma_f32_16x16x32_bf16 v[140:143], a[168:171], v[48:51], v[140:143]
  v_mfma_f32_16x16x32_bf16 v[148:151], a[216:219], v[48:51], v[148:151]
  s_waitcnt lgkmcnt(4)
  v_mfma_f32_16x16x32_bf16 v[116:119], a[28:31], v[52:55], v[116:119]
  v_mfma_f32_16x16x32_bf16 v[124:127], a[76:79], v[52:55], v[124:127]
  v_mfma_f32_16x16x32_bf16 v[132:135], a[124:127], v[52:55], v[132:135]
  v_mfma_f32_16x16x32_bf16 v[140:143], a[172:175], v[52:55], v[140:143]
  v_mfma_f32_16x16x32_bf16 v[148:151], a[220:223], v[52:55], v[148:151]
  s_add_u32 s22, s57, 0
  buffer_store_dwordx4 v[144:147], v1, s[8:11], s22 offen
  s_waitcnt lgkmcnt(3)
  v_mfma_f32_16x16x32_bf16 v[116:119], a[32:35], v[56:59], v[116:119]
  v_mfma_f32_16x16x32_bf16 v[124:127], a[80:83], v[56:59], v[124:127]
  v_mfma_f32_16x16x32_bf16 v[132:135], a[128:131], v[56:59], v[132:135]
  v_mfma_f32_16x16x32_bf16 v[140:143], a[176:179], v[56:59], v[140:143]
  v_mfma_f32_16x16x32_bf16 v[148:151], a[224:227], v[56:59], v[148:151]
  s_waitcnt lgkmcnt(2)
  v_mfma_f32_16x16x32_bf16 v[116:119], a[36:39], v[60:63], v[116:119]
  v_mfma_f32_16x16x32_bf16 v[124:127], a[84:87], v[60:63], v[124:127]
  v_mfma_f32_16x16x32_bf16 v[132:135], a[132:135], v[60:63], v[132:135]
  v_mfma_f32_16x16x32_bf16 v[140:143], a[180:183], v[60:63], v[140:143]
  v_mfma_f32_16x16x32_bf16 v[148:151], a[228:231], v[60:63], v[148:151]
  s_waitcnt lgkmcnt(1)
  v_mfma_f32_16x16x32_bf16 v[116:119], a[40:43], v[64:67], v[116:119]
  v_mfma_f32_16x16x32_bf16 v[124:127], a[88:91], v[64:67], v[124:127]
  v_mfma_f32_16x16x32_bf16 v[132:135], a[136:139], v[64:67], v[132:135]
  v_mfma_f32_16x16x32_bf16 v[140:143], a[184:187], v[64:67], v[140:143]
  v_mfma_f32_16x16x32_bf16 v[148:151], a[232:235], v[64:67], v[148:151]
  s_waitcnt lgkmcnt(0)
  v_mfma_f32_16x16x32_bf16 v[116:119], a[44:47], v[68:71], v[116:119]
  v_mfma_f32_16x16x32_bf16 v[124:127], a[92:95], v[68:71], v[124:127]
  v_mfma_f32_16x16x32_bf16 v[132:135], a[140:143], v[68:71], v[132:135]
  v_mfma_f32_16x16x32_bf16 v[140:143], a[188:191], v[68:71], v[140:143]
  v_mfma_f32_16x16x32_bf16 v[148:151], a[236:239], v[68:71], v[148:151]
  s_nop 4
  v_mov_b32 v152, v124
  v_mov_b32 v153, v125
  v_mov_b32 v154, v126
  v_mov_b32 v155, v127
  v_mov_b32_dpp v124, v116 row_ror:8 row_mask:0xf bank_mask:0x3
  v_mov_b32_dpp v125, v117 row_ror:8 row_mask:0xf bank_mask:0x3
  v_mov_b32_dpp v126, v118 row_ror:8 row_mask:0xf bank_mask:0x3
  v_mov_b32_dpp v127, v119 row_ror:8 row_mask:0xf bank_mask:0x3
  v_mov_b32_dpp v116, v152 row_ror:8 row_mask:0xf bank_mask:0xc
  v_mov_b32_dpp v117, v153 row_ror:8 row_mask:0xf bank_mask:0xc
  v_mov_b32_dpp v118, v154 row_ror:8 row_mask:0xf bank_mask:0xc
  v_mov_b32_dpp v119, v155 row_ror:8 row_mask:0xf bank_mask:0xc
  s_add_u32 s22, s59, 655360
  buffer_store_dwordx4 v[116:119], v9, s[8:11], s22 offen offset:0
  s_add_u32 s23, s59, 983040
  buffer_store_dwordx4 v[124:127], v9, s[8:11], s23 offen offset:0
  v_mov_b32 v152, v140
  v_mov_b32 v153, v141
  v_mov_b32 v154, v142
  v_mov_b32 v155, v143
  v_mov_b32_dpp v140, v132 row_ror:8 row_mask:0xf bank_mask:0x3
  v_mov_b32_dpp v141, v133 row_ror:8 row_mask:0xf bank_mask:0x3
  v_mov_b32_dpp v142, v134 row_ror:8 row_mask:0xf bank_mask:0x3
  v_mov_b32_dpp v143, v135 row_ror:8 row_mask:0xf bank_mask:0x3
  v_mov_b32_dpp v132, v152 row_ror:8 row_mask:0xf bank_mask:0xc
  v_mov_b32_dpp v133, v153 row_ror:8 row_mask:0xf bank_mask:0xc
  v_mov_b32_dpp v134, v154 row_ror:8 row_mask:0xf bank_mask:0xc
  v_mov_b32_dpp v135, v155 row_ror:8 row_mask:0xf bank_mask:0xc
  s_add_u32 s22, s59, 655360
  buffer_store_dwordx4 v[132:135], v9, s[8:11], s22 offen offset:128
  s_add_u32 s23, s59, 983040
  buffer_store_dwordx4 v[140:143], v9, s[8:11], s23 offen offset:128
  s_add_u32 s22, s57, 655360
  buffer_store_dwordx4 v[148:151], v1, s[8:11], s22 offen
  s_add_u32 s42, s42, 1
  s_cmp_eq_u32 s58, 1
  s_cbranch_scc0 XA_sp2
  s_waitcnt vmcnt(22)
  v_pk_add_f32 v[160:161], v[160:161], v[180:181]
  v_pk_add_f32 v[162:163], v[162:163], v[182:183]
  v_pk_add_f32 v[164:165], v[164:165], v[184:185]
  v_pk_add_f32 v[166:167], v[166:167], v[186:187]
  v_pk_add_f32 v[168:169], v[168:169], v[188:189]
  v_pk_add_f32 v[170:171], v[170:171], v[190:191]
  v_pk_add_f32 v[172:173], v[172:173], v[192:193]
  v_pk_add_f32 v[174:175], v[174:175], v[194:195]
  v_pk_add_f32 v[176:177], v[176:177], v[196:197]
  v_pk_add_f32 v[178:179], v[178:179], v[198:199]
  ds_write_b128 v12, v[160:163] offset:0
  ds_write_b128 v12, v[164:167] offset:1024
  ds_write_b128 v12, v[168:171] offset:2048
  ds_write_b128 v12, v[172:175] offset:3072
  ds_write_b128 v12, v[176:179] offset:4096
  s_mov_b32 s96, 2
  s_branch XA_cl2
XA_sp2:
  s_waitcnt vmcnt(0)
  s_mov_b32 s95, 1
  v_mov_b32 v6, s48
  v_mov_b32 v152, s42
  s_mov_b64 exec, 1
  buffer_store_dword v152, v6, s[8:11], 0 offen offset:0
  s_mov_b64 exec, -1
  s_branch XA_cq
XA_wo0:
  s_waitcnt lgkmcnt(7)
  v_mfma_f32_16x16x32_bf16 v[112:115], a[0:3], v[40:43], 0
  v_mfma_f32_16x16x32_bf16 v[120:123], a[48:51], v[40:43], 0
  v_mfma_f32_16x16x32_bf16 v[128:131], a[96:99], v[40:43], 0
  v_mfma_f32_16x16x32_bf16 v[136:139], a[144:147], v[40:43], 0
  v_mfma_f32_16x16x32_bf16 v[144:147], a[192:195], v[40:43], 0
  ds_read_b128 v[40:43], v6 offset:8192
  s_waitcnt lgkmcnt(7)
  v_mfma_f32_16x16x32_bf16 v[112:115], a[4:7], v[44:47], v[112:115]
  v_mfma_f32_16x16x32_bf16 v[120:123], a[52:55], v[44:47], v[120:123]
  v_mfma_f32_16x16x32_bf16 v[128:131], a[100:103], v[44:47], v[128:131]
  v_mfma_f32_16x16x32_bf16 v[136:139], a[148:151], v[44:47], v[136:139]
  v_mfma_f32_16x16x32_bf16 v[144:147], a[196:199], v[44:47], v[144:147]
  ds_read_b128 v[44:47], v6 offset:9216
  s_waitcnt lgkmcnt(7)
  v_mfma_f32_16x16x32_bf16 v[112:115], a[8:11], v[48:51], v[112:115]
  v_mfma_f32_16x16x32_bf16 v[120:123], a[56:59], v[48:51], v[120:123]
  v_mfma_f32_16x16x32_bf16 v[128:131], a[104:107], v[48:51], v[128:131]
  v_mfma_f32_16x16x32_bf16 v[136:139], a[152:155], v[48:51], v[136:139]
  v_mfma_f32_16x16x32_bf16 v[144:147], a[200:203], v[48:51], v[144:147]
  ds_read_b128 v[48:51], v6 offset:10240
  s_waitcnt lgkmcnt(7)
  v_mfma_f32_16x16x32_bf16 v[112:115], a[12:15], v[52:55], v[112:115]
  v_mfma_f32_16x16x32_bf16 v[120:123], a[60:63], v[52:55], v[120:123]
  v_mfma_f32_16x16x32_bf16 v[128:131], a[108:111], v[52:55], v[128:131]
  v_mfma_f32_16x16x32_bf16 v[136:139], a[156:159], v[52:55], v[136:139]
  v_mfma_f32_16x16x32_bf16 v[144:147], a[204:207], v[52:55], v[144:147]
  ds_read_b128 v[52:55], v6 offset:11264
  s_waitcnt lgkmcnt(7)
  v_mfma_f32_16x16x32_bf16 v[112:115], a[16:19], v[56:59], v[112:115]
  v_mfma_f32_16x16x32_bf16 v[120:123], a[64:67], v[56:59], v[120:123]
  v_mfma_f32_16x16x32_bf16 v[128:131], a[112:115], v[56:59], v[128:131]
  v_mfma_f32_16x16x32_bf16 v[136:139], a[160:163], v[56:59], v[136:139]
  v_mfma_f32_16x16x32_bf16 v[144:147], a[208:211], v[56:59], v[144:147]
  ds_read_b128 v[56:59], v6 offset:12288
  s_waitcnt lgkmcnt(7)
  v_mfma_f32_16x16x32_bf16 v[112:115], a[20:23], v[60:63], v[112:115]
  v_mfma_f32_16x16x32_bf16 v[120:123], a[68:71], v[60:63], v[120:123]
  v_mfma_f32_16x16x32_bf16 v[128:131], a[116:119], v[60:63], v[128:131]
  v_mfma_f32_16x16x32_bf16 v[136:139], a[164:167], v[60:63], v[136:139]
  v_mfma_f32_16x16x32_bf16 v[144:147], a[212:215], v[60:63], v[144:147]
  ds_read_b128 v[60:63], v6 offset:13312
  s_waitcnt lgkmcnt(7)
  v_mfma_f32_16x16x32_bf16 v[112:115], a[24:27], v[64:67], v[112:115]
  v_mfma_f32_16x16x32_bf16 v[120:123], a[72:75], v[64:67], v[120:123]
  v_mfma_f32_16x16x32_bf16 v[128:131], a[120:123], v[64:67], v[128:131]
  v_mfma_f32_16x16x32_bf16 v[136:139], a[168:171], v[64:67], v[136:139]
  v_mfma_f32_16x16x32_bf16 v[144:147], a[216:219], v[64:67], v[144:147]
  ds_read_b128 v[64:67], v6 offset:14336
  s_waitcnt lgkmcnt(7)
  v_mfma_f32_16x16x32_bf16 v[112:115], a[28:31], v[68:71], v[112:115]
  v_mfma_f32_16x16x32_bf16 v[120:123], a[76:79], v[68:71], v[120:123]
  v_mfma_f32_16x16x32_bf16 v[128:131], a[124:127], v[68:71], v[128:131]
  v_mfma_f32_16x16x32_bf16 v[136:139], a[172:175], v[68:71], v[136:139]
  v_mfma_f32_16x16x32_bf16 v[144:147], a[220:223], v[68:71], v[144:147]
  ds_read_b128 v[68:71], v6 offset:15360
  s_waitcnt lgkmcnt(7)
  v_mfma_f32_16x16x32_bf16 v[112:115], a[32:35], v[40:43], v[112:115]
  v_mfma_f32_16x16x32_bf16 v[120:123], a[80:83], v[40:43], v[120:123]
  v_mfma_f32_16x16x32_bf16 v[128:131], a[128:131], v[40:43], v[128:131]
  v_mfma_f32_16x16x32_bf16 v[136:139], a[176:179], v[40:43], v[136:139]
  v_mfma_f32_16x16x32_bf16 v[144:147], a[224:227], v[40:43], v[144:147]
  ds_read_b128 v[40:43], v6 offset:16384
  s_waitcnt lgkmcnt(7)
  v_mfma_f32_16x16x32_bf16 v[112:115], a[36:39], v[44:47], v[112:115]
  v_mfma_f32_16x16x32_bf16 v[120:123], a[84:87], v[44:47], v[120:123]
  v_mfma_f32_16x16x32_bf16 v[128:131], a[132:135], v[44:47], v[128:131]
  v_mfma_f32_16x16x32_bf16 v[136:139], a[180:183], v[44:47], v[136:139]
  v_mfma_f32_16x16x32_bf16 v[144:147], a[228:231], v[44:47], v[144:147]
  ds_read_b128 v[44:47], v6 offset:17408
  s_waitcnt lgkmcnt(7)
  v_mfma_f32_16x16x32_bf16 v[112:115], a[40:43], v[48:51], v[112:115]
  v_mfma_f32_16x16x32_bf16 v[120:123], a[88:91], v[48:51], v[120:123]
  v_mfma_f32_16x16x32_bf16 v[128:131], a[136:139], v[48:51], v[128:131]
  v_mfma_f32_16x16x32_bf16 v[136:139], a[184:187], v[48:51], v[136:139]
  v_mfma_f32_16x16x32_bf16 v[144:147], a[232:235], v[48:51], v[144:147]
  ds_read_b128 v[48:51], v6 offset:18432
  s_waitcnt lgkmcnt(7)
  v_mfma_f32_16x16x32_bf16 v[112:115], a[44:47], v[52:55], v[112:115]
  v_mfma_f32_16x16x32_bf16 v[120:123], a[92:95], v[52:55], v[120:123]
  v_mfma_f32_16x16x32_bf16 v[128:131], a[140:143], v[52:55], v[128:131]
  v_mfma_f32_16x16x32_bf16 v[136:139], a[188:191], v[52:55], v[136:139]
  v_mfma_f32_16x16x32_bf16 v[144:147], a[236:239], v[52:55], v[144:147]
  ds_read_b128 v[52:55], v6 offset:19456
  s_waitcnt lgkmcnt(7)
  v_mfma_f32_16x16x32_bf16 v[116:119], a[0:3], v[56:59], 0
  v_mfma_f32_16x16x32_bf16 v[124:127], a[48:51], v[56:59], 0
  v_mfma_f32_16x16x32_bf16 v[132:135], a[96:99], v[56:59], 0
  v_mfma_f32_16x16x32_bf16 v[140:143], a[144:147], v[56:59], 0
  v_mfma_f32_16x16x32_bf16 v[148:151], a[192:195], v[56:59], 0
  ds_read_b128 v[56:59], v6 offset:20480
  s_waitcnt lgkmcnt(7)
  v_mfma_f32_16x16x32_bf16 v[116:119], a[4:7], v[60:63], v[116:119]
  v_mfma_f32_16x16x32_bf16 v[124:127], a[52:55], v[60:63], v[124:127]
  v_mfma_f32_16x16x32_bf16 v[132:135], a[100:103], v[60:63], v[132:135]
  v_mfma_f32_16x16x32_bf16 v[140:143], a[148:151], v[60:63], v[140:143]
  v_mfma_f32_16x16x32_bf16 v[148:151], a[196:199], v[60:63], v[148:151]
  ds_read_b128 v[60:63], v6 offset:21504
  v_mov_b32 v152, v120
  v_mov_b32 v153, v121
  v_mov_b32 v154, v122
  v_mov_b32 v155, v123
  v_mov_b32_dpp v120, v112 row_ror:8 row_mask:0xf bank_mask:0x3
  v_mov_b32_dpp v121, v113 row_ror:8 row_mask:0xf bank_mask:0x3
  v_mov_b32_dpp v122, v114 row_ror:8 row_mask:0xf bank_mask:0x3
  v_mov_b32_dpp v123, v115 row_ror:8 row_mask:0xf bank_mask:0x3
  v_mov_b32_dpp v112, v152 row_ror:8 row_mask:0xf bank_mask:0xc
  v_mov_b32_dpp v113, v153 row_ror:8 row_mask:0xf bank_mask:0xc
  v_mov_b32_dpp v114, v154 row_ror:8 row_mask:0xf bank_mask:0xc
  v_mov_b32_dpp v115, v155 row_ror:8 row_mask:0xf bank_mask:0xc
  s_add_u32 s22, s59, 0
  buffer_store_dwordx4 v[112:115], v9, s[8:11], s22 offen offset:0
  s_add_u32 s23, s59, 327680
  buffer_store_dwordx4 v[120:123], v9, s[8:11], s23 offen offset:0
  s_waitcnt lgkmcnt(7)
  v_mfma_f32_16x16x32_bf16 v[116:119], a[8:11], v[64:67], v[116:119]
  v_mfma_f32_16x16x32_bf16 v[124:127], a[56:59], v[64:67], v[124:127]
  v_mfma_f32_16x16x32_bf16 v[132:135], a[104:107], v[64:67], v[132:135]
  v_mfma_f32_16x16x32_bf16 v[140:143], a[152:155], v[64:67], v[140:143]
  v_mfma_f32_16x16x32_bf16 v[148:151], a[200:203], v[64:67], v[148:151]
  ds_read_b128 v[64:67], v6 offset:22528
  s_waitcnt lgkmcnt(7)
  v_mfma_f32_16x16x32_bf16 v[116:119], a[12:15], v[68:71], v[116:119]
  v_mfma_f32_16x16x32_bf16 v[124:127], a[60:63], v[68:71], v[124:127]
  v_mfma_f32_16x16x32_bf16 v[132:135], a[108:111], v[68:71], v[132:135]
  v_mfma_f32_16x16x32_bf16 v[140:143], a[156:159], v[68:71], v[140:143]
  v_mfma_f32_16x16x32_bf16 v[148:151], a[204:207], v[68:71], v[148:151]
  ds_read_b128 v[68:71], v6 offset:23552
  s_waitcnt lgkmcnt(7)
  v_mfma_f32_16x16x32_bf16 v[116:119], a[16:19], v[40:43], v[116:119]
  v_mfma_f32_16x16x32_bf16 v[124:127], a[64:67], v[40:43], v[124:127]
  v_mfma_f32_16x16x32_bf16 v[132:135], a[112:115], v[40:43], v[132:135]
  v_mfma_f32_16x16x32_bf16 v[140:143], a[160:163], v[40:43], v[140:143]
  v_mfma_f32_16x16x32_bf16 v[148:151], a[208:211], v[40:43], v[148:151]
  v_mov_b32 v152, v136
  v_mov_b32 v153, v137
  v_mov_b32 v154, v138
  v_mov_b32 v155, v139
  v_mov_b32_dpp v136, v128 row_ror:8 row_mask:0xf bank_mask:0x3
  v_mov_b32_dpp v137, v129 row_ror:8 row_mask:0xf bank_mask:0x3
  v_mov_b32_dpp v138, v130 row_ror:8 row_mask:0xf bank_mask:0x3
  v_mov_b32_dpp v139, v131 row_ror:8 row_mask:0xf bank_mask:0x3
  v_mov_b32_dpp v128, v152 row_ror:8 row_mask:0xf bank_mask:0xc
  v_mov_b32_dpp v129, v153 row_ror:8 row_mask:0xf bank_mask:0xc
  v_mov_b32_dpp v130, v154 row_ror:8 row_mask:0xf bank_mask:0xc
  v_mov_b32_dpp v131, v155 row_ror:8 row_mask:0xf bank_mask:0xc
  s_add_u32 s22, s59, 0
  buffer_store_dwordx4 v[128:131], v9, s[8:11], s22 offen offset:128
  s_add_u32 s23, s59, 327680
  buffer_store_dwordx4 v[136:139], v9, s[8:11], s23 offen offset:128
  s_waitcnt lgkmcnt(6)
  v_mfma_f32_16x16x32_bf16 v[116:119], a[20:23], v[44:47], v[116:119]
  v_mfma_f32_16x16x32_bf16 v[124:127], a[68:71], v[44:47], v[124:127]
  v_mfma_f32_16x16x32_bf16 v[132:135], a[116:119], v[44:47], v[132:135]
  v_mfma_f32_16x16x32_bf16 v[140:143], a[164:167], v[44:47], v[140:143]
  v_mfma_f32_16x16x32_bf16 v[148:151], a[212:215], v[44:47], v[148:151]
  s_waitcnt lgkmcnt(5)
  v_mfma_f32_16x16x32_bf16 v[116:119], a[24:27], v[48:51], v[116:119]
  v_mfma_f32_16x16x32_bf16 v[124:127], a[72:75], v[48:51], v[124:127]
  v_mfma_f32_16x16x32_bf16 v[132:135], a[120:123], v[48:51], v[132:135]
  v_mfma_f32_16x16x32_bf16 v[140:143], a[168:171], v[48:51], v[140:143]
  v_mfma_f32_16x16x32_bf16 v[148:151], a[216:219], v[48:51], v[148:151]
  s_waitcnt lgkmcnt(4)
  v_mfma_f32_16x16x32_bf16 v[116:119], a[28:31], v[52:55], v[116:119]
  v_mfma_f32_16x16x32_bf16 v[124:127], a[76:79], v[52:55], v[124:127]
  v_mfma_f32_16x16x32_bf16 v[132:135], a[124:127], v[52:55], v[132:135]
  v_mfma_f32_16x16x32_bf16 v[140:143], a[172:175], v[52:55], v[140:143]
  v_mfma_f32_16x16x32_bf16 v[148:151], a[220:223], v[52:55], v[148:151]
  s_add_u32 s22, s57, 0
  buffer_store_dwordx4 v[144:147], v1, s[8:11], s22 offen
  s_waitcnt lgkmcnt(3)
  v_mfma_f32_16x16x32_bf16 v[116:119], a[32:35], v[56:59], v[116:119]
  v_mfma_f32_16x16x32_bf16 v[124:127], a[80:83], v[56:59], v[124:127]
  v_mfma_f32_16x16x32_bf16 v[132:135], a[128:131], v[56:59], v[132:135]
  v_mfma_f32_16x16x32_bf16 v[140:143], a[176:179], v[56:59], v[140:143]
  v_mfma_f32_16x16x32_bf16 v[148:151], a[224:227], v[56:59], v[148:151]
  s_waitcnt lgkmcnt(2)
  v_mfma_f32_16x16x32_bf16 v[116:119], a[36:39], v[60:63], v[116:119]
  v_mfma_f32_16x16x32_bf16 v[124:127], a[84:87], v[60:63], v[124:127]
  v_mfma_f32_16x16x32_bf16 v[132:135], a[132:135], v[60:63], v[132:135]
  v_mfma_f32_16x16x32_bf16 v[140:143], a[180:183], v[60:63], v[140:143]
  v_mfma_f32_16x16x32_bf16 v[148:151], a[228:231], v[60:63], v[148:151]
  s_waitcnt lgkmcnt(1)
  v_mfma_f32_16x16x32_bf16 v[116:119], a[40:43], v[64:67], v[116:119]
  v_mfma_f32_16x16x32_bf16 v[124:127], a[88:91], v[64:67], v[124:127]
  v_mfma_f32_16x16x32_bf16 v[132:135], a[136:139], v[64:67], v[132:135]
  v_mfma_f32_16x16x32_bf16 v[140:143], a[184:187], v[64:67], v[140:143]
  v_mfma_f32_16x16x32_bf16 v[148:151], a[232:235], v[64:67], v[148:151]
  s_waitcnt lgkmcnt(0)
  v_mfma_f32_16x16x32_bf16 v[116:119], a[44:47], v[68:71], v[116:119]
  v_mfma_f32_16x16x32_bf16 v[124:127], a[92:95], v[68:71], v[124:127]
  v_mfma_f32_16x16x32_bf16 v[132:135], a[140:143], v[68:71], v[132:135]
  v_mfma_f32_16x16x32_bf16 v[140:143], a[188:191], v[68:71], v[140:143]
  v_mfma_f32_16x16x32_bf16 v[148:151], a[236:239], v[68:71], v[148:151]
  s_nop 4
  v_mov_b32 v152, v124
  v_mov_b32 v153, v125
  v_mov_b32 v154, v126
  v_mov_b32 v155, v127
  v_mov_b32_dpp v124, v116 row_ror:8 row_mask:0xf bank_mask:0x3
  v_mov_b32_dpp v125, v117 row_ror:8 row_mask:0xf bank_mask:0x3
  v_mov_b32_dpp v126, v118 row_ror:8 row_mask:0xf bank_mask:0x3
  v_mov_b32_dpp v127, v119 row_ror:8 row_mask:0xf bank_mask:0x3
  v_mov_b32_dpp v116, v152 row_ror:8 row_mask:0xf bank_mask:0xc
  v_mov_b32_dpp v117, v153 row_ror:8 row_mask:0xf bank_mask:0xc
  v_mov_b32_dpp v118, v154 row_ror:8 row_mask:0xf bank_mask:0xc
  v_mov_b32_dpp v119, v155 row_ror:8 row_mask:0xf bank_mask:0xc
  s_add_u32 s22, s59, 655360
  buffer_store_dwordx4 v[116:119], v9, s[8:11], s22 offen offset:0
  s_add_u32 s23, s59, 983040
  buffer_store_dwordx4 v[124:127], v9, s[8:11], s23 offen offset:0
  v_mov_b32 v152, v140
  v_mov_b32 v153, v141
  v_mov_b32 v154, v142
  v_mov_b32 v155, v143
  v_mov_b32_dpp v140, v132 row_ror:8 row_mask:0xf bank_mask:0x3
  v_mov_b32_dpp v141, v133 row_ror:8 row_mask:0xf bank_mask:0x3
  v_mov_b32_dpp v142, v134 row_ror:8 row_mask:0xf bank_mask:0x3
  v_mov_b32_dpp v143, v135 row_ror:8 row_mask:0xf bank_mask:0x3
  v_mov_b32_dpp v132, v152 row_ror:8 row_mask:0xf bank_mask:0xc
  v_mov_b32_dpp v133, v153 row_ror:8 row_mask:0xf bank_mask:0xc
  v_mov_b32_dpp v134, v154 row_ror:8 row_mask:0xf bank_mask:0xc
  v_mov_b32_dpp v135, v155 row_ror:8 row_mask:0xf bank_mask:0xc
  s_add_u32 s22, s59, 655360
  buffer_store_dwordx4 v[132:135], v9, s[8:11], s22 offen offset:128
  s_add_u32 s23, s59, 983040
  buffer_store_dwordx4 v[140:143], v9, s[8:11], s23 offen offset:128
  s_add_u32 s22, s57, 655360
  buffer_store_dwordx4 v[148:151], v1, s[8:11], s22 offen
  s_add_u32 s42, s42, 1
  s_cmp_eq_u32 s58, 1
  s_cbranch_scc0 XA_sp0
  s_waitcnt vmcnt(10)
  v_pk_add_f32 v[160:161], v[160:161], v[180:181]
  v_pk_add_f32 v[162:163], v[162:163], v[182:183]
  v_pk_add_f32 v[164:165], v[164:165], v[184:185]
  v_pk_add_f32 v[166:167], v[166:167], v[186:187]
  v_pk_add_f32 v[168:169], v[168:169], v[188:189]
  v_pk_add_f32 v[170:171], v[170:171], v[190:191]
  v_pk_add_f32 v[172:173], v[172:173], v[192:193]
  v_pk_add_f32 v[174:175], v[174:175], v[194:195]
  v_pk_add_f32 v[176:177], v[176:177], v[196:197]
  v_pk_add_f32 v[178:179], v[178:179], v[198:199]
  ds_write_b128 v12, v[160:163] offset:0
  ds_write_b128 v12, v[164:167] offset:1024
  ds_write_b128 v12, v[168:171] offset:2048
  ds_write_b128 v12, v[172:175] offset:3072
  ds_write_b128 v12, v[176:179] offset:4096
  s_mov_b32 s96, 1
  s_branch XA_cl2
XA_sp0:
  s_waitcnt vmcnt(0)
  v_mov_b32 v6, s48
  v_mov_b32 v152, s42
  s_mov_b64 exec, 1
  buffer_store_dword v152, v6, s[8:11], 0 offen offset:0
  s_mov_b64 exec, -1
XA_cq:
  s_cmp_eq_u32 s56, -1
  s_cbranch_scc0 XA_c
  s_cmp_eq_u32 s40, -1
  s_cbranch_scc1 XA_next
  s_mov_b32 s56, s40
  s_mov_b32 s58, 0
  s_mov_b32 s40, -1
  s_cmp_eq_u32 s54, -1
  s_cbranch_scc1 XA_c
  s_bitcmp1_b64 s[34:35], s56
  s_cbranch_scc0 XA_next
XA_c:
  s_cmp_eq_u32 s58, 1
  s_cbranch_scc1 XA_cl
  s_add_u32 s57, s43, 1
XA_fl:
  buffer_load_dwordx2 v[152:153], v10, s[8:11], s47 offen offset:0 sc1
  s_waitcnt vmcnt(0)
  v_min_u32 v152, v152, v153
  v_cmp_gt_u32 vcc, s57, v152
  s_cbranch_vccz XA_fl_ok
  s_add_u32 s41, s41, 1
  s_cmp_lt_u32 s41, 3000000
  s_cbranch_scc1 XA_fl
  s_branch K3_end
XA_fl_ok:
  s_and_b32 s22, s43, 1
  s_mul_i32 s22, s22, 1310720
  s_add_u32 s22, s22, s46
  buffer_load_dwordx4 v[160:163], v5, s[8:11], s22 offen offset:0 sc1
  buffer_load_dwordx4 v[164:167], v5, s[8:11], s22 offen offset:1024 sc1
  buffer_load_dwordx4 v[168:171], v5, s[8:11], s22 offen offset:2048 sc1
  buffer_load_dwordx4 v[172:175], v5, s[8:11], s22 offen offset:3072 sc1
  s_add_u32 s22, s22, 4096
  buffer_load_dwordx4 v[176:179], v5, s[8:11], s22 offen offset:0 sc1
  buffer_load_dwordx4 v[180:183], v5, s[8:11], s22 offen offset:1024 sc1
  buffer_load_dwordx4 v[184:187], v5, s[8:11], s22 offen offset:2048 sc1
  buffer_load_dwordx4 v[188:191], v5, s[8:11], s22 offen offset:3072 sc1
  s_add_u32 s22, s22, 4096
  buffer_load_dwordx4 v[192:195], v5, s[8:11], s22 offen offset:0 sc1
  buffer_load_dwordx4 v[196:199], v5, s[8:11], s22 offen offset:1024 sc1
  s_lshl_b32 s22, s56, 5
  s_add_u32 s22, s22, s5
  s_mul_i32 s22, s22, 1280
  s_mov_b64 exec, s[86:87]
  s_cbranch_execz XA_xr12342
  buffer_load_dwordx2 v[202:203], v201, s[12:15], s22 offen
XA_xr12342:
  s_mov_b64 exec, -1
  s_cmp_eq_u32 s54, -1
  s_cbranch_scc1 XA_cw
  s_cmp_eq_u32 s55, 1
  s_cbranch_scc1 XA_cw
  s_cmp_eq_u32 s93, 1
  s_cbranch_scc0 XA_cp3
  s_lshl_b32 s50, s54, 5
  s_add_u32 s50, s50, s45
  s_mul_i32 s51, s50, 12288
  s_mul_i32 s92, s91, 3072
  s_add_u32 s51, s51, s92
  s_lshr_b32 s23, s91, 1
  s_add_u32 s50, s50, s23
  s_mul_i32 s52, s50, 3072
  s_add_u32 s52, s52, 5242880
  buffer_load_dwordx4 v[208:211], v7, s[8:11], s52 offen offset:0 sc1
  buffer_load_dwordx4 v[212:215], v7, s[8:11], s52 offen offset:512 sc1
  buffer_load_dwordx4 v[216:219], v7, s[8:11], s52 offen offset:1024 sc1
  buffer_load_dwordx4 v[220:223], v7, s[8:11], s52 offen offset:1536 sc1
  buffer_load_dwordx4 v[224:227], v7, s[8:11], s52 offen offset:2048 sc1
  buffer_load_dwordx4 v[228:231], v7, s[8:11], s52 offen offset:2560 sc1
  s_add_u32 s88, s52, 7340032
  buffer_load_dwordx4 v[232:235], v8, s[8:11], s88 offen offset:0 sc1
  buffer_load_dwordx4 v[236:239], v8, s[8:11], s88 offen offset:512 sc1
  buffer_load_dwordx4 v[240:243], v8, s[8:11], s88 offen offset:1024 sc1
  buffer_load_dwordx4 v[244:247], v8, s[8:11], s88 offen offset:1536 sc1
  buffer_load_dwordx4 v[248:251], v8, s[8:11], s88 offen offset:2048 sc1
  buffer_load_dwordx4 v[252:255], v8, s[8:11], s88 offen offset:2560 sc1
  s_mov_b32 s55, 1
  s_waitcnt vmcnt(12)
  s_branch XA_cl
XA_cp3:
  s_mov_b64 exec, 3
  v_cmp_gt_u32 vcc, v14, v15
  s_mov_b64 exec, -1
  s_cbranch_vccnz XA_cw
  s_lshl_b32 s50, s54, 5
  s_add_u32 s50, s50, s45
  s_mul_i32 s51, s50, 12288
  s_mul_i32 s92, s91, 3072
  s_add_u32 s51, s51, s92
  s_lshr_b32 s23, s91, 1
  s_add_u32 s50, s50, s23
  s_mul_i32 s52, s50, 3072
  s_add_u32 s52, s52, 5242880
  s_add_u32 s53, s51, 75497472
  s_add_u32 m0, s92, 0
  s_nop 0
  buffer_load_dwordx4 v5, s[8:11], s53 offen offset:0 lds
  buffer_load_dwordx4 v5, s[8:11], s53 offen offset:1024 lds
  buffer_load_dwordx4 v5, s[8:11], s53 offen offset:2048 lds
  s_add_u32 s53, s51, 100663296
  s_add_u32 m0, s92, 12288
  s_nop 0
  buffer_load_dwordx4 v5, s[8:11], s53 offen offset:0 lds
  buffer_load_dwordx4 v5, s[8:11], s53 offen offset:1024 lds
  buffer_load_dwordx4 v5, s[8:11], s53 offen offset:2048 lds
  s_add_u32 s53, s51, 75509760
  s_add_u32 m0, s92, 24576
  s_nop 0
  buffer_load_dwordx4 v5, s[8:11], s53 offen offset:0 lds
  buffer_load_dwordx4 v5, s[8:11], s53 offen offset:1024 lds
  buffer_load_dwordx4 v5, s[8:11], s53 offen offset:2048 lds
  s_add_u32 s53, s51, 100675584
  s_add_u32 m0, s92, 36864
  s_nop 0
  buffer_load_dwordx4 v5, s[8:11], s53 offen offset:0 lds
  buffer_load_dwordx4 v5, s[8:11], s53 offen offset:1024 lds
  buffer_load_dwordx4 v5, s[8:11], s53 offen offset:2048 lds
  s_mul_i32 s89, s50, 12288
  s_mul_i32 s53, s49, 384
  s_add_u32 s89, s89, s53
  s_add_u32 s89, s89, 50331648
  buffer_load_dwordx4 v[16:19], v5, s[8:11], s89 offen offset:0
  buffer_load_dwordx4 v[20:23], v5, s[8:11], s89 offen offset:1024
  buffer_load_dwordx4 v[24:27], v5, s[8:11], s89 offen offset:2048
  buffer_load_dwordx4 v[28:31], v5, s[8:11], s89 offen offset:3072
  s_add_u32 s89, s89, 4096
  buffer_load_dwordx4 v[32:35], v5, s[8:11], s89 offen offset:0
  buffer_load_dwordx4 v[36:39], v5, s[8:11], s89 offen offset:1024
  buffer_load_dwordx4 v[208:211], v7, s[8:11], s52 offen offset:0 sc1
  buffer_load_dwordx4 v[212:215], v7, s[8:11], s52 offen offset:512 sc1
  buffer_load_dwordx4 v[216:219], v7, s[8:11], s52 offen offset:1024 sc1
  buffer_load_dwordx4 v[220:223], v7, s[8:11], s52 offen offset:1536 sc1
  buffer_load_dwordx4 v[224:227], v7, s[8:11], s52 offen offset:2048 sc1
  buffer_load_dwordx4 v[228:231], v7, s[8:11], s52 offen offset:2560 sc1
  s_add_u32 s88, s52, 7340032
  buffer_load_dwordx4 v[232:235], v8, s[8:11], s88 offen offset:0 sc1
  buffer_load_dwordx4 v[236:239], v8, s[8:11], s88 offen offset:512 sc1
  buffer_load_dwordx4 v[240:243], v8, s[8:11], s88 offen offset:1024 sc1
  buffer_load_dwordx4 v[244:247], v8, s[8:11], s88 offen offset:1536 sc1
  buffer_load_dwordx4 v[248:251], v8, s[8:11], s88 offen offset:2048 sc1
  buffer_load_dwordx4 v[252:255], v8, s[8:11], s88 offen offset:2560 sc1
  s_mov_b32 s55, 1
  s_waitcnt vmcnt(30)
  s_branch XA_cl
XA_cw:
  s_waitcnt vmcnt(0)
XA_cl:
  v_pk_add_f32 v[160:161], v[160:161], v[180:181]
  v_pk_add_f32 v[162:163], v[162:163], v[182:183]
  v_pk_add_f32 v[164:165], v[164:165], v[184:185]
  v_pk_add_f32 v[166:167], v[166:167], v[186:187]
  v_pk_add_f32 v[168:169], v[168:169], v[188:189]
  v_pk_add_f32 v[170:171], v[170:171], v[190:191]
  v_pk_add_f32 v[172:173], v[172:173], v[192:193]
  v_pk_add_f32 v[174:175], v[174:175], v[194:195]
  v_pk_add_f32 v[176:177], v[176:177], v[196:197]
  v_pk_add_f32 v[178:179], v[178:179], v[198:199]
  ds_write_b128 v12, v[160:163] offset:0
  ds_write_b128 v12, v[164:167] offset:1024
  ds_write_b128 v12, v[168:171] offset:2048
  ds_write_b128 v12, v[172:175] offset:3072
  ds_write_b128 v12, v[176:179] offset:4096
XA_cl2:
  s_mov_b32 s58, 0
  s_add_u32 s43, s43, 1
  v_mov_b32 v6, s48
  v_mov_b32 v152, s43
  s_mov_b64 exec, 1
  buffer_store_dword v152, v6, s[8:11], 0 offen offset:512
  s_mov_b64 exec, -1
  s_waitcnt lgkmcnt(0)
  s_barrier
  s_lshl_b32 s22, s56, 5
  s_add_u32 s22, s22, s5
  s_mul_i32 s23, s22, 1280
  v_add_u32 v84, 73728, v200
  v_add_u32 v85, 94208, v200
  ds_read_b128 v[40:43], v84 offset:0
  ds_read_b128 v[44:47], v84 offset:2560
  ds_read_b128 v[48:51], v84 offset:5120
  ds_read_b128 v[52:55], v84 offset:7680
  ds_read_b128 v[56:59], v84 offset:10240
  ds_read_b128 v[60:63], v84 offset:12800
  ds_read_b128 v[64:67], v84 offset:15360
  ds_read_b128 v[68:71], v84 offset:17920
  ds_read_b128 v[72:75], v85 offset:0
  ds_read_b128 v[76:79], v85 offset:2560
  ds_read_b128 v[80:83], v85 offset:5120
  s_waitcnt lgkmcnt(3)
  v_pk_add_f32 v[40:41], v[40:41], v[56:57]
  v_pk_add_f32 v[42:43], v[42:43], v[58:59]
  v_pk_add_f32 v[44:45], v[44:45], v[60:61]
  v_pk_add_f32 v[46:47], v[46:47], v[62:63]
  v_pk_add_f32 v[48:49], v[48:49], v[64:65]
  v_pk_add_f32 v[50:51], v[50:51], v[66:67]
  v_pk_add_f32 v[52:53], v[52:53], v[68:69]
  v_pk_add_f32 v[54:55], v[54:55], v[70:71]
  v_pk_add_f32 v[40:41], v[40:41], v[48:49]
  v_pk_add_f32 v[42:43], v[42:43], v[50:51]
  v_pk_add_f32 v[44:45], v[44:45], v[52:53]
  v_pk_add_f32 v[46:47], v[46:47], v[54:55]
  v_pk_add_f32 v[40:41], v[40:41], v[44:45]
  v_pk_add_f32 v[42:43], v[42:43], v[46:47]
  s_waitcnt lgkmcnt(0)
  v_cvt_pk_bf16_f32 v84, v40, v41
  v_lshlrev_b32 v40, 16, v84
  v_and_b32 v41, 0xffff0000, v84
  v_mul_f32 v40, v40, v72
  v_mul_f32 v41, v41, v73
  v_cvt_pk_bf16_f32 v84, v40, v41
  v_lshlrev_b32 v40, 16, v84
  v_and_b32 v41, 0xffff0000, v84
  v_lshlrev_b32 v85, 16, v202
  v_and_b32 v86, 0xffff0000, v202
  v_add_f32 v40, v40, v85
  v_add_f32 v41, v41, v86
  v_cvt_pk_bf16_f32 v202, v40, v41
  v_lshlrev_b32 v40, 16, v202
  v_and_b32 v41, 0xffff0000, v202
  v_cvt_pk_bf16_f32 v84, v42, v43
  v_lshlrev_b32 v42, 16, v84
  v_and_b32 v43, 0xffff0000, v84
  v_mul_f32 v42, v42, v74
  v_mul_f32 v43, v43, v75
  v_cvt_pk_bf16_f32 v84, v42, v43
  v_lshlrev_b32 v42, 16, v84
  v_and_b32 v43, 0xffff0000, v84
  v_lshlrev_b32 v85, 16, v203
  v_and_b32 v86, 0xffff0000, v203
  v_add_f32 v42, v42, v85
  v_add_f32 v43, v43, v86
  v_cvt_pk_bf16_f32 v203, v42, v43
  v_lshlrev_b32 v42, 16, v203
  v_and_b32 v43, 0xffff0000, v203
  v_add_f32 v84, v40, v41
  v_add_f32 v85, v42, v43
  v_add_f32 v84, v84, v85
  v_cndmask_b32 v84, 0, v84, s[86:87]
  s_add_u32 s23, s23, 26214400
  s_cmp_eq_u32 s96, 0
  s_cbranch_scc1 XA_lf
  s_waitcnt vmcnt(1)
  v_mov_b32 v6, s48
  v_mov_b32 v152, s42
  s_mov_b64 exec, 1
  buffer_store_dword v152, v6, s[8:11], 0 offen offset:0
  s_mov_b64 exec, -1
  s_lshr_b32 s95, s96, 1
  s_mov_b32 s96, 0
XA_lf:
  s_mov_b64 exec, s[86:87]
  s_cbranch_execz XA_f1
  buffer_store_dwordx2 v[202:203], v201, s[8:11], s23 offen sc1
XA_f1:
  s_mov_b64 exec, -1
  v_mul_f32 v98, v40, v40
  v_fmac_f32 v98, v41, v41
  v_fmac_f32 v98, v42, v42
  v_fmac_f32 v98, v43, v43
  v_cndmask_b32 v98, 0, v98, s[86:87]
  v_add_f32_dpp v84, v84, v84 row_ror:8 row_mask:0xf bank_mask:0xf
  s_nop 0
  v_add_f32_dpp v98, v98, v98 row_ror:8 row_mask:0xf bank_mask:0xf
  v_add_f32_dpp v84, v84, v84 row_ror:4 row_mask:0xf bank_mask:0xf
  s_nop 0
  v_add_f32_dpp v98, v98, v98 row_ror:4 row_mask:0xf bank_mask:0xf
  v_add_f32_dpp v84, v84, v84 row_ror:2 row_mask:0xf bank_mask:0xf
  s_nop 0
  v_add_f32_dpp v98, v98, v98 row_ror:2 row_mask:0xf bank_mask:0xf
  v_add_f32_dpp v84, v84, v84 row_ror:1 row_mask:0xf bank_mask:0xf
  s_nop 0
  v_add_f32_dpp v98, v98, v98 row_ror:1 row_mask:0xf bank_mask:0xf
  v_mov_b32 v85, v84
  s_nop 1
  v_permlane32_swap_b32 v84, v85
  v_add_f32 v84, v84, v85
  v_mov_b32 v85, v84
  s_nop 1
  v_permlane16_swap_b32 v84, v85
  v_add_f32 v84, v84, v85
  v_mov_b32 v99, v98
  s_nop 1
  v_permlane32_swap_b32 v98, v99
  v_add_f32 v98, v98, v99
  v_mov_b32 v99, v98
  s_nop 1
  v_permlane16_swap_b32 v98, v99
  v_add_f32 v98, v98, v99
  s_lshl_b32 s24, s91, 2
  s_add_u32 s24, s24, 101888
  v_mov_b32 v86, s24
  s_mov_b64 exec, 1
  ds_write_b32 v86, v84
  ds_write_b32 v86, v98 offset:16
  s_mov_b64 exec, -1
  v_mov_b32 v87, 101888
  s_waitcnt lgkmcnt(0)
  s_barrier
  ds_read_b128 v[88:91], v87
  ds_read_b128 v[92:95], v87 offset:16
  s_waitcnt lgkmcnt(1)
  v_add_f32 v88, v88, v89
  v_add_f32 v88, v88, v90
  v_mul_f32 v88, 0x3acccccd, v88
  s_waitcnt lgkmcnt(0)
  v_add_f32 v92, v92, v93
  v_add_f32 v92, v92, v94
  v_mul_f32 v92, 0x3acccccd, v92
  v_fma_f32 v92, -v88, v88, v92
  v_max_f32 v92, 0, v92
  v_cvt_pk_bf16_f32 v88, v88, v88
  v_lshlrev_b32 v88, 16, v88
  v_cvt_pk_bf16_f32 v92, v92, v92
  v_lshlrev_b32 v92, 16, v92
  v_add_f32 v92, 0x3727c5ac, v92
  v_cvt_pk_bf16_f32 v92, v92, v92
  v_lshlrev_b32 v92, 16, v92
  v_sqrt_f32 v92, v92
  s_nop 0
  v_cvt_pk_bf16_f32 v92, v92, v92
  v_lshlrev_b32 v92, 16, v92
  v_rcp_f32 v89, v92
  v_sub_f32 v40, v40, v88
  v_sub_f32 v41, v41, v88
  v_cvt_pk_bf16_f32 v85, v40, v41
  v_lshlrev_b32 v40, 16, v85
  v_and_b32 v41, 0xffff0000, v85
  v_mul_f32 v90, v40, v89
  v_fma_f32 v91, -v90, v92, v40
  v_fma_f32 v40, v91, v89, v90
  v_mul_f32 v90, v41, v89
  v_fma_f32 v91, -v90, v92, v41
  v_fma_f32 v41, v91, v89, v90
  v_cvt_pk_bf16_f32 v85, v40, v41
  v_lshlrev_b32 v40, 16, v85
  v_and_b32 v41, 0xffff0000, v85
  v_mul_f32 v40, v40, v76
  v_mul_f32 v41, v41, v77
  v_cvt_pk_bf16_f32 v85, v40, v41
  v_lshlrev_b32 v40, 16, v85
  v_and_b32 v41, 0xffff0000, v85
  v_add_f32 v40, v40, v80
  v_add_f32 v41, v41, v81
  v_cvt_pk_bf16_f32 v96, v40, v41
  v_sub_f32 v42, v42, v88
  v_sub_f32 v43, v43, v88
  v_cvt_pk_bf16_f32 v85, v42, v43
  v_lshlrev_b32 v42, 16, v85
  v_and_b32 v43, 0xffff0000, v85
  v_mul_f32 v90, v42, v89
  v_fma_f32 v91, -v90, v92, v42
  v_fma_f32 v42, v91, v89, v90
  v_mul_f32 v90, v43, v89
  v_fma_f32 v91, -v90, v92, v43
  v_fma_f32 v43, v91, v89, v90
  v_cvt_pk_bf16_f32 v85, v42, v43
  v_lshlrev_b32 v42, 16, v85
  v_and_b32 v43, 0xffff0000, v85
  v_mul_f32 v42, v42, v78
  v_mul_f32 v43, v43, v79
  v_cvt_pk_bf16_f32 v85, v42, v43
  v_lshlrev_b32 v42, 16, v85
  v_and_b32 v43, 0xffff0000, v85
  v_add_f32 v42, v42, v82
  v_add_f32 v43, v43, v83
  v_cvt_pk_bf16_f32 v97, v42, v43
  s_lshr_b32 s22, s22, 4
  s_mul_i32 s22, s22, 20480
  s_add_u32 s22, s22, 23068672
  s_mov_b64 exec, s[86:87]
  s_cbranch_execz XA_f2
  buffer_store_dwordx2 v[96:97], v11, s[8:11], s22 offen sc1
XA_f2:
  s_mov_b64 exec, -1
  s_mov_b32 s56, -1
  s_branch XA_cq
XA_next:
  s_cmp_eq_u32 s54, -1
  s_cbranch_scc1 K3_end
  s_cmp_eq_u32 s55, 1
  s_cbranch_scc1 XA_n2
  s_cmp_eq_u32 s93, 1
  s_cbranch_scc0 XA_dp3
  s_lshl_b32 s50, s54, 5
  s_add_u32 s50, s50, s45
  s_mul_i32 s51, s50, 12288
  s_mul_i32 s92, s91, 3072
  s_add_u32 s51, s51, s92
  s_lshr_b32 s23, s91, 1
  s_add_u32 s50, s50, s23
  s_mul_i32 s52, s50, 3072
  s_add_u32 s52, s52, 5242880
  buffer_load_dwordx4 v[208:211], v7, s[8:11], s52 offen offset:0 sc1
  buffer_load_dwordx4 v[212:215], v7, s[8:11], s52 offen offset:512 sc1
  buffer_load_dwordx4 v[216:219], v7, s[8:11], s52 offen offset:1024 sc1
  buffer_load_dwordx4 v[220:223], v7, s[8:11], s52 offen offset:1536 sc1
  buffer_load_dwordx4 v[224:227], v7, s[8:11], s52 offen offset:2048 sc1
  buffer_load_dwordx4 v[228:231], v7, s[8:11], s52 offen offset:2560 sc1
  s_add_u32 s88, s52, 7340032
  buffer_load_dwordx4 v[232:235], v8, s[8:11], s88 offen offset:0 sc1
  buffer_load_dwordx4 v[236:239], v8, s[8:11], s88 offen offset:512 sc1
  buffer_load_dwordx4 v[240:243], v8, s[8:11], s88 offen offset:1024 sc1
  buffer_load_dwordx4 v[244:247], v8, s[8:11], s88 offen offset:1536 sc1
  buffer_load_dwordx4 v[248:251], v8, s[8:11], s88 offen offset:2048 sc1
  buffer_load_dwordx4 v[252:255], v8, s[8:11], s88 offen offset:2560 sc1
  s_branch XA_n2
XA_dp3:
XA_dg:
  s_lshl_b32 s22, s54, 6
  s_mov_b64 exec, 3
  buffer_load_dword v15, v13, s[8:11], s22 offen sc1
  s_mov_b64 exec, -1
  s_waitcnt vmcnt(0)
  s_mov_b64 exec, 3
  v_cmp_gt_u32 vcc, v14, v15
  s_mov_b64 exec, -1
  s_cbranch_vccz XA_dgok
  s_sleep 8
  s_add_u32 s41, s41, 1
  s_cmp_lt_u32 s41, 3000000
  s_cbranch_scc1 XA_dg
  s_branch K3_end
XA_dgok:
  s_lshl_b32 s50, s54, 5
  s_add_u32 s50, s50, s45
  s_mul_i32 s51, s50, 12288
  s_mul_i32 s92, s91, 3072
  s_add_u32 s51, s51, s92
  s_lshr_b32 s23, s91, 1
  s_add_u32 s50, s50, s23
  s_mul_i32 s52, s50, 3072
  s_add_u32 s52, s52, 5242880
  s_add_u32 s53, s51, 75497472
  s_add_u32 m0, s92, 0
  s_nop 0
  buffer_load_dwordx4 v5, s[8:11], s53 offen offset:0 lds
  buffer_load_dwordx4 v5, s[8:11], s53 offen offset:1024 lds
  buffer_load_dwordx4 v5, s[8:11], s53 offen offset:2048 lds
  s_add_u32 s53, s51, 100663296
  s_add_u32 m0, s92, 12288
  s_nop 0
  buffer_load_dwordx4 v5, s[8:11], s53 offen offset:0 lds
  buffer_load_dwordx4 v5, s[8:11], s53 offen offset:1024 lds
  buffer_load_dwordx4 v5, s[8:11], s53 offen offset:2048 lds
  s_add_u32 s53, s51, 75509760
  s_add_u32 m0, s92, 24576
  s_nop 0
  buffer_load_dwordx4 v5, s[8:11], s53 offen offset:0 lds
  buffer_load_dwordx4 v5, s[8:11], s53 offen offset:1024 lds
  buffer_load_dwordx4 v5, s[8:11], s53 offen offset:2048 lds
  s_add_u32 s53, s51, 100675584
  s_add_u32 m0, s92, 36864
  s_nop 0
  buffer_load_dwordx4 v5, s[8:11], s53 offen offset:0 lds
  buffer_load_dwordx4 v5, s[8:11], s53 offen offset:1024 lds
  buffer_load_dwordx4 v5, s[8:11], s53 offen offset:2048 lds
  s_mul_i32 s89, s50, 12288
  s_mul_i32 s53, s49, 384
  s_add_u32 s89, s89, s53
  s_add_u32 s89, s89, 50331648
  buffer_load_dwordx4 v[16:19], v5, s[8:11], s89 offen offset:0
  buffer_load_dwordx4 v[20:23], v5, s[8:11], s89 offen offset:1024
  buffer_load_dwordx4 v[24:27], v5, s[8:11], s89 offen offset:2048
  buffer_load_dwordx4 v[28:31], v5, s[8:11], s89 offen offset:3072
  s_add_u32 s89, s89, 4096
  buffer_load_dwordx4 v[32:35], v5, s[8:11], s89 offen offset:0
  buffer_load_dwordx4 v[36:39], v5, s[8:11], s89 offen offset:1024
  buffer_load_dwordx4 v[208:211], v7, s[8:11], s52 offen offset:0 sc1
  buffer_load_dwordx4 v[212:215], v7, s[8:11], s52 offen offset:512 sc1
  buffer_load_dwordx4 v[216:219], v7, s[8:11], s52 offen offset:1024 sc1
  buffer_load_dwordx4 v[220:223], v7, s[8:11], s52 offen offset:1536 sc1
  buffer_load_dwordx4 v[224:227], v7, s[8:11], s52 offen offset:2048 sc1
  buffer_load_dwordx4 v[228:231], v7, s[8:11], s52 offen offset:2560 sc1
  s_add_u32 s88, s52, 7340032
  buffer_load_dwordx4 v[232:235], v8, s[8:11], s88 offen offset:0 sc1
  buffer_load_dwordx4 v[236:239], v8, s[8:11], s88 offen offset:512 sc1
  buffer_load_dwordx4 v[240:243], v8, s[8:11], s88 offen offset:1024 sc1
  buffer_load_dwordx4 v[244:247], v8, s[8:11], s88 offen offset:1536 sc1
  buffer_load_dwordx4 v[248:251], v8, s[8:11], s88 offen offset:2048 sc1
  buffer_load_dwordx4 v[252:255], v8, s[8:11], s88 offen offset:2560 sc1
XA_n2:
  s_mov_b32 s40, s54
  s_bitset0_b64 s[36:37], s54
  s_branch XA_loop
XB_start:
  s_barrier
  v_and_b32 v2, 63, v0
  v_lshrrev_b32 v3, 4, v2
  v_and_b32 v4, 15, v2
  s_mul_i32 s21, s91, 32768
  v_lshlrev_b32 v5, 4, v2
  s_mul_i32 s46, s80, 4194304
  s_add_u32 s46, s46, 177209344
  s_lshl_b32 s47, s80, 10
  s_add_u32 s47, s47, 4612096
  s_mov_b32 s41, 0
  s_mov_b32 s42, 0
  s_mov_b32 s24, 2863311488
  s_mov_b32 s25, 2863311530
  s_mov_b32 s26, 2863311528
  s_mov_b32 s27, 2863311530
  s_mov_b32 s28, 1431655767
  s_mov_b32 s29, 1431655765
  s_mov_b32 s30, 1431655807
  s_mov_b32 s31, 1431655765
  s_cmp_eq_u32 s80, 1
  s_cselect_b32 s36, s26, s24
  s_cselect_b32 s37, s27, s25
  s_cmp_eq_u32 s80, 2
  s_cselect_b32 s36, s28, s36
  s_cselect_b32 s37, s29, s37
  s_cmp_eq_u32 s80, 3
  s_cselect_b32 s36, s30, s36
  s_cselect_b32 s37, s31, s37
  s_ff1_i32_b64 s40, s[36:37]
  s_bitset0_b64 s[36:37], s40
  s_mov_b32 s43, 0
  v_mov_b32 v6, 4593600
XB_g:
  buffer_load_dword v7, v6, s[8:11], 0 offen sc1
  s_waitcnt vmcnt(0)
  v_readfirstlane_b32 s57, v7
  s_nop 0
  s_cmp_ge_u32 s57, 32
  s_cbranch_scc1 XB_gok
  s_sleep 8
  s_add_u32 s41, s41, 1
  s_cmp_lt_u32 s41, 3000000
  s_cbranch_scc1 XB_g
  s_branch K3_end
XB_gok:
  s_cmp_ge_u32 s5, 24
  s_cbranch_scc1 XF2_start
  s_lshl_b32 s24, s5, 7
  s_lshl_b32 s25, s91, 5
  s_add_u32 s24, s24, s25
  v_lshrrev_b32 v6, 2, v4
  v_lshl_add_u32 v6, v3, 2, v6
  v_mul_u32_u24 v6, 32, v6
  v_and_b32 v7, 3, v4
  v_lshl_add_u32 v6, v7, 3, v6
  v_add_u32 v10, s21, v6
  s_load_dwordx2 s[16:17], s[0:1], 64
  s_waitcnt lgkmcnt(0)
  s_and_b32 s17, s17, 0xffff
  s_mov_b32 s18, 1966080
  s_mov_b32 s19, 0x00020000
  s_load_dwordx2 s[28:29], s[0:1], 72
  s_waitcnt lgkmcnt(0)
  s_and_b32 s29, s29, 0xffff
  s_mov_b32 s30, 1966080
  s_mov_b32 s31, 0x00020000
  v_lshrrev_b32 v8, 1, v2
  v_and_b32 v9, 1, v2
  v_mul_u32_u24 v8, 3072, v8
  v_lshl_add_u32 v123, v9, 4, v8
  s_add_u32 s25, s24, 0
  s_mov_b32 s26, s25
  s_add_u32 m0, s21, 0
  s_nop 0
  buffer_load_dwordx4 v123, s[16:19], s25 offen lds
  s_add_u32 s25, s25, 98304
  s_add_u32 m0, s21, 1024
  s_nop 0
  buffer_load_dwordx4 v123, s[16:19], s25 offen lds
  s_add_u32 s25, s25, 98304
  s_add_u32 m0, s21, 2048
  s_nop 0
  buffer_load_dwordx4 v123, s[16:19], s25 offen lds
  s_add_u32 s25, s25, 98304
  s_add_u32 m0, s21, 3072
  s_nop 0
  buffer_load_dwordx4 v123, s[16:19], s25 offen lds
  s_add_u32 s25, s25, 98304
  s_add_u32 m0, s21, 4096
  s_nop 0
  buffer_load_dwordx4 v123, s[16:19], s25 offen lds
  s_add_u32 m0, s21, 5120
  s_nop 0
  buffer_load_dwordx4 v123, s[28:31], s26 offen lds
  s_add_u32 s26, s26, 98304
  s_add_u32 m0, s21, 6144
  s_nop 0
  buffer_load_dwordx4 v123, s[28:31], s26 offen lds
  s_add_u32 s26, s26, 98304
  s_add_u32 m0, s21, 7168
  s_nop 0
  buffer_load_dwordx4 v123, s[28:31], s26 offen lds
  s_add_u32 s26, s26, 98304
  s_add_u32 m0, s21, 8192
  s_nop 0
  buffer_load_dwordx4 v123, s[28:31], s26 offen lds
  s_add_u32 s26, s26, 98304
  s_add_u32 m0, s21, 9216
  s_nop 0
  buffer_load_dwordx4 v123, s[28:31], s26 offen lds
  s_add_u32 s25, s24, 491520
  s_mov_b32 s26, s25
  s_add_u32 m0, s21, 10240
  s_nop 0
  buffer_load_dwordx4 v123, s[16:19], s25 offen lds
  s_add_u32 s25, s25, 98304
  s_add_u32 m0, s21, 11264
  s_nop 0
  buffer_load_dwordx4 v123, s[16:19], s25 offen lds
  s_add_u32 s25, s25, 98304
  s_add_u32 m0, s21, 12288
  s_nop 0
  buffer_load_dwordx4 v123, s[16:19], s25 offen lds
  s_add_u32 s25, s25, 98304
  s_add_u32 m0, s21, 13312
  s_nop 0
  buffer_load_dwordx4 v123, s[16:19], s25 offen lds
  s_add_u32 s25, s25, 98304
  s_add_u32 m0, s21, 14336
  s_nop 0
  buffer_load_dwordx4 v123, s[16:19], s25 offen lds
  s_add_u32 m0, s21, 15360
  s_nop 0
  buffer_load_dwordx4 v123, s[28:31], s26 offen lds
  s_add_u32 s26, s26, 98304
  s_add_u32 m0, s21, 16384
  s_nop 0
  buffer_load_dwordx4 v123, s[28:31], s26 offen lds
  s_add_u32 s26, s26, 98304
  s_add_u32 m0, s21, 17408
  s_nop 0
  buffer_load_dwordx4 v123, s[28:31], s26 offen lds
  s_add_u32 s26, s26, 98304
  s_add_u32 m0, s21, 18432
  s_nop 0
  buffer_load_dwordx4 v123, s[28:31], s26 offen lds
  s_add_u32 s26, s26, 98304
  s_add_u32 m0, s21, 19456
  s_nop 0
  buffer_load_dwordx4 v123, s[28:31], s26 offen lds
  s_add_u32 s25, s24, 983040
  s_mov_b32 s26, s25
  s_add_u32 m0, s21, 20480
  s_nop 0
  buffer_load_dwordx4 v123, s[16:19], s25 offen lds
  s_add_u32 s25, s25, 98304
  s_add_u32 m0, s21, 21504
  s_nop 0
  buffer_load_dwordx4 v123, s[16:19], s25 offen lds
  s_add_u32 s25, s25, 98304
  s_add_u32 m0, s21, 22528
  s_nop 0
  buffer_load_dwordx4 v123, s[16:19], s25 offen lds
  s_add_u32 s25, s25, 98304
  s_add_u32 m0, s21, 23552
  s_nop 0
  buffer_load_dwordx4 v123, s[16:19], s25 offen lds
  s_add_u32 s25, s25, 98304
  s_add_u32 m0, s21, 24576
  s_nop 0
  buffer_load_dwordx4 v123, s[16:19], s25 offen lds
  s_add_u32 m0, s21, 25600
  s_nop 0
  buffer_load_dwordx4 v123, s[28:31], s26 offen lds
  s_add_u32 s26, s26, 98304
  s_add_u32 m0, s21, 26624
  s_nop 0
  buffer_load_dwordx4 v123, s[28:31], s26 offen lds
  s_add_u32 s26, s26, 98304
  s_add_u32 m0, s21, 27648
  s_nop 0
  buffer_load_dwordx4 v123, s[28:31], s26 offen lds
  s_add_u32 s26, s26, 98304
  s_add_u32 m0, s21, 28672
  s_nop 0
  buffer_load_dwordx4 v123, s[28:31], s26 offen lds
  s_add_u32 s26, s26, 98304
  s_add_u32 m0, s21, 29696
  s_nop 0
  buffer_load_dwordx4 v123, s[28:31], s26 offen lds
  s_waitcnt vmcnt(20)
  ds_read_b64_tr_b16 a[0:1], v10 offset:0
  ds_read_b64_tr_b16 a[2:3], v10 offset:512
  ds_read_b64_tr_b16 a[4:5], v10 offset:1024
  ds_read_b64_tr_b16 a[6:7], v10 offset:1536
  ds_read_b64_tr_b16 a[8:9], v10 offset:2048
  ds_read_b64_tr_b16 a[10:11], v10 offset:2560
  ds_read_b64_tr_b16 a[12:13], v10 offset:3072
  ds_read_b64_tr_b16 a[14:15], v10 offset:3584
  ds_read_b64_tr_b16 a[16:17], v10 offset:4096
  ds_read_b64_tr_b16 a[18:19], v10 offset:4608
  ds_read_b64_tr_b16 a[80:81], v10 offset:5120
  ds_read_b64_tr_b16 a[82:83], v10 offset:5632
  ds_read_b64_tr_b16 a[84:85], v10 offset:6144
  ds_read_b64_tr_b16 a[86:87], v10 offset:6656
  ds_read_b64_tr_b16 a[88:89], v10 offset:7168
  ds_read_b64_tr_b16 a[90:91], v10 offset:7680
  ds_read_b64_tr_b16 a[92:93], v10 offset:8192
  ds_read_b64_tr_b16 a[94:95], v10 offset:8704
  ds_read_b64_tr_b16 a[96:97], v10 offset:9216
  ds_read_b64_tr_b16 a[98:99], v10 offset:9728
  s_waitcnt lgkmcnt(0)
  s_add_u32 s25, s24, 1474560
  s_mov_b32 s26, s25
  s_add_u32 m0, s21, 0
  s_nop 0
  buffer_load_dwordx4 v123, s[16:19], s25 offen lds
  s_add_u32 s25, s25, 98304
  s_add_u32 m0, s21, 1024
  s_nop 0
  buffer_load_dwordx4 v123, s[16:19], s25 offen lds
  s_add_u32 s25, s25, 98304
  s_add_u32 m0, s21, 2048
  s_nop 0
  buffer_load_dwordx4 v123, s[16:19], s25 offen lds
  s_add_u32 s25, s25, 98304
  s_add_u32 m0, s21, 3072
  s_nop 0
  buffer_load_dwordx4 v123, s[16:19], s25 offen lds
  s_add_u32 s25, s25, 98304
  s_add_u32 m0, s21, 4096
  s_nop 0
  buffer_load_dwordx4 v123, s[16:19], s25 offen lds
  s_add_u32 m0, s21, 5120
  s_nop 0
  buffer_load_dwordx4 v123, s[28:31], s26 offen lds
  s_add_u32 s26, s26, 98304
  s_add_u32 m0, s21, 6144
  s_nop 0
  buffer_load_dwordx4 v123, s[28:31], s26 offen lds
  s_add_u32 s26, s26, 98304
  s_add_u32 m0, s21, 7168
  s_nop 0
  buffer_load_dwordx4 v123, s[28:31], s26 offen lds
  s_add_u32 s26, s26, 98304
  s_add_u32 m0, s21, 8192
  s_nop 0
  buffer_load_dwordx4 v123, s[28:31], s26 offen lds
  s_add_u32 s26, s26, 98304
  s_add_u32 m0, s21, 9216
  s_nop 0
  buffer_load_dwordx4 v123, s[28:31], s26 offen lds
  s_waitcnt vmcnt(20)
  ds_read_b64_tr_b16 a[20:21], v10 offset:10240
  ds_read_b64_tr_b16 a[22:23], v10 offset:10752
  ds_read_b64_tr_b16 a[24:25], v10 offset:11264
  ds_read_b64_tr_b16 a[26:27], v10 offset:11776
  ds_read_b64_tr_b16 a[28:29], v10 offset:12288
  ds_read_b64_tr_b16 a[30:31], v10 offset:12800
  ds_read_b64_tr_b16 a[32:33], v10 offset:13312
  ds_read_b64_tr_b16 a[34:35], v10 offset:13824
  ds_read_b64_tr_b16 a[36:37], v10 offset:14336
  ds_read_b64_tr_b16 a[38:39], v10 offset:14848
  ds_read_b64_tr_b16 a[100:101], v10 offset:15360
  ds_read_b64_tr_b16 a[102:103], v10 offset:15872
  ds_read_b64_tr_b16 a[104:105], v10 offset:16384
  ds_read_b64_tr_b16 a[106:107], v10 offset:16896
  ds_read_b64_tr_b16 a[108:109], v10 offset:17408
  ds_read_b64_tr_b16 a[110:111], v10 offset:17920
  ds_read_b64_tr_b16 a[112:113], v10 offset:18432
  ds_read_b64_tr_b16 a[114:115], v10 offset:18944
  ds_read_b64_tr_b16 a[116:117], v10 offset:19456
  ds_read_b64_tr_b16 a[118:119], v10 offset:19968
  s_waitcnt lgkmcnt(0)
  s_waitcnt vmcnt(10)
  ds_read_b64_tr_b16 a[40:41], v10 offset:20480
  ds_read_b64_tr_b16 a[42:43], v10 offset:20992
  ds_read_b64_tr_b16 a[44:45], v10 offset:21504
  ds_read_b64_tr_b16 a[46:47], v10 offset:22016
  ds_read_b64_tr_b16 a[48:49], v10 offset:22528
  ds_read_b64_tr_b16 a[50:51], v10 offset:23040
  ds_read_b64_tr_b16 a[52:53], v10 offset:23552
  ds_read_b64_tr_b16 a[54:55], v10 offset:24064
  ds_read_b64_tr_b16 a[56:57], v10 offset:24576
  ds_read_b64_tr_b16 a[58:59], v10 offset:25088
  ds_read_b64_tr_b16 a[120:121], v10 offset:25600
  ds_read_b64_tr_b16 a[122:123], v10 offset:26112
  ds_read_b64_tr_b16 a[124:125], v10 offset:26624
  ds_read_b64_tr_b16 a[126:127], v10 offset:27136
  ds_read_b64_tr_b16 a[128:129], v10 offset:27648
  ds_read_b64_tr_b16 a[130:131], v10 offset:28160
  ds_read_b64_tr_b16 a[132:133], v10 offset:28672
  ds_read_b64_tr_b16 a[134:135], v10 offset:29184
  ds_read_b64_tr_b16 a[136:137], v10 offset:29696
  ds_read_b64_tr_b16 a[138:139], v10 offset:30208
  s_waitcnt lgkmcnt(0)
  s_waitcnt vmcnt(0)
  ds_read_b64_tr_b16 a[60:61], v10 offset:0
  ds_read_b64_tr_b16 a[62:63], v10 offset:512
  ds_read_b64_tr_b16 a[64:65], v10 offset:1024
  ds_read_b64_tr_b16 a[66:67], v10 offset:1536
  ds_read_b64_tr_b16 a[68:69], v10 offset:2048
  ds_read_b64_tr_b16 a[70:71], v10 offset:2560
  ds_read_b64_tr_b16 a[72:73], v10 offset:3072
  ds_read_b64_tr_b16 a[74:75], v10 offset:3584
  ds_read_b64_tr_b16 a[76:77], v10 offset:4096
  ds_read_b64_tr_b16 a[78:79], v10 offset:4608
  ds_read_b64_tr_b16 a[140:141], v10 offset:5120
  ds_read_b64_tr_b16 a[142:143], v10 offset:5632
  ds_read_b64_tr_b16 a[144:145], v10 offset:6144
  ds_read_b64_tr_b16 a[146:147], v10 offset:6656
  ds_read_b64_tr_b16 a[148:149], v10 offset:7168
  ds_read_b64_tr_b16 a[150:151], v10 offset:7680
  ds_read_b64_tr_b16 a[152:153], v10 offset:8192
  ds_read_b64_tr_b16 a[154:155], v10 offset:8704
  ds_read_b64_tr_b16 a[156:157], v10 offset:9216
  ds_read_b64_tr_b16 a[158:159], v10 offset:9728
  s_waitcnt lgkmcnt(0)
  s_waitcnt vmcnt(0)
  s_mul_i32 s20, s91, 5120
  v_add_u32 v13, s20, v5
  s_lshl_b32 s22, s5, 1
  s_lshr_b32 s23, s91, 1
  s_add_u32 s22, s22, s23
  s_lshl_b32 s22, s22, 10
  s_and_b32 s23, s91, 1
  s_lshl_b32 s23, s23, 3
  s_add_u32 s22, s22, s23
  s_add_u32 s44, s46, s22
  s_lshl_b32 s48, s5, 4
  s_lshl_b32 s22, s91, 2
  s_add_u32 s48, s48, s22
  s_add_u32 s48, s48, s47
  v_min_u32 v15, 15, v2
  v_lshlrev_b32 v15, 3, v15
  s_mul_i32 s52, s40, 40960
  s_mul_i32 s53, s91, 5120
  s_add_u32 s52, s52, s53
  s_add_u32 s52, s52, 23068672
  s_add_u32 s53, s52, 0
  buffer_load_dwordx4 v[16:19], v5, s[8:11], s53 offen offset:0 sc1
  buffer_load_dwordx4 v[20:23], v5, s[8:11], s53 offen offset:1024 sc1
  buffer_load_dwordx4 v[24:27], v5, s[8:11], s53 offen offset:2048 sc1
  buffer_load_dwordx4 v[28:31], v5, s[8:11], s53 offen offset:3072 sc1
  s_add_u32 s53, s52, 4096
  buffer_load_dwordx4 v[32:35], v5, s[8:11], s53 offen offset:0 sc1
  s_add_u32 s53, s52, 20480
  buffer_load_dwordx4 v[36:39], v5, s[8:11], s53 offen offset:0 sc1
  buffer_load_dwordx4 v[40:43], v5, s[8:11], s53 offen offset:1024 sc1
  buffer_load_dwordx4 v[44:47], v5, s[8:11], s53 offen offset:2048 sc1
  buffer_load_dwordx4 v[48:51], v5, s[8:11], s53 offen offset:3072 sc1
  s_add_u32 s53, s52, 24576
  buffer_load_dwordx4 v[52:55], v5, s[8:11], s53 offen offset:0 sc1
  s_mov_b32 s45, 0
XF1_loop:
  s_ff1_i32_b64 s54, s[36:37]
  s_cmp_eq_u32 s43, 1
  s_cbranch_scc1 XF1_qg_ok
  s_cmp_lt_i32 s54, 30
  s_cbranch_scc1 XF1_qg_ok
  v_mov_b32 v6, 4595648
XF1_qg:
  buffer_load_dword v7, v6, s[8:11], 0 offen sc1
  s_waitcnt vmcnt(0)
  v_readfirstlane_b32 s57, v7
  s_mov_b32 s43, 1
  s_cmp_ge_u32 s57, 32
  s_cbranch_scc1 XF1_qg_ok
  s_sleep 8
  s_add_u32 s41, s41, 1
  s_cmp_lt_u32 s41, 3000000
  s_cbranch_scc1 XF1_qg
  s_branch K3_end
XF1_qg_ok:
XF1_h:
  s_waitcnt vmcnt(0)
  v_max3_u32 v112, v16, v17, v18
  v_max3_u32 v112, v112, v19, v20
  v_max3_u32 v112, v112, v21, v22
  v_max3_u32 v112, v112, v23, v24
  v_max3_u32 v112, v112, v25, v26
  v_max3_u32 v112, v112, v27, v28
  v_max3_u32 v112, v112, v29, v30
  v_max3_u32 v112, v112, v31, v32
  v_max3_u32 v112, v112, v33, v34
  v_max3_u32 v112, v112, v35, v36
  v_max3_u32 v112, v112, v37, v38
  v_max3_u32 v112, v112, v39, v40
  v_max3_u32 v112, v112, v41, v42
  v_max3_u32 v112, v112, v43, v44
  v_max3_u32 v112, v112, v45, v46
  v_max3_u32 v112, v112, v47, v48
  v_max3_u32 v112, v112, v49, v50
  v_max3_u32 v112, v112, v51, v52
  v_max3_u32 v112, v112, v53, v54
  v_max_u32 v112, v112, v55
  v_cmp_eq_u32 vcc, -1, v112
  s_cbranch_vccz XF1_hok
  s_add_u32 s53, s52, 0
  buffer_load_dwordx4 v[16:19], v5, s[8:11], s53 offen offset:0 sc1
  buffer_load_dwordx4 v[20:23], v5, s[8:11], s53 offen offset:1024 sc1
  buffer_load_dwordx4 v[24:27], v5, s[8:11], s53 offen offset:2048 sc1
  buffer_load_dwordx4 v[28:31], v5, s[8:11], s53 offen offset:3072 sc1
  s_add_u32 s53, s52, 4096
  buffer_load_dwordx4 v[32:35], v5, s[8:11], s53 offen offset:0 sc1
  s_add_u32 s53, s52, 20480
  buffer_load_dwordx4 v[36:39], v5, s[8:11], s53 offen offset:0 sc1
  buffer_load_dwordx4 v[40:43], v5, s[8:11], s53 offen offset:1024 sc1
  buffer_load_dwordx4 v[44:47], v5, s[8:11], s53 offen offset:2048 sc1
  buffer_load_dwordx4 v[48:51], v5, s[8:11], s53 offen offset:3072 sc1
  s_add_u32 s53, s52, 24576
  buffer_load_dwordx4 v[52:55], v5, s[8:11], s53 offen offset:0 sc1
  s_add_u32 s41, s41, 1
  s_cmp_lt_u32 s41, 3000000
  s_cbranch_scc1 XF1_h
  s_branch K3_end
XF1_hok:
  s_barrier
  ds_write_b128 v13, v[16:19] offset:0
  ds_write_b128 v13, v[20:23] offset:1024
  ds_write_b128 v13, v[24:27] offset:2048
  ds_write_b128 v13, v[28:31] offset:3072
  ds_write_b128 v13, v[32:35] offset:4096
  ds_write_b128 v13, v[36:39] offset:20480
  ds_write_b128 v13, v[40:43] offset:21504
  ds_write_b128 v13, v[44:47] offset:22528
  ds_write_b128 v13, v[48:51] offset:23552
  ds_write_b128 v13, v[52:55] offset:24576
  buffer_load_dwordx2 v[92:93], v15, s[8:11], s47 offen offset:512 sc1
  s_waitcnt lgkmcnt(0)
  s_barrier
  s_cmp_eq_u32 s54, -1
  s_cbranch_scc1 XF1_np
  s_mul_i32 s52, s54, 40960
  s_mul_i32 s53, s91, 5120
  s_add_u32 s52, s52, s53
  s_add_u32 s52, s52, 23068672
  s_add_u32 s53, s52, 0
  buffer_load_dwordx4 v[16:19], v5, s[8:11], s53 offen offset:0 sc1
  buffer_load_dwordx4 v[20:23], v5, s[8:11], s53 offen offset:1024 sc1
  buffer_load_dwordx4 v[24:27], v5, s[8:11], s53 offen offset:2048 sc1
  buffer_load_dwordx4 v[28:31], v5, s[8:11], s53 offen offset:3072 sc1
  s_add_u32 s53, s52, 4096
  buffer_load_dwordx4 v[32:35], v5, s[8:11], s53 offen offset:0 sc1
  s_add_u32 s53, s52, 20480
  buffer_load_dwordx4 v[36:39], v5, s[8:11], s53 offen offset:0 sc1
  buffer_load_dwordx4 v[40:43], v5, s[8:11], s53 offen offset:1024 sc1
  buffer_load_dwordx4 v[44:47], v5, s[8:11], s53 offen offset:2048 sc1
  buffer_load_dwordx4 v[48:51], v5, s[8:11], s53 offen offset:3072 sc1
  s_add_u32 s53, s52, 24576
  buffer_load_dwordx4 v[52:55], v5, s[8:11], s53 offen offset:0 sc1
XF1_np:
  ds_read_b128 v[56:59], v5 offset:0
  ds_read_b128 v[60:63], v5 offset:20480
  ds_read_b128 v[64:67], v5 offset:1024
  ds_read_b128 v[68:71], v5 offset:21504
  ds_read_b128 v[72:75], v5 offset:2048
  ds_read_b128 v[76:79], v5 offset:22528
  ds_read_b128 v[80:83], v5 offset:3072
  ds_read_b128 v[84:87], v5 offset:23552
  s_waitcnt lgkmcnt(7)
  v_mfma_f32_16x16x32_bf16 v[96:99], a[0:3], v[56:59], 0
  v_mfma_f32_16x16x32_bf16 v[104:107], a[80:83], v[56:59], 0
  ds_read_b128 v[56:59], v5 offset:4096
  s_waitcnt lgkmcnt(7)
  v_mfma_f32_16x16x32_bf16 v[100:103], a[0:3], v[60:63], 0
  v_mfma_f32_16x16x32_bf16 v[108:111], a[80:83], v[60:63], 0
  ds_read_b128 v[60:63], v5 offset:24576
  s_waitcnt lgkmcnt(7)
  v_mfma_f32_16x16x32_bf16 v[96:99], a[4:7], v[64:67], v[96:99]
  v_mfma_f32_16x16x32_bf16 v[104:107], a[84:87], v[64:67], v[104:107]
  ds_read_b128 v[64:67], v5 offset:5120
  s_waitcnt lgkmcnt(7)
  v_mfma_f32_16x16x32_bf16 v[100:103], a[4:7], v[68:71], v[100:103]
  v_mfma_f32_16x16x32_bf16 v[108:111], a[84:87], v[68:71], v[108:111]
  ds_read_b128 v[68:71], v5 offset:25600
  s_waitcnt lgkmcnt(7)
  v_mfma_f32_16x16x32_bf16 v[96:99], a[8:11], v[72:75], v[96:99]
  v_mfma_f32_16x16x32_bf16 v[104:107], a[88:91], v[72:75], v[104:107]
  ds_read_b128 v[72:75], v5 offset:6144
  s_waitcnt lgkmcnt(7)
  v_mfma_f32_16x16x32_bf16 v[100:103], a[8:11], v[76:79], v[100:103]
  v_mfma_f32_16x16x32_bf16 v[108:111], a[88:91], v[76:79], v[108:111]
  ds_read_b128 v[76:79], v5 offset:26624
  s_waitcnt lgkmcnt(7)
  v_mfma_f32_16x16x32_bf16 v[96:99], a[12:15], v[80:83], v[96:99]
  v_mfma_f32_16x16x32_bf16 v[104:107], a[92:95], v[80:83], v[104:107]
  ds_read_b128 v[80:83], v5 offset:7168
  s_waitcnt lgkmcnt(7)
  v_mfma_f32_16x16x32_bf16 v[100:103], a[12:15], v[84:87], v[100:103]
  v_mfma_f32_16x16x32_bf16 v[108:111], a[92:95], v[84:87], v[108:111]
  ds_read_b128 v[84:87], v5 offset:27648
  s_waitcnt lgkmcnt(7)
  v_mfma_f32_16x16x32_bf16 v[96:99], a[16:19], v[56:59], v[96:99]
  v_mfma_f32_16x16x32_bf16 v[104:107], a[96:99], v[56:59], v[104:107]
  ds_read_b128 v[56:59], v5 offset:8192
  s_waitcnt lgkmcnt(7)
  v_mfma_f32_16x16x32_bf16 v[100:103], a[16:19], v[60:63], v[100:103]
  v_mfma_f32_16x16x32_bf16 v[108:111], a[96:99], v[60:63], v[108:111]
  ds_read_b128 v[60:63], v5 offset:28672
  s_waitcnt lgkmcnt(7)
  v_mfma_f32_16x16x32_bf16 v[96:99], a[20:23], v[64:67], v[96:99]
  v_mfma_f32_16x16x32_bf16 v[104:107], a[100:103], v[64:67], v[104:107]
  ds_read_b128 v[64:67], v5 offset:9216
  s_waitcnt lgkmcnt(7)
  v_mfma_f32_16x16x32_bf16 v[100:103], a[20:23], v[68:71], v[100:103]
  v_mfma_f32_16x16x32_bf16 v[108:111], a[100:103], v[68:71], v[108:111]
  ds_read_b128 v[68:71], v5 offset:29696
  s_waitcnt lgkmcnt(7)
  v_mfma_f32_16x16x32_bf16 v[96:99], a[24:27], v[72:75], v[96:99]
  v_mfma_f32_16x16x32_bf16 v[104:107], a[104:107], v[72:75], v[104:107]
  ds_read_b128 v[72:75], v5 offset:10240
  s_waitcnt lgkmcnt(7)
  v_mfma_f32_16x16x32_bf16 v[100:103], a[24:27], v[76:79], v[100:103]
  v_mfma_f32_16x16x32_bf16 v[108:111], a[104:107], v[76:79], v[108:111]
  ds_read_b128 v[76:79], v5 offset:30720
  s_waitcnt lgkmcnt(7)
  v_mfma_f32_16x16x32_bf16 v[96:99], a[28:31], v[80:83], v[96:99]
  v_mfma_f32_16x16x32_bf16 v[104:107], a[108:111], v[80:83], v[104:107]
  ds_read_b128 v[80:83], v5 offset:11264
  s_waitcnt lgkmcnt(7)
  v_mfma_f32_16x16x32_bf16 v[100:103], a[28:31], v[84:87], v[100:103]
  v_mfma_f32_16x16x32_bf16 v[108:111], a[108:111], v[84:87], v[108:111]
  ds_read_b128 v[84:87], v5 offset:31744
  s_waitcnt lgkmcnt(7)
  v_mfma_f32_16x16x32_bf16 v[96:99], a[32:35], v[56:59], v[96:99]
  v_mfma_f32_16x16x32_bf16 v[104:107], a[112:115], v[56:59], v[104:107]
  ds_read_b128 v[56:59], v5 offset:12288
  s_waitcnt lgkmcnt(7)
  v_mfma_f32_16x16x32_bf16 v[100:103], a[32:35], v[60:63], v[100:103]
  v_mfma_f32_16x16x32_bf16 v[108:111], a[112:115], v[60:63], v[108:111]
  ds_read_b128 v[60:63], v5 offset:32768
  s_waitcnt lgkmcnt(7)
  v_mfma_f32_16x16x32_bf16 v[96:99], a[36:39], v[64:67], v[96:99]
  v_mfma_f32_16x16x32_bf16 v[104:107], a[116:119], v[64:67], v[104:107]
  ds_read_b128 v[64:67], v5 offset:13312
  s_waitcnt lgkmcnt(7)
  v_mfma_f32_16x16x32_bf16 v[100:103], a[36:39], v[68:71], v[100:103]
  v_mfma_f32_16x16x32_bf16 v[108:111], a[116:119], v[68:71], v[108:111]
  ds_read_b128 v[68:71], v5 offset:33792
  s_waitcnt lgkmcnt(7)
  v_mfma_f32_16x16x32_bf16 v[96:99], a[40:43], v[72:75], v[96:99]
  v_mfma_f32_16x16x32_bf16 v[104:107], a[120:123], v[72:75], v[104:107]
  ds_read_b128 v[72:75], v5 offset:14336
  s_waitcnt lgkmcnt(7)
  v_mfma_f32_16x16x32_bf16 v[100:103], a[40:43], v[76:79], v[100:103]
  v_mfma_f32_16x16x32_bf16 v[108:111], a[120:123], v[76:79], v[108:111]
  ds_read_b128 v[76:79], v5 offset:34816
  s_waitcnt lgkmcnt(7)
  v_mfma_f32_16x16x32_bf16 v[96:99], a[44:47], v[80:83], v[96:99]
  v_mfma_f32_16x16x32_bf16 v[104:107], a[124:127], v[80:83], v[104:107]
  ds_read_b128 v[80:83], v5 offset:15360
  s_waitcnt lgkmcnt(7)
  v_mfma_f32_16x16x32_bf16 v[100:103], a[44:47], v[84:87], v[100:103]
  v_mfma_f32_16x16x32_bf16 v[108:111], a[124:127], v[84:87], v[108:111]
  ds_read_b128 v[84:87], v5 offset:35840
  s_waitcnt lgkmcnt(7)
  v_mfma_f32_16x16x32_bf16 v[96:99], a[48:51], v[56:59], v[96:99]
  v_mfma_f32_16x16x32_bf16 v[104:107], a[128:131], v[56:59], v[104:107]
  ds_read_b128 v[56:59], v5 offset:16384
  s_waitcnt lgkmcnt(7)
  v_mfma_f32_16x16x32_bf16 v[100:103], a[48:51], v[60:63], v[100:103]
  v_mfma_f32_16x16x32_bf16 v[108:111], a[128:131], v[60:63], v[108:111]
  ds_read_b128 v[60:63], v5 offset:36864
  s_waitcnt lgkmcnt(7)
  v_mfma_f32_16x16x32_bf16 v[96:99], a[52:55], v[64:67], v[96:99]
  v_mfma_f32_16x16x32_bf16 v[104:107], a[132:135], v[64:67], v[104:107]
  ds_read_b128 v[64:67], v5 offset:17408
  s_waitcnt lgkmcnt(7)
  v_mfma_f32_16x16x32_bf16 v[100:103], a[52:55], v[68:71], v[100:103]
  v_mfma_f32_16x16x32_bf16 v[108:111], a[132:135], v[68:71], v[108:111]
  ds_read_b128 v[68:71], v5 offset:37888
  s_waitcnt lgkmcnt(7)
  v_mfma_f32_16x16x32_bf16 v[96:99], a[56:59], v[72:75], v[96:99]
  v_mfma_f32_16x16x32_bf16 v[104:107], a[136:139], v[72:75], v[104:107]
  ds_read_b128 v[72:75], v5 offset:18432
  s_waitcnt lgkmcnt(7)
  v_mfma_f32_16x16x32_bf16 v[100:103], a[56:59], v[76:79], v[100:103]
  v_mfma_f32_16x16x32_bf16 v[108:111], a[136:139], v[76:79], v[108:111]
  ds_read_b128 v[76:79], v5 offset:38912
  s_waitcnt lgkmcnt(7)
  v_mfma_f32_16x16x32_bf16 v[96:99], a[60:63], v[80:83], v[96:99]
  v_mfma_f32_16x16x32_bf16 v[104:107], a[140:143], v[80:83], v[104:107]
  ds_read_b128 v[80:83], v5 offset:19456
  s_waitcnt lgkmcnt(7)
  v_mfma_f32_16x16x32_bf16 v[100:103], a[60:63], v[84:87], v[100:103]
  v_mfma_f32_16x16x32_bf16 v[108:111], a[140:143], v[84:87], v[108:111]
  ds_read_b128 v[84:87], v5 offset:39936
  s_waitcnt lgkmcnt(7)
  v_mfma_f32_16x16x32_bf16 v[96:99], a[64:67], v[56:59], v[96:99]
  v_mfma_f32_16x16x32_bf16 v[104:107], a[144:147], v[56:59], v[104:107]
  s_waitcnt lgkmcnt(6)
  v_mfma_f32_16x16x32_bf16 v[100:103], a[64:67], v[60:63], v[100:103]
  v_mfma_f32_16x16x32_bf16 v[108:111], a[144:147], v[60:63], v[108:111]
  s_waitcnt lgkmcnt(5)
  v_mfma_f32_16x16x32_bf16 v[96:99], a[68:71], v[64:67], v[96:99]
  v_mfma_f32_16x16x32_bf16 v[104:107], a[148:151], v[64:67], v[104:107]
  s_waitcnt lgkmcnt(4)
  v_mfma_f32_16x16x32_bf16 v[100:103], a[68:71], v[68:71], v[100:103]
  v_mfma_f32_16x16x32_bf16 v[108:111], a[148:151], v[68:71], v[108:111]
  s_waitcnt lgkmcnt(3)
  v_mfma_f32_16x16x32_bf16 v[96:99], a[72:75], v[72:75], v[96:99]
  v_mfma_f32_16x16x32_bf16 v[104:107], a[152:155], v[72:75], v[104:107]
  s_waitcnt lgkmcnt(2)
  v_mfma_f32_16x16x32_bf16 v[100:103], a[72:75], v[76:79], v[100:103]
  v_mfma_f32_16x16x32_bf16 v[108:111], a[152:155], v[76:79], v[108:111]
  s_waitcnt lgkmcnt(1)
  v_mfma_f32_16x16x32_bf16 v[96:99], a[76:79], v[80:83], v[96:99]
  v_mfma_f32_16x16x32_bf16 v[104:107], a[156:159], v[80:83], v[104:107]
  s_waitcnt lgkmcnt(0)
  v_mfma_f32_16x16x32_bf16 v[100:103], a[76:79], v[84:87], v[100:103]
  v_mfma_f32_16x16x32_bf16 v[108:111], a[156:159], v[84:87], v[108:111]
  v_mov_b32 v122, 0x3d372713
  v_mov_b32 v123, 0xc0135761
  s_nop 1
  v_cvt_pk_bf16_f32 v112, v96, v97
  v_lshlrev_b32 v96, 16, v112
  v_and_b32 v97, 0xffff0000, v112
  v_cvt_pk_bf16_f32 v112, v104, v105
  v_lshlrev_b32 v104, 16, v112
  v_and_b32 v105, 0xffff0000, v112
  v_cvt_pk_bf16_f32 v112, v98, v99
  v_lshlrev_b32 v98, 16, v112
  v_and_b32 v99, 0xffff0000, v112
  v_cvt_pk_bf16_f32 v112, v106, v107
  v_lshlrev_b32 v106, 16, v112
  v_and_b32 v107, 0xffff0000, v112
  v_cvt_pk_bf16_f32 v112, v100, v101
  v_lshlrev_b32 v100, 16, v112
  v_and_b32 v101, 0xffff0000, v112
  v_cvt_pk_bf16_f32 v112, v108, v109
  v_lshlrev_b32 v108, 16, v112
  v_and_b32 v109, 0xffff0000, v112
  v_cvt_pk_bf16_f32 v112, v102, v103
  v_lshlrev_b32 v102, 16, v112
  v_and_b32 v103, 0xffff0000, v112
  v_cvt_pk_bf16_f32 v112, v110, v111
  v_lshlrev_b32 v110, 16, v112
  v_and_b32 v111, 0xffff0000, v112
  v_mul_f32 v113, v96, v96
  v_fma_f32 v113, v113, v122, 1.0
  v_mul_f32 v113, v113, v96
  v_mul_f32 v113, v123, v113
  v_exp_f32 v113, v113
  s_nop 0
  v_add_f32 v113, 1.0, v113
  v_rcp_f32 v113, v113
  s_nop 0
  v_mul_f32 v96, v96, v113
  v_mul_f32 v114, v97, v97
  v_fma_f32 v114, v114, v122, 1.0
  v_mul_f32 v114, v114, v97
  v_mul_f32 v114, v123, v114
  v_exp_f32 v114, v114
  s_nop 0
  v_add_f32 v114, 1.0, v114
  v_rcp_f32 v114, v114
  s_nop 0
  v_mul_f32 v97, v97, v114
  v_mul_f32 v115, v98, v98
  v_fma_f32 v115, v115, v122, 1.0
  v_mul_f32 v115, v115, v98
  v_mul_f32 v115, v123, v115
  v_exp_f32 v115, v115
  s_nop 0
  v_add_f32 v115, 1.0, v115
  v_rcp_f32 v115, v115
  s_nop 0
  v_mul_f32 v98, v98, v115
  v_mul_f32 v116, v99, v99
  v_fma_f32 v116, v116, v122, 1.0
  v_mul_f32 v116, v116, v99
  v_mul_f32 v116, v123, v116
  v_exp_f32 v116, v116
  s_nop 0
  v_add_f32 v116, 1.0, v116
  v_rcp_f32 v116, v116
  s_nop 0
  v_mul_f32 v99, v99, v116
  v_mul_f32 v117, v100, v100
  v_fma_f32 v117, v117, v122, 1.0
  v_mul_f32 v117, v117, v100
  v_mul_f32 v117, v123, v117
  v_exp_f32 v117, v117
  s_nop 0
  v_add_f32 v117, 1.0, v117
  v_rcp_f32 v117, v117
  s_nop 0
  v_mul_f32 v100, v100, v117
  v_mul_f32 v118, v101, v101
  v_fma_f32 v118, v118, v122, 1.0
  v_mul_f32 v118, v118, v101
  v_mul_f32 v118, v123, v118
  v_exp_f32 v118, v118
  s_nop 0
  v_add_f32 v118, 1.0, v118
  v_rcp_f32 v118, v118
  s_nop 0
  v_mul_f32 v101, v101, v118
  v_mul_f32 v119, v102, v102
  v_fma_f32 v119, v119, v122, 1.0
  v_mul_f32 v119, v119, v102
  v_mul_f32 v119, v123, v119
  v_exp_f32 v119, v119
  s_nop 0
  v_add_f32 v119, 1.0, v119
  v_rcp_f32 v119, v119
  s_nop 0
  v_mul_f32 v102, v102, v119
  v_mul_f32 v120, v103, v103
  v_fma_f32 v120, v120, v122, 1.0
  v_mul_f32 v120, v120, v103
  v_mul_f32 v120, v123, v120
  v_exp_f32 v120, v120
  s_nop 0
  v_add_f32 v120, 1.0, v120
  v_rcp_f32 v120, v120
  s_nop 0
  v_mul_f32 v103, v103, v120
  v_cvt_pk_bf16_f32 v112, v96, v97
  v_lshlrev_b32 v96, 16, v112
  v_and_b32 v97, 0xffff0000, v112
  v_cvt_pk_bf16_f32 v112, v98, v99
  v_lshlrev_b32 v98, 16, v112
  v_and_b32 v99, 0xffff0000, v112
  v_cvt_pk_bf16_f32 v112, v100, v101
  v_lshlrev_b32 v100, 16, v112
  v_and_b32 v101, 0xffff0000, v112
  v_cvt_pk_bf16_f32 v112, v102, v103
  v_lshlrev_b32 v102, 16, v112
  v_and_b32 v103, 0xffff0000, v112
  v_mul_f32 v96, v96, v104
  v_mul_f32 v97, v97, v105
  v_mul_f32 v98, v98, v106
  v_mul_f32 v99, v99, v107
  v_mul_f32 v100, v100, v108
  v_mul_f32 v101, v101, v109
  v_mul_f32 v102, v102, v110
  v_mul_f32 v103, v103, v111
  v_cvt_pk_bf16_f32 v112, v96, v97
  v_cvt_pk_bf16_f32 v113, v98, v99
  v_cvt_pk_bf16_f32 v114, v100, v101
  v_cvt_pk_bf16_f32 v115, v102, v103
  s_cmp_lt_u32 s42, 3
  s_cbranch_scc1 XF1_cfok
  s_sub_u32 s57, s42, 2
  s_waitcnt vmcnt(10)
XF1_cf:
  v_min_u32 v92, v92, v93
  v_cmp_gt_u32 vcc, s57, v92
  s_cbranch_vccz XF1_cfok
  buffer_load_dwordx2 v[92:93], v15, s[8:11], s47 offen offset:512 sc1
  s_waitcnt vmcnt(0)
  s_add_u32 s41, s41, 1
  s_cmp_lt_u32 s41, 3000000
  s_cbranch_scc1 XF1_cf
  s_branch K3_end
XF1_cfok:
  s_add_u32 s22, s45, s44
  s_add_u32 s45, s45, 98304
  s_cmp_ge_u32 s45, 294912
  s_cselect_b32 s45, 0, s45
  buffer_store_dwordx2 v[112:113], v5, s[8:11], s22 offen
  s_add_u32 s22, s22, 49152
  buffer_store_dwordx2 v[114:115], v5, s[8:11], s22 offen
  s_add_u32 s42, s42, 1
  s_waitcnt vmcnt(0)
  v_mov_b32 v6, s48
  v_mov_b32 v116, s42
  s_mov_b64 exec, 1
  buffer_store_dword v116, v6, s[8:11], 0 offen
  s_mov_b64 exec, -1
  s_cmp_eq_u32 s54, -1
  s_cbranch_scc1 K3_end
  s_mov_b32 s40, s54
  s_bitset0_b64 s[36:37], s54
  s_branch XF1_loop
XF2_start:
  s_load_dwordx2 s[16:17], s[0:1], 80
  s_waitcnt lgkmcnt(0)
  s_and_b32 s17, s17, 0xffff
  s_mov_b32 s18, 1966080
  s_mov_b32 s19, 0x00020000
  v_lshrrev_b32 v6, 2, v4
  v_lshl_add_u32 v6, v3, 2, v6
  v_mul_u32_u24 v6, 96, v6
  v_and_b32 v7, 3, v4
  v_lshl_add_u32 v6, v7, 3, v6
  v_add_u32 v10, s21, v6
  v_lshrrev_b32 v6, 2, v4
  v_lshl_add_u32 v6, v3, 2, v6
  v_mul_u32_u24 v6, 32, v6
  v_and_b32 v7, 3, v4
  v_lshl_add_u32 v6, v7, 3, v6
  v_add_u32 v11, s21, v6
  s_sub_u32 s26, s5, 24
  s_mul_i32 s24, s91, 491520
  s_mul_i32 s25, s26, 160
  s_add_u32 s24, s24, s25
  s_mov_b32 s29, 0
  s_mov_b32 s30, 96
  s_mov_b32 s31, 128
  v_add_u32 v7, 0, v2
  v_mul_u32_u24 v8, 10923, v7
  v_lshrrev_b32 v8, 16, v8
  v_mul_u32_u24 v9, 6, v8
  v_sub_u32 v9, v7, v9
  v_mul_u32_u24 v8, 1280, v8
  v_lshl_add_u32 v120, v9, 4, v8
  v_add_u32 v7, 64, v2
  v_mul_u32_u24 v8, 10923, v7
  v_lshrrev_b32 v8, 16, v8
  v_mul_u32_u24 v9, 6, v8
  v_sub_u32 v9, v7, v9
  v_mul_u32_u24 v8, 1280, v8
  v_lshl_add_u32 v121, v9, 4, v8
  v_add_u32 v7, 128, v2
  v_mul_u32_u24 v8, 10923, v7
  v_lshrrev_b32 v8, 16, v8
  v_mul_u32_u24 v9, 6, v8
  v_sub_u32 v9, v7, v9
  v_mul_u32_u24 v8, 1280, v8
  v_lshl_add_u32 v122, v9, 4, v8
  v_lshrrev_b32 v8, 1, v2
  v_and_b32 v9, 1, v2
  v_mul_u32_u24 v8, 1280, v8
  v_lshl_add_u32 v123, v9, 4, v8
  s_add_u32 s25, s24, s29
  s_add_u32 s25, s25, 0
  s_add_u32 m0, s21, 0
  s_nop 0
  buffer_load_dwordx4 v120, s[16:19], s25 offen lds
  s_add_u32 m0, s21, 1024
  s_nop 0
  buffer_load_dwordx4 v121, s[16:19], s25 offen lds
  s_add_u32 m0, s21, 2048
  s_nop 0
  buffer_load_dwordx4 v122, s[16:19], s25 offen lds
  s_add_u32 s25, s25, 40960
  s_add_u32 m0, s21, 3072
  s_nop 0
  buffer_load_dwordx4 v120, s[16:19], s25 offen lds
  s_add_u32 m0, s21, 4096
  s_nop 0
  buffer_load_dwordx4 v121, s[16:19], s25 offen lds
  s_add_u32 m0, s21, 5120
  s_nop 0
  buffer_load_dwordx4 v122, s[16:19], s25 offen lds
  s_add_u32 s25, s24, s30
  s_add_u32 s25, s25, 0
  s_add_u32 m0, s21, 6144
  s_nop 0
  buffer_load_dwordx4 v123, s[16:19], s25 offen lds
  s_add_u32 s25, s25, 40960
  s_add_u32 m0, s21, 7168
  s_nop 0
  buffer_load_dwordx4 v123, s[16:19], s25 offen lds
  s_add_u32 s25, s24, s31
  s_add_u32 s25, s25, 0
  s_add_u32 m0, s21, 8192
  s_nop 0
  buffer_load_dwordx4 v123, s[16:19], s25 offen lds
  s_add_u32 s25, s25, 40960
  s_add_u32 m0, s21, 9216
  s_nop 0
  buffer_load_dwordx4 v123, s[16:19], s25 offen lds
  s_add_u32 s25, s24, s29
  s_add_u32 s25, s25, 81920
  s_add_u32 m0, s21, 10240
  s_nop 0
  buffer_load_dwordx4 v120, s[16:19], s25 offen lds
  s_add_u32 m0, s21, 11264
  s_nop 0
  buffer_load_dwordx4 v121, s[16:19], s25 offen lds
  s_add_u32 m0, s21, 12288
  s_nop 0
  buffer_load_dwordx4 v122, s[16:19], s25 offen lds
  s_add_u32 s25, s25, 40960
  s_add_u32 m0, s21, 13312
  s_nop 0
  buffer_load_dwordx4 v120, s[16:19], s25 offen lds
  s_add_u32 m0, s21, 14336
  s_nop 0
  buffer_load_dwordx4 v121, s[16:19], s25 offen lds
  s_add_u32 m0, s21, 15360
  s_nop 0
  buffer_load_dwordx4 v122, s[16:19], s25 offen lds
  s_add_u32 s25, s24, s30
  s_add_u32 s25, s25, 81920
  s_add_u32 m0, s21, 16384
  s_nop 0
  buffer_load_dwordx4 v123, s[16:19], s25 offen lds
  s_add_u32 s25, s25, 40960
  s_add_u32 m0, s21, 17408
  s_nop 0
  buffer_load_dwordx4 v123, s[16:19], s25 offen lds
  s_add_u32 s25, s24, s31
  s_add_u32 s25, s25, 81920
  s_add_u32 m0, s21, 18432
  s_nop 0
  buffer_load_dwordx4 v123, s[16:19], s25 offen lds
  s_add_u32 s25, s25, 40960
  s_add_u32 m0, s21, 19456
  s_nop 0
  buffer_load_dwordx4 v123, s[16:19], s25 offen lds
  s_add_u32 s25, s24, s29
  s_add_u32 s25, s25, 163840
  s_add_u32 m0, s21, 20480
  s_nop 0
  buffer_load_dwordx4 v120, s[16:19], s25 offen lds
  s_add_u32 m0, s21, 21504
  s_nop 0
  buffer_load_dwordx4 v121, s[16:19], s25 offen lds
  s_add_u32 m0, s21, 22528
  s_nop 0
  buffer_load_dwordx4 v122, s[16:19], s25 offen lds
  s_add_u32 s25, s25, 40960
  s_add_u32 m0, s21, 23552
  s_nop 0
  buffer_load_dwordx4 v120, s[16:19], s25 offen lds
  s_add_u32 m0, s21, 24576
  s_nop 0
  buffer_load_dwordx4 v121, s[16:19], s25 offen lds
  s_add_u32 m0, s21, 25600
  s_nop 0
  buffer_load_dwordx4 v122, s[16:19], s25 offen lds
  s_add_u32 s25, s24, s30
  s_add_u32 s25, s25, 163840
  s_add_u32 m0, s21, 26624
  s_nop 0
  buffer_load_dwordx4 v123, s[16:19], s25 offen lds
  s_add_u32 s25, s25, 40960
  s_add_u32 m0, s21, 27648
  s_nop 0
  buffer_load_dwordx4 v123, s[16:19], s25 offen lds
  s_add_u32 s25, s24, s31
  s_add_u32 s25, s25, 163840
  s_add_u32 m0, s21, 28672
  s_nop 0
  buffer_load_dwordx4 v123, s[16:19], s25 offen lds
  s_add_u32 s25, s25, 40960
  s_add_u32 m0, s21, 29696
  s_nop 0
  buffer_load_dwordx4 v123, s[16:19], s25 offen lds
  s_waitcnt vmcnt(20)
  ds_read_b64_tr_b16 a[0:1], v10 offset:0
  ds_read_b64_tr_b16 a[2:3], v10 offset:1536
  ds_read_b64_tr_b16 a[4:5], v10 offset:3072
  ds_read_b64_tr_b16 a[6:7], v10 offset:4608
  ds_read_b64_tr_b16 a[48:49], v10 offset:32
  ds_read_b64_tr_b16 a[50:51], v10 offset:1568
  ds_read_b64_tr_b16 a[52:53], v10 offset:3104
  ds_read_b64_tr_b16 a[54:55], v10 offset:4640
  ds_read_b64_tr_b16 a[96:97], v10 offset:64
  ds_read_b64_tr_b16 a[98:99], v10 offset:1600
  ds_read_b64_tr_b16 a[100:101], v10 offset:3136
  ds_read_b64_tr_b16 a[102:103], v10 offset:4672
  ds_read_b64_tr_b16 a[144:145], v11 offset:6144
  ds_read_b64_tr_b16 a[146:147], v11 offset:6656
  ds_read_b64_tr_b16 a[148:149], v11 offset:7168
  ds_read_b64_tr_b16 a[150:151], v11 offset:7680
  ds_read_b64_tr_b16 a[192:193], v11 offset:8192
  ds_read_b64_tr_b16 a[194:195], v11 offset:8704
  ds_read_b64_tr_b16 a[196:197], v11 offset:9216
  ds_read_b64_tr_b16 a[198:199], v11 offset:9728
  s_waitcnt lgkmcnt(0)
  s_add_u32 s25, s24, s29
  s_add_u32 s25, s25, 245760
  s_add_u32 m0, s21, 0
  s_nop 0
  buffer_load_dwordx4 v120, s[16:19], s25 offen lds
  s_add_u32 m0, s21, 1024
  s_nop 0
  buffer_load_dwordx4 v121, s[16:19], s25 offen lds
  s_add_u32 m0, s21, 2048
  s_nop 0
  buffer_load_dwordx4 v122, s[16:19], s25 offen lds
  s_add_u32 s25, s25, 40960
  s_add_u32 m0, s21, 3072
  s_nop 0
  buffer_load_dwordx4 v120, s[16:19], s25 offen lds
  s_add_u32 m0, s21, 4096
  s_nop 0
  buffer_load_dwordx4 v121, s[16:19], s25 offen lds
  s_add_u32 m0, s21, 5120
  s_nop 0
  buffer_load_dwordx4 v122, s[16:19], s25 offen lds
  s_add_u32 s25, s24, s30
  s_add_u32 s25, s25, 245760
  s_add_u32 m0, s21, 6144
  s_nop 0
  buffer_load_dwordx4 v123, s[16:19], s25 offen lds
  s_add_u32 s25, s25, 40960
  s_add_u32 m0, s21, 7168
  s_nop 0
  buffer_load_dwordx4 v123, s[16:19], s25 offen lds
  s_add_u32 s25, s24, s31
  s_add_u32 s25, s25, 245760
  s_add_u32 m0, s21, 8192
  s_nop 0
  buffer_load_dwordx4 v123, s[16:19], s25 offen lds
  s_add_u32 s25, s25, 40960
  s_add_u32 m0, s21, 9216
  s_nop 0
  buffer_load_dwordx4 v123, s[16:19], s25 offen lds
  s_waitcnt vmcnt(20)
  ds_read_b64_tr_b16 a[8:9], v10 offset:10240
  ds_read_b64_tr_b16 a[10:11], v10 offset:11776
  ds_read_b64_tr_b16 a[12:13], v10 offset:13312
  ds_read_b64_tr_b16 a[14:15], v10 offset:14848
  ds_read_b64_tr_b16 a[56:57], v10 offset:10272
  ds_read_b64_tr_b16 a[58:59], v10 offset:11808
  ds_read_b64_tr_b16 a[60:61], v10 offset:13344
  ds_read_b64_tr_b16 a[62:63], v10 offset:14880
  ds_read_b64_tr_b16 a[104:105], v10 offset:10304
  ds_read_b64_tr_b16 a[106:107], v10 offset:11840
  ds_read_b64_tr_b16 a[108:109], v10 offset:13376
  ds_read_b64_tr_b16 a[110:111], v10 offset:14912
  ds_read_b64_tr_b16 a[152:153], v11 offset:16384
  ds_read_b64_tr_b16 a[154:155], v11 offset:16896
  ds_read_b64_tr_b16 a[156:157], v11 offset:17408
  ds_read_b64_tr_b16 a[158:159], v11 offset:17920
  ds_read_b64_tr_b16 a[200:201], v11 offset:18432
  ds_read_b64_tr_b16 a[202:203], v11 offset:18944
  ds_read_b64_tr_b16 a[204:205], v11 offset:19456
  ds_read_b64_tr_b16 a[206:207], v11 offset:19968
  s_waitcnt lgkmcnt(0)
  s_add_u32 s25, s24, s29
  s_add_u32 s25, s25, 327680
  s_add_u32 m0, s21, 10240
  s_nop 0
  buffer_load_dwordx4 v120, s[16:19], s25 offen lds
  s_add_u32 m0, s21, 11264
  s_nop 0
  buffer_load_dwordx4 v121, s[16:19], s25 offen lds
  s_add_u32 m0, s21, 12288
  s_nop 0
  buffer_load_dwordx4 v122, s[16:19], s25 offen lds
  s_add_u32 s25, s25, 40960
  s_add_u32 m0, s21, 13312
  s_nop 0
  buffer_load_dwordx4 v120, s[16:19], s25 offen lds
  s_add_u32 m0, s21, 14336
  s_nop 0
  buffer_load_dwordx4 v121, s[16:19], s25 offen lds
  s_add_u32 m0, s21, 15360
  s_nop 0
  buffer_load_dwordx4 v122, s[16:19], s25 offen lds
  s_add_u32 s25, s24, s30
  s_add_u32 s25, s25, 327680
  s_add_u32 m0, s21, 16384
  s_nop 0
  buffer_load_dwordx4 v123, s[16:19], s25 offen lds
  s_add_u32 s25, s25, 40960
  s_add_u32 m0, s21, 17408
  s_nop 0
  buffer_load_dwordx4 v123, s[16:19], s25 offen lds
  s_add_u32 s25, s24, s31
  s_add_u32 s25, s25, 327680
  s_add_u32 m0, s21, 18432
  s_nop 0
  buffer_load_dwordx4 v123, s[16:19], s25 offen lds
  s_add_u32 s25, s25, 40960
  s_add_u32 m0, s21, 19456
  s_nop 0
  buffer_load_dwordx4 v123, s[16:19], s25 offen lds
  s_waitcnt vmcnt(20)
  ds_read_b64_tr_b16 a[16:17], v10 offset:20480
  ds_read_b64_tr_b16 a[18:19], v10 offset:22016
  ds_read_b64_tr_b16 a[20:21], v10 offset:23552
  ds_read_b64_tr_b16 a[22:23], v10 offset:25088
  ds_read_b64_tr_b16 a[64:65], v10 offset:20512
  ds_read_b64_tr_b16 a[66:67], v10 offset:22048
  ds_read_b64_tr_b16 a[68:69], v10 offset:23584
  ds_read_b64_tr_b16 a[70:71], v10 offset:25120
  ds_read_b64_tr_b16 a[112:113], v10 offset:20544
  ds_read_b64_tr_b16 a[114:115], v10 offset:22080
  ds_read_b64_tr_b16 a[116:117], v10 offset:23616
  ds_read_b64_tr_b16 a[118:119], v10 offset:25152
  ds_read_b64_tr_b16 a[160:161], v11 offset:26624
  ds_read_b64_tr_b16 a[162:163], v11 offset:27136
  ds_read_b64_tr_b16 a[164:165], v11 offset:27648
  ds_read_b64_tr_b16 a[166:167], v11 offset:28160
  ds_read_b64_tr_b16 a[208:209], v11 offset:28672
  ds_read_b64_tr_b16 a[210:211], v11 offset:29184
  ds_read_b64_tr_b16 a[212:213], v11 offset:29696
  ds_read_b64_tr_b16 a[214:215], v11 offset:30208
  s_waitcnt lgkmcnt(0)
  s_add_u32 s25, s24, s29
  s_add_u32 s25, s25, 409600
  s_add_u32 m0, s21, 20480
  s_nop 0
  buffer_load_dwordx4 v120, s[16:19], s25 offen lds
  s_add_u32 m0, s21, 21504
  s_nop 0
  buffer_load_dwordx4 v121, s[16:19], s25 offen lds
  s_add_u32 m0, s21, 22528
  s_nop 0
  buffer_load_dwordx4 v122, s[16:19], s25 offen lds
  s_add_u32 s25, s25, 40960
  s_add_u32 m0, s21, 23552
  s_nop 0
  buffer_load_dwordx4 v120, s[16:19], s25 offen lds
  s_add_u32 m0, s21, 24576
  s_nop 0
  buffer_load_dwordx4 v121, s[16:19], s25 offen lds
  s_add_u32 m0, s21, 25600
  s_nop 0
  buffer_load_dwordx4 v122, s[16:19], s25 offen lds
  s_add_u32 s25, s24, s30
  s_add_u32 s25, s25, 409600
  s_add_u32 m0, s21, 26624
  s_nop 0
  buffer_load_dwordx4 v123, s[16:19], s25 offen lds
  s_add_u32 s25, s25, 40960
  s_add_u32 m0, s21, 27648
  s_nop 0
  buffer_load_dwordx4 v123, s[16:19], s25 offen lds
  s_add_u32 s25, s24, s31
  s_add_u32 s25, s25, 409600
  s_add_u32 m0, s21, 28672
  s_nop 0
  buffer_load_dwordx4 v123, s[16:19], s25 offen lds
  s_add_u32 s25, s25, 40960
  s_add_u32 m0, s21, 29696
  s_nop 0
  buffer_load_dwordx4 v123, s[16:19], s25 offen lds
  s_waitcnt vmcnt(20)
  ds_read_b64_tr_b16 a[24:25], v10 offset:0
  ds_read_b64_tr_b16 a[26:27], v10 offset:1536
  ds_read_b64_tr_b16 a[28:29], v10 offset:3072
  ds_read_b64_tr_b16 a[30:31], v10 offset:4608
  ds_read_b64_tr_b16 a[72:73], v10 offset:32
  ds_read_b64_tr_b16 a[74:75], v10 offset:1568
  ds_read_b64_tr_b16 a[76:77], v10 offset:3104
  ds_read_b64_tr_b16 a[78:79], v10 offset:4640
  ds_read_b64_tr_b16 a[120:121], v10 offset:64
  ds_read_b64_tr_b16 a[122:123], v10 offset:1600
  ds_read_b64_tr_b16 a[124:125], v10 offset:3136
  ds_read_b64_tr_b16 a[126:127], v10 offset:4672
  ds_read_b64_tr_b16 a[168:169], v11 offset:6144
  ds_read_b64_tr_b16 a[170:171], v11 offset:6656
  ds_read_b64_tr_b16 a[172:173], v11 offset:7168
  ds_read_b64_tr_b16 a[174:175], v11 offset:7680
  ds_read_b64_tr_b16 a[216:217], v11 offset:8192
  ds_read_b64_tr_b16 a[218:219], v11 offset:8704
  ds_read_b64_tr_b16 a[220:221], v11 offset:9216
  ds_read_b64_tr_b16 a[222:223], v11 offset:9728
  s_waitcnt lgkmcnt(0)
  s_waitcnt vmcnt(10)
  ds_read_b64_tr_b16 a[32:33], v10 offset:10240
  ds_read_b64_tr_b16 a[34:35], v10 offset:11776
  ds_read_b64_tr_b16 a[36:37], v10 offset:13312
  ds_read_b64_tr_b16 a[38:39], v10 offset:14848
  ds_read_b64_tr_b16 a[80:81], v10 offset:10272
  ds_read_b64_tr_b16 a[82:83], v10 offset:11808
  ds_read_b64_tr_b16 a[84:85], v10 offset:13344
  ds_read_b64_tr_b16 a[86:87], v10 offset:14880
  ds_read_b64_tr_b16 a[128:129], v10 offset:10304
  ds_read_b64_tr_b16 a[130:131], v10 offset:11840
  ds_read_b64_tr_b16 a[132:133], v10 offset:13376
  ds_read_b64_tr_b16 a[134:135], v10 offset:14912
  ds_read_b64_tr_b16 a[176:177], v11 offset:16384
  ds_read_b64_tr_b16 a[178:179], v11 offset:16896
  ds_read_b64_tr_b16 a[180:181], v11 offset:17408
  ds_read_b64_tr_b16 a[182:183], v11 offset:17920
  ds_read_b64_tr_b16 a[224:225], v11 offset:18432
  ds_read_b64_tr_b16 a[226:227], v11 offset:18944
  ds_read_b64_tr_b16 a[228:229], v11 offset:19456
  ds_read_b64_tr_b16 a[230:231], v11 offset:19968
  s_waitcnt lgkmcnt(0)
  s_waitcnt vmcnt(0)
  ds_read_b64_tr_b16 a[40:41], v10 offset:20480
  ds_read_b64_tr_b16 a[42:43], v10 offset:22016
  ds_read_b64_tr_b16 a[44:45], v10 offset:23552
  ds_read_b64_tr_b16 a[46:47], v10 offset:25088
  ds_read_b64_tr_b16 a[88:89], v10 offset:20512
  ds_read_b64_tr_b16 a[90:91], v10 offset:22048
  ds_read_b64_tr_b16 a[92:93], v10 offset:23584
  ds_read_b64_tr_b16 a[94:95], v10 offset:25120
  ds_read_b64_tr_b16 a[136:137], v10 offset:20544
  ds_read_b64_tr_b16 a[138:139], v10 offset:22080
  ds_read_b64_tr_b16 a[140:141], v10 offset:23616
  ds_read_b64_tr_b16 a[142:143], v10 offset:25152
  ds_read_b64_tr_b16 a[184:185], v11 offset:26624
  ds_read_b64_tr_b16 a[186:187], v11 offset:27136
  ds_read_b64_tr_b16 a[188:189], v11 offset:27648
  ds_read_b64_tr_b16 a[190:191], v11 offset:28160
  ds_read_b64_tr_b16 a[232:233], v11 offset:28672
  ds_read_b64_tr_b16 a[234:235], v11 offset:29184
  ds_read_b64_tr_b16 a[236:237], v11 offset:29696
  ds_read_b64_tr_b16 a[238:239], v11 offset:30208
  s_waitcnt lgkmcnt(0)
  s_waitcnt vmcnt(0)
  s_load_dwordx2 s[12:13], s[0:1], 104
  s_waitcnt lgkmcnt(0)
  s_and_b32 s13, s13, 0xffff
  s_mov_b32 s14, 2621440
  s_mov_b32 s15, 0x00020000
  s_barrier
  s_lshr_b32 s27, s91, 1
  s_and_b32 s28, s91, 1
  s_lshl_b32 s22, s28, 4
  v_add_u32 v9, s22, v4
  v_mul_u32_u24 v9, 1280, v9
  v_lshl_add_u32 v9, v3, 3, v9
  s_mul_i32 s22, s26, 160
  s_lshl_b32 s23, s27, 5
  s_add_u32 s22, s22, s23
  v_add_u32 v9, s22, v9
  s_lshl_b32 s22, s22, 1
  v_lshlrev_b32 v6, 4, v3
  v_add_u32 v6, s22, v6
  s_mov_b32 s22, 12800
  buffer_load_dwordx4 v[160:163], v6, s[8:11], s22 offen offset:0
  buffer_load_dwordx4 v[164:167], v6, s[8:11], s22 offen offset:128
  buffer_load_dwordx4 v[168:171], v6, s[8:11], s22 offen offset:256
  s_mul_i32 s22, s91, 10240
  v_add_u32 v12, s22, v5
  s_lshl_b32 s22, s27, 11
  s_lshl_b32 s23, s28, 10
  s_add_u32 s22, s22, s23
  v_add_u32 v13, s22, v5
  s_lshl_b32 s48, s26, 4
  s_lshl_b32 s22, s91, 2
  s_add_u32 s48, s48, s22
  s_add_u32 s48, s48, s47
  v_min_u32 v15, 47, v2
  v_lshlrev_b32 v15, 3, v15
  s_mul_i32 s44, s91, 12288
  s_add_u32 s44, s44, s46
  s_waitcnt vmcnt(0)
  s_mov_b32 s45, 0
  s_add_u32 s42, s42, 1
XF2_late:
XF2_fl:
  buffer_load_dwordx2 v[176:177], v15, s[8:11], s47 offen offset:0 sc1
  s_waitcnt vmcnt(0)
  v_min_u32 v176, v176, v177
  v_cmp_gt_u32 vcc, s42, v176
  s_cbranch_vccz XF2_fl_ok
  s_add_u32 s41, s41, 1
  s_cmp_lt_u32 s41, 3000000
  s_cbranch_scc1 XF2_fl
  s_branch K3_end
XF2_fl_ok:
  s_add_u32 s22, s45, s44
  s_add_u32 s45, s45, 98304
  s_cmp_ge_u32 s45, 294912
  s_cselect_b32 s45, 0, s45
  s_add_u32 s23, s22, 0
  buffer_load_dwordx4 v[16:19], v5, s[8:11], s23 offen offset:0 sc1
  s_add_u32 s23, s22, 49152
  buffer_load_dwordx4 v[20:23], v5, s[8:11], s23 offen offset:0 sc1
  s_add_u32 s23, s22, 0
  buffer_load_dwordx4 v[24:27], v5, s[8:11], s23 offen offset:1024 sc1
  s_add_u32 s23, s22, 49152
  buffer_load_dwordx4 v[28:31], v5, s[8:11], s23 offen offset:1024 sc1
  s_add_u32 s23, s22, 0
  buffer_load_dwordx4 v[32:35], v5, s[8:11], s23 offen offset:2048 sc1
  s_add_u32 s23, s22, 49152
  buffer_load_dwordx4 v[36:39], v5, s[8:11], s23 offen offset:2048 sc1
  s_add_u32 s23, s22, 0
  buffer_load_dwordx4 v[40:43], v5, s[8:11], s23 offen offset:3072 sc1
  s_add_u32 s23, s22, 49152
  buffer_load_dwordx4 v[44:47], v5, s[8:11], s23 offen offset:3072 sc1
  s_add_u32 s23, s22, 4096
  buffer_load_dwordx4 v[48:51], v5, s[8:11], s23 offen offset:0 sc1
  s_add_u32 s23, s22, 53248
  buffer_load_dwordx4 v[52:55], v5, s[8:11], s23 offen offset:0 sc1
  s_add_u32 s23, s22, 4096
  buffer_load_dwordx4 v[56:59], v5, s[8:11], s23 offen offset:1024 sc1
  s_add_u32 s23, s22, 53248
  buffer_load_dwordx4 v[60:63], v5, s[8:11], s23 offen offset:1024 sc1
  s_add_u32 s23, s22, 4096
  buffer_load_dwordx4 v[64:67], v5, s[8:11], s23 offen offset:2048 sc1
  s_add_u32 s23, s22, 53248
  buffer_load_dwordx4 v[68:71], v5, s[8:11], s23 offen offset:2048 sc1
  s_add_u32 s23, s22, 4096
  buffer_load_dwordx4 v[72:75], v5, s[8:11], s23 offen offset:3072 sc1
  s_add_u32 s23, s22, 53248
  buffer_load_dwordx4 v[76:79], v5, s[8:11], s23 offen offset:3072 sc1
  s_add_u32 s23, s22, 8192
  buffer_load_dwordx4 v[80:83], v5, s[8:11], s23 offen offset:0 sc1
  s_add_u32 s23, s22, 57344
  buffer_load_dwordx4 v[84:87], v5, s[8:11], s23 offen offset:0 sc1
  s_add_u32 s23, s22, 8192
  buffer_load_dwordx4 v[88:91], v5, s[8:11], s23 offen offset:1024 sc1
  s_add_u32 s23, s22, 57344
  buffer_load_dwordx4 v[92:95], v5, s[8:11], s23 offen offset:1024 sc1
  s_add_u32 s23, s22, 8192
  buffer_load_dwordx4 v[96:99], v5, s[8:11], s23 offen offset:2048 sc1
  s_add_u32 s23, s22, 57344
  buffer_load_dwordx4 v[100:103], v5, s[8:11], s23 offen offset:2048 sc1
  s_add_u32 s23, s22, 8192
  buffer_load_dwordx4 v[104:107], v5, s[8:11], s23 offen offset:3072 sc1
  s_add_u32 s23, s22, 57344
  buffer_load_dwordx4 v[108:111], v5, s[8:11], s23 offen offset:3072 sc1
  s_mov_b32 s59, 0
XF2_loop:
  s_cmp_eq_u32 s43, 1
  s_cbranch_scc1 XF2_qg_ok
  s_cmp_lt_i32 s40, 30
  s_cbranch_scc1 XF2_qg_ok
  v_mov_b32 v6, 4595648
XF2_qg:
  buffer_load_dword v7, v6, s[8:11], 0 offen sc1
  s_waitcnt vmcnt(0)
  v_readfirstlane_b32 s57, v7
  s_mov_b32 s43, 1
  s_cmp_ge_u32 s57, 32
  s_cbranch_scc1 XF2_qg_ok
  s_sleep 8
  s_add_u32 s41, s41, 1
  s_cmp_lt_u32 s41, 3000000
  s_cbranch_scc1 XF2_qg
  s_branch K3_end
XF2_qg_ok:
  s_ff1_i32_b64 s54, s[36:37]
  s_mul_i32 s57, s40, 40960
  s_add_u32 s58, s57, 26214400
  s_cmp_eq_u32 s59, 1
  s_cbranch_scc0 XF2_B
  s_cmp_eq_u32 s54, -1
  s_cbranch_scc1 XF2_B
  s_waitcnt vmcnt(2)
  v_min_u32 v230, v230, v231
  s_add_u32 s23, s42, 1
  v_cmp_gt_u32 vcc, s23, v230
  s_cbranch_vccnz XF2_B
  buffer_load_dwordx2 v[152:153], v9, s[8:11], s58 offen offset:0 sc1
  buffer_load_dwordx2 v[154:155], v9, s[8:11], s58 offen offset:64 sc1
  buffer_load_dwordx2 v[156:157], v9, s[8:11], s58 offen offset:128 sc1
  s_add_u32 s22, s45, s44
  s_add_u32 s45, s45, 98304
  s_cmp_ge_u32 s45, 294912
  s_cselect_b32 s45, 0, s45
  v_mfma_f32_16x16x32_bf16 v[112:115], a[0:3], v[16:19], 0
  v_mfma_f32_16x16x32_bf16 v[120:123], a[48:51], v[16:19], 0
  v_mfma_f32_16x16x32_bf16 v[128:131], a[96:99], v[16:19], 0
  v_mfma_f32_16x16x32_bf16 v[136:139], a[144:147], v[16:19], 0
  v_mfma_f32_16x16x32_bf16 v[144:147], a[192:195], v[16:19], 0
  s_add_u32 s23, s22, 0
  buffer_load_dwordx4 v[16:19], v5, s[8:11], s23 offen offset:0 sc1
  v_mfma_f32_16x16x32_bf16 v[116:119], a[0:3], v[20:23], 0
  v_mfma_f32_16x16x32_bf16 v[124:127], a[48:51], v[20:23], 0
  v_mfma_f32_16x16x32_bf16 v[132:135], a[96:99], v[20:23], 0
  v_mfma_f32_16x16x32_bf16 v[140:143], a[144:147], v[20:23], 0
  v_mfma_f32_16x16x32_bf16 v[148:151], a[192:195], v[20:23], 0
  s_add_u32 s23, s22, 49152
  buffer_load_dwordx4 v[20:23], v5, s[8:11], s23 offen offset:0 sc1
  v_mfma_f32_16x16x32_bf16 v[112:115], a[4:7], v[24:27], v[112:115]
  v_mfma_f32_16x16x32_bf16 v[120:123], a[52:55], v[24:27], v[120:123]
  v_mfma_f32_16x16x32_bf16 v[128:131], a[100:103], v[24:27], v[128:131]
  v_mfma_f32_16x16x32_bf16 v[136:139], a[148:151], v[24:27], v[136:139]
  v_mfma_f32_16x16x32_bf16 v[144:147], a[196:199], v[24:27], v[144:147]
  s_add_u32 s23, s22, 0
  buffer_load_dwordx4 v[24:27], v5, s[8:11], s23 offen offset:1024 sc1
  v_mfma_f32_16x16x32_bf16 v[116:119], a[4:7], v[28:31], v[116:119]
  v_mfma_f32_16x16x32_bf16 v[124:127], a[52:55], v[28:31], v[124:127]
  v_mfma_f32_16x16x32_bf16 v[132:135], a[100:103], v[28:31], v[132:135]
  v_mfma_f32_16x16x32_bf16 v[140:143], a[148:151], v[28:31], v[140:143]
  v_mfma_f32_16x16x32_bf16 v[148:151], a[196:199], v[28:31], v[148:151]
  s_add_u32 s23, s22, 49152
  buffer_load_dwordx4 v[28:31], v5, s[8:11], s23 offen offset:1024 sc1
  v_mfma_f32_16x16x32_bf16 v[112:115], a[8:11], v[32:35], v[112:115]
  v_mfma_f32_16x16x32_bf16 v[120:123], a[56:59], v[32:35], v[120:123]
  v_mfma_f32_16x16x32_bf16 v[128:131], a[104:107], v[32:35], v[128:131]
  v_mfma_f32_16x16x32_bf16 v[136:139], a[152:155], v[32:35], v[136:139]
  v_mfma_f32_16x16x32_bf16 v[144:147], a[200:203], v[32:35], v[144:147]
  s_add_u32 s23, s22, 0
  buffer_load_dwordx4 v[32:35], v5, s[8:11], s23 offen offset:2048 sc1
  v_mfma_f32_16x16x32_bf16 v[116:119], a[8:11], v[36:39], v[116:119]
  v_mfma_f32_16x16x32_bf16 v[124:127], a[56:59], v[36:39], v[124:127]
  v_mfma_f32_16x16x32_bf16 v[132:135], a[104:107], v[36:39], v[132:135]
  v_mfma_f32_16x16x32_bf16 v[140:143], a[152:155], v[36:39], v[140:143]
  v_mfma_f32_16x16x32_bf16 v[148:151], a[200:203], v[36:39], v[148:151]
  s_add_u32 s23, s22, 49152
  buffer_load_dwordx4 v[36:39], v5, s[8:11], s23 offen offset:2048 sc1
  v_mfma_f32_16x16x32_bf16 v[112:115], a[12:15], v[40:43], v[112:115]
  v_mfma_f32_16x16x32_bf16 v[120:123], a[60:63], v[40:43], v[120:123]
  v_mfma_f32_16x16x32_bf16 v[128:131], a[108:111], v[40:43], v[128:131]
  v_mfma_f32_16x16x32_bf16 v[136:139], a[156:159], v[40:43], v[136:139]
  v_mfma_f32_16x16x32_bf16 v[144:147], a[204:207], v[40:43], v[144:147]
  s_add_u32 s23, s22, 0
  buffer_load_dwordx4 v[40:43], v5, s[8:11], s23 offen offset:3072 sc1
  v_mfma_f32_16x16x32_bf16 v[116:119], a[12:15], v[44:47], v[116:119]
  v_mfma_f32_16x16x32_bf16 v[124:127], a[60:63], v[44:47], v[124:127]
  v_mfma_f32_16x16x32_bf16 v[132:135], a[108:111], v[44:47], v[132:135]
  v_mfma_f32_16x16x32_bf16 v[140:143], a[156:159], v[44:47], v[140:143]
  v_mfma_f32_16x16x32_bf16 v[148:151], a[204:207], v[44:47], v[148:151]
  s_add_u32 s23, s22, 49152
  buffer_load_dwordx4 v[44:47], v5, s[8:11], s23 offen offset:3072 sc1
  v_mfma_f32_16x16x32_bf16 v[112:115], a[16:19], v[48:51], v[112:115]
  v_mfma_f32_16x16x32_bf16 v[120:123], a[64:67], v[48:51], v[120:123]
  v_mfma_f32_16x16x32_bf16 v[128:131], a[112:115], v[48:51], v[128:131]
  v_mfma_f32_16x16x32_bf16 v[136:139], a[160:163], v[48:51], v[136:139]
  v_mfma_f32_16x16x32_bf16 v[144:147], a[208:211], v[48:51], v[144:147]
  s_add_u32 s23, s22, 4096
  buffer_load_dwordx4 v[48:51], v5, s[8:11], s23 offen offset:0 sc1
  v_mfma_f32_16x16x32_bf16 v[116:119], a[16:19], v[52:55], v[116:119]
  v_mfma_f32_16x16x32_bf16 v[124:127], a[64:67], v[52:55], v[124:127]
  v_mfma_f32_16x16x32_bf16 v[132:135], a[112:115], v[52:55], v[132:135]
  v_mfma_f32_16x16x32_bf16 v[140:143], a[160:163], v[52:55], v[140:143]
  v_mfma_f32_16x16x32_bf16 v[148:151], a[208:211], v[52:55], v[148:151]
  s_add_u32 s23, s22, 53248
  buffer_load_dwordx4 v[52:55], v5, s[8:11], s23 offen offset:0 sc1
  v_mfma_f32_16x16x32_bf16 v[112:115], a[20:23], v[56:59], v[112:115]
  v_mfma_f32_16x16x32_bf16 v[120:123], a[68:71], v[56:59], v[120:123]
  v_mfma_f32_16x16x32_bf16 v[128:131], a[116:119], v[56:59], v[128:131]
  v_mfma_f32_16x16x32_bf16 v[136:139], a[164:167], v[56:59], v[136:139]
  v_mfma_f32_16x16x32_bf16 v[144:147], a[212:215], v[56:59], v[144:147]
  s_add_u32 s23, s22, 4096
  buffer_load_dwordx4 v[56:59], v5, s[8:11], s23 offen offset:1024 sc1
  v_mfma_f32_16x16x32_bf16 v[116:119], a[20:23], v[60:63], v[116:119]
  v_mfma_f32_16x16x32_bf16 v[124:127], a[68:71], v[60:63], v[124:127]
  v_mfma_f32_16x16x32_bf16 v[132:135], a[116:119], v[60:63], v[132:135]
  v_mfma_f32_16x16x32_bf16 v[140:143], a[164:167], v[60:63], v[140:143]
  v_mfma_f32_16x16x32_bf16 v[148:151], a[212:215], v[60:63], v[148:151]
  s_add_u32 s23, s22, 53248
  buffer_load_dwordx4 v[60:63], v5, s[8:11], s23 offen offset:1024 sc1
  v_mfma_f32_16x16x32_bf16 v[112:115], a[24:27], v[64:67], v[112:115]
  v_mfma_f32_16x16x32_bf16 v[120:123], a[72:75], v[64:67], v[120:123]
  v_mfma_f32_16x16x32_bf16 v[128:131], a[120:123], v[64:67], v[128:131]
  v_mfma_f32_16x16x32_bf16 v[136:139], a[168:171], v[64:67], v[136:139]
  v_mfma_f32_16x16x32_bf16 v[144:147], a[216:219], v[64:67], v[144:147]
  s_add_u32 s23, s22, 4096
  buffer_load_dwordx4 v[64:67], v5, s[8:11], s23 offen offset:2048 sc1
  v_mfma_f32_16x16x32_bf16 v[116:119], a[24:27], v[68:71], v[116:119]
  v_mfma_f32_16x16x32_bf16 v[124:127], a[72:75], v[68:71], v[124:127]
  v_mfma_f32_16x16x32_bf16 v[132:135], a[120:123], v[68:71], v[132:135]
  v_mfma_f32_16x16x32_bf16 v[140:143], a[168:171], v[68:71], v[140:143]
  v_mfma_f32_16x16x32_bf16 v[148:151], a[216:219], v[68:71], v[148:151]
  s_add_u32 s23, s22, 53248
  buffer_load_dwordx4 v[68:71], v5, s[8:11], s23 offen offset:2048 sc1
  v_mfma_f32_16x16x32_bf16 v[112:115], a[28:31], v[72:75], v[112:115]
  v_mfma_f32_16x16x32_bf16 v[120:123], a[76:79], v[72:75], v[120:123]
  v_mfma_f32_16x16x32_bf16 v[128:131], a[124:127], v[72:75], v[128:131]
  v_mfma_f32_16x16x32_bf16 v[136:139], a[172:175], v[72:75], v[136:139]
  v_mfma_f32_16x16x32_bf16 v[144:147], a[220:223], v[72:75], v[144:147]
  s_add_u32 s23, s22, 4096
  buffer_load_dwordx4 v[72:75], v5, s[8:11], s23 offen offset:3072 sc1
  v_mfma_f32_16x16x32_bf16 v[116:119], a[28:31], v[76:79], v[116:119]
  v_mfma_f32_16x16x32_bf16 v[124:127], a[76:79], v[76:79], v[124:127]
  v_mfma_f32_16x16x32_bf16 v[132:135], a[124:127], v[76:79], v[132:135]
  v_mfma_f32_16x16x32_bf16 v[140:143], a[172:175], v[76:79], v[140:143]
  v_mfma_f32_16x16x32_bf16 v[148:151], a[220:223], v[76:79], v[148:151]
  s_add_u32 s23, s22, 53248
  buffer_load_dwordx4 v[76:79], v5, s[8:11], s23 offen offset:3072 sc1
  v_mfma_f32_16x16x32_bf16 v[112:115], a[32:35], v[80:83], v[112:115]
  v_mfma_f32_16x16x32_bf16 v[120:123], a[80:83], v[80:83], v[120:123]
  v_mfma_f32_16x16x32_bf16 v[128:131], a[128:131], v[80:83], v[128:131]
  v_mfma_f32_16x16x32_bf16 v[136:139], a[176:179], v[80:83], v[136:139]
  v_mfma_f32_16x16x32_bf16 v[144:147], a[224:227], v[80:83], v[144:147]
  s_add_u32 s23, s22, 8192
  buffer_load_dwordx4 v[80:83], v5, s[8:11], s23 offen offset:0 sc1
  v_mfma_f32_16x16x32_bf16 v[116:119], a[32:35], v[84:87], v[116:119]
  v_mfma_f32_16x16x32_bf16 v[124:127], a[80:83], v[84:87], v[124:127]
  v_mfma_f32_16x16x32_bf16 v[132:135], a[128:131], v[84:87], v[132:135]
  v_mfma_f32_16x16x32_bf16 v[140:143], a[176:179], v[84:87], v[140:143]
  v_mfma_f32_16x16x32_bf16 v[148:151], a[224:227], v[84:87], v[148:151]
  s_add_u32 s23, s22, 57344
  buffer_load_dwordx4 v[84:87], v5, s[8:11], s23 offen offset:0 sc1
  v_mfma_f32_16x16x32_bf16 v[112:115], a[36:39], v[88:91], v[112:115]
  v_mfma_f32_16x16x32_bf16 v[120:123], a[84:87], v[88:91], v[120:123]
  v_mfma_f32_16x16x32_bf16 v[128:131], a[132:135], v[88:91], v[128:131]
  v_mfma_f32_16x16x32_bf16 v[136:139], a[180:183], v[88:91], v[136:139]
  v_mfma_f32_16x16x32_bf16 v[144:147], a[228:231], v[88:91], v[144:147]
  s_add_u32 s23, s22, 8192
  buffer_load_dwordx4 v[88:91], v5, s[8:11], s23 offen offset:1024 sc1
  v_mfma_f32_16x16x32_bf16 v[116:119], a[36:39], v[92:95], v[116:119]
  v_mfma_f32_16x16x32_bf16 v[124:127], a[84:87], v[92:95], v[124:127]
  v_mfma_f32_16x16x32_bf16 v[132:135], a[132:135], v[92:95], v[132:135]
  v_mfma_f32_16x16x32_bf16 v[140:143], a[180:183], v[92:95], v[140:143]
  v_mfma_f32_16x16x32_bf16 v[148:151], a[228:231], v[92:95], v[148:151]
  s_add_u32 s23, s22, 57344
  buffer_load_dwordx4 v[92:95], v5, s[8:11], s23 offen offset:1024 sc1
  v_mfma_f32_16x16x32_bf16 v[112:115], a[40:43], v[96:99], v[112:115]
  v_mfma_f32_16x16x32_bf16 v[120:123], a[88:91], v[96:99], v[120:123]
  v_mfma_f32_16x16x32_bf16 v[128:131], a[136:139], v[96:99], v[128:131]
  v_mfma_f32_16x16x32_bf16 v[136:139], a[184:187], v[96:99], v[136:139]
  v_mfma_f32_16x16x32_bf16 v[144:147], a[232:235], v[96:99], v[144:147]
  s_add_u32 s23, s22, 8192
  buffer_load_dwordx4 v[96:99], v5, s[8:11], s23 offen offset:2048 sc1
  v_mfma_f32_16x16x32_bf16 v[116:119], a[40:43], v[100:103], v[116:119]
  v_mfma_f32_16x16x32_bf16 v[124:127], a[88:91], v[100:103], v[124:127]
  v_mfma_f32_16x16x32_bf16 v[132:135], a[136:139], v[100:103], v[132:135]
  v_mfma_f32_16x16x32_bf16 v[140:143], a[184:187], v[100:103], v[140:143]
  v_mfma_f32_16x16x32_bf16 v[148:151], a[232:235], v[100:103], v[148:151]
  s_add_u32 s23, s22, 57344
  buffer_load_dwordx4 v[100:103], v5, s[8:11], s23 offen offset:2048 sc1
  v_mfma_f32_16x16x32_bf16 v[112:115], a[44:47], v[104:107], v[112:115]
  v_mfma_f32_16x16x32_bf16 v[120:123], a[92:95], v[104:107], v[120:123]
  v_mfma_f32_16x16x32_bf16 v[128:131], a[140:143], v[104:107], v[128:131]
  v_mfma_f32_16x16x32_bf16 v[136:139], a[188:191], v[104:107], v[136:139]
  v_mfma_f32_16x16x32_bf16 v[144:147], a[236:239], v[104:107], v[144:147]
  s_add_u32 s23, s22, 8192
  buffer_load_dwordx4 v[104:107], v5, s[8:11], s23 offen offset:3072 sc1
  v_mfma_f32_16x16x32_bf16 v[116:119], a[44:47], v[108:111], v[116:119]
  v_mfma_f32_16x16x32_bf16 v[124:127], a[92:95], v[108:111], v[124:127]
  v_mfma_f32_16x16x32_bf16 v[132:135], a[140:143], v[108:111], v[132:135]
  v_mfma_f32_16x16x32_bf16 v[140:143], a[188:191], v[108:111], v[140:143]
  v_mfma_f32_16x16x32_bf16 v[148:151], a[236:239], v[108:111], v[148:151]
  s_add_u32 s23, s22, 57344
  buffer_load_dwordx4 v[108:111], v5, s[8:11], s23 offen offset:3072 sc1
  v_mov_b32 v6, s48
  v_mov_b32 v176, s42
  s_mov_b64 exec, 1
  buffer_store_dword v176, v6, s[8:11], 0 offen offset:512
  s_mov_b64 exec, -1
  s_add_u32 s42, s42, 1
  buffer_load_dwordx2 v[230:231], v15, s[8:11], s47 offen sc1
  s_waitcnt vmcnt(26)
  s_branch XF2_J
XF2_B:
  buffer_load_dwordx2 v[152:153], v9, s[8:11], s58 offen offset:0 sc1
  buffer_load_dwordx2 v[154:155], v9, s[8:11], s58 offen offset:64 sc1
  buffer_load_dwordx2 v[156:157], v9, s[8:11], s58 offen offset:128 sc1
  s_waitcnt vmcnt(26)
  v_mfma_f32_16x16x32_bf16 v[112:115], a[0:3], v[16:19], 0
  v_mfma_f32_16x16x32_bf16 v[120:123], a[48:51], v[16:19], 0
  v_mfma_f32_16x16x32_bf16 v[128:131], a[96:99], v[16:19], 0
  v_mfma_f32_16x16x32_bf16 v[136:139], a[144:147], v[16:19], 0
  v_mfma_f32_16x16x32_bf16 v[144:147], a[192:195], v[16:19], 0
  s_waitcnt vmcnt(25)
  v_mfma_f32_16x16x32_bf16 v[116:119], a[0:3], v[20:23], 0
  v_mfma_f32_16x16x32_bf16 v[124:127], a[48:51], v[20:23], 0
  v_mfma_f32_16x16x32_bf16 v[132:135], a[96:99], v[20:23], 0
  v_mfma_f32_16x16x32_bf16 v[140:143], a[144:147], v[20:23], 0
  v_mfma_f32_16x16x32_bf16 v[148:151], a[192:195], v[20:23], 0
  s_waitcnt vmcnt(24)
  v_mfma_f32_16x16x32_bf16 v[112:115], a[4:7], v[24:27], v[112:115]
  v_mfma_f32_16x16x32_bf16 v[120:123], a[52:55], v[24:27], v[120:123]
  v_mfma_f32_16x16x32_bf16 v[128:131], a[100:103], v[24:27], v[128:131]
  v_mfma_f32_16x16x32_bf16 v[136:139], a[148:151], v[24:27], v[136:139]
  v_mfma_f32_16x16x32_bf16 v[144:147], a[196:199], v[24:27], v[144:147]
  s_waitcnt vmcnt(23)
  v_mfma_f32_16x16x32_bf16 v[116:119], a[4:7], v[28:31], v[116:119]
  v_mfma_f32_16x16x32_bf16 v[124:127], a[52:55], v[28:31], v[124:127]
  v_mfma_f32_16x16x32_bf16 v[132:135], a[100:103], v[28:31], v[132:135]
  v_mfma_f32_16x16x32_bf16 v[140:143], a[148:151], v[28:31], v[140:143]
  v_mfma_f32_16x16x32_bf16 v[148:151], a[196:199], v[28:31], v[148:151]
  s_waitcnt vmcnt(22)
  v_mfma_f32_16x16x32_bf16 v[112:115], a[8:11], v[32:35], v[112:115]
  v_mfma_f32_16x16x32_bf16 v[120:123], a[56:59], v[32:35], v[120:123]
  v_mfma_f32_16x16x32_bf16 v[128:131], a[104:107], v[32:35], v[128:131]
  v_mfma_f32_16x16x32_bf16 v[136:139], a[152:155], v[32:35], v[136:139]
  v_mfma_f32_16x16x32_bf16 v[144:147], a[200:203], v[32:35], v[144:147]
  s_waitcnt vmcnt(21)
  v_mfma_f32_16x16x32_bf16 v[116:119], a[8:11], v[36:39], v[116:119]
  v_mfma_f32_16x16x32_bf16 v[124:127], a[56:59], v[36:39], v[124:127]
  v_mfma_f32_16x16x32_bf16 v[132:135], a[104:107], v[36:39], v[132:135]
  v_mfma_f32_16x16x32_bf16 v[140:143], a[152:155], v[36:39], v[140:143]
  v_mfma_f32_16x16x32_bf16 v[148:151], a[200:203], v[36:39], v[148:151]
  s_waitcnt vmcnt(20)
  v_mfma_f32_16x16x32_bf16 v[112:115], a[12:15], v[40:43], v[112:115]
  v_mfma_f32_16x16x32_bf16 v[120:123], a[60:63], v[40:43], v[120:123]
  v_mfma_f32_16x16x32_bf16 v[128:131], a[108:111], v[40:43], v[128:131]
  v_mfma_f32_16x16x32_bf16 v[136:139], a[156:159], v[40:43], v[136:139]
  v_mfma_f32_16x16x32_bf16 v[144:147], a[204:207], v[40:43], v[144:147]
  s_waitcnt vmcnt(19)
  v_mfma_f32_16x16x32_bf16 v[116:119], a[12:15], v[44:47], v[116:119]
  v_mfma_f32_16x16x32_bf16 v[124:127], a[60:63], v[44:47], v[124:127]
  v_mfma_f32_16x16x32_bf16 v[132:135], a[108:111], v[44:47], v[132:135]
  v_mfma_f32_16x16x32_bf16 v[140:143], a[156:159], v[44:47], v[140:143]
  v_mfma_f32_16x16x32_bf16 v[148:151], a[204:207], v[44:47], v[148:151]
  s_waitcnt vmcnt(18)
  v_mfma_f32_16x16x32_bf16 v[112:115], a[16:19], v[48:51], v[112:115]
  v_mfma_f32_16x16x32_bf16 v[120:123], a[64:67], v[48:51], v[120:123]
  v_mfma_f32_16x16x32_bf16 v[128:131], a[112:115], v[48:51], v[128:131]
  v_mfma_f32_16x16x32_bf16 v[136:139], a[160:163], v[48:51], v[136:139]
  v_mfma_f32_16x16x32_bf16 v[144:147], a[208:211], v[48:51], v[144:147]
  s_waitcnt vmcnt(17)
  v_mfma_f32_16x16x32_bf16 v[116:119], a[16:19], v[52:55], v[116:119]
  v_mfma_f32_16x16x32_bf16 v[124:127], a[64:67], v[52:55], v[124:127]
  v_mfma_f32_16x16x32_bf16 v[132:135], a[112:115], v[52:55], v[132:135]
  v_mfma_f32_16x16x32_bf16 v[140:143], a[160:163], v[52:55], v[140:143]
  v_mfma_f32_16x16x32_bf16 v[148:151], a[208:211], v[52:55], v[148:151]
  s_waitcnt vmcnt(16)
  v_mfma_f32_16x16x32_bf16 v[112:115], a[20:23], v[56:59], v[112:115]
  v_mfma_f32_16x16x32_bf16 v[120:123], a[68:71], v[56:59], v[120:123]
  v_mfma_f32_16x16x32_bf16 v[128:131], a[116:119], v[56:59], v[128:131]
  v_mfma_f32_16x16x32_bf16 v[136:139], a[164:167], v[56:59], v[136:139]
  v_mfma_f32_16x16x32_bf16 v[144:147], a[212:215], v[56:59], v[144:147]
  s_waitcnt vmcnt(15)
  v_mfma_f32_16x16x32_bf16 v[116:119], a[20:23], v[60:63], v[116:119]
  v_mfma_f32_16x16x32_bf16 v[124:127], a[68:71], v[60:63], v[124:127]
  v_mfma_f32_16x16x32_bf16 v[132:135], a[116:119], v[60:63], v[132:135]
  v_mfma_f32_16x16x32_bf16 v[140:143], a[164:167], v[60:63], v[140:143]
  v_mfma_f32_16x16x32_bf16 v[148:151], a[212:215], v[60:63], v[148:151]
  s_waitcnt vmcnt(14)
  v_mfma_f32_16x16x32_bf16 v[112:115], a[24:27], v[64:67], v[112:115]
  v_mfma_f32_16x16x32_bf16 v[120:123], a[72:75], v[64:67], v[120:123]
  v_mfma_f32_16x16x32_bf16 v[128:131], a[120:123], v[64:67], v[128:131]
  v_mfma_f32_16x16x32_bf16 v[136:139], a[168:171], v[64:67], v[136:139]
  v_mfma_f32_16x16x32_bf16 v[144:147], a[216:219], v[64:67], v[144:147]
  buffer_load_dwordx2 v[228:229], v15, s[8:11], s47 offen sc1
  s_waitcnt vmcnt(14)
  v_mfma_f32_16x16x32_bf16 v[116:119], a[24:27], v[68:71], v[116:119]
  v_mfma_f32_16x16x32_bf16 v[124:127], a[72:75], v[68:71], v[124:127]
  v_mfma_f32_16x16x32_bf16 v[132:135], a[120:123], v[68:71], v[132:135]
  v_mfma_f32_16x16x32_bf16 v[140:143], a[168:171], v[68:71], v[140:143]
  v_mfma_f32_16x16x32_bf16 v[148:151], a[216:219], v[68:71], v[148:151]
  s_waitcnt vmcnt(13)
  v_mfma_f32_16x16x32_bf16 v[112:115], a[28:31], v[72:75], v[112:115]
  v_mfma_f32_16x16x32_bf16 v[120:123], a[76:79], v[72:75], v[120:123]
  v_mfma_f32_16x16x32_bf16 v[128:131], a[124:127], v[72:75], v[128:131]
  v_mfma_f32_16x16x32_bf16 v[136:139], a[172:175], v[72:75], v[136:139]
  v_mfma_f32_16x16x32_bf16 v[144:147], a[220:223], v[72:75], v[144:147]
  s_waitcnt vmcnt(12)
  v_mfma_f32_16x16x32_bf16 v[116:119], a[28:31], v[76:79], v[116:119]
  v_mfma_f32_16x16x32_bf16 v[124:127], a[76:79], v[76:79], v[124:127]
  v_mfma_f32_16x16x32_bf16 v[132:135], a[124:127], v[76:79], v[132:135]
  v_mfma_f32_16x16x32_bf16 v[140:143], a[172:175], v[76:79], v[140:143]
  v_mfma_f32_16x16x32_bf16 v[148:151], a[220:223], v[76:79], v[148:151]
  s_waitcnt vmcnt(11)
  v_mfma_f32_16x16x32_bf16 v[112:115], a[32:35], v[80:83], v[112:115]
  v_mfma_f32_16x16x32_bf16 v[120:123], a[80:83], v[80:83], v[120:123]
  v_mfma_f32_16x16x32_bf16 v[128:131], a[128:131], v[80:83], v[128:131]
  v_mfma_f32_16x16x32_bf16 v[136:139], a[176:179], v[80:83], v[136:139]
  v_mfma_f32_16x16x32_bf16 v[144:147], a[224:227], v[80:83], v[144:147]
  s_waitcnt vmcnt(10)
  v_mfma_f32_16x16x32_bf16 v[116:119], a[32:35], v[84:87], v[116:119]
  v_mfma_f32_16x16x32_bf16 v[124:127], a[80:83], v[84:87], v[124:127]
  v_mfma_f32_16x16x32_bf16 v[132:135], a[128:131], v[84:87], v[132:135]
  v_mfma_f32_16x16x32_bf16 v[140:143], a[176:179], v[84:87], v[140:143]
  v_mfma_f32_16x16x32_bf16 v[148:151], a[224:227], v[84:87], v[148:151]
  s_waitcnt vmcnt(9)
  v_mfma_f32_16x16x32_bf16 v[112:115], a[36:39], v[88:91], v[112:115]
  v_mfma_f32_16x16x32_bf16 v[120:123], a[84:87], v[88:91], v[120:123]
  v_mfma_f32_16x16x32_bf16 v[128:131], a[132:135], v[88:91], v[128:131]
  v_mfma_f32_16x16x32_bf16 v[136:139], a[180:183], v[88:91], v[136:139]
  v_mfma_f32_16x16x32_bf16 v[144:147], a[228:231], v[88:91], v[144:147]
  s_waitcnt vmcnt(8)
  v_mfma_f32_16x16x32_bf16 v[116:119], a[36:39], v[92:95], v[116:119]
  v_mfma_f32_16x16x32_bf16 v[124:127], a[84:87], v[92:95], v[124:127]
  v_mfma_f32_16x16x32_bf16 v[132:135], a[132:135], v[92:95], v[132:135]
  v_mfma_f32_16x16x32_bf16 v[140:143], a[180:183], v[92:95], v[140:143]
  v_mfma_f32_16x16x32_bf16 v[148:151], a[228:231], v[92:95], v[148:151]
  s_waitcnt vmcnt(7)
  v_mfma_f32_16x16x32_bf16 v[112:115], a[40:43], v[96:99], v[112:115]
  v_mfma_f32_16x16x32_bf16 v[120:123], a[88:91], v[96:99], v[120:123]
  v_mfma_f32_16x16x32_bf16 v[128:131], a[136:139], v[96:99], v[128:131]
  v_mfma_f32_16x16x32_bf16 v[136:139], a[184:187], v[96:99], v[136:139]
  v_mfma_f32_16x16x32_bf16 v[144:147], a[232:235], v[96:99], v[144:147]
  s_waitcnt vmcnt(6)
  v_mfma_f32_16x16x32_bf16 v[116:119], a[40:43], v[100:103], v[116:119]
  v_mfma_f32_16x16x32_bf16 v[124:127], a[88:91], v[100:103], v[124:127]
  v_mfma_f32_16x16x32_bf16 v[132:135], a[136:139], v[100:103], v[132:135]
  v_mfma_f32_16x16x32_bf16 v[140:143], a[184:187], v[100:103], v[140:143]
  v_mfma_f32_16x16x32_bf16 v[148:151], a[232:235], v[100:103], v[148:151]
  s_waitcnt vmcnt(5)
  v_mfma_f32_16x16x32_bf16 v[112:115], a[44:47], v[104:107], v[112:115]
  v_mfma_f32_16x16x32_bf16 v[120:123], a[92:95], v[104:107], v[120:123]
  v_mfma_f32_16x16x32_bf16 v[128:131], a[140:143], v[104:107], v[128:131]
  v_mfma_f32_16x16x32_bf16 v[136:139], a[188:191], v[104:107], v[136:139]
  v_mfma_f32_16x16x32_bf16 v[144:147], a[236:239], v[104:107], v[144:147]
  s_waitcnt vmcnt(4)
  v_mfma_f32_16x16x32_bf16 v[116:119], a[44:47], v[108:111], v[116:119]
  v_mfma_f32_16x16x32_bf16 v[124:127], a[92:95], v[108:111], v[124:127]
  v_mfma_f32_16x16x32_bf16 v[132:135], a[140:143], v[108:111], v[132:135]
  v_mfma_f32_16x16x32_bf16 v[140:143], a[188:191], v[108:111], v[140:143]
  v_mfma_f32_16x16x32_bf16 v[148:151], a[236:239], v[108:111], v[148:151]
  v_mov_b32 v6, s48
  v_mov_b32 v176, s42
  s_mov_b64 exec, 1
  buffer_store_dword v176, v6, s[8:11], 0 offen offset:512
  s_mov_b64 exec, -1
  s_add_u32 s42, s42, 1
  s_mov_b32 s59, 0
  s_waitcnt vmcnt(1)
  s_cmp_eq_u32 s54, -1
  s_cbranch_scc1 XF2_ne
  v_min_u32 v228, v228, v229
  v_cmp_gt_u32 vcc, s42, v228
  s_cbranch_vccnz XF2_ne
  s_mov_b32 s59, 1
  s_add_u32 s22, s45, s44
  s_add_u32 s45, s45, 98304
  s_cmp_ge_u32 s45, 294912
  s_cselect_b32 s45, 0, s45
  s_add_u32 s23, s22, 0
  buffer_load_dwordx4 v[16:19], v5, s[8:11], s23 offen offset:0 sc1
  s_add_u32 s23, s22, 49152
  buffer_load_dwordx4 v[20:23], v5, s[8:11], s23 offen offset:0 sc1
  s_add_u32 s23, s22, 0
  buffer_load_dwordx4 v[24:27], v5, s[8:11], s23 offen offset:1024 sc1
  s_add_u32 s23, s22, 49152
  buffer_load_dwordx4 v[28:31], v5, s[8:11], s23 offen offset:1024 sc1
  s_add_u32 s23, s22, 0
  buffer_load_dwordx4 v[32:35], v5, s[8:11], s23 offen offset:2048 sc1
  s_add_u32 s23, s22, 49152
  buffer_load_dwordx4 v[36:39], v5, s[8:11], s23 offen offset:2048 sc1
  s_add_u32 s23, s22, 0
  buffer_load_dwordx4 v[40:43], v5, s[8:11], s23 offen offset:3072 sc1
  s_add_u32 s23, s22, 49152
  buffer_load_dwordx4 v[44:47], v5, s[8:11], s23 offen offset:3072 sc1
  s_add_u32 s23, s22, 4096
  buffer_load_dwordx4 v[48:51], v5, s[8:11], s23 offen offset:0 sc1
  s_add_u32 s23, s22, 53248
  buffer_load_dwordx4 v[52:55], v5, s[8:11], s23 offen offset:0 sc1
  s_add_u32 s23, s22, 4096
  buffer_load_dwordx4 v[56:59], v5, s[8:11], s23 offen offset:1024 sc1
  s_add_u32 s23, s22, 53248
  buffer_load_dwordx4 v[60:63], v5, s[8:11], s23 offen offset:1024 sc1
  s_add_u32 s23, s22, 4096
  buffer_load_dwordx4 v[64:67], v5, s[8:11], s23 offen offset:2048 sc1
  s_add_u32 s23, s22, 53248
  buffer_load_dwordx4 v[68:71], v5, s[8:11], s23 offen offset:2048 sc1
  s_add_u32 s23, s22, 4096
  buffer_load_dwordx4 v[72:75], v5, s[8:11], s23 offen offset:3072 sc1
  s_add_u32 s23, s22, 53248
  buffer_load_dwordx4 v[76:79], v5, s[8:11], s23 offen offset:3072 sc1
  s_add_u32 s23, s22, 8192
  buffer_load_dwordx4 v[80:83], v5, s[8:11], s23 offen offset:0 sc1
  s_add_u32 s23, s22, 57344
  buffer_load_dwordx4 v[84:87], v5, s[8:11], s23 offen offset:0 sc1
  s_add_u32 s23, s22, 8192
  buffer_load_dwordx4 v[88:91], v5, s[8:11], s23 offen offset:1024 sc1
  s_add_u32 s23, s22, 57344
  buffer_load_dwordx4 v[92:95], v5, s[8:11], s23 offen offset:1024 sc1
  s_add_u32 s23, s22, 8192
  buffer_load_dwordx4 v[96:99], v5, s[8:11], s23 offen offset:2048 sc1
  s_add_u32 s23, s22, 57344
  buffer_load_dwordx4 v[100:103], v5, s[8:11], s23 offen offset:2048 sc1
  s_add_u32 s23, s22, 8192
  buffer_load_dwordx4 v[104:107], v5, s[8:11], s23 offen offset:3072 sc1
  s_add_u32 s23, s22, 57344
  buffer_load_dwordx4 v[108:111], v5, s[8:11], s23 offen offset:3072 sc1
  buffer_load_dwordx2 v[230:231], v15, s[8:11], s47 offen sc1
XF2_ne:
XF2_J:
  s_barrier
  ds_write_b128 v12, v[112:115] offset:0
  ds_write_b128 v12, v[116:119] offset:1024
  ds_write_b128 v12, v[120:123] offset:2048
  ds_write_b128 v12, v[124:127] offset:3072
  ds_write_b128 v12, v[128:131] offset:4096
  ds_write_b128 v12, v[132:135] offset:5120
  ds_write_b128 v12, v[136:139] offset:6144
  ds_write_b128 v12, v[140:143] offset:7168
  ds_write_b128 v12, v[144:147] offset:8192
  ds_write_b128 v12, v[148:151] offset:9216
  s_waitcnt lgkmcnt(0)
  s_barrier
  ds_read_b128 v[180:183], v13 offset:0
  ds_read_b128 v[184:187], v13 offset:10240
  ds_read_b128 v[188:191], v13 offset:20480
  ds_read_b128 v[192:195], v13 offset:30720
  ds_read_b128 v[196:199], v13 offset:4096
  ds_read_b128 v[200:203], v13 offset:14336
  ds_read_b128 v[204:207], v13 offset:24576
  ds_read_b128 v[208:211], v13 offset:34816
  ds_read_b128 v[212:215], v13 offset:8192
  ds_read_b128 v[216:219], v13 offset:18432
  ds_read_b128 v[220:223], v13 offset:28672
  ds_read_b128 v[224:227], v13 offset:38912
XF2_x:
  v_max3_u32 v176, v152, v153, v154
  v_max_u32 v176, v176, v155
  s_cmp_ge_u32 s91, 2
  s_cbranch_scc1 XF2_x2
  v_max3_u32 v176, v176, v156, v157
XF2_x2:
  v_cmp_eq_u32 vcc, -1, v176
  s_cbranch_vccz XF2_xok
  buffer_load_dwordx2 v[152:153], v9, s[8:11], s58 offen offset:0 sc1
  buffer_load_dwordx2 v[154:155], v9, s[8:11], s58 offen offset:64 sc1
  buffer_load_dwordx2 v[156:157], v9, s[8:11], s58 offen offset:128 sc1
  s_waitcnt vmcnt(0)
  s_add_u32 s41, s41, 1
  s_cmp_lt_u32 s41, 3000000
  s_cbranch_scc1 XF2_x
  s_branch K3_end
XF2_xok:
  s_waitcnt lgkmcnt(0)
  v_pk_add_f32 v[180:181], v[180:181], v[184:185]
  v_pk_add_f32 v[182:183], v[182:183], v[186:187]
  v_pk_add_f32 v[188:189], v[188:189], v[192:193]
  v_pk_add_f32 v[190:191], v[190:191], v[194:195]
  v_pk_add_f32 v[180:181], v[180:181], v[188:189]
  v_pk_add_f32 v[182:183], v[182:183], v[190:191]
  v_cvt_pk_bf16_f32 v176, v180, v181
  v_lshlrev_b32 v180, 16, v176
  v_and_b32 v181, 0xffff0000, v176
  v_mul_f32 v180, v180, v160
  v_mul_f32 v181, v181, v161
  v_cvt_pk_bf16_f32 v176, v180, v181
  v_lshlrev_b32 v180, 16, v176
  v_and_b32 v181, 0xffff0000, v176
  v_lshlrev_b32 v177, 16, v152
  v_and_b32 v178, 0xffff0000, v152
  v_add_f32 v180, v180, v177
  v_add_f32 v181, v181, v178
  v_cvt_pk_bf16_f32 v152, v180, v181
  v_cvt_pk_bf16_f32 v176, v182, v183
  v_lshlrev_b32 v182, 16, v176
  v_and_b32 v183, 0xffff0000, v176
  v_mul_f32 v182, v182, v162
  v_mul_f32 v183, v183, v163
  v_cvt_pk_bf16_f32 v176, v182, v183
  v_lshlrev_b32 v182, 16, v176
  v_and_b32 v183, 0xffff0000, v176
  v_lshlrev_b32 v177, 16, v153
  v_and_b32 v178, 0xffff0000, v153
  v_add_f32 v182, v182, v177
  v_add_f32 v183, v183, v178
  v_cvt_pk_bf16_f32 v153, v182, v183
  buffer_store_dwordx2 v[152:153], v9, s[12:15], s57 offen offset:0
  v_pk_add_f32 v[196:197], v[196:197], v[200:201]
  v_pk_add_f32 v[198:199], v[198:199], v[202:203]
  v_pk_add_f32 v[204:205], v[204:205], v[208:209]
  v_pk_add_f32 v[206:207], v[206:207], v[210:211]
  v_pk_add_f32 v[196:197], v[196:197], v[204:205]
  v_pk_add_f32 v[198:199], v[198:199], v[206:207]
  v_cvt_pk_bf16_f32 v176, v196, v197
  v_lshlrev_b32 v196, 16, v176
  v_and_b32 v197, 0xffff0000, v176
  v_mul_f32 v196, v196, v164
  v_mul_f32 v197, v197, v165
  v_cvt_pk_bf16_f32 v176, v196, v197
  v_lshlrev_b32 v196, 16, v176
  v_and_b32 v197, 0xffff0000, v176
  v_lshlrev_b32 v177, 16, v154
  v_and_b32 v178, 0xffff0000, v154
  v_add_f32 v196, v196, v177
  v_add_f32 v197, v197, v178
  v_cvt_pk_bf16_f32 v154, v196, v197
  v_cvt_pk_bf16_f32 v176, v198, v199
  v_lshlrev_b32 v198, 16, v176
  v_and_b32 v199, 0xffff0000, v176
  v_mul_f32 v198, v198, v166
  v_mul_f32 v199, v199, v167
  v_cvt_pk_bf16_f32 v176, v198, v199
  v_lshlrev_b32 v198, 16, v176
  v_and_b32 v199, 0xffff0000, v176
  v_lshlrev_b32 v177, 16, v155
  v_and_b32 v178, 0xffff0000, v155
  v_add_f32 v198, v198, v177
  v_add_f32 v199, v199, v178
  v_cvt_pk_bf16_f32 v155, v198, v199
  buffer_store_dwordx2 v[154:155], v9, s[12:15], s57 offen offset:64
  s_cmp_ge_u32 s91, 2
  s_cbranch_scc1 XF2_d
  v_pk_add_f32 v[212:213], v[212:213], v[216:217]
  v_pk_add_f32 v[214:215], v[214:215], v[218:219]
  v_pk_add_f32 v[220:221], v[220:221], v[224:225]
  v_pk_add_f32 v[222:223], v[222:223], v[226:227]
  v_pk_add_f32 v[212:213], v[212:213], v[220:221]
  v_pk_add_f32 v[214:215], v[214:215], v[222:223]
  v_cvt_pk_bf16_f32 v176, v212, v213
  v_lshlrev_b32 v212, 16, v176
  v_and_b32 v213, 0xffff0000, v176
  v_mul_f32 v212, v212, v168
  v_mul_f32 v213, v213, v169
  v_cvt_pk_bf16_f32 v176, v212, v213
  v_lshlrev_b32 v212, 16, v176
  v_and_b32 v213, 0xffff0000, v176
  v_lshlrev_b32 v177, 16, v156
  v_and_b32 v178, 0xffff0000, v156
  v_add_f32 v212, v212, v177
  v_add_f32 v213, v213, v178
  v_cvt_pk_bf16_f32 v156, v212, v213
  v_cvt_pk_bf16_f32 v176, v214, v215
  v_lshlrev_b32 v214, 16, v176
  v_and_b32 v215, 0xffff0000, v176
  v_mul_f32 v214, v214, v170
  v_mul_f32 v215, v215, v171
  v_cvt_pk_bf16_f32 v176, v214, v215
  v_lshlrev_b32 v214, 16, v176
  v_and_b32 v215, 0xffff0000, v176
  v_lshlrev_b32 v177, 16, v157
  v_and_b32 v178, 0xffff0000, v157
  v_add_f32 v214, v214, v177
  v_add_f32 v215, v215, v178
  v_cvt_pk_bf16_f32 v157, v214, v215
  buffer_store_dwordx2 v[156:157], v9, s[12:15], s57 offen offset:128
XF2_d:
  s_cmp_eq_u32 s54, -1
  s_cbranch_scc1 K3_end
  s_mov_b32 s40, s54
  s_bitset0_b64 s[36:37], s54
  s_cmp_eq_u32 s59, 1
  s_cbranch_scc1 XF2_loop
  s_branch XF2_late
K3_end:
  s_endpgm

.section .rodata,"a"
.p2align 6
.amdhsa_kernel kf_kernel
  .amdhsa_next_free_vgpr 512
  .amdhsa_next_free_sgpr 102
  .amdhsa_accum_offset 256
  .amdhsa_group_segment_fixed_size 0
  .amdhsa_kernarg_size 128
  .amdhsa_user_sgpr_count 2
  .amdhsa_user_sgpr_kernarg_segment_ptr 1
  .amdhsa_system_sgpr_workgroup_id_x 1
  .amdhsa_float_denorm_mode_32 3
.end_amdhsa_kernel
```
